```python
import torch

def _softmax(x, axis=-1):
    return torch.softmax(x, dim=axis)
def _gelu(x):
    return torch.nn.functional.gelu(x, approximate="tanh")
def _silu(x):
    return torch.nn.functional.silu(x)
def _sigmoid(x):
    return torch.sigmoid(x)
def _layernorm(x, axis=-1, eps=1e-5):
    m = x.mean(dim=axis, keepdim=True)
    v = x.var(dim=axis, keepdim=True, unbiased=False)
    return (x - m) / torch.sqrt(v + eps)
def _scatter_add(tgt, idx, src, axis=0):
    return tgt.clone().index_add_(axis, idx, src)
def _segment_sum(src, seg, n):
    out = torch.zeros((n,) + src.shape[1:], dtype=src.dtype)
    return out.index_add_(0, seg, src)
def _pad(x, pw):
    flat = tuple(v for pair in reversed(pw) for v in pair)
    return torch.nn.functional.pad(x, flat)

kernel_name = 'gated_mix__grouped_kv_mqa__glu_gated_glu__prompt'

def setup_inputs():

    _w = (lambda a: (lambda t: t.to(torch.bfloat16) if t.is_floating_point() else t)(torch.as_tensor(a)))
    def _A_setup():
        B, S, D, H = 1, 2048, 1024, 32
        Dh = D // H
        return {
            "x": _w((lambda *s: torch.randn(*s, dtype=torch.bfloat16) * 0.05)(B, S, D)),
            "wq": _w((lambda *s: torch.randn(*s, dtype=torch.bfloat16) * 0.8)(D, H * Dh)),
            "wk": _w((lambda *s: torch.randn(*s, dtype=torch.bfloat16) * 0.8)(D, Dh)),
            "wv": _w((lambda *s: torch.randn(*s, dtype=torch.bfloat16) * 0.2)(D, Dh)),
            "wo": _w((lambda *s: torch.randn(*s, dtype=torch.bfloat16) * 0.2)(H * Dh, D)),
        }
    _A_in = _A_setup()

    def _B_setup():
        B, S, D, F = 1, 2048, 1024, 3584
        return {
            "x": _w((lambda *s: torch.randn(*s, dtype=torch.bfloat16) * 0.05)(B, S, D)),
            "w_gate": _w((lambda *s: torch.randn(*s, dtype=torch.bfloat16) * 1.6)(D, F)),
            "w_up": _w((lambda *s: torch.randn(*s, dtype=torch.bfloat16) * 0.05)(D, F)),
            "w_down": _w((lambda *s: torch.randn(*s, dtype=torch.bfloat16) * 0.05)(F, D)),
        }
    _B_in = _B_setup()

    return {
        "A_x": _A_in["x"],
        "A_wq": _A_in["wq"],
        "A_wk": _A_in["wk"],
        "A_wv": _A_in["wv"],
        "A_wo": _A_in["wo"],
        "B_x": _B_in["x"],
        "B_w_gate": _B_in["w_gate"],
        "B_w_up": _B_in["w_up"],
        "B_w_down": _B_in["w_down"],
        "gate_w": _w((lambda *s: torch.randn(*s, dtype=torch.bfloat16) * 0.05)(1024) * 16.0),
    }

def reference(A_x, A_wq, A_wk, A_wv, A_wo, B_x, B_w_gate, B_w_up, B_w_down, gate_w):
    def _A_ref(x, wq, wk, wv, wo):
        B, S, D = x.shape
        H = 32
        Dh = D // H
        q = (lambda x, *d: x.permute(*d))((x @ wq).reshape(B, S, H, Dh), 0, 2, 1, 3)
        k = x @ wk
        v = x @ wv
        scores = torch.einsum("bhqd,bkd->bhqk", q, k) * (Dh ** -0.5)
        p = _softmax(scores, axis=-1)
        o = torch.einsum("bhqk,bkd->bhqd", p, v)
        return (lambda x, *d: x.permute(*d))(o, 0, 2, 1, 3).reshape(B, S, H * Dh) @ wo

    def _B_ref(x, w_gate, w_up, w_down):
        g = torch.einsum("bsd,df->bsf", x, w_gate)
        u = torch.einsum("bsd,df->bsf", x, w_up)
        h = _sigmoid(g) * u
        return torch.einsum("bsf,fd->bsd", h, w_down)

    x = A_x
    g = _sigmoid((x * gate_w).sum(-1, keepdims=True))
    a = _A_ref(x, A_wq, A_wk, A_wv, A_wo)
    b = _B_ref(x, B_w_gate, B_w_up, B_w_down)
    return g * a + (1 - g) * b
```

```asm
; @launch grid=(256,1,1) block=(256,1,1) lds=163840
.amdgcn_target "amdgcn-amd-amdhsa--gfx950"
.text
.globl gated_mix__grouped_kv_mqa__glu_gated_glu__prompt_kernel
.p2align 8
.type gated_mix__grouped_kv_mqa__glu_gated_glu__prompt_kernel,@function
gated_mix__grouped_kv_mqa__glu_gated_glu__prompt_kernel:
    s_cmp_ge_u32 s2, 256
    s_cbranch_scc1 K_END
    s_load_dwordx8 s[48:55], s[0:1], 0
    s_load_dwordx4 s[56:59], s[0:1], 48
    s_getpc_b64 s[4:5]
K_PC:
    s_lshr_b32 s3, s2, 3
    s_lshl_b32 s3, s3, 12
    v_lshl_add_u32 v122, v0, 4, s3
    v_min_u32 v122, K_CODE_END-K_PC-4, v122
    v_mov_b32 v123, s5
    v_add_co_u32 v122, vcc, s4, v122
    s_nop 1
    v_addc_co_u32 v123, vcc, 0, v123, vcc
    global_load_dword v127, v[122:123], off
    s_load_dwordx2 s[60:61], s[0:1], 72
    s_load_dwordx2 s[62:63], s[0:1], 96
    s_load_dwordx2 s[90:91], s[0:1], 32
    s_load_dwordx2 s[92:93], s[0:1], 64
    s_load_dwordx2 s[94:95], s[0:1], 80
    s_load_dwordx2 s[68:69], s[0:1], 88
    s_memrealtime s[46:47]
    v_lshrrev_b32 v2, 6, v0
    v_and_b32 v1, 63, v0
    v_readfirstlane_b32 s28, v2
    s_bfe_u32 s29, s2, 0x30003
    s_bfe_u32 s30, s2, 0x20001
    s_and_b32 s3, s2, 1
    s_lshl_b32 s3, s3, 2
    s_add_u32 s30, s30, s3
    s_lshl_b32 s30, s30, 2
    s_lshr_b32 s3, s2, 6
    s_add_u32 s30, s30, s3
    s_bfe_u32 s31, s30, 0x30001
    s_and_b32 s6, s28, 1
    s_mul_i32 s84, s30, 224
    s_lshl_b32 s85, s30, 6
    s_movk_i32 s7, 7168
    v_lshrrev_b32 v2, 3, v1
    v_lshrrev_b32 v3, 4, v1
    v_and_b32 v4, 7, v1
    v_xor_b32 v5, v4, v3
    v_xor_b32 v6, 4, v5
    v_lshlrev_b32 v2, 11, v2
    v_lshl_add_u32 v5, v5, 4, v2
    v_lshl_add_u32 v6, v6, 4, v2
    v_add_u32 v6, 15360, v6
    s_lshl_b32 s4, s29, 4
    s_lshl_b32 s5, s28, 2
    s_add_u32 s4, s4, s5
    s_xor_b32 s4, s4, s31
    s_lshl_b32 s4, s4, 15
    s_xor_b32 s3, s4, 0
    v_add_u32 v8, s3, v5
    v_add_u32 v9, s3, v6
    s_xor_b32 s3, s4, 32768
    v_add_u32 v10, s3, v5
    v_add_u32 v11, s3, v6
    s_xor_b32 s3, s4, 65536
    v_add_u32 v12, s3, v5
    v_add_u32 v13, s3, v6
    s_xor_b32 s3, s4, 98304
    v_add_u32 v14, s3, v5
    v_add_u32 v15, s3, v6
    s_lshl_b32 s36, s28, 13
    s_add_u32 s37, s36, 4096
    s_mov_b32 s24, 0
    s_mov_b32 s10, 4194304
    s_mov_b32 s11, 0x20000
    s_waitcnt lgkmcnt(0)
    s_mov_b32 s8, s48
    s_mov_b32 s9, s49
    s_mov_b32 m0, s36
    s_nop 0
    buffer_load_dwordx4 v8, s[8:11], s24 offen offset:0 lds
    buffer_load_dwordx4 v9, s[8:11], s24 offen offset:1024 lds
    s_add_u32 m0, s36, 2048
    s_nop 0
    buffer_load_dwordx4 v10, s[8:11], s24 offen offset:0 lds
    buffer_load_dwordx4 v11, s[8:11], s24 offen offset:1024 lds
    s_mov_b32 m0, s37
    s_nop 0
    buffer_load_dwordx4 v12, s[8:11], s24 offen offset:0 lds
    buffer_load_dwordx4 v13, s[8:11], s24 offen offset:1024 lds
    s_add_u32 m0, s37, 2048
    s_nop 0
    buffer_load_dwordx4 v14, s[8:11], s24 offen offset:0 lds
    buffer_load_dwordx4 v15, s[8:11], s24 offen offset:1024 lds
    s_lshl_b32 s4, s28, 10
    s_add_u32 s38, s36, 32768
    s_add_u32 s39, s36, 36864
    s_add_u32 s40, s4, 65536
    s_add_u32 s41, s36, 69632
    s_add_u32 s42, s36, 73728
    s_add_u32 s43, s36, 102400
    s_add_u32 s44, s36, 106496
    s_add_u32 s45, s4, 135168
    s_cmp_ge_u32 s28, 2
    s_cselect_b32 s12, s58, s56
    s_cselect_b32 s13, s59, s57
    s_cselect_b32 s64, s54, s52
    s_cselect_b32 s65, s55, s53
    s_mov_b32 s14, 7340032
    s_mov_b32 s15, 0x20000
    s_mov_b32 s66, 65536
    s_mov_b32 s67, 0x20000
    s_cmp_eq_u32 s6, 1
    s_cselect_b32 s16, s50, s12
    s_cselect_b32 s17, s51, s13
    s_cselect_b32 s18, 2097152, s14
    s_mov_b32 s19, 0x20000
    s_mov_b32 s27, 458752
    s_cselect_b32 s27, 131072, s27
    s_mov_b32 s25, 0
    s_mov_b32 s26, 0
    s_mov_b32 s33, 0
    s_lshl_b32 s3, s6, 9
    s_movk_i32 s5, 4682
    v_add_u32 v7, s3, v1
    v_mov_b32 v6, s84
    v_mul_u32_u24 v3, s5, v7
    v_lshrrev_b32 v3, 16, v3
    v_mad_i32_i24 v2, v3, -14, v7
    v_lshrrev_b32 v4, 1, v3
    v_xor_b32 v4, v4, v3
    v_and_b32 v4, 4, v4
    v_mul_u32_u24 v4, 3, v4
    v_xor_b32 v3, v3, v4
    v_mad_u32_u24 v3, v3, s7, v6
    v_lshl_add_u32 v16, v2, 4, v3
    s_mov_b32 m0, s38
    s_nop 0
    buffer_load_dwordx4 v16, s[12:15], s25 offen offset:0 lds
    v_add_u32 v7, 64, v7
    v_mul_u32_u24 v3, s5, v7
    v_lshrrev_b32 v3, 16, v3
    v_mad_i32_i24 v2, v3, -14, v7
    v_lshrrev_b32 v4, 1, v3
    v_xor_b32 v4, v4, v3
    v_and_b32 v4, 4, v4
    v_mul_u32_u24 v4, 3, v4
    v_xor_b32 v3, v3, v4
    v_mad_u32_u24 v3, v3, s7, v6
    v_lshl_add_u32 v17, v2, 4, v3
    v_subrev_u32 v17, 1024, v17
    buffer_load_dwordx4 v17, s[12:15], s25 offen offset:1024 lds
    v_add_u32 v7, 64, v7
    v_mul_u32_u24 v3, s5, v7
    v_lshrrev_b32 v3, 16, v3
    v_mad_i32_i24 v2, v3, -14, v7
    v_lshrrev_b32 v4, 1, v3
    v_xor_b32 v4, v4, v3
    v_and_b32 v4, 4, v4
    v_mul_u32_u24 v4, 3, v4
    v_xor_b32 v3, v3, v4
    v_mad_u32_u24 v3, v3, s7, v6
    v_lshl_add_u32 v18, v2, 4, v3
    v_subrev_u32 v18, 2048, v18
    buffer_load_dwordx4 v18, s[12:15], s25 offen offset:2048 lds
    v_add_u32 v7, 64, v7
    v_mul_u32_u24 v3, s5, v7
    v_lshrrev_b32 v3, 16, v3
    v_mad_i32_i24 v2, v3, -14, v7
    v_lshrrev_b32 v4, 1, v3
    v_xor_b32 v4, v4, v3
    v_and_b32 v4, 4, v4
    v_mul_u32_u24 v4, 3, v4
    v_xor_b32 v3, v3, v4
    v_mad_u32_u24 v3, v3, s7, v6
    v_lshl_add_u32 v19, v2, 4, v3
    v_subrev_u32 v19, 3072, v19
    buffer_load_dwordx4 v19, s[12:15], s25 offen offset:3072 lds
    v_add_u32 v7, 64, v7
    v_mul_u32_u24 v3, s5, v7
    v_lshrrev_b32 v3, 16, v3
    v_mad_i32_i24 v2, v3, -14, v7
    v_lshrrev_b32 v4, 1, v3
    v_xor_b32 v4, v4, v3
    v_and_b32 v4, 4, v4
    v_mul_u32_u24 v4, 3, v4
    v_xor_b32 v3, v3, v4
    v_mad_u32_u24 v3, v3, s7, v6
    v_lshl_add_u32 v20, v2, 4, v3
    s_mov_b32 m0, s39
    s_nop 0
    buffer_load_dwordx4 v20, s[12:15], s25 offen offset:0 lds
    v_add_u32 v7, 64, v7
    v_mul_u32_u24 v3, s5, v7
    v_lshrrev_b32 v3, 16, v3
    v_mad_i32_i24 v2, v3, -14, v7
    v_lshrrev_b32 v4, 1, v3
    v_xor_b32 v4, v4, v3
    v_and_b32 v4, 4, v4
    v_mul_u32_u24 v4, 3, v4
    v_xor_b32 v3, v3, v4
    v_mad_u32_u24 v3, v3, s7, v6
    v_lshl_add_u32 v21, v2, 4, v3
    v_subrev_u32 v21, 1024, v21
    buffer_load_dwordx4 v21, s[12:15], s25 offen offset:1024 lds
    v_add_u32 v7, 64, v7
    v_mul_u32_u24 v3, s5, v7
    v_lshrrev_b32 v3, 16, v3
    v_mad_i32_i24 v2, v3, -14, v7
    v_lshrrev_b32 v4, 1, v3
    v_xor_b32 v4, v4, v3
    v_and_b32 v4, 4, v4
    v_mul_u32_u24 v4, 3, v4
    v_xor_b32 v3, v3, v4
    v_mad_u32_u24 v3, v3, s7, v6
    v_lshl_add_u32 v22, v2, 4, v3
    v_add_u32 v7, 64, v7
    v_mul_u32_u24 v3, s5, v7
    v_lshrrev_b32 v3, 16, v3
    v_mad_i32_i24 v2, v3, -14, v7
    v_lshrrev_b32 v4, 1, v3
    v_xor_b32 v4, v4, v3
    v_and_b32 v4, 4, v4
    v_mul_u32_u24 v4, 3, v4
    v_xor_b32 v3, v3, v4
    v_mad_u32_u24 v3, v3, s7, v6
    v_lshl_add_u32 v23, v2, 4, v3
    v_subrev_u32 v23, 1024, v23
    s_lshr_b32 s3, s28, 1
    s_lshl_b32 s3, s3, 16
    s_add_u32 s3, s3, s85
    s_cmp_eq_u32 s6, 0
    s_cbranch_scc1 K_EVENW
    v_lshrrev_b32 v2, 2, v1
    v_lshlrev_b32 v2, 11, v2
    v_lshrrev_b32 v3, 5, v1
    v_lshlrev_b32 v3, 1, v3
    v_xor_b32 v3, v3, v1
    v_and_b32 v3, 3, v3
    v_lshl_add_u32 v2, v3, 4, v2
    v_add_u32 v22, s3, v2
    s_add_u32 s4, s3, 31744
    v_add_u32 v23, s4, v2
K_EVENW:
    s_add_u32 m0, s39, 2048
    s_nop 0
    buffer_load_dwordx4 v22, s[16:19], s26 offen offset:0 lds
    buffer_load_dwordx4 v23, s[16:19], s26 offen offset:1024 lds
    v_lshrrev_b32 v3, 1, v1
    v_lshrrev_b32 v4, 1, v3
    v_xor_b32 v4, v4, v3
    v_and_b32 v4, 4, v4
    v_mul_u32_u24 v4, 3, v4
    v_xor_b32 v3, v3, v4
    v_lshlrev_b32 v3, 6, v3
    v_and_b32 v4, 1, v1
    v_lshl_add_u32 v3, v4, 4, v3
    s_lshl_b32 s3, s6, 11
    s_and_b32 s4, s30, 1
    s_lshl_b32 s4, s4, 5
    s_add_u32 s3, s3, s4
    v_add_u32 v24, s3, v3
    s_mov_b32 m0, s40
    s_nop 0
    buffer_load_dwordx4 v24, s[64:67], s33 offen lds
    s_add_u32 s24, s24, 128
    s_add_u32 s25, s25, 458752
    s_add_u32 s26, s26, s27
    s_add_u32 s33, s33, 4096
    s_mov_b32 s20, s62
    s_mov_b32 s21, s63
    s_mov_b32 s22, 0x10000000
    s_mov_b32 s23, 0x20000
    s_mov_b32 s80, s92
    s_mov_b32 s81, s93
    s_mov_b32 s82, 0x700000
    s_mov_b32 s83, 0x20000
    s_lshr_b32 s3, s2, 6
    s_lshl_b32 s3, s3, 2
    s_add_u32 s3, s3, s28
    s_lshl_b32 s4, s29, 4
    s_add_u32 s3, s3, s4
    s_lshl_b32 s3, s3, 15
    v_lshrrev_b32 v7, 2, v1
    v_lshlrev_b32 v2, 11, v7
    v_bfe_u32 v3, v1, 1, 1
    v_lshl_add_u32 v2, v3, 7, v2
    v_add_u32 v40, s3, v2
    s_lshl_b32 s3, s29, 1
    s_add_u32 s3, s3, s6
    s_lshl_b32 s3, s3, 3
    s_add_u32 s3, s3, 128
    v_lshrrev_b32 v5, 3, v1
    v_add_u32 v2, s3, v5
    v_mul_u32_u24 v2, s7, v2
    v_bfe_u32 v3, v1, 1, 2
    v_lshlrev_b32 v3, 7, v3
    v_min_u32 v3, 208, v3
    v_add3_u32 v41, v2, v3, s84
    s_lshl_b32 s3, s29, 1
    s_lshr_b32 s4, s28, 1
    s_add_u32 s3, s3, s4
    s_add_u32 s3, s3, 16
    s_lshl_b32 s3, s3, 14
    s_add_u32 s3, s3, s85
    s_cmp_eq_u32 s6, 1
    s_cselect_b32 s3, s3, 2147418112
    v_lshl_add_u32 v42, v5, 11, s3
    v_lshlrev_b32 v43, 7, v5
    s_lshr_b32 s3, s2, 3
    s_lshl_b32 s34, s3, 1
    s_add_u32 s34, s34, s6
    s_lshl_b32 s34, s34, 10
    s_lshl_b32 s35, s3, 2
    s_add_u32 s35, s35, s28
    s_lshl_b32 s35, s35, 10
    s_lshl_b32 s3, s29, 5
    s_add_u32 s3, s3, s30
    s_lshl_b32 s3, s3, 2
    s_add_u32 s3, s3, s28
    s_lshl_b32 s3, s3, 12
    v_lshrrev_b32 v2, 5, v1
    v_lshlrev_b32 v2, 11, v2
    v_add_u32_e64 v2, s3, v2
    v_bfe_u32 v3, v1, 3, 2
    v_lshl_add_u32 v25, v3, 7, v2
    v_bfe_u32 v3, v1, 4, 1
    v_lshl_add_u32 v40, v3, 7, v2
    v_and_b32 v6, 15, v1
    v_lshrrev_b32 v3, 4, v1
    v_bfe_u32 v4, v1, 1, 3
    v_xor_b32 v4, v4, v3
    v_lshlrev_b32 v2, 7, v6
    s_lshr_b32 s3, s28, 1
    s_lshl_b32 s3, s3, 14
    v_add_u32 v2, s3, v2
    v_xor_b32 v5, 0, v4
    v_lshl_add_u32 v26, v5, 4, v2
    v_add_u32 v28, 69632, v26
    v_xor_b32_e64 v5, 4, v4
    v_lshl_add_u32 v27, v5, 4, v2
    v_add_u32 v29, 69632, v27
    v_bfe_u32 v2, v1, 2, 3
    v_lshrrev_b32 v4, 5, v1
    v_lshl_add_u32 v2, v4, 4, v2
    v_and_b32 v5, 3, v1
    v_lshlrev_b32 v5, 3, v5
    v_mul_u32_u24 v4, 224, v2
    v_add_u32 v4, v4, v5
    s_and_b32 s7, s30, 1
    s_lshl_b32 s3, s6, 2
    s_add_u32 s3, s3, s7
    s_lshl_b32 s3, s3, 5
    s_add_u32 s3, s3, 0x8000
    v_add_u32 v30, s3, v4
    v_add_u32 v31, 69632, v30
    s_cmp_eq_u32 s7, 0
    s_cselect_b32 s3, 192, 0
    s_add_u32 s3, s3, 0x8000
    v_add_u32 v32, s3, v4
    v_add_u32 v33, 69632, v32
    v_lshl_add_u32 v4, v2, 5, v5
    s_lshl_b32 s3, s6, 11
    s_add_u32 s3, s3, 0x10000
    v_add_u32_e64 v38, s3, v4
    v_add_u32 v39, 69632, v38
    v_bfe_u32 v2, v1, 2, 2
    v_lshl_add_u32 v2, v3, 3, v2
    v_lshl_add_u32 v4, v2, 6, v5
    v_bfe_u32 v2, v1, 4, 1
    v_lshl_add_u32 v4, v2, 5, v4
    v_add_u32 v34, 47104, v4
    v_add_u32 v35, 69632, v34
    v_xor_b32 v36, 32, v34
    v_xor_b32 v37, 32, v35
    s_lshr_b32 s0, s2, 3
    s_and_b32 s53, s2, 1
    s_and_b32 s54, s0, 7
    s_bfe_u32 s1, s2, 0x10001
    s_lshl_b32 s1, s1, 3
    s_add_u32 s54, s54, s1
    s_lshr_b32 s55, s0, 3
    s_bfe_u32 s1, s2, 0x10002
    s_lshl_b32 s1, s1, 2
    s_add_u32 s55, s55, s1
    s_lshl_b32 s56, s54, 2
    s_add_u32 s56, s56, s28
    v_lshlrev_b32 v92, 4, v1
    s_lshl_b32 s3, s28, 12
    v_add_u32 v93, s3, v92
    v_add_u32 v94, 32768, v92
    v_mov_b32 v95, v94
    v_xor_b32 v4, v3, v7
    v_and_b32 v4, 1, v4
    v_cmp_eq_u32 vcc, 0, v4
    v_mov_b32 v2, 0x3f803f80
    s_nop 0
    v_cndmask_b32 v96, 0, v2, vcc
    v_cndmask_b32 v97, 0, v2, vcc
    v_cndmask_b32 v98, 0, v2, vcc
    v_cndmask_b32 v99, 0, v2, vcc
    v_and_b32 v4, 1, v3
    v_mul_u32_u24 v4, 147456, v4
    v_lshrrev_b32 v2, 5, v1
    v_lshl_add_u32 v4, v2, 8, v4
    v_lshl_add_u32 v100, v6, 4, v4
    s_mul_i32 s3, s56, 294912
    v_add_u32 v101, s3, v92
    v_add_u32 v102, 147456, v101
    v_and_b32 v2, 31, v1
    v_lshlrev_b32 v103, 3, v2
    v_lshlrev_b32 v105, 2, v2
    v_lshlrev_b32 v106, 2, v6
    v_mov_b32 v2, 23330816
    v_mov_b32 v4, 2147418112
    v_cmp_eq_u32 vcc, 63, v1
    v_lshlrev_b32 v108, 11, v7
    s_nop 0
    v_cndmask_b32 v107, v4, v2, vcc
    v_bfe_u32 v2, v1, 1, 1
    v_lshl_add_u32 v108, v2, 7, v108
    v_lshlrev_b32 v2, 9, v3
    v_lshl_add_u32 v119, v6, 4, v2
    v_and_b32_e64 v4, 7, v1
    v_lshl_add_u32 v2, v4, 4, v2
    v_bfe_u32 v4, v1, 3, 1
    v_lshl_add_u32 v120, v4, 8, v2
    s_lshl_b32 s3, s54, 3
    s_add_u32 s3, s3, s55
    s_lshl_b32 s3, s3, 2
    s_add_u32 s3, s3, s28
    s_lshl_b32 s3, s3, 1
    s_add_u32 s3, s3, s53
    s_lshl_b32 s3, s3, 13
    s_add_u32 s3, s3, 25165824
    v_add_u32 v118, s3, v92
    s_lshl_b32 s3, s29, 8
    s_lshr_b32 s4, s54, 1
    s_lshl_b32 s4, s4, 8
    v_mov_b32 v2, s3
    v_mov_b32 v4, s4
    v_cmp_gt_u32 vcc, 32, v1
    s_nop 1
    v_cndmask_b32 v2, v4, v2, vcc
    v_add_u32 v2, 24121344, v2
    v_add_u32 v104, v2, v103
    v_lshlrev_b32 v2, 1, v3
    v_xor_b32 v2, v2, v6
    v_lshlrev_b32 v2, 4, v2
    v_lshl_add_u32 v2, v3, 11, v2
    v_xor_b32 v4, 128, v2
    s_lshl_b32 s3, s28, 16
    s_lshl_b32 s4, s55, 8
    s_add_u32 s3, s3, s4
    v_add_u32 v110, s3, v2
    s_add_u32 s3, s3, 7168
    v_add_u32 v111, s3, v4
    s_add_u32 s3, s3, 7168
    v_add_u32 v112, s3, v2
    s_add_u32 s3, s3, 7168
    v_add_u32 v113, s3, v4
    s_add_u32 s3, s3, 11264
    v_add_u32 v114, s3, v2
    s_add_u32 s3, s3, 7168
    v_add_u32 v115, s3, v4
    s_add_u32 s3, s3, 7168
    v_add_u32 v116, s3, v2
    s_add_u32 s3, s3, 7168
    v_add_u32 v117, s3, v4
    v_and_b32 v2, 7, v7
    v_lshl_add_u32 v2, v2, 5, v5
    v_lshl_add_u32 v109, v7, 8, v2
    s_lshl_b32 s3, s53, 7
    v_xor_b32 v109, s3, v109
    v_accvgpr_write_b32 a0, 0
    v_accvgpr_write_b32 a1, 0
    v_accvgpr_write_b32 a2, 0
    v_accvgpr_write_b32 a3, 0
    v_accvgpr_write_b32 a4, 0
    v_accvgpr_write_b32 a5, 0
    v_accvgpr_write_b32 a6, 0
    v_accvgpr_write_b32 a7, 0
    v_accvgpr_write_b32 a8, 0
    v_accvgpr_write_b32 a9, 0
    v_accvgpr_write_b32 a10, 0
    v_accvgpr_write_b32 a11, 0
    v_accvgpr_write_b32 a12, 0
    v_accvgpr_write_b32 a13, 0
    v_accvgpr_write_b32 a14, 0
    v_accvgpr_write_b32 a15, 0
    v_accvgpr_write_b32 a16, 0
    v_accvgpr_write_b32 a17, 0
    v_accvgpr_write_b32 a18, 0
    v_accvgpr_write_b32 a19, 0
    v_accvgpr_write_b32 a20, 0
    v_accvgpr_write_b32 a21, 0
    v_accvgpr_write_b32 a22, 0
    v_accvgpr_write_b32 a23, 0
    v_accvgpr_write_b32 a24, 0
    v_accvgpr_write_b32 a25, 0
    v_accvgpr_write_b32 a26, 0
    v_accvgpr_write_b32 a27, 0
    v_accvgpr_write_b32 a28, 0
    v_accvgpr_write_b32 a29, 0
    v_accvgpr_write_b32 a30, 0
    v_accvgpr_write_b32 a31, 0
    v_accvgpr_write_b32 a32, 0
    v_accvgpr_write_b32 a33, 0
    v_accvgpr_write_b32 a34, 0
    v_accvgpr_write_b32 a35, 0
    v_accvgpr_write_b32 a36, 0
    v_accvgpr_write_b32 a37, 0
    v_accvgpr_write_b32 a38, 0
    v_accvgpr_write_b32 a39, 0
    v_accvgpr_write_b32 a40, 0
    v_accvgpr_write_b32 a41, 0
    v_accvgpr_write_b32 a42, 0
    v_accvgpr_write_b32 a43, 0
    v_accvgpr_write_b32 a44, 0
    v_accvgpr_write_b32 a45, 0
    v_accvgpr_write_b32 a46, 0
    v_accvgpr_write_b32 a47, 0
    v_accvgpr_write_b32 a48, 0
    v_accvgpr_write_b32 a49, 0
    v_accvgpr_write_b32 a50, 0
    v_accvgpr_write_b32 a51, 0
    v_accvgpr_write_b32 a52, 0
    v_accvgpr_write_b32 a53, 0
    v_accvgpr_write_b32 a54, 0
    v_accvgpr_write_b32 a55, 0
    v_accvgpr_write_b32 a56, 0
    v_accvgpr_write_b32 a57, 0
    v_accvgpr_write_b32 a58, 0
    v_accvgpr_write_b32 a59, 0
    v_accvgpr_write_b32 a60, 0
    v_accvgpr_write_b32 a61, 0
    v_accvgpr_write_b32 a62, 0
    v_accvgpr_write_b32 a63, 0
    v_accvgpr_write_b32 a64, 0
    v_accvgpr_write_b32 a65, 0
    v_accvgpr_write_b32 a66, 0
    v_accvgpr_write_b32 a67, 0
    v_accvgpr_write_b32 a68, 0
    v_accvgpr_write_b32 a69, 0
    v_accvgpr_write_b32 a70, 0
    v_accvgpr_write_b32 a71, 0
    v_accvgpr_write_b32 a72, 0
    v_accvgpr_write_b32 a73, 0
    v_accvgpr_write_b32 a74, 0
    v_accvgpr_write_b32 a75, 0
    v_accvgpr_write_b32 a76, 0
    v_accvgpr_write_b32 a77, 0
    v_accvgpr_write_b32 a78, 0
    v_accvgpr_write_b32 a79, 0
    v_accvgpr_write_b32 a80, 0
    v_accvgpr_write_b32 a81, 0
    v_accvgpr_write_b32 a82, 0
    v_accvgpr_write_b32 a83, 0
    v_accvgpr_write_b32 a84, 0
    v_accvgpr_write_b32 a85, 0
    v_accvgpr_write_b32 a86, 0
    v_accvgpr_write_b32 a87, 0
    v_accvgpr_write_b32 a88, 0
    v_accvgpr_write_b32 a89, 0
    v_accvgpr_write_b32 a90, 0
    v_accvgpr_write_b32 a91, 0
    v_accvgpr_write_b32 a92, 0
    v_accvgpr_write_b32 a93, 0
    v_accvgpr_write_b32 a94, 0
    v_accvgpr_write_b32 a95, 0
    v_accvgpr_write_b32 a96, 0
    v_accvgpr_write_b32 a97, 0
    v_accvgpr_write_b32 a98, 0
    v_accvgpr_write_b32 a99, 0
    v_accvgpr_write_b32 a100, 0
    v_accvgpr_write_b32 a101, 0
    v_accvgpr_write_b32 a102, 0
    v_accvgpr_write_b32 a103, 0
    v_accvgpr_write_b32 a104, 0
    v_accvgpr_write_b32 a105, 0
    v_accvgpr_write_b32 a106, 0
    v_accvgpr_write_b32 a107, 0
    v_accvgpr_write_b32 a108, 0
    v_accvgpr_write_b32 a109, 0
    v_accvgpr_write_b32 a110, 0
    v_accvgpr_write_b32 a111, 0
    v_accvgpr_write_b32 a112, 0
    v_accvgpr_write_b32 a113, 0
    v_accvgpr_write_b32 a114, 0
    v_accvgpr_write_b32 a115, 0
    v_accvgpr_write_b32 a116, 0
    v_accvgpr_write_b32 a117, 0
    v_accvgpr_write_b32 a118, 0
    v_accvgpr_write_b32 a119, 0
    v_accvgpr_write_b32 a120, 0
    v_accvgpr_write_b32 a121, 0
    v_accvgpr_write_b32 a122, 0
    v_accvgpr_write_b32 a123, 0
    v_accvgpr_write_b32 a124, 0
    v_accvgpr_write_b32 a125, 0
    v_accvgpr_write_b32 a126, 0
    v_accvgpr_write_b32 a127, 0
    s_mov_b32 s32, 7
    s_mov_b32 m0, s41
    s_nop 0
    buffer_load_dwordx4 v8, s[8:11], s24 offen offset:0 lds
    buffer_load_dwordx4 v9, s[8:11], s24 offen offset:1024 lds
    s_add_u32 m0, s41, 2048
    s_nop 0
    buffer_load_dwordx4 v10, s[8:11], s24 offen offset:0 lds
    buffer_load_dwordx4 v11, s[8:11], s24 offen offset:1024 lds
    s_mov_b32 m0, s42
    s_nop 0
    buffer_load_dwordx4 v12, s[8:11], s24 offen offset:0 lds
    buffer_load_dwordx4 v13, s[8:11], s24 offen offset:1024 lds
    s_add_u32 m0, s42, 2048
    s_nop 0
    buffer_load_dwordx4 v14, s[8:11], s24 offen offset:0 lds
    buffer_load_dwordx4 v15, s[8:11], s24 offen offset:1024 lds
    s_mov_b32 m0, s43
    s_nop 0
    buffer_load_dwordx4 v16, s[12:15], s25 offen offset:0 lds
    buffer_load_dwordx4 v17, s[12:15], s25 offen offset:1024 lds
    buffer_load_dwordx4 v18, s[12:15], s25 offen offset:2048 lds
    buffer_load_dwordx4 v19, s[12:15], s25 offen offset:3072 lds
    s_mov_b32 m0, s44
    s_nop 0
    buffer_load_dwordx4 v20, s[12:15], s25 offen offset:0 lds
    buffer_load_dwordx4 v21, s[12:15], s25 offen offset:1024 lds
    s_add_u32 m0, s44, 2048
    s_nop 0
    buffer_load_dwordx4 v22, s[16:19], s26 offen offset:0 lds
    buffer_load_dwordx4 v23, s[16:19], s26 offen offset:1024 lds
    s_mov_b32 m0, s45
    s_nop 0
    buffer_load_dwordx4 v24, s[64:67], s33 offen lds
    s_or_b32 s3, s2, s28
    s_cmp_lg_u32 s3, 0
    s_cbranch_scc1 K_NOTAG
    s_mov_b32 s4, s68
    s_mov_b32 s5, s69
    s_mov_b32 s6, 0x100
    s_mov_b32 s7, 0x20000
    s_or_b32 s46, s46, 1
    v_mov_b32 v2, s46
    v_mov_b32 v3, s47
    s_mov_b64 exec, 1
    buffer_store_dwordx2 v[2:3], off, s[4:7], 0 sc1
    s_mov_b64 exec, -1
K_NOTAG:
    s_waitcnt vmcnt(17)
    s_barrier
    s_bitcmp1_b32 s28, 0
    s_cbranch_scc1 K1_W1
    ds_read_b64_tr_b16 a[128:129], v30 offset:0
    ds_read_b64_tr_b16 a[130:131], v30 offset:1792
    ds_read_b64_tr_b16 a[132:133], v30 offset:7168
    ds_read_b64_tr_b16 a[134:135], v30 offset:8960
    ds_read_b64_tr_b16 a[136:137], v30 offset:32
    ds_read_b64_tr_b16 a[138:139], v30 offset:1824
    ds_read_b64_tr_b16 a[140:141], v30 offset:7200
    ds_read_b64_tr_b16 a[142:143], v30 offset:8992
    ds_read_b64_tr_b16 a[144:145], v30 offset:64
    ds_read_b64_tr_b16 a[146:147], v30 offset:1856
    ds_read_b64_tr_b16 a[148:149], v30 offset:7232
    ds_read_b64_tr_b16 a[150:151], v30 offset:9024
    ds_read_b64_tr_b16 a[152:153], v30 offset:96
    ds_read_b64_tr_b16 a[154:155], v30 offset:1888
    ds_read_b64_tr_b16 a[156:157], v30 offset:7264
    ds_read_b64_tr_b16 a[158:159], v30 offset:9056
    ds_read_b128 a[192:195], v26 offset:0
    ds_read_b128 a[196:199], v27 offset:0
    ds_read_b128 a[200:203], v26 offset:2048
    ds_read_b128 a[204:207], v27 offset:2048
    ds_read_b128 a[208:211], v26 offset:4096
    ds_read_b128 a[212:215], v27 offset:4096
    ds_read_b128 a[216:219], v26 offset:6144
    ds_read_b128 a[220:223], v27 offset:6144
    ds_read_b64_tr_b16 v[44:45], v38 offset:0
    ds_read_b64_tr_b16 v[46:47], v38 offset:256
    ds_read_b64_tr_b16 v[48:49], v38 offset:1024
    ds_read_b64_tr_b16 v[50:51], v38 offset:1280
    s_waitcnt lgkmcnt(0)
    v_mfma_f32_16x16x32_bf16 v[128:131], a[128:131], a[192:195], 0
    ds_read_b128 a[224:227], v26 offset:8192
    v_mfma_f32_16x16x32_bf16 v[128:131], a[132:135], a[196:199], v[128:131]
    buffer_load_dword v125, v41, s[12:15], 0 offen
    v_mfma_f32_16x16x32_bf16 v[132:135], a[132:135], a[204:207], 0
    ds_read_b128 a[228:231], v27 offset:8192
    v_mfma_f32_16x16x32_bf16 v[132:135], a[128:131], a[200:203], v[132:135]
    v_mfma_f32_16x16x32_bf16 v[136:139], a[128:131], a[208:211], 0
    ds_read_b128 a[232:235], v26 offset:10240
    v_mfma_f32_16x16x32_bf16 v[136:139], a[132:135], a[212:215], v[136:139]
    v_mfma_f32_16x16x32_bf16 v[140:143], a[132:135], a[220:223], 0
    ds_read_b128 a[236:239], v27 offset:10240
    v_mfma_f32_16x16x32_bf16 v[140:143], a[128:131], a[216:219], v[140:143]
    ds_read_b128 a[240:243], v26 offset:12288
    v_mfma_f32_16x16x32_bf16 v[172:175], a[136:139], a[216:219], 0
    v_mfma_f32_16x16x32_bf16 v[172:175], a[140:143], a[220:223], v[172:175]
    ds_read_b128 a[244:247], v27 offset:12288
    v_mfma_f32_16x16x32_bf16 v[168:171], a[140:143], a[212:215], 0
    v_mfma_f32_16x16x32_bf16 v[168:171], a[136:139], a[208:211], v[168:171]
    ds_read_b128 a[248:251], v26 offset:14336
    v_mfma_f32_16x16x32_bf16 v[164:167], a[136:139], a[200:203], 0
    ds_read_b128 a[252:255], v27 offset:14336
    v_mfma_f32_16x16x32_bf16 v[164:167], a[140:143], a[204:207], v[164:167]
    buffer_load_dword v126, v42, s[16:19], 0 offen
    v_mfma_f32_16x16x32_bf16 v[160:163], a[140:143], a[196:199], 0
    v_mfma_f32_16x16x32_bf16 v[160:163], a[136:139], a[192:195], v[160:163]
    v_mfma_f32_16x16x32_bf16 v[192:195], a[144:147], a[192:195], 0
    v_mfma_f32_16x16x32_bf16 v[192:195], a[148:151], a[196:199], v[192:195]
    v_mfma_f32_16x16x32_bf16 v[196:199], a[148:151], a[204:207], 0
    v_mfma_f32_16x16x32_bf16 v[196:199], a[144:147], a[200:203], v[196:199]
    v_mfma_f32_16x16x32_bf16 v[200:203], a[144:147], a[208:211], 0
    v_mfma_f32_16x16x32_bf16 v[200:203], a[148:151], a[212:215], v[200:203]
    v_mfma_f32_16x16x32_bf16 v[204:207], a[148:151], a[220:223], 0
    v_mfma_f32_16x16x32_bf16 v[204:207], a[144:147], a[216:219], v[204:207]
    v_mfma_f32_16x16x32_bf16 v[236:239], a[152:155], a[216:219], 0
    v_mfma_f32_16x16x32_bf16 v[236:239], a[156:159], a[220:223], v[236:239]
    buffer_load_dword v124, v25, s[8:11], 0 offen offset:256
    v_mfma_f32_16x16x32_bf16 v[232:235], a[156:159], a[212:215], 0
    v_mfma_f32_16x16x32_bf16 v[232:235], a[152:155], a[208:211], v[232:235]
    v_mfma_f32_16x16x32_bf16 v[228:231], a[152:155], a[200:203], 0
    v_mfma_f32_16x16x32_bf16 v[228:231], a[156:159], a[204:207], v[228:231]
    v_mfma_f32_16x16x32_bf16 v[224:227], a[156:159], a[196:199], 0
    v_mfma_f32_16x16x32_bf16 v[224:227], a[152:155], a[192:195], v[224:227]
    v_mfma_f32_16x16x32_bf16 v[52:55], v[44:47], a[192:195], 0
    v_mfma_f32_16x16x32_bf16 v[52:55], v[48:51], a[196:199], v[52:55]
    s_waitcnt lgkmcnt(0)
    v_mfma_f32_16x16x32_bf16 v[144:147], a[128:131], a[224:227], 0
    ds_read_b64_tr_b16 a[160:161], v30 offset:16384
    v_mfma_f32_16x16x32_bf16 v[144:147], a[132:135], a[228:231], v[144:147]
    ds_read_b64_tr_b16 a[162:163], v30 offset:18176
    v_mfma_f32_16x16x32_bf16 v[148:151], a[132:135], a[236:239], 0
    ds_read_b64_tr_b16 a[164:165], v30 offset:23552
    v_mfma_f32_16x16x32_bf16 v[148:151], a[128:131], a[232:235], v[148:151]
    ds_read_b64_tr_b16 a[166:167], v30 offset:25344
    v_mfma_f32_16x16x32_bf16 v[152:155], a[128:131], a[240:243], 0
    v_mfma_f32_16x16x32_bf16 v[152:155], a[132:135], a[244:247], v[152:155]
    buffer_load_dword v127, v43, s[64:67], s34 offen
    v_mfma_f32_16x16x32_bf16 v[156:159], a[132:135], a[252:255], 0
    ds_read_b64_tr_b16 a[168:169], v30 offset:16416
    v_mfma_f32_16x16x32_bf16 v[156:159], a[128:131], a[248:251], v[156:159]
    ds_read_b64_tr_b16 a[170:171], v30 offset:18208
    v_mfma_f32_16x16x32_bf16 v[188:191], a[136:139], a[248:251], 0
    ds_read_b64_tr_b16 a[172:173], v30 offset:23584
    v_mfma_f32_16x16x32_bf16 v[188:191], a[140:143], a[252:255], v[188:191]
    ds_read_b64_tr_b16 a[174:175], v30 offset:25376
    v_mfma_f32_16x16x32_bf16 v[184:187], a[140:143], a[244:247], 0
    v_mfma_f32_16x16x32_bf16 v[184:187], a[136:139], a[240:243], v[184:187]
    ds_read_b64_tr_b16 a[176:177], v30 offset:16448
    v_mfma_f32_16x16x32_bf16 v[180:183], a[136:139], a[232:235], 0
    ds_read_b64_tr_b16 a[178:179], v30 offset:18240
    v_mfma_f32_16x16x32_bf16 v[180:183], a[140:143], a[236:239], v[180:183]
    ds_read_b64_tr_b16 a[180:181], v30 offset:23616
    v_mfma_f32_16x16x32_bf16 v[176:179], a[140:143], a[228:231], 0
    ds_read_b64_tr_b16 a[182:183], v30 offset:25408
    v_mfma_f32_16x16x32_bf16 v[176:179], a[136:139], a[224:227], v[176:179]
    v_mfma_f32_16x16x32_bf16 v[208:211], a[144:147], a[224:227], 0
    ds_read_b64_tr_b16 a[184:185], v30 offset:16480
    v_mfma_f32_16x16x32_bf16 v[208:211], a[148:151], a[228:231], v[208:211]
    ds_read_b64_tr_b16 a[186:187], v30 offset:18272
    v_mfma_f32_16x16x32_bf16 v[212:215], a[148:151], a[236:239], 0
    ds_read_b64_tr_b16 a[188:189], v30 offset:23648
    v_mfma_f32_16x16x32_bf16 v[212:215], a[144:147], a[232:235], v[212:215]
    ds_read_b64_tr_b16 a[190:191], v30 offset:25440
    v_mfma_f32_16x16x32_bf16 v[216:219], a[144:147], a[240:243], 0
    s_add_u32 s24, s24, 128
    v_mfma_f32_16x16x32_bf16 v[216:219], a[148:151], a[244:247], v[216:219]
    s_add_u32 s25, s25, 458752
    v_mfma_f32_16x16x32_bf16 v[220:223], a[148:151], a[252:255], 0
    s_add_u32 s26, s26, s27
    v_mfma_f32_16x16x32_bf16 v[220:223], a[144:147], a[248:251], v[220:223]
    s_add_u32 s33, s33, 4096
    v_mfma_f32_16x16x32_bf16 v[252:255], a[152:155], a[248:251], 0
    v_mfma_f32_16x16x32_bf16 v[252:255], a[156:159], a[252:255], v[252:255]
    v_mfma_f32_16x16x32_bf16 v[248:251], a[156:159], a[244:247], 0
    v_mfma_f32_16x16x32_bf16 v[248:251], a[152:155], a[240:243], v[248:251]
    v_mfma_f32_16x16x32_bf16 v[244:247], a[152:155], a[232:235], 0
    v_mfma_f32_16x16x32_bf16 v[244:247], a[156:159], a[236:239], v[244:247]
    v_mfma_f32_16x16x32_bf16 v[240:243], a[156:159], a[228:231], 0
    v_mfma_f32_16x16x32_bf16 v[240:243], a[152:155], a[224:227], v[240:243]
    s_waitcnt vmcnt(4) lgkmcnt(0)
    s_barrier
    s_cmp_ge_u32 s30, 16
    s_cbranch_scc1 K1_W0_LOOPB
.p2align 6
K1_W0_LOOP:
    v_mfma_f32_16x16x32_bf16 a[16:19], a[160:163], a[224:227], a[16:19]
    ds_read_b64_tr_b16 a[128:129], v31 offset:0
    v_mfma_f32_16x16x32_bf16 a[16:19], a[164:167], a[228:231], a[16:19]
    ds_read_b64_tr_b16 a[130:131], v31 offset:1792
    s_mov_b32 m0, s36
    v_mfma_f32_16x16x32_bf16 a[20:23], a[164:167], a[236:239], a[20:23]
    buffer_load_dwordx4 v8, s[8:11], s24 offen offset:0 lds
    v_mfma_f32_16x16x32_bf16 a[20:23], a[160:163], a[232:235], a[20:23]
    ds_read_b64_tr_b16 a[132:133], v31 offset:7168
    v_mfma_f32_16x16x32_bf16 a[24:27], a[160:163], a[240:243], a[24:27]
    ds_read_b64_tr_b16 a[134:135], v31 offset:8960
    v_mfma_f32_16x16x32_bf16 a[24:27], a[164:167], a[244:247], a[24:27]
    v_mfma_f32_16x16x32_bf16 a[28:31], a[164:167], a[252:255], a[28:31]
    ds_read_b64_tr_b16 a[136:137], v31 offset:32
    v_mfma_f32_16x16x32_bf16 a[28:31], a[160:163], a[248:251], a[28:31]
    buffer_load_dwordx4 v9, s[8:11], s24 offen offset:1024 lds
    v_mfma_f32_16x16x32_bf16 a[60:63], a[168:171], a[248:251], a[60:63]
    ds_read_b64_tr_b16 a[138:139], v31 offset:1824
    v_mfma_f32_16x16x32_bf16 a[60:63], a[172:175], a[252:255], a[60:63]
    ds_read_b64_tr_b16 a[140:141], v31 offset:7200
    v_mfma_f32_16x16x32_bf16 a[56:59], a[172:175], a[244:247], a[56:59]
    ds_read_b64_tr_b16 a[142:143], v31 offset:8992
    v_mfma_f32_16x16x32_bf16 a[56:59], a[168:171], a[240:243], a[56:59]
    s_add_u32 m0, s36, 2048
    v_mfma_f32_16x16x32_bf16 a[52:55], a[168:171], a[232:235], a[52:55]
    buffer_load_dwordx4 v10, s[8:11], s24 offen offset:0 lds
    v_mfma_f32_16x16x32_bf16 a[52:55], a[172:175], a[236:239], a[52:55]
    ds_read_b64_tr_b16 a[144:145], v31 offset:64
    v_mfma_f32_16x16x32_bf16 a[48:51], a[172:175], a[228:231], a[48:51]
    ds_read_b64_tr_b16 a[146:147], v31 offset:1856
    v_mfma_f32_16x16x32_bf16 a[48:51], a[168:171], a[224:227], a[48:51]
    ds_read_b64_tr_b16 a[148:149], v31 offset:7232
    v_mfma_f32_16x16x32_bf16 a[80:83], a[176:179], a[224:227], a[80:83]
    ds_read_b64_tr_b16 a[150:151], v31 offset:9024
    v_mfma_f32_16x16x32_bf16 a[80:83], a[180:183], a[228:231], a[80:83]
    buffer_load_dwordx4 v11, s[8:11], s24 offen offset:1024 lds
    v_mfma_f32_16x16x32_bf16 a[84:87], a[180:183], a[236:239], a[84:87]
    v_mfma_f32_16x16x32_bf16 a[84:87], a[176:179], a[232:235], a[84:87]
    ds_read_b64_tr_b16 a[152:153], v31 offset:96
    v_mfma_f32_16x16x32_bf16 a[88:91], a[176:179], a[240:243], a[88:91]
    ds_read_b64_tr_b16 a[154:155], v31 offset:1888
    v_mfma_f32_16x16x32_bf16 a[88:91], a[180:183], a[244:247], a[88:91]
    ds_read_b64_tr_b16 a[156:157], v31 offset:7264
    s_mov_b32 m0, s37
    v_mfma_f32_16x16x32_bf16 a[92:95], a[180:183], a[252:255], a[92:95]
    buffer_load_dwordx4 v12, s[8:11], s24 offen offset:0 lds
    v_mfma_f32_16x16x32_bf16 a[92:95], a[176:179], a[248:251], a[92:95]
    ds_read_b64_tr_b16 a[158:159], v31 offset:9056
    v_mfma_f32_16x16x32_bf16 a[124:127], a[184:187], a[248:251], a[124:127]
    v_mfma_f32_16x16x32_bf16 a[124:127], a[188:191], a[252:255], a[124:127]
    v_mfma_f32_16x16x32_bf16 a[120:123], a[188:191], a[244:247], a[120:123]
    v_mfma_f32_16x16x32_bf16 a[120:123], a[184:187], a[240:243], a[120:123]
    buffer_load_dwordx4 v13, s[8:11], s24 offen offset:1024 lds
    v_mfma_f32_16x16x32_bf16 a[116:119], a[184:187], a[232:235], a[116:119]
    v_mfma_f32_16x16x32_bf16 a[116:119], a[188:191], a[236:239], a[116:119]
    v_mfma_f32_16x16x32_bf16 a[112:115], a[188:191], a[228:231], a[112:115]
    v_mfma_f32_16x16x32_bf16 a[112:115], a[184:187], a[224:227], a[112:115]
    s_add_u32 m0, s37, 2048
    v_mfma_f32_16x16x32_bf16 a[0:3], a[160:163], a[192:195], a[0:3]
    buffer_load_dwordx4 v14, s[8:11], s24 offen offset:0 lds
    v_mfma_f32_16x16x32_bf16 a[0:3], a[164:167], a[196:199], a[0:3]
    ds_read_b128 a[224:227], v28 offset:8192
    v_mfma_f32_16x16x32_bf16 a[4:7], a[164:167], a[204:207], a[4:7]
    ds_read_b128 a[228:231], v29 offset:8192
    v_mfma_f32_16x16x32_bf16 a[4:7], a[160:163], a[200:203], a[4:7]
    v_mfma_f32_16x16x32_bf16 a[8:11], a[160:163], a[208:211], a[8:11]
    ds_read_b128 a[232:235], v28 offset:10240
    v_mfma_f32_16x16x32_bf16 a[8:11], a[164:167], a[212:215], a[8:11]
    buffer_load_dwordx4 v15, s[8:11], s24 offen offset:1024 lds
    v_mfma_f32_16x16x32_bf16 a[12:15], a[164:167], a[220:223], a[12:15]
    v_mfma_f32_16x16x32_bf16 a[12:15], a[160:163], a[216:219], a[12:15]
    ds_read_b128 a[236:239], v29 offset:10240
    v_mfma_f32_16x16x32_bf16 a[44:47], a[168:171], a[216:219], a[44:47]
    ds_read_b128 a[240:243], v28 offset:12288
    v_mfma_f32_16x16x32_bf16 a[44:47], a[172:175], a[220:223], a[44:47]
    s_mov_b32 m0, s38
    v_mfma_f32_16x16x32_bf16 a[40:43], a[172:175], a[212:215], a[40:43]
    buffer_load_dwordx4 v16, s[12:15], s25 offen offset:0 lds
    v_mfma_f32_16x16x32_bf16 a[40:43], a[168:171], a[208:211], a[40:43]
    ds_read_b128 a[244:247], v29 offset:12288
    v_mfma_f32_16x16x32_bf16 a[36:39], a[168:171], a[200:203], a[36:39]
    v_mfma_f32_16x16x32_bf16 a[36:39], a[172:175], a[204:207], a[36:39]
    ds_read_b128 a[248:251], v28 offset:14336
    v_mfma_f32_16x16x32_bf16 a[32:35], a[172:175], a[196:199], a[32:35]
    ds_read_b128 a[252:255], v29 offset:14336
    v_mfma_f32_16x16x32_bf16 a[32:35], a[168:171], a[192:195], a[32:35]
    buffer_load_dwordx4 v17, s[12:15], s25 offen offset:1024 lds
    v_mfma_f32_16x16x32_bf16 a[64:67], a[176:179], a[192:195], a[64:67]
    v_mfma_f32_16x16x32_bf16 a[64:67], a[180:183], a[196:199], a[64:67]
    ds_read_b64_tr_b16 v[44:45], v39 offset:0
    v_mfma_f32_16x16x32_bf16 a[68:71], a[180:183], a[204:207], a[68:71]
    v_mfma_f32_16x16x32_bf16 a[68:71], a[176:179], a[200:203], a[68:71]
    ds_read_b64_tr_b16 v[46:47], v39 offset:256
    v_mfma_f32_16x16x32_bf16 a[72:75], a[176:179], a[208:211], a[72:75]
    buffer_load_dwordx4 v18, s[12:15], s25 offen offset:2048 lds
    v_mfma_f32_16x16x32_bf16 a[72:75], a[180:183], a[212:215], a[72:75]
    ds_read_b64_tr_b16 v[48:49], v39 offset:1024
    v_mfma_f32_16x16x32_bf16 a[76:79], a[180:183], a[220:223], a[76:79]
    v_mfma_f32_16x16x32_bf16 a[76:79], a[176:179], a[216:219], a[76:79]
    ds_read_b64_tr_b16 v[50:51], v39 offset:1280
    v_mfma_f32_16x16x32_bf16 a[108:111], a[184:187], a[216:219], a[108:111]
    v_mfma_f32_16x16x32_bf16 a[108:111], a[188:191], a[220:223], a[108:111]
    buffer_load_dwordx4 v19, s[12:15], s25 offen offset:3072 lds
    v_mfma_f32_16x16x32_bf16 a[104:107], a[188:191], a[212:215], a[104:107]
    v_mfma_f32_16x16x32_bf16 a[104:107], a[184:187], a[208:211], a[104:107]
    v_mfma_f32_16x16x32_bf16 a[100:103], a[184:187], a[200:203], a[100:103]
    v_mfma_f32_16x16x32_bf16 a[100:103], a[188:191], a[204:207], a[100:103]
    s_mov_b32 m0, s39
    v_mfma_f32_16x16x32_bf16 a[96:99], a[188:191], a[196:199], a[96:99]
    buffer_load_dwordx4 v20, s[12:15], s25 offen offset:0 lds
    v_mfma_f32_16x16x32_bf16 a[96:99], a[184:187], a[192:195], a[96:99]
    s_waitcnt lgkmcnt(0)
    v_mfma_f32_16x16x32_bf16 v[144:147], a[128:131], a[224:227], v[144:147]
    ds_read_b128 a[192:195], v28 offset:0
    v_mfma_f32_16x16x32_bf16 v[144:147], a[132:135], a[228:231], v[144:147]
    ds_read_b128 a[196:199], v29 offset:0
    v_mfma_f32_16x16x32_bf16 v[148:151], a[132:135], a[236:239], v[148:151]
    v_mfma_f32_16x16x32_bf16 v[148:151], a[128:131], a[232:235], v[148:151]
    buffer_load_dwordx4 v21, s[12:15], s25 offen offset:1024 lds
    v_mfma_f32_16x16x32_bf16 v[152:155], a[128:131], a[240:243], v[152:155]
    ds_read_b128 a[200:203], v28 offset:2048
    v_mfma_f32_16x16x32_bf16 v[152:155], a[132:135], a[244:247], v[152:155]
    v_mfma_f32_16x16x32_bf16 v[156:159], a[132:135], a[252:255], v[156:159]
    ds_read_b128 a[204:207], v29 offset:2048
    v_mfma_f32_16x16x32_bf16 v[156:159], a[128:131], a[248:251], v[156:159]
    ds_read_b128 a[208:211], v28 offset:4096
    s_add_u32 m0, s39, 2048
    v_mfma_f32_16x16x32_bf16 v[188:191], a[136:139], a[248:251], v[188:191]
    buffer_load_dwordx4 v22, s[16:19], s26 offen offset:0 lds
    v_mfma_f32_16x16x32_bf16 v[188:191], a[140:143], a[252:255], v[188:191]
    v_mfma_f32_16x16x32_bf16 v[184:187], a[140:143], a[244:247], v[184:187]
    ds_read_b128 a[212:215], v29 offset:4096
    v_mfma_f32_16x16x32_bf16 v[184:187], a[136:139], a[240:243], v[184:187]
    v_mfma_f32_16x16x32_bf16 v[180:183], a[136:139], a[232:235], v[180:183]
    ds_read_b128 a[216:219], v28 offset:6144
    v_mfma_f32_16x16x32_bf16 v[180:183], a[140:143], a[236:239], v[180:183]
    buffer_load_dwordx4 v23, s[16:19], s26 offen offset:1024 lds
    v_mfma_f32_16x16x32_bf16 v[176:179], a[140:143], a[228:231], v[176:179]
    ds_read_b128 a[220:223], v29 offset:6144
    v_mfma_f32_16x16x32_bf16 v[176:179], a[136:139], a[224:227], v[176:179]
    v_mfma_f32_16x16x32_bf16 v[208:211], a[144:147], a[224:227], v[208:211]
    v_mfma_f32_16x16x32_bf16 v[208:211], a[148:151], a[228:231], v[208:211]
    s_mov_b32 m0, s40
    v_mfma_f32_16x16x32_bf16 v[212:215], a[148:151], a[236:239], v[212:215]
    buffer_load_dwordx4 v24, s[64:67], s33 offen lds
    v_mfma_f32_16x16x32_bf16 v[212:215], a[144:147], a[232:235], v[212:215]
    v_mfma_f32_16x16x32_bf16 v[216:219], a[144:147], a[240:243], v[216:219]
    v_mfma_f32_16x16x32_bf16 v[216:219], a[148:151], a[244:247], v[216:219]
    v_mfma_f32_16x16x32_bf16 v[220:223], a[148:151], a[252:255], v[220:223]
    v_mfma_f32_16x16x32_bf16 v[220:223], a[144:147], a[248:251], v[220:223]
    v_mfma_f32_16x16x32_bf16 v[252:255], a[152:155], a[248:251], v[252:255]
    v_mfma_f32_16x16x32_bf16 v[252:255], a[156:159], a[252:255], v[252:255]
    v_mfma_f32_16x16x32_bf16 v[248:251], a[156:159], a[244:247], v[248:251]
    buffer_load_dword v125, v41, s[12:15], s25 offen
    v_mfma_f32_16x16x32_bf16 v[248:251], a[152:155], a[240:243], v[248:251]
    v_mfma_f32_16x16x32_bf16 v[244:247], a[152:155], a[232:235], v[244:247]
    v_mfma_f32_16x16x32_bf16 v[244:247], a[156:159], a[236:239], v[244:247]
    v_mfma_f32_16x16x32_bf16 v[240:243], a[156:159], a[228:231], v[240:243]
    v_mfma_f32_16x16x32_bf16 v[240:243], a[152:155], a[224:227], v[240:243]
    buffer_load_dword v126, v42, s[16:19], s26 offen
    s_waitcnt lgkmcnt(0)
    v_mfma_f32_16x16x32_bf16 v[128:131], a[128:131], a[192:195], v[128:131]
    ds_read_b64_tr_b16 a[160:161], v31 offset:16384
    v_mfma_f32_16x16x32_bf16 v[128:131], a[132:135], a[196:199], v[128:131]
    ds_read_b64_tr_b16 a[162:163], v31 offset:18176
    v_mfma_f32_16x16x32_bf16 v[132:135], a[132:135], a[204:207], v[132:135]
    ds_read_b64_tr_b16 a[164:165], v31 offset:23552
    v_mfma_f32_16x16x32_bf16 v[132:135], a[128:131], a[200:203], v[132:135]
    ds_read_b64_tr_b16 a[166:167], v31 offset:25344
    v_mfma_f32_16x16x32_bf16 v[136:139], a[128:131], a[208:211], v[136:139]
    v_mfma_f32_16x16x32_bf16 v[136:139], a[132:135], a[212:215], v[136:139]
    ds_read_b64_tr_b16 a[168:169], v31 offset:16416
    v_mfma_f32_16x16x32_bf16 v[140:143], a[132:135], a[220:223], v[140:143]
    ds_read_b64_tr_b16 a[170:171], v31 offset:18208
    v_mfma_f32_16x16x32_bf16 v[140:143], a[128:131], a[216:219], v[140:143]
    ds_read_b64_tr_b16 a[172:173], v31 offset:23584
    v_mfma_f32_16x16x32_bf16 v[172:175], a[136:139], a[216:219], v[172:175]
    ds_read_b64_tr_b16 a[174:175], v31 offset:25376
    v_mfma_f32_16x16x32_bf16 v[172:175], a[140:143], a[220:223], v[172:175]
    v_mfma_f32_16x16x32_bf16 v[168:171], a[140:143], a[212:215], v[168:171]
    ds_read_b64_tr_b16 a[176:177], v31 offset:16448
    v_mfma_f32_16x16x32_bf16 v[168:171], a[136:139], a[208:211], v[168:171]
    ds_read_b64_tr_b16 a[178:179], v31 offset:18240
    v_mfma_f32_16x16x32_bf16 v[164:167], a[136:139], a[200:203], v[164:167]
    ds_read_b64_tr_b16 a[180:181], v31 offset:23616
    v_mfma_f32_16x16x32_bf16 v[164:167], a[140:143], a[204:207], v[164:167]
    ds_read_b64_tr_b16 a[182:183], v31 offset:25408
    v_mfma_f32_16x16x32_bf16 v[160:163], a[140:143], a[196:199], v[160:163]
    v_mfma_f32_16x16x32_bf16 v[160:163], a[136:139], a[192:195], v[160:163]
    ds_read_b64_tr_b16 a[184:185], v31 offset:16480
    v_mfma_f32_16x16x32_bf16 v[192:195], a[144:147], a[192:195], v[192:195]
    ds_read_b64_tr_b16 a[186:187], v31 offset:18272
    v_mfma_f32_16x16x32_bf16 v[192:195], a[148:151], a[196:199], v[192:195]
    ds_read_b64_tr_b16 a[188:189], v31 offset:23648
    v_mfma_f32_16x16x32_bf16 v[196:199], a[148:151], a[204:207], v[196:199]
    ds_read_b64_tr_b16 a[190:191], v31 offset:25440
    v_mfma_f32_16x16x32_bf16 v[196:199], a[144:147], a[200:203], v[196:199]
    v_mfma_f32_16x16x32_bf16 v[200:203], a[144:147], a[208:211], v[200:203]
    s_add_u32 s24, s24, 128
    v_mfma_f32_16x16x32_bf16 v[200:203], a[148:151], a[212:215], v[200:203]
    s_add_u32 s25, s25, 458752
    v_mfma_f32_16x16x32_bf16 v[204:207], a[148:151], a[220:223], v[204:207]
    s_add_u32 s26, s26, s27
    v_mfma_f32_16x16x32_bf16 v[204:207], a[144:147], a[216:219], v[204:207]
    s_add_u32 s33, s33, 4096
    v_mfma_f32_16x16x32_bf16 v[236:239], a[152:155], a[216:219], v[236:239]
    v_mfma_f32_16x16x32_bf16 v[236:239], a[156:159], a[220:223], v[236:239]
    v_mfma_f32_16x16x32_bf16 v[232:235], a[156:159], a[212:215], v[232:235]
    v_mfma_f32_16x16x32_bf16 v[232:235], a[152:155], a[208:211], v[232:235]
    v_mfma_f32_16x16x32_bf16 v[228:231], a[152:155], a[200:203], v[228:231]
    v_mfma_f32_16x16x32_bf16 v[228:231], a[156:159], a[204:207], v[228:231]
    v_mfma_f32_16x16x32_bf16 v[224:227], a[156:159], a[196:199], v[224:227]
    v_mfma_f32_16x16x32_bf16 v[224:227], a[152:155], a[192:195], v[224:227]
    v_mfma_f32_16x16x32_bf16 v[52:55], v[44:47], a[192:195], v[52:55]
    v_mfma_f32_16x16x32_bf16 v[52:55], v[48:51], a[196:199], v[52:55]
    s_waitcnt vmcnt(2) lgkmcnt(0)
    s_barrier
    v_mfma_f32_16x16x32_bf16 a[0:3], a[160:163], a[192:195], a[0:3]
    ds_read_b64_tr_b16 a[128:129], v30 offset:0
    v_mfma_f32_16x16x32_bf16 a[0:3], a[164:167], a[196:199], a[0:3]
    ds_read_b64_tr_b16 a[130:131], v30 offset:1792
    s_mov_b32 m0, s41
    v_mfma_f32_16x16x32_bf16 a[4:7], a[164:167], a[204:207], a[4:7]
    buffer_load_dwordx4 v8, s[8:11], s24 offen offset:0 lds
    v_mfma_f32_16x16x32_bf16 a[4:7], a[160:163], a[200:203], a[4:7]
    ds_read_b64_tr_b16 a[132:133], v30 offset:7168
    v_mfma_f32_16x16x32_bf16 a[8:11], a[160:163], a[208:211], a[8:11]
    ds_read_b64_tr_b16 a[134:135], v30 offset:8960
    v_mfma_f32_16x16x32_bf16 a[8:11], a[164:167], a[212:215], a[8:11]
    v_mfma_f32_16x16x32_bf16 a[12:15], a[164:167], a[220:223], a[12:15]
    ds_read_b64_tr_b16 a[136:137], v30 offset:32
    v_mfma_f32_16x16x32_bf16 a[12:15], a[160:163], a[216:219], a[12:15]
    buffer_load_dwordx4 v9, s[8:11], s24 offen offset:1024 lds
    v_mfma_f32_16x16x32_bf16 a[44:47], a[168:171], a[216:219], a[44:47]
    ds_read_b64_tr_b16 a[138:139], v30 offset:1824
    v_mfma_f32_16x16x32_bf16 a[44:47], a[172:175], a[220:223], a[44:47]
    ds_read_b64_tr_b16 a[140:141], v30 offset:7200
    v_mfma_f32_16x16x32_bf16 a[40:43], a[172:175], a[212:215], a[40:43]
    ds_read_b64_tr_b16 a[142:143], v30 offset:8992
    v_mfma_f32_16x16x32_bf16 a[40:43], a[168:171], a[208:211], a[40:43]
    s_add_u32 m0, s41, 2048
    v_mfma_f32_16x16x32_bf16 a[36:39], a[168:171], a[200:203], a[36:39]
    buffer_load_dwordx4 v10, s[8:11], s24 offen offset:0 lds
    v_mfma_f32_16x16x32_bf16 a[36:39], a[172:175], a[204:207], a[36:39]
    ds_read_b64_tr_b16 a[144:145], v30 offset:64
    v_mfma_f32_16x16x32_bf16 a[32:35], a[172:175], a[196:199], a[32:35]
    ds_read_b64_tr_b16 a[146:147], v30 offset:1856
    v_mfma_f32_16x16x32_bf16 a[32:35], a[168:171], a[192:195], a[32:35]
    ds_read_b64_tr_b16 a[148:149], v30 offset:7232
    v_mfma_f32_16x16x32_bf16 a[64:67], a[176:179], a[192:195], a[64:67]
    ds_read_b64_tr_b16 a[150:151], v30 offset:9024
    v_mfma_f32_16x16x32_bf16 a[64:67], a[180:183], a[196:199], a[64:67]
    buffer_load_dwordx4 v11, s[8:11], s24 offen offset:1024 lds
    v_mfma_f32_16x16x32_bf16 a[68:71], a[180:183], a[204:207], a[68:71]
    v_mfma_f32_16x16x32_bf16 a[68:71], a[176:179], a[200:203], a[68:71]
    ds_read_b64_tr_b16 a[152:153], v30 offset:96
    v_mfma_f32_16x16x32_bf16 a[72:75], a[176:179], a[208:211], a[72:75]
    ds_read_b64_tr_b16 a[154:155], v30 offset:1888
    v_mfma_f32_16x16x32_bf16 a[72:75], a[180:183], a[212:215], a[72:75]
    ds_read_b64_tr_b16 a[156:157], v30 offset:7264
    s_mov_b32 m0, s42
    v_mfma_f32_16x16x32_bf16 a[76:79], a[180:183], a[220:223], a[76:79]
    buffer_load_dwordx4 v12, s[8:11], s24 offen offset:0 lds
    v_mfma_f32_16x16x32_bf16 a[76:79], a[176:179], a[216:219], a[76:79]
    ds_read_b64_tr_b16 a[158:159], v30 offset:9056
    v_mfma_f32_16x16x32_bf16 a[108:111], a[184:187], a[216:219], a[108:111]
    v_mfma_f32_16x16x32_bf16 a[108:111], a[188:191], a[220:223], a[108:111]
    v_mfma_f32_16x16x32_bf16 a[104:107], a[188:191], a[212:215], a[104:107]
    v_mfma_f32_16x16x32_bf16 a[104:107], a[184:187], a[208:211], a[104:107]
    buffer_load_dwordx4 v13, s[8:11], s24 offen offset:1024 lds
    v_mfma_f32_16x16x32_bf16 a[100:103], a[184:187], a[200:203], a[100:103]
    v_mfma_f32_16x16x32_bf16 a[100:103], a[188:191], a[204:207], a[100:103]
    v_mfma_f32_16x16x32_bf16 a[96:99], a[188:191], a[196:199], a[96:99]
    v_mfma_f32_16x16x32_bf16 a[96:99], a[184:187], a[192:195], a[96:99]
    s_add_u32 m0, s42, 2048
    v_mfma_f32_16x16x32_bf16 a[16:19], a[160:163], a[224:227], a[16:19]
    buffer_load_dwordx4 v14, s[8:11], s24 offen offset:0 lds
    v_mfma_f32_16x16x32_bf16 a[16:19], a[164:167], a[228:231], a[16:19]
    ds_read_b128 a[192:195], v26 offset:0
    v_mfma_f32_16x16x32_bf16 a[20:23], a[164:167], a[236:239], a[20:23]
    ds_read_b128 a[196:199], v27 offset:0
    v_mfma_f32_16x16x32_bf16 a[20:23], a[160:163], a[232:235], a[20:23]
    v_mfma_f32_16x16x32_bf16 a[24:27], a[160:163], a[240:243], a[24:27]
    ds_read_b128 a[200:203], v26 offset:2048
    v_mfma_f32_16x16x32_bf16 a[24:27], a[164:167], a[244:247], a[24:27]
    buffer_load_dwordx4 v15, s[8:11], s24 offen offset:1024 lds
    v_mfma_f32_16x16x32_bf16 a[28:31], a[164:167], a[252:255], a[28:31]
    v_mfma_f32_16x16x32_bf16 a[28:31], a[160:163], a[248:251], a[28:31]
    ds_read_b128 a[204:207], v27 offset:2048
    v_mfma_f32_16x16x32_bf16 a[60:63], a[168:171], a[248:251], a[60:63]
    ds_read_b128 a[208:211], v26 offset:4096
    v_mfma_f32_16x16x32_bf16 a[60:63], a[172:175], a[252:255], a[60:63]
    s_mov_b32 m0, s43
    v_mfma_f32_16x16x32_bf16 a[56:59], a[172:175], a[244:247], a[56:59]
    buffer_load_dwordx4 v16, s[12:15], s25 offen offset:0 lds
    v_mfma_f32_16x16x32_bf16 a[56:59], a[168:171], a[240:243], a[56:59]
    ds_read_b128 a[212:215], v27 offset:4096
    v_mfma_f32_16x16x32_bf16 a[52:55], a[168:171], a[232:235], a[52:55]
    v_mfma_f32_16x16x32_bf16 a[52:55], a[172:175], a[236:239], a[52:55]
    ds_read_b128 a[216:219], v26 offset:6144
    v_mfma_f32_16x16x32_bf16 a[48:51], a[172:175], a[228:231], a[48:51]
    ds_read_b128 a[220:223], v27 offset:6144
    v_mfma_f32_16x16x32_bf16 a[48:51], a[168:171], a[224:227], a[48:51]
    buffer_load_dwordx4 v17, s[12:15], s25 offen offset:1024 lds
    v_mfma_f32_16x16x32_bf16 a[80:83], a[176:179], a[224:227], a[80:83]
    v_mfma_f32_16x16x32_bf16 a[80:83], a[180:183], a[228:231], a[80:83]
    ds_read_b64_tr_b16 v[44:45], v38 offset:0
    v_mfma_f32_16x16x32_bf16 a[84:87], a[180:183], a[236:239], a[84:87]
    v_mfma_f32_16x16x32_bf16 a[84:87], a[176:179], a[232:235], a[84:87]
    ds_read_b64_tr_b16 v[46:47], v38 offset:256
    v_mfma_f32_16x16x32_bf16 a[88:91], a[176:179], a[240:243], a[88:91]
    buffer_load_dwordx4 v18, s[12:15], s25 offen offset:2048 lds
    v_mfma_f32_16x16x32_bf16 a[88:91], a[180:183], a[244:247], a[88:91]
    ds_read_b64_tr_b16 v[48:49], v38 offset:1024
    v_mfma_f32_16x16x32_bf16 a[92:95], a[180:183], a[252:255], a[92:95]
    v_mfma_f32_16x16x32_bf16 a[92:95], a[176:179], a[248:251], a[92:95]
    ds_read_b64_tr_b16 v[50:51], v38 offset:1280
    v_mfma_f32_16x16x32_bf16 a[124:127], a[184:187], a[248:251], a[124:127]
    v_mfma_f32_16x16x32_bf16 a[124:127], a[188:191], a[252:255], a[124:127]
    buffer_load_dwordx4 v19, s[12:15], s25 offen offset:3072 lds
    v_mfma_f32_16x16x32_bf16 a[120:123], a[188:191], a[244:247], a[120:123]
    v_mfma_f32_16x16x32_bf16 a[120:123], a[184:187], a[240:243], a[120:123]
    v_mfma_f32_16x16x32_bf16 a[116:119], a[184:187], a[232:235], a[116:119]
    v_mfma_f32_16x16x32_bf16 a[116:119], a[188:191], a[236:239], a[116:119]
    s_mov_b32 m0, s44
    v_mfma_f32_16x16x32_bf16 a[112:115], a[188:191], a[228:231], a[112:115]
    buffer_load_dwordx4 v20, s[12:15], s25 offen offset:0 lds
    v_mfma_f32_16x16x32_bf16 a[112:115], a[184:187], a[224:227], a[112:115]
    s_waitcnt lgkmcnt(0)
    v_mfma_f32_16x16x32_bf16 v[128:131], a[128:131], a[192:195], v[128:131]
    ds_read_b128 a[224:227], v26 offset:8192
    v_mfma_f32_16x16x32_bf16 v[128:131], a[132:135], a[196:199], v[128:131]
    ds_read_b128 a[228:231], v27 offset:8192
    v_mfma_f32_16x16x32_bf16 v[132:135], a[132:135], a[204:207], v[132:135]
    v_mfma_f32_16x16x32_bf16 v[132:135], a[128:131], a[200:203], v[132:135]
    buffer_load_dwordx4 v21, s[12:15], s25 offen offset:1024 lds
    v_mfma_f32_16x16x32_bf16 v[136:139], a[128:131], a[208:211], v[136:139]
    ds_read_b128 a[232:235], v26 offset:10240
    v_mfma_f32_16x16x32_bf16 v[136:139], a[132:135], a[212:215], v[136:139]
    v_mfma_f32_16x16x32_bf16 v[140:143], a[132:135], a[220:223], v[140:143]
    ds_read_b128 a[236:239], v27 offset:10240
    v_mfma_f32_16x16x32_bf16 v[140:143], a[128:131], a[216:219], v[140:143]
    ds_read_b128 a[240:243], v26 offset:12288
    s_add_u32 m0, s44, 2048
    v_mfma_f32_16x16x32_bf16 v[172:175], a[136:139], a[216:219], v[172:175]
    buffer_load_dwordx4 v22, s[16:19], s26 offen offset:0 lds
    v_mfma_f32_16x16x32_bf16 v[172:175], a[140:143], a[220:223], v[172:175]
    v_mfma_f32_16x16x32_bf16 v[168:171], a[140:143], a[212:215], v[168:171]
    ds_read_b128 a[244:247], v27 offset:12288
    v_mfma_f32_16x16x32_bf16 v[168:171], a[136:139], a[208:211], v[168:171]
    v_mfma_f32_16x16x32_bf16 v[164:167], a[136:139], a[200:203], v[164:167]
    ds_read_b128 a[248:251], v26 offset:14336
    v_mfma_f32_16x16x32_bf16 v[164:167], a[140:143], a[204:207], v[164:167]
    buffer_load_dwordx4 v23, s[16:19], s26 offen offset:1024 lds
    v_mfma_f32_16x16x32_bf16 v[160:163], a[140:143], a[196:199], v[160:163]
    ds_read_b128 a[252:255], v27 offset:14336
    v_mfma_f32_16x16x32_bf16 v[160:163], a[136:139], a[192:195], v[160:163]
    v_mfma_f32_16x16x32_bf16 v[192:195], a[144:147], a[192:195], v[192:195]
    v_mfma_f32_16x16x32_bf16 v[192:195], a[148:151], a[196:199], v[192:195]
    s_mov_b32 m0, s45
    v_mfma_f32_16x16x32_bf16 v[196:199], a[148:151], a[204:207], v[196:199]
    buffer_load_dwordx4 v24, s[64:67], s33 offen lds
    v_mfma_f32_16x16x32_bf16 v[196:199], a[144:147], a[200:203], v[196:199]
    v_mfma_f32_16x16x32_bf16 v[200:203], a[144:147], a[208:211], v[200:203]
    v_mfma_f32_16x16x32_bf16 v[200:203], a[148:151], a[212:215], v[200:203]
    v_mfma_f32_16x16x32_bf16 v[204:207], a[148:151], a[220:223], v[204:207]
    v_mfma_f32_16x16x32_bf16 v[204:207], a[144:147], a[216:219], v[204:207]
    v_mfma_f32_16x16x32_bf16 v[236:239], a[152:155], a[216:219], v[236:239]
    v_mfma_f32_16x16x32_bf16 v[236:239], a[156:159], a[220:223], v[236:239]
    v_mfma_f32_16x16x32_bf16 v[232:235], a[156:159], a[212:215], v[232:235]
    buffer_load_dword v124, v40, s[8:11], s24 offen offset:256
    v_mfma_f32_16x16x32_bf16 v[232:235], a[152:155], a[208:211], v[232:235]
    v_mfma_f32_16x16x32_bf16 v[228:231], a[152:155], a[200:203], v[228:231]
    v_mfma_f32_16x16x32_bf16 v[228:231], a[156:159], a[204:207], v[228:231]
    v_mfma_f32_16x16x32_bf16 v[224:227], a[156:159], a[196:199], v[224:227]
    v_mfma_f32_16x16x32_bf16 v[224:227], a[152:155], a[192:195], v[224:227]
    global_load_dword v127, v[122:123], off
    v_mfma_f32_16x16x32_bf16 v[52:55], v[44:47], a[192:195], v[52:55]
    v_mfma_f32_16x16x32_bf16 v[52:55], v[48:51], a[196:199], v[52:55]
    s_waitcnt lgkmcnt(0)
    v_mfma_f32_16x16x32_bf16 v[144:147], a[128:131], a[224:227], v[144:147]
    ds_read_b64_tr_b16 a[160:161], v30 offset:16384
    v_mfma_f32_16x16x32_bf16 v[144:147], a[132:135], a[228:231], v[144:147]
    ds_read_b64_tr_b16 a[162:163], v30 offset:18176
    v_mfma_f32_16x16x32_bf16 v[148:151], a[132:135], a[236:239], v[148:151]
    ds_read_b64_tr_b16 a[164:165], v30 offset:23552
    v_mfma_f32_16x16x32_bf16 v[148:151], a[128:131], a[232:235], v[148:151]
    ds_read_b64_tr_b16 a[166:167], v30 offset:25344
    v_mfma_f32_16x16x32_bf16 v[152:155], a[128:131], a[240:243], v[152:155]
    v_mfma_f32_16x16x32_bf16 v[152:155], a[132:135], a[244:247], v[152:155]
    ds_read_b64_tr_b16 a[168:169], v30 offset:16416
    v_mfma_f32_16x16x32_bf16 v[156:159], a[132:135], a[252:255], v[156:159]
    ds_read_b64_tr_b16 a[170:171], v30 offset:18208
    v_mfma_f32_16x16x32_bf16 v[156:159], a[128:131], a[248:251], v[156:159]
    ds_read_b64_tr_b16 a[172:173], v30 offset:23584
    v_mfma_f32_16x16x32_bf16 v[188:191], a[136:139], a[248:251], v[188:191]
    ds_read_b64_tr_b16 a[174:175], v30 offset:25376
    v_mfma_f32_16x16x32_bf16 v[188:191], a[140:143], a[252:255], v[188:191]
    v_mfma_f32_16x16x32_bf16 v[184:187], a[140:143], a[244:247], v[184:187]
    ds_read_b64_tr_b16 a[176:177], v30 offset:16448
    v_mfma_f32_16x16x32_bf16 v[184:187], a[136:139], a[240:243], v[184:187]
    ds_read_b64_tr_b16 a[178:179], v30 offset:18240
    v_mfma_f32_16x16x32_bf16 v[180:183], a[136:139], a[232:235], v[180:183]
    ds_read_b64_tr_b16 a[180:181], v30 offset:23616
    v_mfma_f32_16x16x32_bf16 v[180:183], a[140:143], a[236:239], v[180:183]
    ds_read_b64_tr_b16 a[182:183], v30 offset:25408
    v_mfma_f32_16x16x32_bf16 v[176:179], a[140:143], a[228:231], v[176:179]
    v_mfma_f32_16x16x32_bf16 v[176:179], a[136:139], a[224:227], v[176:179]
    ds_read_b64_tr_b16 a[184:185], v30 offset:16480
    v_mfma_f32_16x16x32_bf16 v[208:211], a[144:147], a[224:227], v[208:211]
    ds_read_b64_tr_b16 a[186:187], v30 offset:18272
    v_mfma_f32_16x16x32_bf16 v[208:211], a[148:151], a[228:231], v[208:211]
    ds_read_b64_tr_b16 a[188:189], v30 offset:23648
    v_mfma_f32_16x16x32_bf16 v[212:215], a[148:151], a[236:239], v[212:215]
    ds_read_b64_tr_b16 a[190:191], v30 offset:25440
    v_mfma_f32_16x16x32_bf16 v[212:215], a[144:147], a[232:235], v[212:215]
    v_mfma_f32_16x16x32_bf16 v[216:219], a[144:147], a[240:243], v[216:219]
    s_add_u32 s24, s24, 128
    v_mfma_f32_16x16x32_bf16 v[216:219], a[148:151], a[244:247], v[216:219]
    s_add_u32 s25, s25, 458752
    v_mfma_f32_16x16x32_bf16 v[220:223], a[148:151], a[252:255], v[220:223]
    s_add_u32 s26, s26, s27
    v_mfma_f32_16x16x32_bf16 v[220:223], a[144:147], a[248:251], v[220:223]
    s_add_u32 s33, s33, 4096
    v_mfma_f32_16x16x32_bf16 v[252:255], a[152:155], a[248:251], v[252:255]
    v_mfma_f32_16x16x32_bf16 v[252:255], a[156:159], a[252:255], v[252:255]
    v_mfma_f32_16x16x32_bf16 v[248:251], a[156:159], a[244:247], v[248:251]
    s_sub_u32 s32, s32, 1
    v_mfma_f32_16x16x32_bf16 v[248:251], a[152:155], a[240:243], v[248:251]
    s_cmp_lg_u32 s32, 0
    v_mfma_f32_16x16x32_bf16 v[244:247], a[152:155], a[232:235], v[244:247]
    v_mfma_f32_16x16x32_bf16 v[244:247], a[156:159], a[236:239], v[244:247]
    v_mfma_f32_16x16x32_bf16 v[240:243], a[156:159], a[228:231], v[240:243]
    v_mfma_f32_16x16x32_bf16 v[240:243], a[152:155], a[224:227], v[240:243]
    s_waitcnt vmcnt(2) lgkmcnt(0)
    s_barrier
    s_cbranch_scc1 K1_W0_LOOP
    v_mfma_f32_16x16x32_bf16 a[16:19], a[160:163], a[224:227], a[16:19]
    ds_read_b64_tr_b16 a[128:129], v31 offset:0
    v_mfma_f32_16x16x32_bf16 a[16:19], a[164:167], a[228:231], a[16:19]
    ds_read_b64_tr_b16 a[130:131], v31 offset:1792
    v_mfma_f32_16x16x32_bf16 a[20:23], a[164:167], a[236:239], a[20:23]
    ds_read_b64_tr_b16 a[132:133], v31 offset:7168
    v_mfma_f32_16x16x32_bf16 a[20:23], a[160:163], a[232:235], a[20:23]
    ds_read_b64_tr_b16 a[134:135], v31 offset:8960
    v_mfma_f32_16x16x32_bf16 a[24:27], a[160:163], a[240:243], a[24:27]
    v_mfma_f32_16x16x32_bf16 a[24:27], a[164:167], a[244:247], a[24:27]
    ds_read_b64_tr_b16 a[136:137], v31 offset:32
    v_mfma_f32_16x16x32_bf16 a[28:31], a[164:167], a[252:255], a[28:31]
    ds_read_b64_tr_b16 a[138:139], v31 offset:1824
    v_mfma_f32_16x16x32_bf16 a[28:31], a[160:163], a[248:251], a[28:31]
    ds_read_b64_tr_b16 a[140:141], v31 offset:7200
    v_mfma_f32_16x16x32_bf16 a[60:63], a[168:171], a[248:251], a[60:63]
    ds_read_b64_tr_b16 a[142:143], v31 offset:8992
    v_mfma_f32_16x16x32_bf16 a[60:63], a[172:175], a[252:255], a[60:63]
    v_mfma_f32_16x16x32_bf16 a[56:59], a[172:175], a[244:247], a[56:59]
    ds_read_b64_tr_b16 a[144:145], v31 offset:64
    v_mfma_f32_16x16x32_bf16 a[56:59], a[168:171], a[240:243], a[56:59]
    ds_read_b64_tr_b16 a[146:147], v31 offset:1856
    v_mfma_f32_16x16x32_bf16 a[52:55], a[168:171], a[232:235], a[52:55]
    ds_read_b64_tr_b16 a[148:149], v31 offset:7232
    v_mfma_f32_16x16x32_bf16 a[52:55], a[172:175], a[236:239], a[52:55]
    ds_read_b64_tr_b16 a[150:151], v31 offset:9024
    v_mfma_f32_16x16x32_bf16 a[48:51], a[172:175], a[228:231], a[48:51]
    v_mfma_f32_16x16x32_bf16 a[48:51], a[168:171], a[224:227], a[48:51]
    ds_read_b64_tr_b16 a[152:153], v31 offset:96
    v_mfma_f32_16x16x32_bf16 a[80:83], a[176:179], a[224:227], a[80:83]
    ds_read_b64_tr_b16 a[154:155], v31 offset:1888
    v_mfma_f32_16x16x32_bf16 a[80:83], a[180:183], a[228:231], a[80:83]
    ds_read_b64_tr_b16 a[156:157], v31 offset:7264
    v_mfma_f32_16x16x32_bf16 a[84:87], a[180:183], a[236:239], a[84:87]
    ds_read_b64_tr_b16 a[158:159], v31 offset:9056
    v_mfma_f32_16x16x32_bf16 a[84:87], a[176:179], a[232:235], a[84:87]
    v_mfma_f32_16x16x32_bf16 a[88:91], a[176:179], a[240:243], a[88:91]
    v_mfma_f32_16x16x32_bf16 a[88:91], a[180:183], a[244:247], a[88:91]
    v_mfma_f32_16x16x32_bf16 a[92:95], a[180:183], a[252:255], a[92:95]
    v_mfma_f32_16x16x32_bf16 a[92:95], a[176:179], a[248:251], a[92:95]
    v_mfma_f32_16x16x32_bf16 a[124:127], a[184:187], a[248:251], a[124:127]
    v_mfma_f32_16x16x32_bf16 a[124:127], a[188:191], a[252:255], a[124:127]
    v_mfma_f32_16x16x32_bf16 a[120:123], a[188:191], a[244:247], a[120:123]
    v_mfma_f32_16x16x32_bf16 a[120:123], a[184:187], a[240:243], a[120:123]
    v_mfma_f32_16x16x32_bf16 a[116:119], a[184:187], a[232:235], a[116:119]
    v_mfma_f32_16x16x32_bf16 a[116:119], a[188:191], a[236:239], a[116:119]
    v_mfma_f32_16x16x32_bf16 a[112:115], a[188:191], a[228:231], a[112:115]
    v_mfma_f32_16x16x32_bf16 a[112:115], a[184:187], a[224:227], a[112:115]
    v_mfma_f32_16x16x32_bf16 a[0:3], a[160:163], a[192:195], a[0:3]
    ds_read_b128 a[224:227], v28 offset:8192
    v_mfma_f32_16x16x32_bf16 a[0:3], a[164:167], a[196:199], a[0:3]
    ds_read_b128 a[228:231], v29 offset:8192
    v_mfma_f32_16x16x32_bf16 a[4:7], a[164:167], a[204:207], a[4:7]
    v_mfma_f32_16x16x32_bf16 a[4:7], a[160:163], a[200:203], a[4:7]
    ds_read_b128 a[232:235], v28 offset:10240
    v_mfma_f32_16x16x32_bf16 a[8:11], a[160:163], a[208:211], a[8:11]
    v_mfma_f32_16x16x32_bf16 a[8:11], a[164:167], a[212:215], a[8:11]
    ds_read_b128 a[236:239], v29 offset:10240
    v_mfma_f32_16x16x32_bf16 a[12:15], a[164:167], a[220:223], a[12:15]
    ds_read_b128 a[240:243], v28 offset:12288
    v_mfma_f32_16x16x32_bf16 a[12:15], a[160:163], a[216:219], a[12:15]
    v_mfma_f32_16x16x32_bf16 a[44:47], a[168:171], a[216:219], a[44:47]
    ds_read_b128 a[244:247], v29 offset:12288
    v_mfma_f32_16x16x32_bf16 a[44:47], a[172:175], a[220:223], a[44:47]
    v_mfma_f32_16x16x32_bf16 a[40:43], a[172:175], a[212:215], a[40:43]
    ds_read_b128 a[248:251], v28 offset:14336
    v_mfma_f32_16x16x32_bf16 a[40:43], a[168:171], a[208:211], a[40:43]
    ds_read_b128 a[252:255], v29 offset:14336
    v_mfma_f32_16x16x32_bf16 a[36:39], a[168:171], a[200:203], a[36:39]
    v_mfma_f32_16x16x32_bf16 a[36:39], a[172:175], a[204:207], a[36:39]
    ds_read_b64_tr_b16 v[44:45], v39 offset:0
    v_mfma_f32_16x16x32_bf16 a[32:35], a[172:175], a[196:199], a[32:35]
    v_mfma_f32_16x16x32_bf16 a[32:35], a[168:171], a[192:195], a[32:35]
    ds_read_b64_tr_b16 v[46:47], v39 offset:256
    v_mfma_f32_16x16x32_bf16 a[64:67], a[176:179], a[192:195], a[64:67]
    ds_read_b64_tr_b16 v[48:49], v39 offset:1024
    v_mfma_f32_16x16x32_bf16 a[64:67], a[180:183], a[196:199], a[64:67]
    v_mfma_f32_16x16x32_bf16 a[68:71], a[180:183], a[204:207], a[68:71]
    ds_read_b64_tr_b16 v[50:51], v39 offset:1280
    v_mfma_f32_16x16x32_bf16 a[68:71], a[176:179], a[200:203], a[68:71]
    v_mfma_f32_16x16x32_bf16 a[72:75], a[176:179], a[208:211], a[72:75]
    v_mfma_f32_16x16x32_bf16 a[72:75], a[180:183], a[212:215], a[72:75]
    v_mfma_f32_16x16x32_bf16 a[76:79], a[180:183], a[220:223], a[76:79]
    v_mfma_f32_16x16x32_bf16 a[76:79], a[176:179], a[216:219], a[76:79]
    v_mfma_f32_16x16x32_bf16 a[108:111], a[184:187], a[216:219], a[108:111]
    v_mfma_f32_16x16x32_bf16 a[108:111], a[188:191], a[220:223], a[108:111]
    v_mfma_f32_16x16x32_bf16 a[104:107], a[188:191], a[212:215], a[104:107]
    v_mfma_f32_16x16x32_bf16 a[104:107], a[184:187], a[208:211], a[104:107]
    v_mfma_f32_16x16x32_bf16 a[100:103], a[184:187], a[200:203], a[100:103]
    v_mfma_f32_16x16x32_bf16 a[100:103], a[188:191], a[204:207], a[100:103]
    v_mfma_f32_16x16x32_bf16 a[96:99], a[188:191], a[196:199], a[96:99]
    v_mfma_f32_16x16x32_bf16 a[96:99], a[184:187], a[192:195], a[96:99]
    s_waitcnt lgkmcnt(0)
    v_mfma_f32_16x16x32_bf16 v[144:147], a[128:131], a[224:227], v[144:147]
    ds_read_b128 a[192:195], v28 offset:0
    s_lshr_b32 s3, s28, 1
    v_mfma_f32_16x16x32_bf16 v[144:147], a[132:135], a[228:231], v[144:147]
    ds_read_b128 a[196:199], v29 offset:0
    s_lshl_b32 s4, s29, 1
    v_mfma_f32_16x16x32_bf16 v[148:151], a[132:135], a[236:239], v[148:151]
    s_add_u32 s3, s3, s4
    v_mfma_f32_16x16x32_bf16 v[148:151], a[128:131], a[232:235], v[148:151]
    ds_read_b128 a[200:203], v28 offset:2048
    s_lshl_b32 s85, s3, 3
    v_mfma_f32_16x16x32_bf16 v[152:155], a[128:131], a[240:243], v[152:155]
    s_lshl_b32 s3, s3, 2
    v_mfma_f32_16x16x32_bf16 v[152:155], a[132:135], a[244:247], v[152:155]
    ds_read_b128 a[204:207], v29 offset:2048
    s_lshr_b32 s4, s31, 1
    v_mfma_f32_16x16x32_bf16 v[156:159], a[132:135], a[252:255], v[156:159]
    ds_read_b128 a[208:211], v28 offset:4096
    s_add_u32 s3, s3, s4
    v_mfma_f32_16x16x32_bf16 v[156:159], a[128:131], a[248:251], v[156:159]
    s_lshl_b32 s3, s3, 12
    v_mfma_f32_16x16x32_bf16 v[188:191], a[136:139], a[248:251], v[188:191]
    ds_read_b128 a[212:215], v29 offset:4096
    s_and_b32 s4, s31, 1
    v_mfma_f32_16x16x32_bf16 v[188:191], a[140:143], a[252:255], v[188:191]
    s_and_b32 s5, s30, 1
    v_mfma_f32_16x16x32_bf16 v[184:187], a[140:143], a[244:247], v[184:187]
    ds_read_b128 a[216:219], v28 offset:6144
    s_lshl_b32 s4, s4, 7
    v_mfma_f32_16x16x32_bf16 v[184:187], a[136:139], a[240:243], v[184:187]
    ds_read_b128 a[220:223], v29 offset:6144
    s_lshl_b32 s6, s5, 3
    v_mfma_f32_16x16x32_bf16 v[180:183], a[136:139], a[232:235], v[180:183]
    s_add_u32 s3, s3, s4
    v_mfma_f32_16x16x32_bf16 v[180:183], a[140:143], a[236:239], v[180:183]
    s_add_u32 s3, s3, s6
    v_mfma_f32_16x16x32_bf16 v[176:179], a[140:143], a[228:231], v[176:179]
    s_add_u32 s3, s3, 23068672
    v_mfma_f32_16x16x32_bf16 v[176:179], a[136:139], a[224:227], v[176:179]
    s_cmp_ge_u32 s30, 16
    v_mfma_f32_16x16x32_bf16 v[208:211], a[144:147], a[224:227], v[208:211]
    s_cselect_b32 s3, 2147418112, s3
    v_mfma_f32_16x16x32_bf16 v[208:211], a[148:151], a[228:231], v[208:211]
    v_mfma_f32_16x16x32_bf16 v[212:215], a[148:151], a[236:239], v[212:215]
    v_mfma_f32_16x16x32_bf16 v[212:215], a[144:147], a[232:235], v[212:215]
    v_mfma_f32_16x16x32_bf16 v[216:219], a[144:147], a[240:243], v[216:219]
    v_mfma_f32_16x16x32_bf16 v[216:219], a[148:151], a[244:247], v[216:219]
    v_mfma_f32_16x16x32_bf16 v[220:223], a[148:151], a[252:255], v[220:223]
    v_mfma_f32_16x16x32_bf16 v[220:223], a[144:147], a[248:251], v[220:223]
    v_mfma_f32_16x16x32_bf16 v[252:255], a[152:155], a[248:251], v[252:255]
    v_mfma_f32_16x16x32_bf16 v[252:255], a[156:159], a[252:255], v[252:255]
    v_mfma_f32_16x16x32_bf16 v[248:251], a[156:159], a[244:247], v[248:251]
    v_mfma_f32_16x16x32_bf16 v[248:251], a[152:155], a[240:243], v[248:251]
    v_mfma_f32_16x16x32_bf16 v[244:247], a[152:155], a[232:235], v[244:247]
    v_mfma_f32_16x16x32_bf16 v[244:247], a[156:159], a[236:239], v[244:247]
    v_mfma_f32_16x16x32_bf16 v[240:243], a[156:159], a[228:231], v[240:243]
    v_mfma_f32_16x16x32_bf16 v[240:243], a[152:155], a[224:227], v[240:243]
    s_waitcnt lgkmcnt(0)
    v_mfma_f32_16x16x32_bf16 v[52:55], v[44:47], a[192:195], v[52:55]
    ds_read_b64_tr_b16 a[160:161], v31 offset:16384
    v_mfma_f32_16x16x32_bf16 v[52:55], v[48:51], a[196:199], v[52:55]
    ds_read_b64_tr_b16 a[162:163], v31 offset:18176
    v_mfma_f32_16x16x32_bf16 v[128:131], a[128:131], a[192:195], v[128:131]
    ds_read_b64_tr_b16 a[164:165], v31 offset:23552
    v_mfma_f32_16x16x32_bf16 v[128:131], a[132:135], a[196:199], v[128:131]
    ds_read_b64_tr_b16 a[166:167], v31 offset:25344
    v_mfma_f32_16x16x32_bf16 v[132:135], a[132:135], a[204:207], v[132:135]
    v_mfma_f32_16x16x32_bf16 v[132:135], a[128:131], a[200:203], v[132:135]
    ds_read_b64_tr_b16 a[168:169], v31 offset:16416
    v_mfma_f32_16x16x32_bf16 v[136:139], a[128:131], a[208:211], v[136:139]
    ds_read_b64_tr_b16 a[170:171], v31 offset:18208
    v_mfma_f32_16x16x32_bf16 v[136:139], a[132:135], a[212:215], v[136:139]
    ds_read_b64_tr_b16 a[172:173], v31 offset:23584
    v_mfma_f32_16x16x32_bf16 v[140:143], a[132:135], a[220:223], v[140:143]
    ds_read_b64_tr_b16 a[174:175], v31 offset:25376
    v_mfma_f32_16x16x32_bf16 v[140:143], a[128:131], a[216:219], v[140:143]
    v_mfma_f32_16x16x32_bf16 v[172:175], a[136:139], a[216:219], v[172:175]
    ds_read_b64_tr_b16 a[176:177], v31 offset:16448
    v_mfma_f32_16x16x32_bf16 v[172:175], a[140:143], a[220:223], v[172:175]
    ds_read_b64_tr_b16 a[178:179], v31 offset:18240
    v_cvt_pk_bf16_f32 v4, v52, v53
    v_mfma_f32_16x16x32_bf16 v[168:171], a[140:143], a[212:215], v[168:171]
    ds_read_b64_tr_b16 a[180:181], v31 offset:23616
    v_cvt_pk_bf16_f32 v5, v54, v55
    v_mfma_f32_16x16x32_bf16 v[168:171], a[136:139], a[208:211], v[168:171]
    ds_read_b64_tr_b16 a[182:183], v31 offset:25408
    v_mfma_f32_16x16x32_bf16 v[164:167], a[136:139], a[200:203], v[164:167]
    buffer_store_dwordx2 v[4:5], v120, s[20:23], s3 offen sc1
    v_mfma_f32_16x16x32_bf16 v[164:167], a[140:143], a[204:207], v[164:167]
    v_mfma_f32_16x16x32_bf16 v[160:163], a[140:143], a[196:199], v[160:163]
    ds_read_b64_tr_b16 a[184:185], v31 offset:16480
    v_mfma_f32_16x16x32_bf16 v[160:163], a[136:139], a[192:195], v[160:163]
    ds_read_b64_tr_b16 a[186:187], v31 offset:18272
    v_mfma_f32_16x16x32_bf16 v[192:195], a[144:147], a[192:195], v[192:195]
    ds_read_b64_tr_b16 a[188:189], v31 offset:23648
    v_mfma_f32_16x16x32_bf16 v[192:195], a[148:151], a[196:199], v[192:195]
    ds_read_b64_tr_b16 a[190:191], v31 offset:25440
    v_mfma_f32_16x16x32_bf16 v[196:199], a[148:151], a[204:207], v[196:199]
    v_mfma_f32_16x16x32_bf16 v[196:199], a[144:147], a[200:203], v[196:199]
    v_mfma_f32_16x16x32_bf16 v[200:203], a[144:147], a[208:211], v[200:203]
    v_mfma_f32_16x16x32_bf16 v[200:203], a[148:151], a[212:215], v[200:203]
    v_mfma_f32_16x16x32_bf16 v[204:207], a[148:151], a[220:223], v[204:207]
    v_mfma_f32_16x16x32_bf16 v[204:207], a[144:147], a[216:219], v[204:207]
    v_mfma_f32_16x16x32_bf16 v[236:239], a[152:155], a[216:219], v[236:239]
    v_mfma_f32_16x16x32_bf16 v[236:239], a[156:159], a[220:223], v[236:239]
    v_mfma_f32_16x16x32_bf16 v[232:235], a[156:159], a[212:215], v[232:235]
    v_mfma_f32_16x16x32_bf16 v[232:235], a[152:155], a[208:211], v[232:235]
    v_mfma_f32_16x16x32_bf16 v[228:231], a[152:155], a[200:203], v[228:231]
    v_mfma_f32_16x16x32_bf16 v[228:231], a[156:159], a[204:207], v[228:231]
    v_mfma_f32_16x16x32_bf16 v[224:227], a[156:159], a[196:199], v[224:227]
    v_mfma_f32_16x16x32_bf16 v[224:227], a[152:155], a[192:195], v[224:227]
    s_waitcnt lgkmcnt(0)
K1_W0_TAIL:
    s_mov_b32 s0, 0xbfb8aa3b
    s_mov_b32 s1, 0xbfb8aa3b
    s_nop 0
    v_pk_mul_f32 v[128:129], v[128:129], s[0:1]
    v_pk_mul_f32 v[130:131], v[130:131], s[0:1]
    v_pk_mul_f32 v[160:161], v[160:161], s[0:1]
    v_pk_mul_f32 v[162:163], v[162:163], s[0:1]
    v_pk_mul_f32 v[192:193], v[192:193], s[0:1]
    v_pk_mul_f32 v[194:195], v[194:195], s[0:1]
    v_pk_mul_f32 v[224:225], v[224:225], s[0:1]
    v_pk_mul_f32 v[226:227], v[226:227], s[0:1]
    v_pk_mul_f32 v[132:133], v[132:133], s[0:1]
    v_pk_mul_f32 v[134:135], v[134:135], s[0:1]
    v_pk_mul_f32 v[164:165], v[164:165], s[0:1]
    v_pk_mul_f32 v[166:167], v[166:167], s[0:1]
    v_pk_mul_f32 v[196:197], v[196:197], s[0:1]
    v_pk_mul_f32 v[198:199], v[198:199], s[0:1]
    v_pk_mul_f32 v[228:229], v[228:229], s[0:1]
    v_pk_mul_f32 v[230:231], v[230:231], s[0:1]
    v_pk_mul_f32 v[136:137], v[136:137], s[0:1]
    v_pk_mul_f32 v[138:139], v[138:139], s[0:1]
    v_pk_mul_f32 v[168:169], v[168:169], s[0:1]
    v_pk_mul_f32 v[170:171], v[170:171], s[0:1]
    v_pk_mul_f32 v[200:201], v[200:201], s[0:1]
    v_pk_mul_f32 v[202:203], v[202:203], s[0:1]
    v_pk_mul_f32 v[232:233], v[232:233], s[0:1]
    v_pk_mul_f32 v[234:235], v[234:235], s[0:1]
    v_pk_mul_f32 v[140:141], v[140:141], s[0:1]
    v_pk_mul_f32 v[142:143], v[142:143], s[0:1]
    v_pk_mul_f32 v[172:173], v[172:173], s[0:1]
    v_pk_mul_f32 v[174:175], v[174:175], s[0:1]
    v_pk_mul_f32 v[204:205], v[204:205], s[0:1]
    v_pk_mul_f32 v[206:207], v[206:207], s[0:1]
    v_pk_mul_f32 v[236:237], v[236:237], s[0:1]
    v_pk_mul_f32 v[238:239], v[238:239], s[0:1]
    v_mfma_f32_16x16x32_bf16 a[0:3], a[160:163], a[192:195], a[0:3]
    s_mov_b32 s10, 4194304
    v_exp_f32 v128, v128
    v_mfma_f32_16x16x32_bf16 a[0:3], a[164:167], a[196:199], a[0:3]
    s_mov_b32 s64, s60
    v_exp_f32 v129, v129
    v_mfma_f32_16x16x32_bf16 a[4:7], a[164:167], a[204:207], a[4:7]
    s_mov_b32 s65, s61
    v_exp_f32 v130, v130
    v_mfma_f32_16x16x32_bf16 a[4:7], a[160:163], a[200:203], a[4:7]
    s_movk_i32 s66, 2048
    v_exp_f32 v131, v131
    v_mfma_f32_16x16x32_bf16 a[8:11], a[160:163], a[208:211], a[8:11]
    s_lshl_b32 s3, s29, 5
    v_exp_f32 v160, v160
    v_mfma_f32_16x16x32_bf16 a[8:11], a[164:167], a[212:215], a[8:11]
    s_add_u32 s3, s3, s30
    v_exp_f32 v161, v161
    v_mfma_f32_16x16x32_bf16 a[12:15], a[164:167], a[220:223], a[12:15]
    s_lshl_b32 s3, s3, 2
    v_exp_f32 v162, v162
    v_mfma_f32_16x16x32_bf16 a[12:15], a[160:163], a[216:219], a[12:15]
    s_add_u32 s3, s3, s28
    v_exp_f32 v163, v163
    v_mfma_f32_16x16x32_bf16 a[44:47], a[168:171], a[216:219], a[44:47]
    s_lshl_b32 s51, s3, 3
    v_exp_f32 v192, v192
    v_mfma_f32_16x16x32_bf16 a[44:47], a[172:175], a[220:223], a[44:47]
    s_lshl_b32 s3, s3, 12
    v_exp_f32 v193, v193
    v_mfma_f32_16x16x32_bf16 a[40:43], a[172:175], a[212:215], a[40:43]
    s_mov_b32 s16, s68
    v_exp_f32 v194, v194
    v_mfma_f32_16x16x32_bf16 a[40:43], a[168:171], a[208:211], a[40:43]
    s_mov_b32 s17, s69
    v_exp_f32 v195, v195
    v_mfma_f32_16x16x32_bf16 a[36:39], a[168:171], a[200:203], a[36:39]
    s_movk_i32 s18, 256
    v_exp_f32 v224, v224
    v_mfma_f32_16x16x32_bf16 a[36:39], a[172:175], a[204:207], a[36:39]
    s_mul_i32 s4, s30, 7
    v_exp_f32 v225, v225
    v_mfma_f32_16x16x32_bf16 a[32:35], a[172:175], a[196:199], a[32:35]
    buffer_load_dwordx2 v[88:89], off, s[16:19], 0 sc1
    v_exp_f32 v226, v226
    v_mfma_f32_16x16x32_bf16 a[32:35], a[168:171], a[192:195], a[32:35]
    s_add_u32 s6, s4, s5
    v_exp_f32 v227, v227
    v_mfma_f32_16x16x32_bf16 a[64:67], a[176:179], a[192:195], a[64:67]
    s_lshr_b32 s6, s6, 1
    v_exp_f32 v132, v132
    v_mfma_f32_16x16x32_bf16 a[64:67], a[180:183], a[196:199], a[64:67]
    s_add_u32 s6, s6, 32
    v_exp_f32 v133, v133
    v_mfma_f32_16x16x32_bf16 a[68:71], a[180:183], a[204:207], a[68:71]
    s_lshl_b32 s48, s6, 10
    v_exp_f32 v134, v134
    v_mfma_f32_16x16x32_bf16 a[68:71], a[176:179], a[200:203], a[68:71]
    buffer_load_dwordx4 v[8:11], v92, s[8:11], s3 offen offset:0
    v_exp_f32 v135, v135
    v_mfma_f32_16x16x32_bf16 a[72:75], a[176:179], a[208:211], a[72:75]
    s_movk_i32 s49, 1024
    v_exp_f32 v164, v164
    v_mfma_f32_16x16x32_bf16 a[72:75], a[180:183], a[212:215], a[72:75]
    s_mov_b32 s50, 2147418112
    v_exp_f32 v165, v165
    v_mfma_f32_16x16x32_bf16 a[76:79], a[180:183], a[220:223], a[76:79]
    s_lshl_b32 s24, s28, 12
    v_exp_f32 v166, v166
    v_mfma_f32_16x16x32_bf16 a[76:79], a[176:179], a[216:219], a[76:79]
    s_mov_b32 s25, s24
    v_exp_f32 v167, v167
    v_mfma_f32_16x16x32_bf16 a[108:111], a[184:187], a[216:219], a[108:111]
    buffer_load_dwordx4 v[12:15], v92, s[8:11], s3 offen offset:1024
    v_exp_f32 v196, v196
    v_mfma_f32_16x16x32_bf16 a[108:111], a[188:191], a[220:223], a[108:111]
    s_mov_b32 s35, 0
    v_exp_f32 v197, v197
    v_mfma_f32_16x16x32_bf16 a[104:107], a[188:191], a[212:215], a[104:107]
    s_mov_b32 s59, 24117248
    v_exp_f32 v198, v198
    v_mfma_f32_16x16x32_bf16 a[104:107], a[184:187], a[208:211], a[104:107]
    s_lshl_b32 s26, s29, 4
    v_exp_f32 v199, v199
    v_mfma_f32_16x16x32_bf16 a[100:103], a[184:187], a[200:203], a[100:103]
    s_add_u32 s26, s26, s30
    v_exp_f32 v228, v228
    v_mfma_f32_16x16x32_bf16 a[100:103], a[188:191], a[204:207], a[100:103]
    buffer_load_dwordx4 v[16:19], v92, s[8:11], s3 offen offset:2048
    v_exp_f32 v229, v229
    v_mfma_f32_16x16x32_bf16 a[96:99], a[188:191], a[196:199], a[96:99]
    s_lshl_b32 s26, s26, 3
    v_exp_f32 v230, v230
    v_mfma_f32_16x16x32_bf16 a[96:99], a[184:187], a[192:195], a[96:99]
    s_add_u32 s26, s26, 24117248
    v_exp_f32 v231, v231
    v_mfma_f32_16x16x32_bf16 a[16:19], a[160:163], a[224:227], a[16:19]
    v_exp_f32 v136, v136
    v_mfma_f32_16x16x32_bf16 a[16:19], a[164:167], a[228:231], a[16:19]
    v_exp_f32 v137, v137
    v_mfma_f32_16x16x32_bf16 a[20:23], a[164:167], a[236:239], a[20:23]
    buffer_load_dwordx4 v[20:23], v92, s[8:11], s3 offen offset:3072
    v_exp_f32 v138, v138
    v_mfma_f32_16x16x32_bf16 a[20:23], a[160:163], a[232:235], a[20:23]
    v_exp_f32 v139, v139
    v_mfma_f32_16x16x32_bf16 a[24:27], a[160:163], a[240:243], a[24:27]
    v_exp_f32 v168, v168
    v_mfma_f32_16x16x32_bf16 a[24:27], a[164:167], a[244:247], a[24:27]
    v_exp_f32 v169, v169
    v_mfma_f32_16x16x32_bf16 a[28:31], a[164:167], a[252:255], a[28:31]
    v_exp_f32 v170, v170
    v_mfma_f32_16x16x32_bf16 a[28:31], a[160:163], a[248:251], a[28:31]
    buffer_load_dwordx4 v[56:59], v92, s[64:67], 0 offen offset:0
    v_exp_f32 v171, v171
    v_mfma_f32_16x16x32_bf16 a[60:63], a[168:171], a[248:251], a[60:63]
    v_exp_f32 v200, v200
    v_mfma_f32_16x16x32_bf16 a[60:63], a[172:175], a[252:255], a[60:63]
    v_exp_f32 v201, v201
    v_mfma_f32_16x16x32_bf16 a[56:59], a[172:175], a[244:247], a[56:59]
    v_exp_f32 v202, v202
    v_mfma_f32_16x16x32_bf16 a[56:59], a[168:171], a[240:243], a[56:59]
    v_exp_f32 v203, v203
    v_mfma_f32_16x16x32_bf16 a[52:55], a[168:171], a[232:235], a[52:55]
    buffer_load_dwordx4 v[60:63], v92, s[64:67], 0 offen offset:1024
    v_exp_f32 v232, v232
    v_mfma_f32_16x16x32_bf16 a[52:55], a[172:175], a[236:239], a[52:55]
    v_exp_f32 v233, v233
    v_mfma_f32_16x16x32_bf16 a[48:51], a[172:175], a[228:231], a[48:51]
    v_exp_f32 v234, v234
    v_mfma_f32_16x16x32_bf16 a[48:51], a[168:171], a[224:227], a[48:51]
    v_exp_f32 v235, v235
    v_mfma_f32_16x16x32_bf16 a[80:83], a[176:179], a[224:227], a[80:83]
    v_exp_f32 v140, v140
    v_mfma_f32_16x16x32_bf16 a[80:83], a[180:183], a[228:231], a[80:83]
    v_exp_f32 v141, v141
    v_mfma_f32_16x16x32_bf16 a[84:87], a[180:183], a[236:239], a[84:87]
    v_exp_f32 v142, v142
    v_mfma_f32_16x16x32_bf16 a[84:87], a[176:179], a[232:235], a[84:87]
    v_exp_f32 v143, v143
    v_mfma_f32_16x16x32_bf16 a[88:91], a[176:179], a[240:243], a[88:91]
    v_exp_f32 v172, v172
    v_mfma_f32_16x16x32_bf16 a[88:91], a[180:183], a[244:247], a[88:91]
    v_exp_f32 v173, v173
    v_mfma_f32_16x16x32_bf16 a[92:95], a[180:183], a[252:255], a[92:95]
    v_exp_f32 v174, v174
    v_mfma_f32_16x16x32_bf16 a[92:95], a[176:179], a[248:251], a[92:95]
    v_exp_f32 v175, v175
    v_mfma_f32_16x16x32_bf16 a[124:127], a[184:187], a[248:251], a[124:127]
    v_exp_f32 v204, v204
    v_mfma_f32_16x16x32_bf16 a[124:127], a[188:191], a[252:255], a[124:127]
    v_exp_f32 v205, v205
    v_mfma_f32_16x16x32_bf16 a[120:123], a[188:191], a[244:247], a[120:123]
    v_exp_f32 v206, v206
    v_mfma_f32_16x16x32_bf16 a[120:123], a[184:187], a[240:243], a[120:123]
    v_exp_f32 v207, v207
    v_mfma_f32_16x16x32_bf16 a[116:119], a[184:187], a[232:235], a[116:119]
    v_exp_f32 v236, v236
    v_mfma_f32_16x16x32_bf16 a[116:119], a[188:191], a[236:239], a[116:119]
    v_exp_f32 v237, v237
    v_mfma_f32_16x16x32_bf16 a[112:115], a[188:191], a[228:231], a[112:115]
    v_exp_f32 v238, v238
    v_mfma_f32_16x16x32_bf16 a[112:115], a[184:187], a[224:227], a[112:115]
    v_exp_f32 v239, v239
    s_waitcnt vmcnt(6)
    v_readfirstlane_b32 s46, v88
    v_readfirstlane_b32 s47, v89
    s_mov_b32 s3, 0
K_TAG0:
    s_cmp_lg_u32 s46, 0
    s_cbranch_scc0 K_TAG0_RETRY
K_TAG0_OK:
    s_barrier
    s_lshr_b32 s6, s30, 4
    s_or_b32 s6, s6, s28
    s_cmp_lg_u32 s6, 0
    s_cbranch_scc1 K_NOKVF
    s_mov_b64 exec, 1
    v_mov_b32 v2, s46
    v_mov_b32_e64 v3, s47
    buffer_store_dwordx2 v[2:3], off, s[20:23], s26 sc1
    s_mov_b64 exec, -1
K_NOKVF:
    v_accvgpr_read_b32 v68, a0
    v_accvgpr_read_b32 v69, a1
    v_accvgpr_read_b32 v70, a2
    v_accvgpr_read_b32 v71, a3
    v_accvgpr_read_b32 v72, a32
    v_accvgpr_read_b32 v73, a33
    v_accvgpr_read_b32 v74, a34
    v_pk_add_f32 v[128:129], v[128:129], 1.0 op_sel_hi:[1,0]
    v_pk_add_f32 v[130:131], v[130:131], 1.0 op_sel_hi:[1,0]
    v_pk_add_f32 v[160:161], v[160:161], 1.0 op_sel_hi:[1,0]
    v_pk_add_f32 v[162:163], v[162:163], 1.0 op_sel_hi:[1,0]
    v_rcp_f32 v128, v128
    v_rcp_f32 v129, v129
    v_rcp_f32 v130, v130
    v_rcp_f32 v131, v131
    v_rcp_f32 v160, v160
    v_rcp_f32 v161, v161
    v_rcp_f32 v162, v162
    v_rcp_f32 v163, v163
    v_accvgpr_read_b32 v75, a35
    v_pk_mul_f32 v[128:129], v[128:129], v[68:69]
    v_pk_mul_f32 v[130:131], v[130:131], v[70:71]
    v_pk_mul_f32 v[160:161], v[160:161], v[72:73]
    v_pk_mul_f32 v[162:163], v[162:163], v[74:75]
    v_cvt_pk_bf16_f32 v163, v162, v163
    v_cvt_pk_bf16_f32 v162, v160, v161
    v_cvt_pk_bf16_f32 v161, v130, v131
    v_cvt_pk_bf16_f32 v160, v128, v129
    v_accvgpr_read_b32 v76, a64
    v_accvgpr_read_b32 v77, a65
    v_accvgpr_read_b32 v78, a66
    v_accvgpr_read_b32 v79, a67
    v_accvgpr_read_b32 v80, a96
    v_accvgpr_read_b32 v81, a97
    v_accvgpr_read_b32 v82, a98
    v_pk_add_f32 v[192:193], v[192:193], 1.0 op_sel_hi:[1,0]
    v_pk_add_f32 v[194:195], v[194:195], 1.0 op_sel_hi:[1,0]
    v_pk_add_f32 v[224:225], v[224:225], 1.0 op_sel_hi:[1,0]
    v_pk_add_f32 v[226:227], v[226:227], 1.0 op_sel_hi:[1,0]
    v_rcp_f32 v192, v192
    v_rcp_f32 v193, v193
    v_rcp_f32 v194, v194
    v_rcp_f32 v195, v195
    v_rcp_f32 v224, v224
    v_rcp_f32 v225, v225
    v_rcp_f32 v226, v226
    v_rcp_f32 v227, v227
    v_accvgpr_read_b32 v83, a99
    v_pk_mul_f32 v[192:193], v[192:193], v[76:77]
    v_pk_mul_f32 v[194:195], v[194:195], v[78:79]
    v_pk_mul_f32 v[224:225], v[224:225], v[80:81]
    v_pk_mul_f32 v[226:227], v[226:227], v[82:83]
    v_cvt_pk_bf16_f32 v192, v192, v193
    v_cvt_pk_bf16_f32 v193, v194, v195
    v_cvt_pk_bf16_f32 v194, v224, v225
    v_cvt_pk_bf16_f32 v195, v226, v227
    v_accvgpr_read_b32 v68, a4
    v_accvgpr_read_b32 v69, a5
    v_accvgpr_read_b32 v70, a6
    v_accvgpr_read_b32 v71, a7
    v_accvgpr_read_b32 v72, a36
    v_accvgpr_read_b32 v73, a37
    v_accvgpr_read_b32 v74, a38
    v_pk_add_f32 v[132:133], v[132:133], 1.0 op_sel_hi:[1,0]
    v_pk_add_f32 v[134:135], v[134:135], 1.0 op_sel_hi:[1,0]
    v_pk_add_f32 v[164:165], v[164:165], 1.0 op_sel_hi:[1,0]
    v_pk_add_f32 v[166:167], v[166:167], 1.0 op_sel_hi:[1,0]
    v_rcp_f32 v132, v132
    v_rcp_f32 v133, v133
    v_rcp_f32 v134, v134
    v_rcp_f32 v135, v135
    v_rcp_f32 v164, v164
    v_rcp_f32 v165, v165
    v_rcp_f32 v166, v166
    v_rcp_f32 v167, v167
    v_accvgpr_read_b32 v75, a39
    v_pk_mul_f32 v[132:133], v[132:133], v[68:69]
    v_pk_mul_f32 v[134:135], v[134:135], v[70:71]
    v_pk_mul_f32 v[164:165], v[164:165], v[72:73]
    v_pk_mul_f32 v[166:167], v[166:167], v[74:75]
    v_cvt_pk_bf16_f32 v167, v166, v167
    v_cvt_pk_bf16_f32 v166, v164, v165
    v_cvt_pk_bf16_f32 v165, v134, v135
    v_cvt_pk_bf16_f32 v164, v132, v133
    v_accvgpr_read_b32 v76, a68
    v_accvgpr_read_b32 v77, a69
    v_accvgpr_read_b32 v78, a70
    v_accvgpr_read_b32 v79, a71
    v_accvgpr_read_b32 v80, a100
    v_accvgpr_read_b32 v81, a101
    v_accvgpr_read_b32 v82, a102
    v_pk_add_f32 v[196:197], v[196:197], 1.0 op_sel_hi:[1,0]
    v_pk_add_f32 v[198:199], v[198:199], 1.0 op_sel_hi:[1,0]
    v_pk_add_f32 v[228:229], v[228:229], 1.0 op_sel_hi:[1,0]
    v_pk_add_f32 v[230:231], v[230:231], 1.0 op_sel_hi:[1,0]
    v_rcp_f32 v196, v196
    v_rcp_f32 v197, v197
    v_rcp_f32 v198, v198
    v_rcp_f32 v199, v199
    v_rcp_f32 v228, v228
    v_rcp_f32 v229, v229
    v_rcp_f32 v230, v230
    v_rcp_f32 v231, v231
    v_accvgpr_read_b32 v83, a103
    v_pk_mul_f32 v[196:197], v[196:197], v[76:77]
    v_pk_mul_f32 v[198:199], v[198:199], v[78:79]
    v_pk_mul_f32 v[228:229], v[228:229], v[80:81]
    v_pk_mul_f32 v[230:231], v[230:231], v[82:83]
    v_cvt_pk_bf16_f32 v196, v196, v197
    v_cvt_pk_bf16_f32 v197, v198, v199
    v_cvt_pk_bf16_f32 v198, v228, v229
    v_cvt_pk_bf16_f32 v199, v230, v231
    v_accvgpr_read_b32 v68, a8
    v_accvgpr_read_b32 v69, a9
    v_accvgpr_read_b32 v70, a10
    v_accvgpr_read_b32 v71, a11
    v_accvgpr_read_b32 v72, a40
    v_accvgpr_read_b32 v73, a41
    v_accvgpr_read_b32 v74, a42
    v_pk_add_f32 v[136:137], v[136:137], 1.0 op_sel_hi:[1,0]
    v_pk_add_f32 v[138:139], v[138:139], 1.0 op_sel_hi:[1,0]
    v_pk_add_f32 v[168:169], v[168:169], 1.0 op_sel_hi:[1,0]
    v_pk_add_f32 v[170:171], v[170:171], 1.0 op_sel_hi:[1,0]
    v_rcp_f32 v136, v136
    v_rcp_f32 v137, v137
    v_rcp_f32 v138, v138
    v_rcp_f32 v139, v139
    v_rcp_f32 v168, v168
    v_rcp_f32 v169, v169
    v_rcp_f32 v170, v170
    v_rcp_f32 v171, v171
    v_accvgpr_read_b32 v75, a43
    v_pk_mul_f32 v[136:137], v[136:137], v[68:69]
    v_pk_mul_f32 v[138:139], v[138:139], v[70:71]
    v_pk_mul_f32 v[168:169], v[168:169], v[72:73]
    v_pk_mul_f32 v[170:171], v[170:171], v[74:75]
    v_cvt_pk_bf16_f32 v171, v170, v171
    v_cvt_pk_bf16_f32 v170, v168, v169
    v_cvt_pk_bf16_f32 v169, v138, v139
    v_cvt_pk_bf16_f32 v168, v136, v137
    v_accvgpr_read_b32 v76, a72
    v_accvgpr_read_b32 v77, a73
    v_accvgpr_read_b32 v78, a74
    v_accvgpr_read_b32 v79, a75
    v_accvgpr_read_b32 v80, a104
    v_accvgpr_read_b32 v81, a105
    v_accvgpr_read_b32 v82, a106
    v_pk_add_f32 v[200:201], v[200:201], 1.0 op_sel_hi:[1,0]
    v_pk_add_f32 v[202:203], v[202:203], 1.0 op_sel_hi:[1,0]
    v_pk_add_f32 v[232:233], v[232:233], 1.0 op_sel_hi:[1,0]
    v_pk_add_f32 v[234:235], v[234:235], 1.0 op_sel_hi:[1,0]
    v_rcp_f32 v200, v200
    v_rcp_f32 v201, v201
    v_rcp_f32 v202, v202
    v_rcp_f32 v203, v203
    v_rcp_f32 v232, v232
    v_rcp_f32 v233, v233
    v_rcp_f32 v234, v234
    v_rcp_f32 v235, v235
    v_accvgpr_read_b32 v83, a107
    v_pk_mul_f32 v[200:201], v[200:201], v[76:77]
    v_pk_mul_f32 v[202:203], v[202:203], v[78:79]
    v_pk_mul_f32 v[232:233], v[232:233], v[80:81]
    v_pk_mul_f32 v[234:235], v[234:235], v[82:83]
    v_cvt_pk_bf16_f32 v200, v200, v201
    v_cvt_pk_bf16_f32 v201, v202, v203
    v_cvt_pk_bf16_f32 v202, v232, v233
    v_cvt_pk_bf16_f32 v203, v234, v235
    v_accvgpr_read_b32 v68, a12
    v_accvgpr_read_b32 v69, a13
    v_accvgpr_read_b32 v70, a14
    v_accvgpr_read_b32 v71, a15
    v_accvgpr_read_b32 v72, a44
    v_accvgpr_read_b32 v73, a45
    v_accvgpr_read_b32 v74, a46
    v_pk_add_f32 v[140:141], v[140:141], 1.0 op_sel_hi:[1,0]
    v_pk_add_f32 v[142:143], v[142:143], 1.0 op_sel_hi:[1,0]
    v_pk_add_f32 v[172:173], v[172:173], 1.0 op_sel_hi:[1,0]
    v_pk_add_f32 v[174:175], v[174:175], 1.0 op_sel_hi:[1,0]
    v_rcp_f32 v140, v140
    v_rcp_f32 v141, v141
    v_rcp_f32 v142, v142
    v_rcp_f32 v143, v143
    v_rcp_f32 v172, v172
    v_rcp_f32 v173, v173
    v_rcp_f32 v174, v174
    v_rcp_f32 v175, v175
    v_accvgpr_read_b32 v75, a47
    v_pk_mul_f32 v[140:141], v[140:141], v[68:69]
    v_pk_mul_f32 v[142:143], v[142:143], v[70:71]
    v_pk_mul_f32 v[172:173], v[172:173], v[72:73]
    v_pk_mul_f32 v[174:175], v[174:175], v[74:75]
    v_cvt_pk_bf16_f32 v175, v174, v175
    v_cvt_pk_bf16_f32 v174, v172, v173
    v_cvt_pk_bf16_f32 v173, v142, v143
    v_cvt_pk_bf16_f32 v172, v140, v141
    v_accvgpr_read_b32 v76, a76
    v_accvgpr_read_b32 v77, a77
    v_accvgpr_read_b32 v78, a78
    v_accvgpr_read_b32 v79, a79
    v_accvgpr_read_b32 v80, a108
    v_accvgpr_read_b32 v81, a109
    v_accvgpr_read_b32 v82, a110
    v_pk_add_f32 v[204:205], v[204:205], 1.0 op_sel_hi:[1,0]
    v_pk_add_f32 v[206:207], v[206:207], 1.0 op_sel_hi:[1,0]
    v_pk_add_f32 v[236:237], v[236:237], 1.0 op_sel_hi:[1,0]
    v_pk_add_f32 v[238:239], v[238:239], 1.0 op_sel_hi:[1,0]
    v_rcp_f32 v204, v204
    v_rcp_f32 v205, v205
    v_rcp_f32 v206, v206
    v_rcp_f32 v207, v207
    v_rcp_f32 v236, v236
    v_rcp_f32 v237, v237
    v_rcp_f32 v238, v238
    v_rcp_f32 v239, v239
    v_accvgpr_read_b32 v83, a111
    v_pk_mul_f32 v[204:205], v[204:205], v[76:77]
    v_pk_mul_f32 v[206:207], v[206:207], v[78:79]
    v_pk_mul_f32 v[236:237], v[236:237], v[80:81]
    v_pk_mul_f32 v[238:239], v[238:239], v[82:83]
    v_cvt_pk_bf16_f32 v204, v204, v205
    v_cvt_pk_bf16_f32 v205, v206, v207
    v_cvt_pk_bf16_f32 v206, v236, v237
    v_cvt_pk_bf16_f32 v207, v238, v239
    s_waitcnt vmcnt(0)
    s_nop 0
    v_dot2_f32_bf16 v84, v8, v56, 0
    v_dot2_f32_bf16 v86, v16, v56, 0
    v_dot2_f32_bf16 v85, v9, v57, 0
    v_dot2_f32_bf16 v87, v17, v57, 0
    v_dot2_f32_bf16 v84, v10, v58, v84
    v_dot2_f32_bf16 v86, v18, v58, v86
    v_dot2_f32_bf16 v85, v11, v59, v85
    v_dot2_f32_bf16 v87, v19, v59, v87
    v_dot2_f32_bf16 v84, v12, v60, v84
    v_dot2_f32_bf16 v86, v20, v60, v86
    v_dot2_f32_bf16 v85, v13, v61, v85
    v_dot2_f32_bf16 v87, v21, v61, v87
    v_dot2_f32_bf16 v84, v14, v62, v84
    v_dot2_f32_bf16 v86, v22, v62, v86
    v_dot2_f32_bf16 v85, v15, v63, v85
    v_dot2_f32_bf16 v87, v23, v63, v87
    s_nop 2
    v_add_f32 v84, v84, v85
    v_add_f32 v85, v86, v87
    s_nop 1
    v_add_f32_dpp v84, v84, v84 quad_perm:[1,0,3,2] row_mask:0xf bank_mask:0xf
    v_add_f32_dpp v85, v85, v85 quad_perm:[1,0,3,2] row_mask:0xf bank_mask:0xf
    s_nop 1
    v_add_f32_dpp v84, v84, v84 quad_perm:[2,3,0,1] row_mask:0xf bank_mask:0xf
    v_add_f32_dpp v85, v85, v85 quad_perm:[2,3,0,1] row_mask:0xf bank_mask:0xf
    s_nop 1
    v_add_f32_dpp v84, v84, v84 row_half_mirror row_mask:0xf bank_mask:0xf
    v_add_f32_dpp v85, v85, v85 row_half_mirror row_mask:0xf bank_mask:0xf
    s_nop 1
    v_add_f32_dpp v84, v84, v84 row_mirror row_mask:0xf bank_mask:0xf
    v_add_f32_dpp v85, v85, v85 row_mirror row_mask:0xf bank_mask:0xf
    s_nop 1
    v_add_f32_dpp v84, v84, v84 row_bcast:15 row_mask:0xa bank_mask:0xf
    v_add_f32_dpp v85, v85, v85 row_bcast:15 row_mask:0xa bank_mask:0xf
    s_nop 1
    v_add_f32_dpp v84, v84, v84 row_bcast:31 row_mask:0xc bank_mask:0xf
    v_add_f32_dpp v85, v85, v85 row_bcast:31 row_mask:0xc bank_mask:0xf
    v_cvt_pk_bf16_f32 v86, v84, v85
    v_lshlrev_b32 v84, 16, v86
    v_and_b32 v85, 0xffff0000, v86
    v_pk_mul_f32 v[84:85], v[84:85], s[0:1]
    v_exp_f32 v84, v84
    v_exp_f32 v85, v85
    s_nop 0
    v_pk_add_f32 v[84:85], v[84:85], 1.0 op_sel_hi:[1,0]
    v_rcp_f32 v84, v84
    v_rcp_f32 v85, v85
    s_nop 0
    v_cvt_pk_bf16_f32 v86, v84, v85
    v_lshlrev_b32 v84, 16, v86
    v_and_b32 v85, 0xffff0000, v86
    v_sub_f32 v86, 1.0, v84
    v_sub_f32 v87, 1.0, v85
    v_cvt_pk_bf16_f32 v87, v86, v87
    v_lshlrev_b32_e64 v86, 16, v87
    v_and_b32 v87, 0xffff0000, v87
    s_add_u32 s8, s62, 23068672
    s_addc_u32 s9, s63, 0
    s_mov_b32 s10, 0x40000
    v_pk_mul_f32 v[144:145], v[144:145], s[0:1]
    v_pk_mul_f32 v[146:147], v[146:147], s[0:1]
    v_pk_mul_f32 v[176:177], v[176:177], s[0:1]
    v_pk_mul_f32 v[178:179], v[178:179], s[0:1]
    v_exp_f32 v144, v144
    v_exp_f32 v145, v145
    v_exp_f32 v146, v146
    v_exp_f32 v147, v147
    v_exp_f32 v176, v176
    v_exp_f32 v177, v177
    v_exp_f32 v178, v178
    v_exp_f32 v179, v179
    v_accvgpr_read_b32 v68, a16
    v_accvgpr_read_b32 v69, a17
    v_accvgpr_read_b32 v70, a18
    v_accvgpr_read_b32 v71, a19
    v_accvgpr_read_b32 v72, a48
    v_accvgpr_read_b32 v73, a49
    v_accvgpr_read_b32 v74, a50
    v_pk_add_f32 v[144:145], v[144:145], 1.0 op_sel_hi:[1,0]
    v_pk_add_f32 v[146:147], v[146:147], 1.0 op_sel_hi:[1,0]
    v_pk_add_f32 v[176:177], v[176:177], 1.0 op_sel_hi:[1,0]
    v_pk_add_f32 v[178:179], v[178:179], 1.0 op_sel_hi:[1,0]
    v_rcp_f32 v144, v144
    v_rcp_f32 v145, v145
    v_rcp_f32 v146, v146
    v_rcp_f32 v147, v147
    v_rcp_f32 v176, v176
    v_rcp_f32 v177, v177
    v_rcp_f32 v178, v178
    v_rcp_f32 v179, v179
    v_accvgpr_read_b32 v75, a51
    v_pk_mul_f32 v[144:145], v[144:145], v[68:69]
    v_pk_mul_f32 v[146:147], v[146:147], v[70:71]
    v_pk_mul_f32 v[176:177], v[176:177], v[72:73]
    v_pk_mul_f32 v[178:179], v[178:179], v[74:75]
    v_cvt_pk_bf16_f32 v179, v178, v179
    v_cvt_pk_bf16_f32 v178, v176, v177
    v_cvt_pk_bf16_f32 v177, v146, v147
    v_cvt_pk_bf16_f32 v176, v144, v145
    v_pk_mul_f32 v[208:209], v[208:209], s[0:1]
    v_pk_mul_f32 v[210:211], v[210:211], s[0:1]
    v_pk_mul_f32 v[240:241], v[240:241], s[0:1]
    v_pk_mul_f32 v[242:243], v[242:243], s[0:1]
    v_exp_f32 v208, v208
    v_exp_f32 v209, v209
    v_exp_f32 v210, v210
    v_exp_f32 v211, v211
    v_exp_f32 v240, v240
    v_exp_f32 v241, v241
    v_exp_f32 v242, v242
    v_exp_f32 v243, v243
    v_accvgpr_read_b32 v76, a80
    v_accvgpr_read_b32 v77, a81
    v_accvgpr_read_b32 v78, a82
    v_accvgpr_read_b32 v79, a83
    v_accvgpr_read_b32 v80, a112
    v_accvgpr_read_b32 v81, a113
    v_accvgpr_read_b32 v82, a114
    v_pk_add_f32 v[208:209], v[208:209], 1.0 op_sel_hi:[1,0]
    v_pk_add_f32 v[210:211], v[210:211], 1.0 op_sel_hi:[1,0]
    v_pk_add_f32 v[240:241], v[240:241], 1.0 op_sel_hi:[1,0]
    v_pk_add_f32 v[242:243], v[242:243], 1.0 op_sel_hi:[1,0]
    v_rcp_f32 v208, v208
    v_rcp_f32 v209, v209
    v_rcp_f32 v210, v210
    v_rcp_f32 v211, v211
    v_rcp_f32 v240, v240
    v_rcp_f32 v241, v241
    v_rcp_f32 v242, v242
    v_rcp_f32 v243, v243
    v_accvgpr_read_b32 v83, a115
    v_pk_mul_f32 v[208:209], v[208:209], v[76:77]
    v_pk_mul_f32 v[210:211], v[210:211], v[78:79]
    v_pk_mul_f32 v[240:241], v[240:241], v[80:81]
    v_pk_mul_f32 v[242:243], v[242:243], v[82:83]
    v_cvt_pk_bf16_f32 v208, v208, v209
    v_cvt_pk_bf16_f32 v209, v210, v211
    v_cvt_pk_bf16_f32 v210, v240, v241
    v_cvt_pk_bf16_f32 v211, v242, v243
    v_pk_mul_f32 v[148:149], v[148:149], s[0:1]
    v_pk_mul_f32 v[150:151], v[150:151], s[0:1]
    v_pk_mul_f32 v[180:181], v[180:181], s[0:1]
    v_pk_mul_f32 v[182:183], v[182:183], s[0:1]
    v_exp_f32 v148, v148
    v_exp_f32 v149, v149
    v_exp_f32 v150, v150
    v_exp_f32 v151, v151
    v_exp_f32 v180, v180
    v_exp_f32 v181, v181
    v_exp_f32 v182, v182
    v_exp_f32 v183, v183
    v_accvgpr_read_b32 v68, a20
    v_accvgpr_read_b32 v69, a21
    v_accvgpr_read_b32 v70, a22
    v_accvgpr_read_b32 v71, a23
    v_accvgpr_read_b32 v72, a52
    v_accvgpr_read_b32 v73, a53
    v_accvgpr_read_b32 v74, a54
    v_pk_add_f32 v[148:149], v[148:149], 1.0 op_sel_hi:[1,0]
    v_pk_add_f32 v[150:151], v[150:151], 1.0 op_sel_hi:[1,0]
    v_pk_add_f32 v[180:181], v[180:181], 1.0 op_sel_hi:[1,0]
    v_pk_add_f32 v[182:183], v[182:183], 1.0 op_sel_hi:[1,0]
    v_rcp_f32 v148, v148
    v_rcp_f32 v149, v149
    v_rcp_f32 v150, v150
    v_rcp_f32 v151, v151
    v_rcp_f32 v180, v180
    v_rcp_f32 v181, v181
    v_rcp_f32 v182, v182
    v_rcp_f32 v183, v183
    v_accvgpr_read_b32 v75, a55
    v_pk_mul_f32 v[148:149], v[148:149], v[68:69]
    v_pk_mul_f32 v[150:151], v[150:151], v[70:71]
    v_pk_mul_f32 v[180:181], v[180:181], v[72:73]
    v_pk_mul_f32 v[182:183], v[182:183], v[74:75]
    v_cvt_pk_bf16_f32 v183, v182, v183
    v_cvt_pk_bf16_f32 v182, v180, v181
    v_cvt_pk_bf16_f32 v181, v150, v151
    v_cvt_pk_bf16_f32 v180, v148, v149
    v_pk_mul_f32 v[212:213], v[212:213], s[0:1]
    v_pk_mul_f32 v[214:215], v[214:215], s[0:1]
    v_pk_mul_f32 v[244:245], v[244:245], s[0:1]
    v_pk_mul_f32 v[246:247], v[246:247], s[0:1]
    v_exp_f32 v212, v212
    v_exp_f32 v213, v213
    v_exp_f32 v214, v214
    v_exp_f32 v215, v215
    v_exp_f32 v244, v244
    v_exp_f32 v245, v245
    v_exp_f32 v246, v246
    v_exp_f32 v247, v247
    v_accvgpr_read_b32 v76, a84
    v_accvgpr_read_b32 v77, a85
    v_accvgpr_read_b32 v78, a86
    v_accvgpr_read_b32 v79, a87
    v_accvgpr_read_b32 v80, a116
    v_accvgpr_read_b32 v81, a117
    v_accvgpr_read_b32 v82, a118
    v_pk_add_f32 v[212:213], v[212:213], 1.0 op_sel_hi:[1,0]
    v_pk_add_f32 v[214:215], v[214:215], 1.0 op_sel_hi:[1,0]
    v_pk_add_f32 v[244:245], v[244:245], 1.0 op_sel_hi:[1,0]
    v_pk_add_f32 v[246:247], v[246:247], 1.0 op_sel_hi:[1,0]
    v_rcp_f32 v212, v212
    v_rcp_f32 v213, v213
    v_rcp_f32 v214, v214
    v_rcp_f32 v215, v215
    v_rcp_f32 v244, v244
    v_rcp_f32 v245, v245
    v_rcp_f32 v246, v246
    v_rcp_f32 v247, v247
    v_accvgpr_read_b32 v83, a119
    v_pk_mul_f32 v[212:213], v[212:213], v[76:77]
    v_pk_mul_f32 v[214:215], v[214:215], v[78:79]
    v_pk_mul_f32 v[244:245], v[244:245], v[80:81]
    v_pk_mul_f32 v[246:247], v[246:247], v[82:83]
    v_cvt_pk_bf16_f32 v212, v212, v213
    v_cvt_pk_bf16_f32 v213, v214, v215
    v_cvt_pk_bf16_f32 v214, v244, v245
    v_cvt_pk_bf16_f32 v215, v246, v247
    buffer_load_dwordx4 v[88:91], v92, s[20:23], s59 offen sc1
    v_pk_mul_f32 v[152:153], v[152:153], s[0:1]
    v_pk_mul_f32 v[154:155], v[154:155], s[0:1]
    v_pk_mul_f32 v[184:185], v[184:185], s[0:1]
    v_pk_mul_f32 v[186:187], v[186:187], s[0:1]
    v_exp_f32 v152, v152
    v_exp_f32 v153, v153
    v_exp_f32 v154, v154
    v_exp_f32 v155, v155
    v_exp_f32 v184, v184
    v_exp_f32 v185, v185
    v_exp_f32 v186, v186
    v_exp_f32 v187, v187
    v_accvgpr_read_b32 v68, a24
    v_accvgpr_read_b32 v69, a25
    v_accvgpr_read_b32 v70, a26
    v_accvgpr_read_b32 v71, a27
    v_accvgpr_read_b32 v72, a56
    v_accvgpr_read_b32 v73, a57
    v_accvgpr_read_b32 v74, a58
    v_pk_add_f32 v[152:153], v[152:153], 1.0 op_sel_hi:[1,0]
    v_pk_add_f32 v[154:155], v[154:155], 1.0 op_sel_hi:[1,0]
    v_pk_add_f32 v[184:185], v[184:185], 1.0 op_sel_hi:[1,0]
    v_pk_add_f32 v[186:187], v[186:187], 1.0 op_sel_hi:[1,0]
    v_rcp_f32 v152, v152
    v_rcp_f32 v153, v153
    v_rcp_f32 v154, v154
    v_rcp_f32 v155, v155
    v_rcp_f32 v184, v184
    v_rcp_f32 v185, v185
    v_rcp_f32 v186, v186
    v_rcp_f32 v187, v187
    v_accvgpr_read_b32 v75, a59
    v_pk_mul_f32 v[152:153], v[152:153], v[68:69]
    v_pk_mul_f32 v[154:155], v[154:155], v[70:71]
    v_pk_mul_f32 v[184:185], v[184:185], v[72:73]
    v_pk_mul_f32 v[186:187], v[186:187], v[74:75]
    v_cvt_pk_bf16_f32 v187, v186, v187
    v_cvt_pk_bf16_f32 v186, v184, v185
    v_cvt_pk_bf16_f32 v185, v154, v155
    v_cvt_pk_bf16_f32 v184, v152, v153
    v_pk_mul_f32 v[216:217], v[216:217], s[0:1]
    v_pk_mul_f32 v[218:219], v[218:219], s[0:1]
    v_pk_mul_f32 v[248:249], v[248:249], s[0:1]
    v_pk_mul_f32 v[250:251], v[250:251], s[0:1]
    v_exp_f32 v216, v216
    v_exp_f32 v217, v217
    v_exp_f32 v218, v218
    v_exp_f32 v219, v219
    v_exp_f32 v248, v248
    v_exp_f32 v249, v249
    v_exp_f32 v250, v250
    v_exp_f32 v251, v251
    v_accvgpr_read_b32 v76, a88
    v_accvgpr_read_b32 v77, a89
    v_accvgpr_read_b32 v78, a90
    v_accvgpr_read_b32 v79, a91
    v_accvgpr_read_b32 v80, a120
    v_accvgpr_read_b32 v81, a121
    v_accvgpr_read_b32 v82, a122
    v_pk_add_f32 v[216:217], v[216:217], 1.0 op_sel_hi:[1,0]
    v_pk_add_f32 v[218:219], v[218:219], 1.0 op_sel_hi:[1,0]
    v_pk_add_f32 v[248:249], v[248:249], 1.0 op_sel_hi:[1,0]
    v_pk_add_f32 v[250:251], v[250:251], 1.0 op_sel_hi:[1,0]
    v_rcp_f32 v216, v216
    v_rcp_f32 v217, v217
    v_rcp_f32 v218, v218
    v_rcp_f32 v219, v219
    v_rcp_f32 v248, v248
    v_rcp_f32 v249, v249
    v_rcp_f32 v250, v250
    v_rcp_f32 v251, v251
    v_accvgpr_read_b32 v83, a123
    v_pk_mul_f32 v[216:217], v[216:217], v[76:77]
    v_pk_mul_f32 v[218:219], v[218:219], v[78:79]
    v_pk_mul_f32 v[248:249], v[248:249], v[80:81]
    v_pk_mul_f32 v[250:251], v[250:251], v[82:83]
    v_cvt_pk_bf16_f32 v216, v216, v217
    v_cvt_pk_bf16_f32 v217, v218, v219
    v_cvt_pk_bf16_f32 v218, v248, v249
    v_cvt_pk_bf16_f32 v219, v250, v251
    v_pk_mul_f32 v[156:157], v[156:157], s[0:1]
    v_pk_mul_f32 v[158:159], v[158:159], s[0:1]
    v_pk_mul_f32 v[188:189], v[188:189], s[0:1]
    v_pk_mul_f32 v[190:191], v[190:191], s[0:1]
    v_exp_f32 v156, v156
    v_exp_f32 v157, v157
    v_exp_f32 v158, v158
    v_exp_f32 v159, v159
    v_exp_f32 v188, v188
    v_exp_f32 v189, v189
    v_exp_f32 v190, v190
    v_exp_f32 v191, v191
    v_accvgpr_read_b32 v68, a28
    v_accvgpr_read_b32 v69, a29
    v_accvgpr_read_b32 v70, a30
    v_accvgpr_read_b32 v71, a31
    v_accvgpr_read_b32 v72, a60
    v_accvgpr_read_b32 v73, a61
    v_accvgpr_read_b32 v74, a62
    v_pk_add_f32 v[156:157], v[156:157], 1.0 op_sel_hi:[1,0]
    v_pk_add_f32 v[158:159], v[158:159], 1.0 op_sel_hi:[1,0]
    v_pk_add_f32 v[188:189], v[188:189], 1.0 op_sel_hi:[1,0]
    v_pk_add_f32 v[190:191], v[190:191], 1.0 op_sel_hi:[1,0]
    v_rcp_f32 v156, v156
    v_rcp_f32 v157, v157
    v_rcp_f32 v158, v158
    v_rcp_f32 v159, v159
    v_rcp_f32 v188, v188
    v_rcp_f32 v189, v189
    v_rcp_f32 v190, v190
    v_rcp_f32 v191, v191
    v_accvgpr_read_b32 v75, a63
    v_pk_mul_f32 v[156:157], v[156:157], v[68:69]
    v_pk_mul_f32 v[158:159], v[158:159], v[70:71]
    v_pk_mul_f32 v[188:189], v[188:189], v[72:73]
    v_pk_mul_f32 v[190:191], v[190:191], v[74:75]
    v_cvt_pk_bf16_f32 v191, v190, v191
    v_cvt_pk_bf16_f32 v190, v188, v189
    v_cvt_pk_bf16_f32 v189, v158, v159
    v_cvt_pk_bf16_f32 v188, v156, v157
    s_mov_b32 s3, 0
    s_waitcnt vmcnt(0)
K_SPIN_KV0:
    v_cmp_ne_u64 vcc, s[46:47], v[88:89]
    v_cmp_ne_u64 s[4:5], s[46:47], v[90:91]
    s_nop 4
    s_or_b64 vcc, vcc, s[4:5]
    s_cmp_eq_u64 vcc, 0
    s_cbranch_scc0 K_SPIN_KV0_RETRY
K_SPIN_KV0_OK:
    s_add_u32 m0, s25, 32768
    s_nop 0
    buffer_load_dwordx4 v92, s[8:11], s24 offen offset:0 sc1 lds
    buffer_load_dwordx4 v92, s[8:11], s24 offen offset:1024 sc1 lds
    buffer_load_dwordx4 v92, s[8:11], s24 offen offset:2048 sc1 lds
    buffer_load_dwordx4 v92, s[8:11], s24 offen offset:3072 sc1 lds
    s_add_u32 s24, s24, 16384
    s_add_u32 s25, s25, 16384
    s_and_b32 s25, s25, 131071
    s_add_u32 m0, s25, 32768
    s_nop 0
    buffer_load_dwordx4 v92, s[8:11], s24 offen offset:0 sc1 lds
    buffer_load_dwordx4 v92, s[8:11], s24 offen offset:1024 sc1 lds
    buffer_load_dwordx4 v92, s[8:11], s24 offen offset:2048 sc1 lds
    buffer_load_dwordx4 v92, s[8:11], s24 offen offset:3072 sc1 lds
    s_add_u32 s24, s24, 16384
    s_add_u32 s25, s25, 16384
    s_and_b32 s25, s25, 131071
    v_pk_mul_f32 v[220:221], v[220:221], s[0:1]
    v_pk_mul_f32 v[222:223], v[222:223], s[0:1]
    v_pk_mul_f32 v[252:253], v[252:253], s[0:1]
    v_pk_mul_f32 v[254:255], v[254:255], s[0:1]
    v_exp_f32 v220, v220
    v_exp_f32 v221, v221
    v_exp_f32 v222, v222
    v_exp_f32 v223, v223
    v_exp_f32 v252, v252
    v_exp_f32 v253, v253
    v_exp_f32 v254, v254
    v_exp_f32_e64 v255, v255
    v_accvgpr_read_b32 v76, a92
    v_accvgpr_read_b32 v77, a93
    v_accvgpr_read_b32 v78, a94
    v_accvgpr_read_b32 v79, a95
    v_accvgpr_read_b32 v80, a124
    v_accvgpr_read_b32 v81, a125
    v_accvgpr_read_b32 v82, a126
    v_pk_add_f32 v[220:221], v[220:221], 1.0 op_sel_hi:[1,0]
    v_pk_add_f32 v[222:223], v[222:223], 1.0 op_sel_hi:[1,0]
    v_pk_add_f32 v[252:253], v[252:253], 1.0 op_sel_hi:[1,0]
    v_pk_add_f32 v[254:255], v[254:255], 1.0 op_sel_hi:[1,0]
    v_rcp_f32 v220, v220
    v_rcp_f32 v221, v221
    v_rcp_f32 v222, v222
    v_rcp_f32 v223, v223
    v_rcp_f32 v252, v252
    v_rcp_f32 v253, v253
    v_rcp_f32 v254, v254
    v_rcp_f32 v255, v255
    v_accvgpr_read_b32 v83, a127
    v_pk_mul_f32 v[220:221], v[220:221], v[76:77]
    v_pk_mul_f32 v[222:223], v[222:223], v[78:79]
    v_pk_mul_f32 v[252:253], v[252:253], v[80:81]
    v_pk_mul_f32 v[254:255], v[254:255], v[82:83]
    v_cvt_pk_bf16_f32 v220, v220, v221
    v_cvt_pk_bf16_f32 v221, v222, v223
    v_cvt_pk_bf16_f32 v222, v252, v253
    v_cvt_pk_bf16_f32 v223, v254, v255
    s_branch K_P2
K1_W1:
    ds_read_b64_tr_b16 a[128:129], v30 offset:0
    ds_read_b64_tr_b16 a[130:131], v30 offset:1792
    ds_read_b64_tr_b16 a[132:133], v30 offset:7168
    ds_read_b64_tr_b16 a[134:135], v30 offset:8960
    ds_read_b64_tr_b16 a[136:137], v30 offset:32
    ds_read_b64_tr_b16 a[138:139], v30 offset:1824
    ds_read_b64_tr_b16 a[140:141], v30 offset:7200
    ds_read_b64_tr_b16 a[142:143], v30 offset:8992
    ds_read_b64_tr_b16 a[144:145], v32 offset:0
    ds_read_b64_tr_b16 a[146:147], v32 offset:1792
    ds_read_b64_tr_b16 a[148:149], v32 offset:7168
    ds_read_b64_tr_b16 a[150:151], v32 offset:8960
    ds_read_b64_tr_b16 a[152:153], v34 offset:0
    ds_read_b64_tr_b16 a[154:155], v34 offset:256
    ds_read_b64_tr_b16 a[156:157], v34 offset:16384
    ds_read_b64_tr_b16 a[158:159], v34 offset:16640
    ds_read_b128 a[192:195], v26 offset:0
    ds_read_b128 a[196:199], v27 offset:0
    ds_read_b128 a[200:203], v26 offset:2048
    ds_read_b128 a[204:207], v27 offset:2048
    ds_read_b128 a[208:211], v26 offset:4096
    ds_read_b128 a[212:215], v27 offset:4096
    ds_read_b128 a[216:219], v26 offset:6144
    ds_read_b128 a[220:223], v27 offset:6144
    ds_read_b64_tr_b16 v[44:45], v38 offset:0
    ds_read_b64_tr_b16 v[46:47], v38 offset:256
    ds_read_b64_tr_b16 v[48:49], v38 offset:1024
    ds_read_b64_tr_b16 v[50:51], v38 offset:1280
    s_waitcnt lgkmcnt(0)
    v_mfma_f32_16x16x32_bf16 v[128:131], a[128:131], a[192:195], 0
    ds_read_b128 a[224:227], v26 offset:8192
    v_mfma_f32_16x16x32_bf16 v[128:131], a[132:135], a[196:199], v[128:131]
    buffer_load_dword v125, v41, s[12:15], 0 offen
    v_mfma_f32_16x16x32_bf16 v[132:135], a[132:135], a[204:207], 0
    ds_read_b128 a[228:231], v27 offset:8192
    v_mfma_f32_16x16x32_bf16 v[132:135], a[128:131], a[200:203], v[132:135]
    v_mfma_f32_16x16x32_bf16 v[136:139], a[128:131], a[208:211], 0
    ds_read_b128 a[232:235], v26 offset:10240
    v_mfma_f32_16x16x32_bf16 v[136:139], a[132:135], a[212:215], v[136:139]
    v_mfma_f32_16x16x32_bf16 v[140:143], a[132:135], a[220:223], 0
    ds_read_b128 a[236:239], v27 offset:10240
    v_mfma_f32_16x16x32_bf16 v[140:143], a[128:131], a[216:219], v[140:143]
    ds_read_b128 a[240:243], v26 offset:12288
    v_mfma_f32_16x16x32_bf16 v[172:175], a[136:139], a[216:219], 0
    v_mfma_f32_16x16x32_bf16 v[172:175], a[140:143], a[220:223], v[172:175]
    ds_read_b128 a[244:247], v27 offset:12288
    v_mfma_f32_16x16x32_bf16 v[168:171], a[140:143], a[212:215], 0
    v_mfma_f32_16x16x32_bf16 v[168:171], a[136:139], a[208:211], v[168:171]
    ds_read_b128 a[248:251], v26 offset:14336
    v_mfma_f32_16x16x32_bf16 v[164:167], a[136:139], a[200:203], 0
    ds_read_b128 a[252:255], v27 offset:14336
    v_mfma_f32_16x16x32_bf16 v[164:167], a[140:143], a[204:207], v[164:167]
    buffer_load_dword v126, v42, s[16:19], 0 offen
    v_mfma_f32_16x16x32_bf16 v[160:163], a[140:143], a[196:199], 0
    v_mfma_f32_16x16x32_bf16 v[160:163], a[136:139], a[192:195], v[160:163]
    v_mfma_f32_16x16x32_bf16 v[192:195], a[144:147], a[192:195], 0
    v_mfma_f32_16x16x32_bf16 v[192:195], a[148:151], a[196:199], v[192:195]
    v_mfma_f32_16x16x32_bf16 v[196:199], a[148:151], a[204:207], 0
    v_mfma_f32_16x16x32_bf16 v[196:199], a[144:147], a[200:203], v[196:199]
    v_mfma_f32_16x16x32_bf16 v[200:203], a[144:147], a[208:211], 0
    v_mfma_f32_16x16x32_bf16 v[200:203], a[148:151], a[212:215], v[200:203]
    v_mfma_f32_16x16x32_bf16 v[204:207], a[148:151], a[220:223], 0
    v_mfma_f32_16x16x32_bf16 v[204:207], a[144:147], a[216:219], v[204:207]
    v_mfma_f32_16x16x32_bf16 v[236:239], a[152:155], a[216:219], 0
    v_mfma_f32_16x16x32_bf16 v[236:239], a[156:159], a[220:223], v[236:239]
    buffer_load_dword v124, v25, s[8:11], 0 offen offset:256
    v_mfma_f32_16x16x32_bf16 v[232:235], a[156:159], a[212:215], 0
    v_mfma_f32_16x16x32_bf16 v[232:235], a[152:155], a[208:211], v[232:235]
    v_mfma_f32_16x16x32_bf16 v[228:231], a[152:155], a[200:203], 0
    v_mfma_f32_16x16x32_bf16 v[228:231], a[156:159], a[204:207], v[228:231]
    v_mfma_f32_16x16x32_bf16 v[224:227], a[156:159], a[196:199], 0
    v_mfma_f32_16x16x32_bf16 v[224:227], a[152:155], a[192:195], v[224:227]
    v_mfma_f32_16x16x32_bf16 v[52:55], a[192:195], v[44:47], 0
    v_mfma_f32_16x16x32_bf16 v[52:55], a[196:199], v[48:51], v[52:55]
    s_waitcnt lgkmcnt(0)
    v_mfma_f32_16x16x32_bf16 v[144:147], a[128:131], a[224:227], 0
    ds_read_b64_tr_b16 a[160:161], v30 offset:16384
    v_mfma_f32_16x16x32_bf16 v[144:147], a[132:135], a[228:231], v[144:147]
    ds_read_b64_tr_b16 a[162:163], v30 offset:18176
    v_mfma_f32_16x16x32_bf16 v[148:151], a[132:135], a[236:239], 0
    ds_read_b64_tr_b16 a[164:165], v30 offset:23552
    v_mfma_f32_16x16x32_bf16 v[148:151], a[128:131], a[232:235], v[148:151]
    ds_read_b64_tr_b16 a[166:167], v30 offset:25344
    v_mfma_f32_16x16x32_bf16 v[152:155], a[128:131], a[240:243], 0
    v_mfma_f32_16x16x32_bf16 v[152:155], a[132:135], a[244:247], v[152:155]
    buffer_load_dword v127, v43, s[64:67], s34 offen
    v_mfma_f32_16x16x32_bf16 v[156:159], a[132:135], a[252:255], 0
    ds_read_b64_tr_b16 a[168:169], v30 offset:16416
    v_mfma_f32_16x16x32_bf16 v[156:159], a[128:131], a[248:251], v[156:159]
    ds_read_b64_tr_b16 a[170:171], v30 offset:18208
    v_mfma_f32_16x16x32_bf16 v[188:191], a[136:139], a[248:251], 0
    ds_read_b64_tr_b16 a[172:173], v30 offset:23584
    v_mfma_f32_16x16x32_bf16 v[188:191], a[140:143], a[252:255], v[188:191]
    ds_read_b64_tr_b16 a[174:175], v30 offset:25376
    v_mfma_f32_16x16x32_bf16 v[184:187], a[140:143], a[244:247], 0
    v_mfma_f32_16x16x32_bf16 v[184:187], a[136:139], a[240:243], v[184:187]
    ds_read_b64_tr_b16 a[176:177], v32 offset:16384
    v_mfma_f32_16x16x32_bf16 v[180:183], a[136:139], a[232:235], 0
    ds_read_b64_tr_b16 a[178:179], v32 offset:18176
    v_mfma_f32_16x16x32_bf16 v[180:183], a[140:143], a[236:239], v[180:183]
    ds_read_b64_tr_b16 a[180:181], v32 offset:23552
    v_mfma_f32_16x16x32_bf16 v[176:179], a[140:143], a[228:231], 0
    ds_read_b64_tr_b16 a[182:183], v32 offset:25344
    v_mfma_f32_16x16x32_bf16 v[176:179], a[136:139], a[224:227], v[176:179]
    v_mfma_f32_16x16x32_bf16 v[208:211], a[144:147], a[224:227], 0
    ds_read_b64_tr_b16 a[184:185], v36 offset:0
    v_mfma_f32_16x16x32_bf16 v[208:211], a[148:151], a[228:231], v[208:211]
    ds_read_b64_tr_b16 a[186:187], v36 offset:256
    v_mfma_f32_16x16x32_bf16 v[212:215], a[148:151], a[236:239], 0
    ds_read_b64_tr_b16 a[188:189], v36 offset:16384
    v_mfma_f32_16x16x32_bf16 v[212:215], a[144:147], a[232:235], v[212:215]
    ds_read_b64_tr_b16 a[190:191], v36 offset:16640
    v_mfma_f32_16x16x32_bf16 v[216:219], a[144:147], a[240:243], 0
    s_add_u32 s24, s24, 128
    v_mfma_f32_16x16x32_bf16 v[216:219], a[148:151], a[244:247], v[216:219]
    s_add_u32 s25, s25, 458752
    v_mfma_f32_16x16x32_bf16 v[220:223], a[148:151], a[252:255], 0
    s_add_u32 s26, s26, s27
    v_mfma_f32_16x16x32_bf16 v[220:223], a[144:147], a[248:251], v[220:223]
    s_add_u32 s33, s33, 4096
    v_mfma_f32_16x16x32_bf16 v[252:255], a[152:155], a[248:251], 0
    v_mfma_f32_16x16x32_bf16 v[252:255], a[156:159], a[252:255], v[252:255]
    v_mfma_f32_16x16x32_bf16 v[248:251], a[156:159], a[244:247], 0
    v_mfma_f32_16x16x32_bf16 v[248:251], a[152:155], a[240:243], v[248:251]
    v_mfma_f32_16x16x32_bf16 v[244:247], a[152:155], a[232:235], 0
    v_mfma_f32_16x16x32_bf16 v[244:247], a[156:159], a[236:239], v[244:247]
    v_mfma_f32_16x16x32_bf16 v[240:243], a[156:159], a[228:231], 0
    v_mfma_f32_16x16x32_bf16 v[240:243], a[152:155], a[224:227], v[240:243]
    s_waitcnt vmcnt(4) lgkmcnt(0)
    s_barrier
    s_cmp_ge_u32 s30, 16
    s_cbranch_scc1 K1_W1_LOOPB
.p2align 6
K1_W1_LOOP:
    v_mfma_f32_16x16x32_bf16 a[16:19], a[160:163], a[224:227], a[16:19]
    ds_read_b64_tr_b16 a[128:129], v31 offset:0
    v_mfma_f32_16x16x32_bf16 a[16:19], a[164:167], a[228:231], a[16:19]
    ds_read_b64_tr_b16 a[130:131], v31 offset:1792
    v_mfma_f32_16x16x32_bf16 a[20:23], a[164:167], a[236:239], a[20:23]
    ds_read_b64_tr_b16 a[132:133], v31 offset:7168
    v_mfma_f32_16x16x32_bf16 a[20:23], a[160:163], a[232:235], a[20:23]
    ds_read_b64_tr_b16 a[134:135], v31 offset:8960
    v_mfma_f32_16x16x32_bf16 a[24:27], a[160:163], a[240:243], a[24:27]
    s_mov_b32 m0, s36
    v_mfma_f32_16x16x32_bf16 a[24:27], a[164:167], a[244:247], a[24:27]
    buffer_load_dwordx4 v8, s[8:11], s24 offen offset:0 lds
    v_mfma_f32_16x16x32_bf16 a[28:31], a[164:167], a[252:255], a[28:31]
    ds_read_b64_tr_b16 a[136:137], v31 offset:32
    v_mfma_f32_16x16x32_bf16 a[28:31], a[160:163], a[248:251], a[28:31]
    ds_read_b64_tr_b16 a[138:139], v31 offset:1824
    v_mfma_f32_16x16x32_bf16 a[60:63], a[168:171], a[248:251], a[60:63]
    ds_read_b64_tr_b16 a[140:141], v31 offset:7200
    v_mfma_f32_16x16x32_bf16 a[60:63], a[172:175], a[252:255], a[60:63]
    ds_read_b64_tr_b16 a[142:143], v31 offset:8992
    v_mfma_f32_16x16x32_bf16 a[56:59], a[172:175], a[244:247], a[56:59]
    buffer_load_dwordx4 v9, s[8:11], s24 offen offset:1024 lds
    v_mfma_f32_16x16x32_bf16 a[56:59], a[168:171], a[240:243], a[56:59]
    v_mfma_f32_16x16x32_bf16 a[52:55], a[168:171], a[232:235], a[52:55]
    ds_read_b64_tr_b16 a[144:145], v33 offset:0
    v_mfma_f32_16x16x32_bf16 a[52:55], a[172:175], a[236:239], a[52:55]
    ds_read_b64_tr_b16 a[146:147], v33 offset:1792
    v_mfma_f32_16x16x32_bf16 a[48:51], a[172:175], a[228:231], a[48:51]
    ds_read_b64_tr_b16 a[148:149], v33 offset:7168
    s_add_u32 m0, s36, 2048
    v_mfma_f32_16x16x32_bf16 a[48:51], a[168:171], a[224:227], a[48:51]
    buffer_load_dwordx4 v10, s[8:11], s24 offen offset:0 lds
    v_mfma_f32_16x16x32_bf16 a[80:83], a[176:179], a[224:227], a[80:83]
    ds_read_b64_tr_b16 a[150:151], v33 offset:8960
    v_mfma_f32_16x16x32_bf16 a[80:83], a[180:183], a[228:231], a[80:83]
    v_mfma_f32_16x16x32_bf16 a[84:87], a[180:183], a[236:239], a[84:87]
    ds_read_b64_tr_b16 a[152:153], v35 offset:0
    v_mfma_f32_16x16x32_bf16 a[84:87], a[176:179], a[232:235], a[84:87]
    ds_read_b64_tr_b16 a[154:155], v35 offset:256
    v_mfma_f32_16x16x32_bf16 a[88:91], a[176:179], a[240:243], a[88:91]
    buffer_load_dwordx4 v11, s[8:11], s24 offen offset:1024 lds
    v_mfma_f32_16x16x32_bf16 a[88:91], a[180:183], a[244:247], a[88:91]
    ds_read_b64_tr_b16 a[156:157], v35 offset:16384
    v_mfma_f32_16x16x32_bf16 a[92:95], a[180:183], a[252:255], a[92:95]
    ds_read_b64_tr_b16 a[158:159], v35 offset:16640
    v_mfma_f32_16x16x32_bf16 a[92:95], a[176:179], a[248:251], a[92:95]
    v_mfma_f32_16x16x32_bf16 a[124:127], a[184:187], a[248:251], a[124:127]
    s_mov_b32 m0, s37
    v_mfma_f32_16x16x32_bf16 a[124:127], a[188:191], a[252:255], a[124:127]
    buffer_load_dwordx4 v12, s[8:11], s24 offen offset:0 lds
    v_mfma_f32_16x16x32_bf16 a[120:123], a[188:191], a[244:247], a[120:123]
    v_mfma_f32_16x16x32_bf16 a[120:123], a[184:187], a[240:243], a[120:123]
    v_mfma_f32_16x16x32_bf16 a[116:119], a[184:187], a[232:235], a[116:119]
    v_mfma_f32_16x16x32_bf16 a[116:119], a[188:191], a[236:239], a[116:119]
    v_mfma_f32_16x16x32_bf16 a[112:115], a[188:191], a[228:231], a[112:115]
    buffer_load_dwordx4 v13, s[8:11], s24 offen offset:1024 lds
    v_mfma_f32_16x16x32_bf16 a[112:115], a[184:187], a[224:227], a[112:115]
    v_mfma_f32_16x16x32_bf16 a[0:3], a[160:163], a[192:195], a[0:3]
    ds_read_b128 a[224:227], v28 offset:8192
    v_mfma_f32_16x16x32_bf16 a[0:3], a[164:167], a[196:199], a[0:3]
    ds_read_b128 a[228:231], v29 offset:8192
    v_mfma_f32_16x16x32_bf16 a[4:7], a[164:167], a[204:207], a[4:7]
    s_add_u32 m0, s37, 2048
    v_mfma_f32_16x16x32_bf16 a[4:7], a[160:163], a[200:203], a[4:7]
    buffer_load_dwordx4 v14, s[8:11], s24 offen offset:0 lds
    v_mfma_f32_16x16x32_bf16 a[8:11], a[160:163], a[208:211], a[8:11]
    ds_read_b128 a[232:235], v28 offset:10240
    v_mfma_f32_16x16x32_bf16 a[8:11], a[164:167], a[212:215], a[8:11]
    v_mfma_f32_16x16x32_bf16 a[12:15], a[164:167], a[220:223], a[12:15]
    ds_read_b128 a[236:239], v29 offset:10240
    v_mfma_f32_16x16x32_bf16 a[12:15], a[160:163], a[216:219], a[12:15]
    ds_read_b128 a[240:243], v28 offset:12288
    v_mfma_f32_16x16x32_bf16 a[44:47], a[168:171], a[216:219], a[44:47]
    buffer_load_dwordx4 v15, s[8:11], s24 offen offset:1024 lds
    v_mfma_f32_16x16x32_bf16 a[44:47], a[172:175], a[220:223], a[44:47]
    v_mfma_f32_16x16x32_bf16 a[40:43], a[172:175], a[212:215], a[40:43]
    ds_read_b128 a[244:247], v29 offset:12288
    v_mfma_f32_16x16x32_bf16 a[40:43], a[168:171], a[208:211], a[40:43]
    v_mfma_f32_16x16x32_bf16 a[36:39], a[168:171], a[200:203], a[36:39]
    ds_read_b128 a[248:251], v28 offset:14336
    s_mov_b32 m0, s38
    v_mfma_f32_16x16x32_bf16 a[36:39], a[172:175], a[204:207], a[36:39]
    buffer_load_dwordx4 v16, s[12:15], s25 offen offset:0 lds
    v_mfma_f32_16x16x32_bf16 a[32:35], a[172:175], a[196:199], a[32:35]
    ds_read_b128 a[252:255], v29 offset:14336
    v_mfma_f32_16x16x32_bf16 a[32:35], a[168:171], a[192:195], a[32:35]
    v_mfma_f32_16x16x32_bf16 a[64:67], a[176:179], a[192:195], a[64:67]
    ds_read_b64_tr_b16 v[44:45], v39 offset:0
    v_mfma_f32_16x16x32_bf16 a[64:67], a[180:183], a[196:199], a[64:67]
    v_mfma_f32_16x16x32_bf16 a[68:71], a[180:183], a[204:207], a[68:71]
    buffer_load_dwordx4 v17, s[12:15], s25 offen offset:1024 lds
    v_mfma_f32_16x16x32_bf16 a[68:71], a[176:179], a[200:203], a[68:71]
    ds_read_b64_tr_b16 v[46:47], v39 offset:256
    v_mfma_f32_16x16x32_bf16 a[72:75], a[176:179], a[208:211], a[72:75]
    ds_read_b64_tr_b16 v[48:49], v39 offset:1024
    v_mfma_f32_16x16x32_bf16 a[72:75], a[180:183], a[212:215], a[72:75]
    v_mfma_f32_16x16x32_bf16 a[76:79], a[180:183], a[220:223], a[76:79]
    ds_read_b64_tr_b16 v[50:51], v39 offset:1280
    v_mfma_f32_16x16x32_bf16 a[76:79], a[176:179], a[216:219], a[76:79]
    buffer_load_dwordx4 v18, s[12:15], s25 offen offset:2048 lds
    v_mfma_f32_16x16x32_bf16 a[108:111], a[184:187], a[216:219], a[108:111]
    v_mfma_f32_16x16x32_bf16 a[108:111], a[188:191], a[220:223], a[108:111]
    v_mfma_f32_16x16x32_bf16 a[104:107], a[188:191], a[212:215], a[104:107]
    v_mfma_f32_16x16x32_bf16 a[104:107], a[184:187], a[208:211], a[104:107]
    v_mfma_f32_16x16x32_bf16 a[100:103], a[184:187], a[200:203], a[100:103]
    buffer_load_dwordx4 v19, s[12:15], s25 offen offset:3072 lds
    v_mfma_f32_16x16x32_bf16 a[100:103], a[188:191], a[204:207], a[100:103]
    v_mfma_f32_16x16x32_bf16 a[96:99], a[188:191], a[196:199], a[96:99]
    v_mfma_f32_16x16x32_bf16 a[96:99], a[184:187], a[192:195], a[96:99]
    s_waitcnt lgkmcnt(0)
    v_mfma_f32_16x16x32_bf16 v[144:147], a[128:131], a[224:227], v[144:147]
    ds_read_b128 a[192:195], v28 offset:0
    s_mov_b32 m0, s39
    v_mfma_f32_16x16x32_bf16 v[144:147], a[132:135], a[228:231], v[144:147]
    buffer_load_dwordx4 v20, s[12:15], s25 offen offset:0 lds
    v_mfma_f32_16x16x32_bf16 v[148:151], a[132:135], a[236:239], v[148:151]
    ds_read_b128 a[196:199], v29 offset:0
    v_mfma_f32_16x16x32_bf16 v[148:151], a[128:131], a[232:235], v[148:151]
    v_mfma_f32_16x16x32_bf16 v[152:155], a[128:131], a[240:243], v[152:155]
    ds_read_b128 a[200:203], v28 offset:2048
    v_mfma_f32_16x16x32_bf16 v[152:155], a[132:135], a[244:247], v[152:155]
    v_mfma_f32_16x16x32_bf16 v[156:159], a[132:135], a[252:255], v[156:159]
    buffer_load_dwordx4 v21, s[12:15], s25 offen offset:1024 lds
    v_mfma_f32_16x16x32_bf16 v[156:159], a[128:131], a[248:251], v[156:159]
    ds_read_b128 a[204:207], v29 offset:2048
    v_mfma_f32_16x16x32_bf16 v[188:191], a[136:139], a[248:251], v[188:191]
    ds_read_b128 a[208:211], v28 offset:4096
    v_mfma_f32_16x16x32_bf16 v[188:191], a[140:143], a[252:255], v[188:191]
    v_mfma_f32_16x16x32_bf16 v[184:187], a[140:143], a[244:247], v[184:187]
    ds_read_b128 a[212:215], v29 offset:4096
    s_add_u32 m0, s39, 2048
    v_mfma_f32_16x16x32_bf16 v[184:187], a[136:139], a[240:243], v[184:187]
    buffer_load_dwordx4 v22, s[16:19], s26 offen offset:0 lds
    v_mfma_f32_16x16x32_bf16 v[180:183], a[136:139], a[232:235], v[180:183]
    v_mfma_f32_16x16x32_bf16 v[180:183], a[140:143], a[236:239], v[180:183]
    ds_read_b128 a[216:219], v28 offset:6144
    v_mfma_f32_16x16x32_bf16 v[176:179], a[140:143], a[228:231], v[176:179]
    ds_read_b128 a[220:223], v29 offset:6144
    v_mfma_f32_16x16x32_bf16 v[176:179], a[136:139], a[224:227], v[176:179]
    v_mfma_f32_16x16x32_bf16 v[208:211], a[144:147], a[224:227], v[208:211]
    buffer_load_dwordx4 v23, s[16:19], s26 offen offset:1024 lds
    v_mfma_f32_16x16x32_bf16 v[208:211], a[148:151], a[228:231], v[208:211]
    v_mfma_f32_16x16x32_bf16 v[212:215], a[148:151], a[236:239], v[212:215]
    v_mfma_f32_16x16x32_bf16 v[212:215], a[144:147], a[232:235], v[212:215]
    v_mfma_f32_16x16x32_bf16 v[216:219], a[144:147], a[240:243], v[216:219]
    s_mov_b32 m0, s40
    v_mfma_f32_16x16x32_bf16 v[216:219], a[148:151], a[244:247], v[216:219]
    buffer_load_dwordx4 v24, s[64:67], s33 offen lds
    v_mfma_f32_16x16x32_bf16 v[220:223], a[148:151], a[252:255], v[220:223]
    v_mfma_f32_16x16x32_bf16 v[220:223], a[144:147], a[248:251], v[220:223]
    v_mfma_f32_16x16x32_bf16 v[252:255], a[152:155], a[248:251], v[252:255]
    v_mfma_f32_16x16x32_bf16 v[252:255], a[156:159], a[252:255], v[252:255]
    v_mfma_f32_16x16x32_bf16 v[248:251], a[156:159], a[244:247], v[248:251]
    v_mfma_f32_16x16x32_bf16 v[248:251], a[152:155], a[240:243], v[248:251]
    v_mfma_f32_16x16x32_bf16 v[244:247], a[152:155], a[232:235], v[244:247]
    v_mfma_f32_16x16x32_bf16 v[244:247], a[156:159], a[236:239], v[244:247]
    buffer_load_dword v125, v41, s[12:15], s25 offen
    v_mfma_f32_16x16x32_bf16 v[240:243], a[156:159], a[228:231], v[240:243]
    v_mfma_f32_16x16x32_bf16 v[240:243], a[152:155], a[224:227], v[240:243]
    s_waitcnt lgkmcnt(0)
    v_mfma_f32_16x16x32_bf16 v[128:131], a[128:131], a[192:195], v[128:131]
    ds_read_b64_tr_b16 a[160:161], v31 offset:16384
    v_mfma_f32_16x16x32_bf16 v[128:131], a[132:135], a[196:199], v[128:131]
    ds_read_b64_tr_b16 a[162:163], v31 offset:18176
    v_mfma_f32_16x16x32_bf16 v[132:135], a[132:135], a[204:207], v[132:135]
    buffer_load_dword v126, v42, s[16:19], s26 offen
    v_mfma_f32_16x16x32_bf16 v[132:135], a[128:131], a[200:203], v[132:135]
    ds_read_b64_tr_b16 a[164:165], v31 offset:23552
    v_mfma_f32_16x16x32_bf16 v[136:139], a[128:131], a[208:211], v[136:139]
    ds_read_b64_tr_b16 a[166:167], v31 offset:25344
    v_mfma_f32_16x16x32_bf16 v[136:139], a[132:135], a[212:215], v[136:139]
    v_mfma_f32_16x16x32_bf16 v[140:143], a[132:135], a[220:223], v[140:143]
    ds_read_b64_tr_b16 a[168:169], v31 offset:16416
    v_mfma_f32_16x16x32_bf16 v[140:143], a[128:131], a[216:219], v[140:143]
    ds_read_b64_tr_b16 a[170:171], v31 offset:18208
    v_mfma_f32_16x16x32_bf16 v[172:175], a[136:139], a[216:219], v[172:175]
    ds_read_b64_tr_b16 a[172:173], v31 offset:23584
    v_mfma_f32_16x16x32_bf16 v[172:175], a[140:143], a[220:223], v[172:175]
    ds_read_b64_tr_b16 a[174:175], v31 offset:25376
    v_mfma_f32_16x16x32_bf16 v[168:171], a[140:143], a[212:215], v[168:171]
    v_mfma_f32_16x16x32_bf16 v[168:171], a[136:139], a[208:211], v[168:171]
    ds_read_b64_tr_b16 a[176:177], v33 offset:16384
    v_mfma_f32_16x16x32_bf16 v[164:167], a[136:139], a[200:203], v[164:167]
    ds_read_b64_tr_b16 a[178:179], v33 offset:18176
    v_mfma_f32_16x16x32_bf16 v[164:167], a[140:143], a[204:207], v[164:167]
    ds_read_b64_tr_b16 a[180:181], v33 offset:23552
    v_mfma_f32_16x16x32_bf16 v[160:163], a[140:143], a[196:199], v[160:163]
    ds_read_b64_tr_b16 a[182:183], v33 offset:25344
    v_mfma_f32_16x16x32_bf16 v[160:163], a[136:139], a[192:195], v[160:163]
    v_mfma_f32_16x16x32_bf16 v[192:195], a[144:147], a[192:195], v[192:195]
    ds_read_b64_tr_b16 a[184:185], v37 offset:0
    v_mfma_f32_16x16x32_bf16 v[192:195], a[148:151], a[196:199], v[192:195]
    ds_read_b64_tr_b16 a[186:187], v37 offset:256
    v_mfma_f32_16x16x32_bf16 v[196:199], a[148:151], a[204:207], v[196:199]
    ds_read_b64_tr_b16 a[188:189], v37 offset:16384
    v_mfma_f32_16x16x32_bf16 v[196:199], a[144:147], a[200:203], v[196:199]
    ds_read_b64_tr_b16 a[190:191], v37 offset:16640
    v_mfma_f32_16x16x32_bf16 v[200:203], a[144:147], a[208:211], v[200:203]
    s_add_u32 s24, s24, 128
    v_mfma_f32_16x16x32_bf16 v[200:203], a[148:151], a[212:215], v[200:203]
    s_add_u32 s25, s25, 458752
    v_mfma_f32_16x16x32_bf16 v[204:207], a[148:151], a[220:223], v[204:207]
    s_add_u32 s26, s26, s27
    v_mfma_f32_16x16x32_bf16 v[204:207], a[144:147], a[216:219], v[204:207]
    s_add_u32 s33, s33, 4096
    v_mfma_f32_16x16x32_bf16 v[236:239], a[152:155], a[216:219], v[236:239]
    v_mfma_f32_16x16x32_bf16 v[236:239], a[156:159], a[220:223], v[236:239]
    v_mfma_f32_16x16x32_bf16 v[232:235], a[156:159], a[212:215], v[232:235]
    v_mfma_f32_16x16x32_bf16 v[232:235], a[152:155], a[208:211], v[232:235]
    v_mfma_f32_16x16x32_bf16 v[228:231], a[152:155], a[200:203], v[228:231]
    v_mfma_f32_16x16x32_bf16 v[228:231], a[156:159], a[204:207], v[228:231]
    v_mfma_f32_16x16x32_bf16 v[224:227], a[156:159], a[196:199], v[224:227]
    v_mfma_f32_16x16x32_bf16 v[224:227], a[152:155], a[192:195], v[224:227]
    v_mfma_f32_16x16x32_bf16 v[52:55], a[192:195], v[44:47], v[52:55]
    v_mfma_f32_16x16x32_bf16 v[52:55], a[196:199], v[48:51], v[52:55]
    s_waitcnt vmcnt(2) lgkmcnt(0)
    s_barrier
    v_mfma_f32_16x16x32_bf16 a[0:3], a[160:163], a[192:195], a[0:3]
    ds_read_b64_tr_b16 a[128:129], v30 offset:0
    v_mfma_f32_16x16x32_bf16 a[0:3], a[164:167], a[196:199], a[0:3]
    ds_read_b64_tr_b16 a[130:131], v30 offset:1792
    v_mfma_f32_16x16x32_bf16 a[4:7], a[164:167], a[204:207], a[4:7]
    ds_read_b64_tr_b16 a[132:133], v30 offset:7168
    v_mfma_f32_16x16x32_bf16 a[4:7], a[160:163], a[200:203], a[4:7]
    ds_read_b64_tr_b16 a[134:135], v30 offset:8960
    v_mfma_f32_16x16x32_bf16 a[8:11], a[160:163], a[208:211], a[8:11]
    s_mov_b32 m0, s41
    v_mfma_f32_16x16x32_bf16 a[8:11], a[164:167], a[212:215], a[8:11]
    buffer_load_dwordx4 v8, s[8:11], s24 offen offset:0 lds
    v_mfma_f32_16x16x32_bf16 a[12:15], a[164:167], a[220:223], a[12:15]
    ds_read_b64_tr_b16 a[136:137], v30 offset:32
    v_mfma_f32_16x16x32_bf16 a[12:15], a[160:163], a[216:219], a[12:15]
    ds_read_b64_tr_b16 a[138:139], v30 offset:1824
    v_mfma_f32_16x16x32_bf16 a[44:47], a[168:171], a[216:219], a[44:47]
    ds_read_b64_tr_b16 a[140:141], v30 offset:7200
    v_mfma_f32_16x16x32_bf16 a[44:47], a[172:175], a[220:223], a[44:47]
    ds_read_b64_tr_b16 a[142:143], v30 offset:8992
    v_mfma_f32_16x16x32_bf16 a[40:43], a[172:175], a[212:215], a[40:43]
    buffer_load_dwordx4 v9, s[8:11], s24 offen offset:1024 lds
    v_mfma_f32_16x16x32_bf16 a[40:43], a[168:171], a[208:211], a[40:43]
    v_mfma_f32_16x16x32_bf16 a[36:39], a[168:171], a[200:203], a[36:39]
    ds_read_b64_tr_b16 a[144:145], v32 offset:0
    v_mfma_f32_16x16x32_bf16 a[36:39], a[172:175], a[204:207], a[36:39]
    ds_read_b64_tr_b16 a[146:147], v32 offset:1792
    v_mfma_f32_16x16x32_bf16 a[32:35], a[172:175], a[196:199], a[32:35]
    ds_read_b64_tr_b16 a[148:149], v32 offset:7168
    s_add_u32 m0, s41, 2048
    v_mfma_f32_16x16x32_bf16 a[32:35], a[168:171], a[192:195], a[32:35]
    buffer_load_dwordx4 v10, s[8:11], s24 offen offset:0 lds
    v_mfma_f32_16x16x32_bf16 a[64:67], a[176:179], a[192:195], a[64:67]
    ds_read_b64_tr_b16 a[150:151], v32 offset:8960
    v_mfma_f32_16x16x32_bf16 a[64:67], a[180:183], a[196:199], a[64:67]
    v_mfma_f32_16x16x32_bf16 a[68:71], a[180:183], a[204:207], a[68:71]
    ds_read_b64_tr_b16 a[152:153], v34 offset:0
    v_mfma_f32_16x16x32_bf16 a[68:71], a[176:179], a[200:203], a[68:71]
    ds_read_b64_tr_b16 a[154:155], v34 offset:256
    v_mfma_f32_16x16x32_bf16 a[72:75], a[176:179], a[208:211], a[72:75]
    buffer_load_dwordx4 v11, s[8:11], s24 offen offset:1024 lds
    v_mfma_f32_16x16x32_bf16 a[72:75], a[180:183], a[212:215], a[72:75]
    ds_read_b64_tr_b16 a[156:157], v34 offset:16384
    v_mfma_f32_16x16x32_bf16 a[76:79], a[180:183], a[220:223], a[76:79]
    ds_read_b64_tr_b16 a[158:159], v34 offset:16640
    v_mfma_f32_16x16x32_bf16 a[76:79], a[176:179], a[216:219], a[76:79]
    v_mfma_f32_16x16x32_bf16 a[108:111], a[184:187], a[216:219], a[108:111]
    s_mov_b32 m0, s42
    v_mfma_f32_16x16x32_bf16 a[108:111], a[188:191], a[220:223], a[108:111]
    buffer_load_dwordx4 v12, s[8:11], s24 offen offset:0 lds
    v_mfma_f32_16x16x32_bf16 a[104:107], a[188:191], a[212:215], a[104:107]
    v_mfma_f32_16x16x32_bf16 a[104:107], a[184:187], a[208:211], a[104:107]
    v_mfma_f32_16x16x32_bf16 a[100:103], a[184:187], a[200:203], a[100:103]
    v_mfma_f32_16x16x32_bf16 a[100:103], a[188:191], a[204:207], a[100:103]
    v_mfma_f32_16x16x32_bf16 a[96:99], a[188:191], a[196:199], a[96:99]
    buffer_load_dwordx4 v13, s[8:11], s24 offen offset:1024 lds
    v_mfma_f32_16x16x32_bf16 a[96:99], a[184:187], a[192:195], a[96:99]
    v_mfma_f32_16x16x32_bf16 a[16:19], a[160:163], a[224:227], a[16:19]
    ds_read_b128 a[192:195], v26 offset:0
    v_mfma_f32_16x16x32_bf16 a[16:19], a[164:167], a[228:231], a[16:19]
    ds_read_b128 a[196:199], v27 offset:0
    v_mfma_f32_16x16x32_bf16 a[20:23], a[164:167], a[236:239], a[20:23]
    s_add_u32 m0, s42, 2048
    v_mfma_f32_16x16x32_bf16 a[20:23], a[160:163], a[232:235], a[20:23]
    buffer_load_dwordx4 v14, s[8:11], s24 offen offset:0 lds
    v_mfma_f32_16x16x32_bf16 a[24:27], a[160:163], a[240:243], a[24:27]
    ds_read_b128 a[200:203], v26 offset:2048
    v_mfma_f32_16x16x32_bf16 a[24:27], a[164:167], a[244:247], a[24:27]
    v_mfma_f32_16x16x32_bf16 a[28:31], a[164:167], a[252:255], a[28:31]
    ds_read_b128 a[204:207], v27 offset:2048
    v_mfma_f32_16x16x32_bf16 a[28:31], a[160:163], a[248:251], a[28:31]
    ds_read_b128 a[208:211], v26 offset:4096
    v_mfma_f32_16x16x32_bf16 a[60:63], a[168:171], a[248:251], a[60:63]
    buffer_load_dwordx4 v15, s[8:11], s24 offen offset:1024 lds
    v_mfma_f32_16x16x32_bf16 a[60:63], a[172:175], a[252:255], a[60:63]
    v_mfma_f32_16x16x32_bf16 a[56:59], a[172:175], a[244:247], a[56:59]
    ds_read_b128 a[212:215], v27 offset:4096
    v_mfma_f32_16x16x32_bf16 a[56:59], a[168:171], a[240:243], a[56:59]
    v_mfma_f32_16x16x32_bf16 a[52:55], a[168:171], a[232:235], a[52:55]
    ds_read_b128 a[216:219], v26 offset:6144
    s_mov_b32 m0, s43
    v_mfma_f32_16x16x32_bf16 a[52:55], a[172:175], a[236:239], a[52:55]
    buffer_load_dwordx4 v16, s[12:15], s25 offen offset:0 lds
    v_mfma_f32_16x16x32_bf16 a[48:51], a[172:175], a[228:231], a[48:51]
    ds_read_b128 a[220:223], v27 offset:6144
    v_mfma_f32_16x16x32_bf16 a[48:51], a[168:171], a[224:227], a[48:51]
    v_mfma_f32_16x16x32_bf16 a[80:83], a[176:179], a[224:227], a[80:83]
    ds_read_b64_tr_b16 v[44:45], v38 offset:0
    v_mfma_f32_16x16x32_bf16 a[80:83], a[180:183], a[228:231], a[80:83]
    v_mfma_f32_16x16x32_bf16 a[84:87], a[180:183], a[236:239], a[84:87]
    buffer_load_dwordx4 v17, s[12:15], s25 offen offset:1024 lds
    v_mfma_f32_16x16x32_bf16 a[84:87], a[176:179], a[232:235], a[84:87]
    ds_read_b64_tr_b16 v[46:47], v38 offset:256
    v_mfma_f32_16x16x32_bf16 a[88:91], a[176:179], a[240:243], a[88:91]
    ds_read_b64_tr_b16 v[48:49], v38 offset:1024
    v_mfma_f32_16x16x32_bf16 a[88:91], a[180:183], a[244:247], a[88:91]
    v_mfma_f32_16x16x32_bf16 a[92:95], a[180:183], a[252:255], a[92:95]
    ds_read_b64_tr_b16 v[50:51], v38 offset:1280
    v_mfma_f32_16x16x32_bf16 a[92:95], a[176:179], a[248:251], a[92:95]
    buffer_load_dwordx4 v18, s[12:15], s25 offen offset:2048 lds
    v_mfma_f32_16x16x32_bf16 a[124:127], a[184:187], a[248:251], a[124:127]
    v_mfma_f32_16x16x32_bf16 a[124:127], a[188:191], a[252:255], a[124:127]
    v_mfma_f32_16x16x32_bf16 a[120:123], a[188:191], a[244:247], a[120:123]
    v_mfma_f32_16x16x32_bf16 a[120:123], a[184:187], a[240:243], a[120:123]
    v_mfma_f32_16x16x32_bf16 a[116:119], a[184:187], a[232:235], a[116:119]
    buffer_load_dwordx4 v19, s[12:15], s25 offen offset:3072 lds
    v_mfma_f32_16x16x32_bf16 a[116:119], a[188:191], a[236:239], a[116:119]
    v_mfma_f32_16x16x32_bf16 a[112:115], a[188:191], a[228:231], a[112:115]
    v_mfma_f32_16x16x32_bf16 a[112:115], a[184:187], a[224:227], a[112:115]
    s_waitcnt lgkmcnt(0)
    v_mfma_f32_16x16x32_bf16 v[128:131], a[128:131], a[192:195], v[128:131]
    ds_read_b128 a[224:227], v26 offset:8192
    s_mov_b32 m0, s44
    v_mfma_f32_16x16x32_bf16 v[128:131], a[132:135], a[196:199], v[128:131]
    buffer_load_dwordx4 v20, s[12:15], s25 offen offset:0 lds
    v_mfma_f32_16x16x32_bf16 v[132:135], a[132:135], a[204:207], v[132:135]
    ds_read_b128 a[228:231], v27 offset:8192
    v_mfma_f32_16x16x32_bf16 v[132:135], a[128:131], a[200:203], v[132:135]
    v_mfma_f32_16x16x32_bf16 v[136:139], a[128:131], a[208:211], v[136:139]
    ds_read_b128 a[232:235], v26 offset:10240
    v_mfma_f32_16x16x32_bf16 v[136:139], a[132:135], a[212:215], v[136:139]
    v_mfma_f32_16x16x32_bf16 v[140:143], a[132:135], a[220:223], v[140:143]
    buffer_load_dwordx4 v21, s[12:15], s25 offen offset:1024 lds
    v_mfma_f32_16x16x32_bf16 v[140:143], a[128:131], a[216:219], v[140:143]
    ds_read_b128 a[236:239], v27 offset:10240
    v_mfma_f32_16x16x32_bf16 v[172:175], a[136:139], a[216:219], v[172:175]
    ds_read_b128 a[240:243], v26 offset:12288
    v_mfma_f32_16x16x32_bf16 v[172:175], a[140:143], a[220:223], v[172:175]
    v_mfma_f32_16x16x32_bf16 v[168:171], a[140:143], a[212:215], v[168:171]
    ds_read_b128 a[244:247], v27 offset:12288
    s_add_u32 m0, s44, 2048
    v_mfma_f32_16x16x32_bf16 v[168:171], a[136:139], a[208:211], v[168:171]
    buffer_load_dwordx4 v22, s[16:19], s26 offen offset:0 lds
    v_mfma_f32_16x16x32_bf16 v[164:167], a[136:139], a[200:203], v[164:167]
    v_mfma_f32_16x16x32_bf16 v[164:167], a[140:143], a[204:207], v[164:167]
    ds_read_b128 a[248:251], v26 offset:14336
    v_mfma_f32_16x16x32_bf16 v[160:163], a[140:143], a[196:199], v[160:163]
    ds_read_b128 a[252:255], v27 offset:14336
    v_mfma_f32_16x16x32_bf16 v[160:163], a[136:139], a[192:195], v[160:163]
    v_mfma_f32_16x16x32_bf16 v[192:195], a[144:147], a[192:195], v[192:195]
    buffer_load_dwordx4 v23, s[16:19], s26 offen offset:1024 lds
    v_mfma_f32_16x16x32_bf16 v[192:195], a[148:151], a[196:199], v[192:195]
    v_mfma_f32_16x16x32_bf16 v[196:199], a[148:151], a[204:207], v[196:199]
    v_mfma_f32_16x16x32_bf16 v[196:199], a[144:147], a[200:203], v[196:199]
    v_mfma_f32_16x16x32_bf16 v[200:203], a[144:147], a[208:211], v[200:203]
    s_mov_b32 m0, s45
    v_mfma_f32_16x16x32_bf16 v[200:203], a[148:151], a[212:215], v[200:203]
    buffer_load_dwordx4 v24, s[64:67], s33 offen lds
    v_mfma_f32_16x16x32_bf16 v[204:207], a[148:151], a[220:223], v[204:207]
    v_mfma_f32_16x16x32_bf16 v[204:207], a[144:147], a[216:219], v[204:207]
    v_mfma_f32_16x16x32_bf16 v[236:239], a[152:155], a[216:219], v[236:239]
    v_mfma_f32_16x16x32_bf16 v[236:239], a[156:159], a[220:223], v[236:239]
    v_mfma_f32_16x16x32_bf16 v[232:235], a[156:159], a[212:215], v[232:235]
    v_mfma_f32_16x16x32_bf16 v[232:235], a[152:155], a[208:211], v[232:235]
    v_mfma_f32_16x16x32_bf16 v[228:231], a[152:155], a[200:203], v[228:231]
    v_mfma_f32_16x16x32_bf16 v[228:231], a[156:159], a[204:207], v[228:231]
    buffer_load_dword v124, v40, s[8:11], s24 offen offset:256
    v_mfma_f32_16x16x32_bf16 v[224:227], a[156:159], a[196:199], v[224:227]
    v_mfma_f32_16x16x32_bf16 v[224:227], a[152:155], a[192:195], v[224:227]
    v_mfma_f32_16x16x32_bf16 v[52:55], a[192:195], v[44:47], v[52:55]
    v_mfma_f32_16x16x32_bf16 v[52:55], a[196:199], v[48:51], v[52:55]
    s_waitcnt lgkmcnt(0)
    v_mfma_f32_16x16x32_bf16 v[144:147], a[128:131], a[224:227], v[144:147]
    ds_read_b64_tr_b16 a[160:161], v30 offset:16384
    v_mfma_f32_16x16x32_bf16 v[144:147], a[132:135], a[228:231], v[144:147]
    ds_read_b64_tr_b16 a[162:163], v30 offset:18176
    v_mfma_f32_16x16x32_bf16 v[148:151], a[132:135], a[236:239], v[148:151]
    global_load_dword v127, v[122:123], off
    v_mfma_f32_16x16x32_bf16 v[148:151], a[128:131], a[232:235], v[148:151]
    ds_read_b64_tr_b16 a[164:165], v30 offset:23552
    v_mfma_f32_16x16x32_bf16 v[152:155], a[128:131], a[240:243], v[152:155]
    ds_read_b64_tr_b16 a[166:167], v30 offset:25344
    v_mfma_f32_16x16x32_bf16 v[152:155], a[132:135], a[244:247], v[152:155]
    v_mfma_f32_16x16x32_bf16 v[156:159], a[132:135], a[252:255], v[156:159]
    ds_read_b64_tr_b16 a[168:169], v30 offset:16416
    v_mfma_f32_16x16x32_bf16 v[156:159], a[128:131], a[248:251], v[156:159]
    ds_read_b64_tr_b16 a[170:171], v30 offset:18208
    v_mfma_f32_16x16x32_bf16 v[188:191], a[136:139], a[248:251], v[188:191]
    ds_read_b64_tr_b16 a[172:173], v30 offset:23584
    v_mfma_f32_16x16x32_bf16 v[188:191], a[140:143], a[252:255], v[188:191]
    ds_read_b64_tr_b16 a[174:175], v30 offset:25376
    v_mfma_f32_16x16x32_bf16 v[184:187], a[140:143], a[244:247], v[184:187]
    v_mfma_f32_16x16x32_bf16 v[184:187], a[136:139], a[240:243], v[184:187]
    ds_read_b64_tr_b16 a[176:177], v32 offset:16384
    v_mfma_f32_16x16x32_bf16 v[180:183], a[136:139], a[232:235], v[180:183]
    ds_read_b64_tr_b16 a[178:179], v32 offset:18176
    v_mfma_f32_16x16x32_bf16 v[180:183], a[140:143], a[236:239], v[180:183]
    ds_read_b64_tr_b16 a[180:181], v32 offset:23552
    v_mfma_f32_16x16x32_bf16 v[176:179], a[140:143], a[228:231], v[176:179]
    ds_read_b64_tr_b16 a[182:183], v32 offset:25344
    v_mfma_f32_16x16x32_bf16 v[176:179], a[136:139], a[224:227], v[176:179]
    v_mfma_f32_16x16x32_bf16 v[208:211], a[144:147], a[224:227], v[208:211]
    ds_read_b64_tr_b16 a[184:185], v36 offset:0
    v_mfma_f32_16x16x32_bf16 v[208:211], a[148:151], a[228:231], v[208:211]
    ds_read_b64_tr_b16 a[186:187], v36 offset:256
    v_mfma_f32_16x16x32_bf16 v[212:215], a[148:151], a[236:239], v[212:215]
    ds_read_b64_tr_b16 a[188:189], v36 offset:16384
    v_mfma_f32_16x16x32_bf16 v[212:215], a[144:147], a[232:235], v[212:215]
    ds_read_b64_tr_b16 a[190:191], v36 offset:16640
    v_mfma_f32_16x16x32_bf16 v[216:219], a[144:147], a[240:243], v[216:219]
    s_add_u32 s24, s24, 128
    v_mfma_f32_16x16x32_bf16 v[216:219], a[148:151], a[244:247], v[216:219]
    s_add_u32 s25, s25, 458752
    v_mfma_f32_16x16x32_bf16 v[220:223], a[148:151], a[252:255], v[220:223]
    s_add_u32 s26, s26, s27
    v_mfma_f32_16x16x32_bf16 v[220:223], a[144:147], a[248:251], v[220:223]
    s_add_u32 s33, s33, 4096
    v_mfma_f32_16x16x32_bf16 v[252:255], a[152:155], a[248:251], v[252:255]
    v_mfma_f32_16x16x32_bf16 v[252:255], a[156:159], a[252:255], v[252:255]
    v_mfma_f32_16x16x32_bf16 v[248:251], a[156:159], a[244:247], v[248:251]
    s_sub_u32 s32, s32, 1
    v_mfma_f32_16x16x32_bf16 v[248:251], a[152:155], a[240:243], v[248:251]
    s_cmp_lg_u32 s32, 0
    v_mfma_f32_16x16x32_bf16 v[244:247], a[152:155], a[232:235], v[244:247]
    v_mfma_f32_16x16x32_bf16 v[244:247], a[156:159], a[236:239], v[244:247]
    v_mfma_f32_16x16x32_bf16 v[240:243], a[156:159], a[228:231], v[240:243]
    v_mfma_f32_16x16x32_bf16 v[240:243], a[152:155], a[224:227], v[240:243]
    s_waitcnt vmcnt(2) lgkmcnt(0)
    s_barrier
    s_cbranch_scc1 K1_W1_LOOP
    v_mfma_f32_16x16x32_bf16 a[16:19], a[160:163], a[224:227], a[16:19]
    ds_read_b64_tr_b16 a[128:129], v31 offset:0
    v_mfma_f32_16x16x32_bf16 a[16:19], a[164:167], a[228:231], a[16:19]
    ds_read_b64_tr_b16 a[130:131], v31 offset:1792
    v_mfma_f32_16x16x32_bf16 a[20:23], a[164:167], a[236:239], a[20:23]
    ds_read_b64_tr_b16 a[132:133], v31 offset:7168
    v_mfma_f32_16x16x32_bf16 a[20:23], a[160:163], a[232:235], a[20:23]
    ds_read_b64_tr_b16 a[134:135], v31 offset:8960
    v_mfma_f32_16x16x32_bf16 a[24:27], a[160:163], a[240:243], a[24:27]
    v_mfma_f32_16x16x32_bf16 a[24:27], a[164:167], a[244:247], a[24:27]
    ds_read_b64_tr_b16 a[136:137], v31 offset:32
    v_mfma_f32_16x16x32_bf16 a[28:31], a[164:167], a[252:255], a[28:31]
    ds_read_b64_tr_b16 a[138:139], v31 offset:1824
    v_mfma_f32_16x16x32_bf16 a[28:31], a[160:163], a[248:251], a[28:31]
    ds_read_b64_tr_b16 a[140:141], v31 offset:7200
    v_mfma_f32_16x16x32_bf16 a[60:63], a[168:171], a[248:251], a[60:63]
    ds_read_b64_tr_b16 a[142:143], v31 offset:8992
    v_mfma_f32_16x16x32_bf16 a[60:63], a[172:175], a[252:255], a[60:63]
    v_mfma_f32_16x16x32_bf16 a[56:59], a[172:175], a[244:247], a[56:59]
    ds_read_b64_tr_b16 a[144:145], v33 offset:0
    v_mfma_f32_16x16x32_bf16 a[56:59], a[168:171], a[240:243], a[56:59]
    ds_read_b64_tr_b16 a[146:147], v33 offset:1792
    v_mfma_f32_16x16x32_bf16 a[52:55], a[168:171], a[232:235], a[52:55]
    ds_read_b64_tr_b16 a[148:149], v33 offset:7168
    v_mfma_f32_16x16x32_bf16 a[52:55], a[172:175], a[236:239], a[52:55]
    ds_read_b64_tr_b16 a[150:151], v33 offset:8960
    v_mfma_f32_16x16x32_bf16 a[48:51], a[172:175], a[228:231], a[48:51]
    v_mfma_f32_16x16x32_bf16 a[48:51], a[168:171], a[224:227], a[48:51]
    ds_read_b64_tr_b16 a[152:153], v35 offset:0
    v_mfma_f32_16x16x32_bf16 a[80:83], a[176:179], a[224:227], a[80:83]
    ds_read_b64_tr_b16 a[154:155], v35 offset:256
    v_mfma_f32_16x16x32_bf16 a[80:83], a[180:183], a[228:231], a[80:83]
    ds_read_b64_tr_b16 a[156:157], v35 offset:16384
    v_mfma_f32_16x16x32_bf16 a[84:87], a[180:183], a[236:239], a[84:87]
    ds_read_b64_tr_b16 a[158:159], v35 offset:16640
    v_mfma_f32_16x16x32_bf16 a[84:87], a[176:179], a[232:235], a[84:87]
    v_mfma_f32_16x16x32_bf16 a[88:91], a[176:179], a[240:243], a[88:91]
    v_mfma_f32_16x16x32_bf16 a[88:91], a[180:183], a[244:247], a[88:91]
    v_mfma_f32_16x16x32_bf16 a[92:95], a[180:183], a[252:255], a[92:95]
    v_mfma_f32_16x16x32_bf16 a[92:95], a[176:179], a[248:251], a[92:95]
    v_mfma_f32_16x16x32_bf16 a[124:127], a[184:187], a[248:251], a[124:127]
    v_mfma_f32_16x16x32_bf16 a[124:127], a[188:191], a[252:255], a[124:127]
    v_mfma_f32_16x16x32_bf16 a[120:123], a[188:191], a[244:247], a[120:123]
    v_mfma_f32_16x16x32_bf16 a[120:123], a[184:187], a[240:243], a[120:123]
    v_mfma_f32_16x16x32_bf16 a[116:119], a[184:187], a[232:235], a[116:119]
    v_mfma_f32_16x16x32_bf16 a[116:119], a[188:191], a[236:239], a[116:119]
    v_mfma_f32_16x16x32_bf16 a[112:115], a[188:191], a[228:231], a[112:115]
    v_mfma_f32_16x16x32_bf16 a[112:115], a[184:187], a[224:227], a[112:115]
    v_mfma_f32_16x16x32_bf16 a[0:3], a[160:163], a[192:195], a[0:3]
    ds_read_b128 a[224:227], v28 offset:8192
    v_mfma_f32_16x16x32_bf16 a[0:3], a[164:167], a[196:199], a[0:3]
    ds_read_b128 a[228:231], v29 offset:8192
    v_mfma_f32_16x16x32_bf16 a[4:7], a[164:167], a[204:207], a[4:7]
    v_mfma_f32_16x16x32_bf16 a[4:7], a[160:163], a[200:203], a[4:7]
    ds_read_b128 a[232:235], v28 offset:10240
    v_mfma_f32_16x16x32_bf16 a[8:11], a[160:163], a[208:211], a[8:11]
    v_mfma_f32_16x16x32_bf16 a[8:11], a[164:167], a[212:215], a[8:11]
    ds_read_b128 a[236:239], v29 offset:10240
    v_mfma_f32_16x16x32_bf16 a[12:15], a[164:167], a[220:223], a[12:15]
    ds_read_b128 a[240:243], v28 offset:12288
    v_mfma_f32_16x16x32_bf16 a[12:15], a[160:163], a[216:219], a[12:15]
    v_mfma_f32_16x16x32_bf16 a[44:47], a[168:171], a[216:219], a[44:47]
    ds_read_b128 a[244:247], v29 offset:12288
    v_mfma_f32_16x16x32_bf16 a[44:47], a[172:175], a[220:223], a[44:47]
    v_mfma_f32_16x16x32_bf16 a[40:43], a[172:175], a[212:215], a[40:43]
    ds_read_b128 a[248:251], v28 offset:14336
    v_mfma_f32_16x16x32_bf16 a[40:43], a[168:171], a[208:211], a[40:43]
    ds_read_b128 a[252:255], v29 offset:14336
    v_mfma_f32_16x16x32_bf16 a[36:39], a[168:171], a[200:203], a[36:39]
    v_mfma_f32_16x16x32_bf16 a[36:39], a[172:175], a[204:207], a[36:39]
    ds_read_b64_tr_b16 v[44:45], v39 offset:0
    v_mfma_f32_16x16x32_bf16 a[32:35], a[172:175], a[196:199], a[32:35]
    v_mfma_f32_16x16x32_bf16 a[32:35], a[168:171], a[192:195], a[32:35]
    ds_read_b64_tr_b16 v[46:47], v39 offset:256
    v_mfma_f32_16x16x32_bf16 a[64:67], a[176:179], a[192:195], a[64:67]
    ds_read_b64_tr_b16 v[48:49], v39 offset:1024
    v_mfma_f32_16x16x32_bf16 a[64:67], a[180:183], a[196:199], a[64:67]
    v_mfma_f32_16x16x32_bf16 a[68:71], a[180:183], a[204:207], a[68:71]
    ds_read_b64_tr_b16 v[50:51], v39 offset:1280
    v_mfma_f32_16x16x32_bf16 a[68:71], a[176:179], a[200:203], a[68:71]
    v_mfma_f32_16x16x32_bf16 a[72:75], a[176:179], a[208:211], a[72:75]
    v_mfma_f32_16x16x32_bf16 a[72:75], a[180:183], a[212:215], a[72:75]
    v_mfma_f32_16x16x32_bf16 a[76:79], a[180:183], a[220:223], a[76:79]
    v_mfma_f32_16x16x32_bf16 a[76:79], a[176:179], a[216:219], a[76:79]
    v_mfma_f32_16x16x32_bf16 a[108:111], a[184:187], a[216:219], a[108:111]
    v_mfma_f32_16x16x32_bf16 a[108:111], a[188:191], a[220:223], a[108:111]
    v_mfma_f32_16x16x32_bf16 a[104:107], a[188:191], a[212:215], a[104:107]
    v_mfma_f32_16x16x32_bf16 a[104:107], a[184:187], a[208:211], a[104:107]
    v_mfma_f32_16x16x32_bf16 a[100:103], a[184:187], a[200:203], a[100:103]
    v_mfma_f32_16x16x32_bf16 a[100:103], a[188:191], a[204:207], a[100:103]
    v_mfma_f32_16x16x32_bf16 a[96:99], a[188:191], a[196:199], a[96:99]
    v_mfma_f32_16x16x32_bf16 a[96:99], a[184:187], a[192:195], a[96:99]
    s_waitcnt lgkmcnt(0)
    v_mfma_f32_16x16x32_bf16 v[144:147], a[128:131], a[224:227], v[144:147]
    ds_read_b128 a[192:195], v28 offset:0
    s_lshr_b32 s3, s28, 1
    v_mfma_f32_16x16x32_bf16 v[144:147], a[132:135], a[228:231], v[144:147]
    ds_read_b128 a[196:199], v29 offset:0
    s_lshl_b32 s4, s29, 1
    v_mfma_f32_16x16x32_bf16 v[148:151], a[132:135], a[236:239], v[148:151]
    s_add_u32 s3, s3, s4
    v_mfma_f32_16x16x32_bf16 v[148:151], a[128:131], a[232:235], v[148:151]
    ds_read_b128 a[200:203], v28 offset:2048
    s_lshl_b32 s85, s3, 3
    v_mfma_f32_16x16x32_bf16 v[152:155], a[128:131], a[240:243], v[152:155]
    s_lshl_b32 s3, s3, 2
    v_mfma_f32_16x16x32_bf16 v[152:155], a[132:135], a[244:247], v[152:155]
    ds_read_b128 a[204:207], v29 offset:2048
    s_lshr_b32 s4, s31, 1
    v_mfma_f32_16x16x32_bf16 v[156:159], a[132:135], a[252:255], v[156:159]
    ds_read_b128 a[208:211], v28 offset:4096
    s_add_u32 s3, s3, s4
    v_mfma_f32_16x16x32_bf16 v[156:159], a[128:131], a[248:251], v[156:159]
    s_lshl_b32 s3, s3, 12
    v_mfma_f32_16x16x32_bf16 v[188:191], a[136:139], a[248:251], v[188:191]
    ds_read_b128 a[212:215], v29 offset:4096
    s_and_b32 s4, s31, 1
    v_mfma_f32_16x16x32_bf16 v[188:191], a[140:143], a[252:255], v[188:191]
    s_and_b32 s5, s30, 1
    v_mfma_f32_16x16x32_bf16 v[184:187], a[140:143], a[244:247], v[184:187]
    ds_read_b128 a[216:219], v28 offset:6144
    s_lshl_b32 s4, s4, 3
    v_mfma_f32_16x16x32_bf16 v[184:187], a[136:139], a[240:243], v[184:187]
    ds_read_b128 a[220:223], v29 offset:6144
    s_lshl_b32 s6, s5, 8
    v_mfma_f32_16x16x32_bf16 v[180:183], a[136:139], a[232:235], v[180:183]
    s_add_u32 s3, s3, s4
    v_mfma_f32_16x16x32_bf16 v[180:183], a[140:143], a[236:239], v[180:183]
    s_add_u32 s3, s3, s6
    v_mfma_f32_16x16x32_bf16 v[176:179], a[140:143], a[228:231], v[176:179]
    s_add_u32 s3, s3, 23070720
    v_mfma_f32_16x16x32_bf16 v[176:179], a[136:139], a[224:227], v[176:179]
    s_cmp_ge_u32 s30, 16
    v_mfma_f32_16x16x32_bf16 v[208:211], a[144:147], a[224:227], v[208:211]
    s_cselect_b32 s3, 2147418112, s3
    v_mfma_f32_16x16x32_bf16 v[208:211], a[148:151], a[228:231], v[208:211]
    v_mfma_f32_16x16x32_bf16 v[212:215], a[148:151], a[236:239], v[212:215]
    v_mfma_f32_16x16x32_bf16 v[212:215], a[144:147], a[232:235], v[212:215]
    v_mfma_f32_16x16x32_bf16 v[216:219], a[144:147], a[240:243], v[216:219]
    v_mfma_f32_16x16x32_bf16 v[216:219], a[148:151], a[244:247], v[216:219]
    v_mfma_f32_16x16x32_bf16 v[220:223], a[148:151], a[252:255], v[220:223]
    v_mfma_f32_16x16x32_bf16 v[220:223], a[144:147], a[248:251], v[220:223]
    v_mfma_f32_16x16x32_bf16 v[252:255], a[152:155], a[248:251], v[252:255]
    v_mfma_f32_16x16x32_bf16 v[252:255], a[156:159], a[252:255], v[252:255]
    v_mfma_f32_16x16x32_bf16 v[248:251], a[156:159], a[244:247], v[248:251]
    v_mfma_f32_16x16x32_bf16 v[248:251], a[152:155], a[240:243], v[248:251]
    v_mfma_f32_16x16x32_bf16 v[244:247], a[152:155], a[232:235], v[244:247]
    v_mfma_f32_16x16x32_bf16 v[244:247], a[156:159], a[236:239], v[244:247]
    v_mfma_f32_16x16x32_bf16 v[240:243], a[156:159], a[228:231], v[240:243]
    v_mfma_f32_16x16x32_bf16 v[240:243], a[152:155], a[224:227], v[240:243]
    s_waitcnt lgkmcnt(0)
    v_mfma_f32_16x16x32_bf16 v[52:55], a[192:195], v[44:47], v[52:55]
    ds_read_b64_tr_b16 a[160:161], v31 offset:16384
    v_mfma_f32_16x16x32_bf16 v[52:55], a[196:199], v[48:51], v[52:55]
    ds_read_b64_tr_b16 a[162:163], v31 offset:18176
    v_mfma_f32_16x16x32_bf16 v[128:131], a[128:131], a[192:195], v[128:131]
    ds_read_b64_tr_b16 a[164:165], v31 offset:23552
    v_mfma_f32_16x16x32_bf16 v[128:131], a[132:135], a[196:199], v[128:131]
    ds_read_b64_tr_b16 a[166:167], v31 offset:25344
    v_mfma_f32_16x16x32_bf16 v[132:135], a[132:135], a[204:207], v[132:135]
    v_mfma_f32_16x16x32_bf16 v[132:135], a[128:131], a[200:203], v[132:135]
    ds_read_b64_tr_b16 a[168:169], v31 offset:16416
    v_mfma_f32_16x16x32_bf16 v[136:139], a[128:131], a[208:211], v[136:139]
    ds_read_b64_tr_b16 a[170:171], v31 offset:18208
    v_mfma_f32_16x16x32_bf16 v[136:139], a[132:135], a[212:215], v[136:139]
    ds_read_b64_tr_b16 a[172:173], v31 offset:23584
    v_mfma_f32_16x16x32_bf16 v[140:143], a[132:135], a[220:223], v[140:143]
    ds_read_b64_tr_b16 a[174:175], v31 offset:25376
    v_mfma_f32_16x16x32_bf16 v[140:143], a[128:131], a[216:219], v[140:143]
    v_mfma_f32_16x16x32_bf16 v[172:175], a[136:139], a[216:219], v[172:175]
    ds_read_b64_tr_b16 a[176:177], v33 offset:16384
    v_mfma_f32_16x16x32_bf16 v[172:175], a[140:143], a[220:223], v[172:175]
    ds_read_b64_tr_b16 a[178:179], v33 offset:18176
    v_cvt_pk_bf16_f32 v4, v52, v53
    v_mfma_f32_16x16x32_bf16 v[168:171], a[140:143], a[212:215], v[168:171]
    ds_read_b64_tr_b16 a[180:181], v33 offset:23552
    v_cvt_pk_bf16_f32 v5, v54, v55
    v_mfma_f32_16x16x32_bf16 v[168:171], a[136:139], a[208:211], v[168:171]
    ds_read_b64_tr_b16 a[182:183], v33 offset:25344
    v_mfma_f32_16x16x32_bf16 v[164:167], a[136:139], a[200:203], v[164:167]
    buffer_store_dwordx2 v[4:5], v119, s[20:23], s3 offen sc1
    v_mfma_f32_16x16x32_bf16 v[164:167], a[140:143], a[204:207], v[164:167]
    v_mfma_f32_16x16x32_bf16 v[160:163], a[140:143], a[196:199], v[160:163]
    ds_read_b64_tr_b16 a[184:185], v37 offset:0
    v_mfma_f32_16x16x32_bf16 v[160:163], a[136:139], a[192:195], v[160:163]
    ds_read_b64_tr_b16 a[186:187], v37 offset:256
    v_mfma_f32_16x16x32_bf16 v[192:195], a[144:147], a[192:195], v[192:195]
    ds_read_b64_tr_b16 a[188:189], v37 offset:16384
    v_mfma_f32_16x16x32_bf16 v[192:195], a[148:151], a[196:199], v[192:195]
    ds_read_b64_tr_b16 a[190:191], v37 offset:16640
    v_mfma_f32_16x16x32_bf16 v[196:199], a[148:151], a[204:207], v[196:199]
    v_mfma_f32_16x16x32_bf16 v[196:199], a[144:147], a[200:203], v[196:199]
    v_mfma_f32_16x16x32_bf16 v[200:203], a[144:147], a[208:211], v[200:203]
    v_mfma_f32_16x16x32_bf16 v[200:203], a[148:151], a[212:215], v[200:203]
    v_mfma_f32_16x16x32_bf16 v[204:207], a[148:151], a[220:223], v[204:207]
    v_mfma_f32_16x16x32_bf16 v[204:207], a[144:147], a[216:219], v[204:207]
    v_mfma_f32_16x16x32_bf16 v[236:239], a[152:155], a[216:219], v[236:239]
    v_mfma_f32_16x16x32_bf16 v[236:239], a[156:159], a[220:223], v[236:239]
    v_mfma_f32_16x16x32_bf16 v[232:235], a[156:159], a[212:215], v[232:235]
    v_mfma_f32_16x16x32_bf16 v[232:235], a[152:155], a[208:211], v[232:235]
    v_mfma_f32_16x16x32_bf16 v[228:231], a[152:155], a[200:203], v[228:231]
    v_mfma_f32_16x16x32_bf16 v[228:231], a[156:159], a[204:207], v[228:231]
    v_mfma_f32_16x16x32_bf16 v[224:227], a[156:159], a[196:199], v[224:227]
    v_mfma_f32_16x16x32_bf16 v[224:227], a[152:155], a[192:195], v[224:227]
    s_waitcnt lgkmcnt(0)
K1_W1_TAIL:
    s_mov_b32 s0, 0xbfb8aa3b
    s_mov_b32 s1, 0xbfb8aa3b
    s_nop 0
    v_pk_mul_f32 v[128:129], v[128:129], s[0:1]
    v_pk_mul_f32 v[130:131], v[130:131], s[0:1]
    v_pk_mul_f32 v[160:161], v[160:161], s[0:1]
    v_pk_mul_f32 v[162:163], v[162:163], s[0:1]
    v_pk_mul_f32 v[192:193], v[192:193], s[0:1]
    v_pk_mul_f32 v[194:195], v[194:195], s[0:1]
    v_pk_mul_f32 v[132:133], v[132:133], s[0:1]
    v_pk_mul_f32 v[134:135], v[134:135], s[0:1]
    v_pk_mul_f32 v[164:165], v[164:165], s[0:1]
    v_pk_mul_f32 v[166:167], v[166:167], s[0:1]
    v_pk_mul_f32 v[196:197], v[196:197], s[0:1]
    v_pk_mul_f32 v[198:199], v[198:199], s[0:1]
    v_pk_mul_f32 v[136:137], v[136:137], s[0:1]
    v_pk_mul_f32 v[138:139], v[138:139], s[0:1]
    v_pk_mul_f32 v[168:169], v[168:169], s[0:1]
    v_pk_mul_f32 v[170:171], v[170:171], s[0:1]
    v_pk_mul_f32 v[200:201], v[200:201], s[0:1]
    v_pk_mul_f32 v[202:203], v[202:203], s[0:1]
    v_pk_mul_f32 v[140:141], v[140:141], s[0:1]
    v_pk_mul_f32 v[142:143], v[142:143], s[0:1]
    v_pk_mul_f32 v[172:173], v[172:173], s[0:1]
    v_pk_mul_f32 v[174:175], v[174:175], s[0:1]
    v_pk_mul_f32 v[204:205], v[204:205], s[0:1]
    v_pk_mul_f32 v[206:207], v[206:207], s[0:1]
    v_pk_mul_f32 v[144:145], v[144:145], s[0:1]
    v_pk_mul_f32 v[146:147], v[146:147], s[0:1]
    v_pk_mul_f32 v[176:177], v[176:177], s[0:1]
    v_pk_mul_f32 v[178:179], v[178:179], s[0:1]
    v_pk_mul_f32 v[208:209], v[208:209], s[0:1]
    v_pk_mul_f32 v[210:211], v[210:211], s[0:1]
    v_pk_mul_f32 v[148:149], v[148:149], s[0:1]
    v_pk_mul_f32 v[150:151], v[150:151], s[0:1]
    v_mfma_f32_16x16x32_bf16 a[0:3], a[160:163], a[192:195], a[0:3]
    s_mov_b32 s10, 4194304
    v_exp_f32 v128, v128
    v_mfma_f32_16x16x32_bf16 a[0:3], a[164:167], a[196:199], a[0:3]
    s_mov_b32 s64, s60
    v_exp_f32 v129, v129
    v_mfma_f32_16x16x32_bf16 a[4:7], a[164:167], a[204:207], a[4:7]
    s_mov_b32 s65, s61
    v_exp_f32 v130, v130
    v_mfma_f32_16x16x32_bf16 a[4:7], a[160:163], a[200:203], a[4:7]
    s_movk_i32 s66, 2048
    v_exp_f32 v131, v131
    v_mfma_f32_16x16x32_bf16 a[8:11], a[160:163], a[208:211], a[8:11]
    s_lshl_b32 s3, s29, 5
    v_exp_f32 v160, v160
    v_mfma_f32_16x16x32_bf16 a[8:11], a[164:167], a[212:215], a[8:11]
    s_add_u32 s3, s3, s30
    v_exp_f32 v161, v161
    v_mfma_f32_16x16x32_bf16 a[12:15], a[164:167], a[220:223], a[12:15]
    s_lshl_b32 s3, s3, 2
    v_exp_f32 v162, v162
    v_mfma_f32_16x16x32_bf16 a[12:15], a[160:163], a[216:219], a[12:15]
    s_add_u32 s3, s3, s28
    v_exp_f32 v163, v163
    v_mfma_f32_16x16x32_bf16 a[44:47], a[168:171], a[216:219], a[44:47]
    s_lshl_b32 s51, s3, 3
    v_exp_f32 v192, v192
    v_mfma_f32_16x16x32_bf16 a[44:47], a[172:175], a[220:223], a[44:47]
    s_lshl_b32 s3, s3, 12
    v_exp_f32 v193, v193
    v_mfma_f32_16x16x32_bf16 a[40:43], a[172:175], a[212:215], a[40:43]
    s_mov_b32 s16, s68
    v_exp_f32 v194, v194
    v_mfma_f32_16x16x32_bf16 a[40:43], a[168:171], a[208:211], a[40:43]
    s_mov_b32 s17, s69
    v_exp_f32 v195, v195
    v_mfma_f32_16x16x32_bf16 a[36:39], a[168:171], a[200:203], a[36:39]
    s_movk_i32 s18, 256
    v_exp_f32 v132, v132
    v_mfma_f32_16x16x32_bf16 a[36:39], a[172:175], a[204:207], a[36:39]
    s_mul_i32 s4, s30, 7
    v_exp_f32 v133, v133
    v_mfma_f32_16x16x32_bf16 a[32:35], a[172:175], a[196:199], a[32:35]
    buffer_load_dwordx2 v[88:89], off, s[16:19], 0 sc1
    v_exp_f32 v134, v134
    v_mfma_f32_16x16x32_bf16 a[32:35], a[168:171], a[192:195], a[32:35]
    s_add_u32 s6, s4, s5
    v_exp_f32 v135, v135
    v_mfma_f32_16x16x32_bf16 a[64:67], a[176:179], a[192:195], a[64:67]
    s_lshr_b32 s6, s6, 1
    v_exp_f32 v164, v164
    v_mfma_f32_16x16x32_bf16 a[64:67], a[180:183], a[196:199], a[64:67]
    s_add_u32 s6, s6, 34
    v_exp_f32 v165, v165
    v_mfma_f32_16x16x32_bf16 a[68:71], a[180:183], a[204:207], a[68:71]
    s_lshl_b32 s48, s6, 10
    v_exp_f32 v166, v166
    v_mfma_f32_16x16x32_bf16 a[68:71], a[176:179], a[200:203], a[68:71]
    buffer_load_dwordx4 v[8:11], v92, s[8:11], s3 offen offset:0
    v_exp_f32 v167, v167
    v_mfma_f32_16x16x32_bf16 a[72:75], a[176:179], a[208:211], a[72:75]
    s_add_u32 s7, s4, 6
    v_exp_f32 v196, v196
    v_mfma_f32_16x16x32_bf16 a[72:75], a[180:183], a[212:215], a[72:75]
    s_cmp_eq_u32 s5, 0
    v_exp_f32 v197, v197
    v_mfma_f32_16x16x32_bf16 a[76:79], a[180:183], a[220:223], a[76:79]
    s_cselect_b32 s7, s7, s4
    v_exp_f32 v198, v198
    v_mfma_f32_16x16x32_bf16 a[76:79], a[176:179], a[216:219], a[76:79]
    s_lshr_b32 s7, s7, 1
    v_exp_f32 v199, v199
    v_mfma_f32_16x16x32_bf16 a[108:111], a[184:187], a[216:219], a[108:111]
    buffer_load_dwordx4 v[12:15], v92, s[8:11], s3 offen offset:1024
    v_exp_f32 v136, v136
    v_mfma_f32_16x16x32_bf16 a[108:111], a[188:191], a[220:223], a[108:111]
    s_add_u32 s7, s7, 32
    v_exp_f32 v137, v137
    v_mfma_f32_16x16x32_bf16 a[104:107], a[188:191], a[212:215], a[104:107]
    s_lshl_b32 s7, s7, 10
    v_exp_f32 v138, v138
    v_mfma_f32_16x16x32_bf16 a[104:107], a[184:187], a[208:211], a[104:107]
    s_lshl_b32 s5, s5, 3
    v_exp_f32 v139, v139
    v_mfma_f32_16x16x32_bf16 a[100:103], a[184:187], a[200:203], a[100:103]
    s_add_u32 s7, s7, s5
    v_exp_f32 v168, v168
    v_mfma_f32_16x16x32_bf16 a[100:103], a[188:191], a[204:207], a[100:103]
    buffer_load_dwordx4 v[16:19], v92, s[8:11], s3 offen offset:2048
    v_exp_f32 v169, v169
    v_mfma_f32_16x16x32_bf16 a[96:99], a[188:191], a[196:199], a[96:99]
    s_sub_u32 s50, s7, s48
    v_exp_f32 v170, v170
    v_mfma_f32_16x16x32_bf16 a[96:99], a[184:187], a[192:195], a[96:99]
    s_mov_b32 s49, 2147418112
    v_exp_f32 v171, v171
    v_mfma_f32_16x16x32_bf16 a[16:19], a[160:163], a[224:227], a[16:19]
    s_lshl_b32 s24, s28, 12
    v_exp_f32 v200, v200
    v_mfma_f32_16x16x32_bf16 a[16:19], a[164:167], a[228:231], a[16:19]
    s_mov_b32 s25, s24
    v_exp_f32 v201, v201
    v_mfma_f32_16x16x32_bf16 a[20:23], a[164:167], a[236:239], a[20:23]
    buffer_load_dwordx4 v[20:23], v92, s[8:11], s3 offen offset:3072
    v_exp_f32 v202, v202
    v_mfma_f32_16x16x32_bf16 a[20:23], a[160:163], a[232:235], a[20:23]
    s_mov_b32 s35, 0
    v_exp_f32 v203, v203
    v_mfma_f32_16x16x32_bf16 a[24:27], a[160:163], a[240:243], a[24:27]
    s_mov_b32 s59, 24117248
    v_exp_f32 v140, v140
    v_mfma_f32_16x16x32_bf16 a[24:27], a[164:167], a[244:247], a[24:27]
    s_lshl_b32 s26, s29, 4
    v_exp_f32 v141, v141
    v_mfma_f32_16x16x32_bf16 a[28:31], a[164:167], a[252:255], a[28:31]
    s_add_u32 s26, s26, s30
    v_exp_f32 v142, v142
    v_mfma_f32_16x16x32_bf16 a[28:31], a[160:163], a[248:251], a[28:31]
    buffer_load_dwordx4 v[56:59], v92, s[64:67], 0 offen offset:0
    v_exp_f32 v143, v143
    v_mfma_f32_16x16x32_bf16 a[60:63], a[168:171], a[248:251], a[60:63]
    s_lshl_b32 s26, s26, 3
    v_exp_f32 v172, v172
    v_mfma_f32_16x16x32_bf16 a[60:63], a[172:175], a[252:255], a[60:63]
    s_add_u32 s26, s26, 24117248
    v_exp_f32 v173, v173
    v_mfma_f32_16x16x32_bf16 a[56:59], a[172:175], a[244:247], a[56:59]
    v_exp_f32 v174, v174
    v_mfma_f32_16x16x32_bf16 a[56:59], a[168:171], a[240:243], a[56:59]
    v_exp_f32 v175, v175
    v_mfma_f32_16x16x32_bf16 a[52:55], a[168:171], a[232:235], a[52:55]
    buffer_load_dwordx4 v[60:63], v92, s[64:67], 0 offen offset:1024
    v_exp_f32 v204, v204
    v_mfma_f32_16x16x32_bf16 a[52:55], a[172:175], a[236:239], a[52:55]
    v_exp_f32 v205, v205
    v_mfma_f32_16x16x32_bf16 a[48:51], a[172:175], a[228:231], a[48:51]
    v_exp_f32 v206, v206
    v_mfma_f32_16x16x32_bf16 a[48:51], a[168:171], a[224:227], a[48:51]
    v_exp_f32 v207, v207
    v_mfma_f32_16x16x32_bf16 a[80:83], a[176:179], a[224:227], a[80:83]
    v_exp_f32 v144, v144
    v_mfma_f32_16x16x32_bf16 a[80:83], a[180:183], a[228:231], a[80:83]
    v_exp_f32 v145, v145
    v_mfma_f32_16x16x32_bf16 a[84:87], a[180:183], a[236:239], a[84:87]
    v_exp_f32 v146, v146
    v_mfma_f32_16x16x32_bf16 a[84:87], a[176:179], a[232:235], a[84:87]
    v_exp_f32 v147, v147
    v_mfma_f32_16x16x32_bf16 a[88:91], a[176:179], a[240:243], a[88:91]
    v_exp_f32 v176, v176
    v_mfma_f32_16x16x32_bf16 a[88:91], a[180:183], a[244:247], a[88:91]
    v_exp_f32 v177, v177
    v_mfma_f32_16x16x32_bf16 a[92:95], a[180:183], a[252:255], a[92:95]
    v_exp_f32 v178, v178
    v_mfma_f32_16x16x32_bf16 a[92:95], a[176:179], a[248:251], a[92:95]
    v_exp_f32 v179, v179
    v_mfma_f32_16x16x32_bf16 a[124:127], a[184:187], a[248:251], a[124:127]
    v_exp_f32 v208, v208
    v_mfma_f32_16x16x32_bf16 a[124:127], a[188:191], a[252:255], a[124:127]
    v_exp_f32 v209, v209
    v_mfma_f32_16x16x32_bf16 a[120:123], a[188:191], a[244:247], a[120:123]
    v_exp_f32 v210, v210
    v_mfma_f32_16x16x32_bf16 a[120:123], a[184:187], a[240:243], a[120:123]
    v_exp_f32 v211, v211
    v_mfma_f32_16x16x32_bf16 a[116:119], a[184:187], a[232:235], a[116:119]
    v_exp_f32 v148, v148
    v_mfma_f32_16x16x32_bf16 a[116:119], a[188:191], a[236:239], a[116:119]
    v_exp_f32 v149, v149
    v_mfma_f32_16x16x32_bf16 a[112:115], a[188:191], a[228:231], a[112:115]
    v_exp_f32 v150, v150
    v_mfma_f32_16x16x32_bf16 a[112:115], a[184:187], a[224:227], a[112:115]
    v_exp_f32_e64 v151, v151
    s_waitcnt vmcnt(6)
    v_readfirstlane_b32 s46, v88
    v_readfirstlane_b32 s47, v89
    s_mov_b32 s3, 0
K_TAG1:
    s_cmp_lg_u32 s46, 0
    s_cbranch_scc0 K_TAG1_RETRY
K_TAG1_OK:
    s_barrier
    v_accvgpr_read_b32 v68, a0
    v_accvgpr_read_b32 v69, a1
    v_accvgpr_read_b32 v70, a2
    v_accvgpr_read_b32 v71, a3
    v_accvgpr_read_b32 v72, a32
    v_accvgpr_read_b32 v73, a33
    v_accvgpr_read_b32 v74, a34
    v_pk_add_f32 v[128:129], v[128:129], 1.0 op_sel_hi:[1,0]
    v_pk_add_f32 v[130:131], v[130:131], 1.0 op_sel_hi:[1,0]
    v_pk_add_f32 v[160:161], v[160:161], 1.0 op_sel_hi:[1,0]
    v_pk_add_f32 v[162:163], v[162:163], 1.0 op_sel_hi:[1,0]
    v_rcp_f32 v128, v128
    v_rcp_f32 v129, v129
    v_rcp_f32 v130, v130
    v_rcp_f32 v131, v131
    v_rcp_f32 v160, v160
    v_rcp_f32 v161, v161
    v_rcp_f32 v162, v162
    v_rcp_f32 v163, v163
    v_accvgpr_read_b32 v75, a35
    v_pk_mul_f32 v[128:129], v[128:129], v[68:69]
    v_pk_mul_f32 v[130:131], v[130:131], v[70:71]
    v_pk_mul_f32 v[160:161], v[160:161], v[72:73]
    v_pk_mul_f32 v[162:163], v[162:163], v[74:75]
    v_cvt_pk_bf16_f32 v163, v162, v163
    v_cvt_pk_bf16_f32 v162, v160, v161
    v_cvt_pk_bf16_f32 v161, v130, v131
    v_cvt_pk_bf16_f32 v160, v128, v129
    v_accvgpr_read_b32 v76, a64
    v_accvgpr_read_b32 v77, a65
    v_accvgpr_read_b32 v78, a66
    v_pk_add_f32 v[192:193], v[192:193], 1.0 op_sel_hi:[1,0]
    v_pk_add_f32 v[194:195], v[194:195], 1.0 op_sel_hi:[1,0]
    v_rcp_f32 v192, v192
    v_rcp_f32 v193, v193
    v_rcp_f32 v194, v194
    v_rcp_f32 v195, v195
    v_accvgpr_read_b32 v79, a67
    v_pk_mul_f32 v[192:193], v[192:193], v[76:77]
    v_pk_mul_f32 v[194:195], v[194:195], v[78:79]
    v_cvt_pk_bf16_f32 v192, v192, v193
    v_cvt_pk_bf16_f32 v193, v194, v195
    v_accvgpr_read_b32 v68, a4
    v_accvgpr_read_b32 v69, a5
    v_accvgpr_read_b32 v70, a6
    v_accvgpr_read_b32 v71, a7
    v_accvgpr_read_b32 v72, a36
    v_accvgpr_read_b32 v73, a37
    v_accvgpr_read_b32 v74, a38
    v_pk_add_f32 v[132:133], v[132:133], 1.0 op_sel_hi:[1,0]
    v_pk_add_f32 v[134:135], v[134:135], 1.0 op_sel_hi:[1,0]
    v_pk_add_f32 v[164:165], v[164:165], 1.0 op_sel_hi:[1,0]
    v_pk_add_f32 v[166:167], v[166:167], 1.0 op_sel_hi:[1,0]
    v_rcp_f32 v132, v132
    v_rcp_f32 v133, v133
    v_rcp_f32 v134, v134
    v_rcp_f32 v135, v135
    v_rcp_f32 v164, v164
    v_rcp_f32 v165, v165
    v_rcp_f32 v166, v166
    v_rcp_f32 v167, v167
    v_accvgpr_read_b32 v75, a39
    v_pk_mul_f32 v[132:133], v[132:133], v[68:69]
    v_pk_mul_f32 v[134:135], v[134:135], v[70:71]
    v_pk_mul_f32 v[164:165], v[164:165], v[72:73]
    v_pk_mul_f32 v[166:167], v[166:167], v[74:75]
    v_cvt_pk_bf16_f32 v167, v166, v167
    v_cvt_pk_bf16_f32 v166, v164, v165
    v_cvt_pk_bf16_f32 v165, v134, v135
    v_cvt_pk_bf16_f32 v164, v132, v133
    v_accvgpr_read_b32 v76, a68
    v_accvgpr_read_b32 v77, a69
    v_accvgpr_read_b32 v78, a70
    v_pk_add_f32 v[196:197], v[196:197], 1.0 op_sel_hi:[1,0]
    v_pk_add_f32 v[198:199], v[198:199], 1.0 op_sel_hi:[1,0]
    v_rcp_f32 v196, v196
    v_rcp_f32 v197, v197
    v_rcp_f32 v198, v198
    v_rcp_f32 v199, v199
    v_accvgpr_read_b32 v79, a71
    v_pk_mul_f32 v[196:197], v[196:197], v[76:77]
    v_pk_mul_f32 v[198:199], v[198:199], v[78:79]
    v_cvt_pk_bf16_f32 v196, v196, v197
    v_cvt_pk_bf16_f32 v197, v198, v199
    v_accvgpr_read_b32 v68, a8
    v_accvgpr_read_b32 v69, a9
    v_accvgpr_read_b32 v70, a10
    v_accvgpr_read_b32 v71, a11
    v_accvgpr_read_b32 v72, a40
    v_accvgpr_read_b32 v73, a41
    v_accvgpr_read_b32 v74, a42
    v_pk_add_f32 v[136:137], v[136:137], 1.0 op_sel_hi:[1,0]
    v_pk_add_f32 v[138:139], v[138:139], 1.0 op_sel_hi:[1,0]
    v_pk_add_f32 v[168:169], v[168:169], 1.0 op_sel_hi:[1,0]
    v_pk_add_f32 v[170:171], v[170:171], 1.0 op_sel_hi:[1,0]
    v_rcp_f32 v136, v136
    v_rcp_f32 v137, v137
    v_rcp_f32 v138, v138
    v_rcp_f32 v139, v139
    v_rcp_f32 v168, v168
    v_rcp_f32 v169, v169
    v_rcp_f32 v170, v170
    v_rcp_f32 v171, v171
    v_accvgpr_read_b32 v75, a43
    v_pk_mul_f32 v[136:137], v[136:137], v[68:69]
    v_pk_mul_f32 v[138:139], v[138:139], v[70:71]
    v_pk_mul_f32 v[168:169], v[168:169], v[72:73]
    v_pk_mul_f32 v[170:171], v[170:171], v[74:75]
    v_cvt_pk_bf16_f32 v171, v170, v171
    v_cvt_pk_bf16_f32 v170, v168, v169
    v_cvt_pk_bf16_f32 v169, v138, v139
    v_cvt_pk_bf16_f32 v168, v136, v137
    v_accvgpr_read_b32 v76, a72
    v_accvgpr_read_b32 v77, a73
    v_accvgpr_read_b32 v78, a74
    v_pk_add_f32 v[200:201], v[200:201], 1.0 op_sel_hi:[1,0]
    v_pk_add_f32 v[202:203], v[202:203], 1.0 op_sel_hi:[1,0]
    v_rcp_f32 v200, v200
    v_rcp_f32 v201, v201
    v_rcp_f32 v202, v202
    v_rcp_f32 v203, v203
    v_accvgpr_read_b32 v79, a75
    v_pk_mul_f32 v[200:201], v[200:201], v[76:77]
    v_pk_mul_f32 v[202:203], v[202:203], v[78:79]
    v_cvt_pk_bf16_f32 v200, v200, v201
    v_cvt_pk_bf16_f32 v201, v202, v203
    v_accvgpr_read_b32 v68, a12
    v_accvgpr_read_b32 v69, a13
    v_accvgpr_read_b32 v70, a14
    v_accvgpr_read_b32 v71, a15
    v_accvgpr_read_b32 v72, a44
    v_accvgpr_read_b32 v73, a45
    v_accvgpr_read_b32 v74, a46
    v_pk_add_f32 v[140:141], v[140:141], 1.0 op_sel_hi:[1,0]
    v_pk_add_f32 v[142:143], v[142:143], 1.0 op_sel_hi:[1,0]
    v_pk_add_f32 v[172:173], v[172:173], 1.0 op_sel_hi:[1,0]
    v_pk_add_f32 v[174:175], v[174:175], 1.0 op_sel_hi:[1,0]
    v_rcp_f32 v140, v140
    v_rcp_f32 v141, v141
    v_rcp_f32 v142, v142
    v_rcp_f32 v143, v143
    v_rcp_f32 v172, v172
    v_rcp_f32 v173, v173
    v_rcp_f32 v174, v174
    v_rcp_f32 v175, v175
    v_accvgpr_read_b32 v75, a47
    v_pk_mul_f32 v[140:141], v[140:141], v[68:69]
    v_pk_mul_f32 v[142:143], v[142:143], v[70:71]
    v_pk_mul_f32 v[172:173], v[172:173], v[72:73]
    v_pk_mul_f32 v[174:175], v[174:175], v[74:75]
    v_cvt_pk_bf16_f32 v175, v174, v175
    v_cvt_pk_bf16_f32 v174, v172, v173
    v_cvt_pk_bf16_f32 v173, v142, v143
    v_cvt_pk_bf16_f32 v172, v140, v141
    v_accvgpr_read_b32 v76, a76
    v_accvgpr_read_b32 v77, a77
    v_accvgpr_read_b32 v78, a78
    v_pk_add_f32 v[204:205], v[204:205], 1.0 op_sel_hi:[1,0]
    v_pk_add_f32 v[206:207], v[206:207], 1.0 op_sel_hi:[1,0]
    v_rcp_f32 v204, v204
    v_rcp_f32 v205, v205
    v_rcp_f32 v206, v206
    v_rcp_f32 v207, v207
    v_accvgpr_read_b32 v79, a79
    v_pk_mul_f32 v[204:205], v[204:205], v[76:77]
    v_pk_mul_f32 v[206:207], v[206:207], v[78:79]
    v_cvt_pk_bf16_f32 v204, v204, v205
    v_cvt_pk_bf16_f32 v205, v206, v207
    s_waitcnt vmcnt(0)
    s_nop 0
    v_dot2_f32_bf16 v84, v8, v56, 0
    v_dot2_f32_bf16 v86, v16, v56, 0
    v_dot2_f32_bf16 v85, v9, v57, 0
    v_dot2_f32_bf16 v87, v17, v57, 0
    v_dot2_f32_bf16 v84, v10, v58, v84
    v_dot2_f32_bf16 v86, v18, v58, v86
    v_dot2_f32_bf16 v85, v11, v59, v85
    v_dot2_f32_bf16 v87, v19, v59, v87
    v_dot2_f32_bf16 v84, v12, v60, v84
    v_dot2_f32_bf16 v86, v20, v60, v86
    v_dot2_f32_bf16 v85, v13, v61, v85
    v_dot2_f32_bf16 v87, v21, v61, v87
    v_dot2_f32_bf16 v84, v14, v62, v84
    v_dot2_f32_bf16 v86, v22, v62, v86
    v_dot2_f32_bf16 v85, v15, v63, v85
    v_dot2_f32_bf16 v87, v23, v63, v87
    s_nop 2
    v_add_f32 v84, v84, v85
    v_add_f32 v85, v86, v87
    s_nop 1
    v_add_f32_dpp v84, v84, v84 quad_perm:[1,0,3,2] row_mask:0xf bank_mask:0xf
    v_add_f32_dpp v85, v85, v85 quad_perm:[1,0,3,2] row_mask:0xf bank_mask:0xf
    s_nop 1
    v_add_f32_dpp v84, v84, v84 quad_perm:[2,3,0,1] row_mask:0xf bank_mask:0xf
    v_add_f32_dpp v85, v85, v85 quad_perm:[2,3,0,1] row_mask:0xf bank_mask:0xf
    s_nop 1
    v_add_f32_dpp v84, v84, v84 row_half_mirror row_mask:0xf bank_mask:0xf
    v_add_f32_dpp v85, v85, v85 row_half_mirror row_mask:0xf bank_mask:0xf
    s_nop 1
    v_add_f32_dpp v84, v84, v84 row_mirror row_mask:0xf bank_mask:0xf
    v_add_f32_dpp v85, v85, v85 row_mirror row_mask:0xf bank_mask:0xf
    s_nop 1
    v_add_f32_dpp v84, v84, v84 row_bcast:15 row_mask:0xa bank_mask:0xf
    v_add_f32_dpp v85, v85, v85 row_bcast:15 row_mask:0xa bank_mask:0xf
    s_nop 1
    v_add_f32_dpp v84, v84, v84 row_bcast:31 row_mask:0xc bank_mask:0xf
    v_add_f32_dpp v85, v85, v85 row_bcast:31 row_mask:0xc bank_mask:0xf
    v_cvt_pk_bf16_f32 v86, v84, v85
    v_lshlrev_b32 v84, 16, v86
    v_and_b32 v85, 0xffff0000, v86
    v_pk_mul_f32 v[84:85], v[84:85], s[0:1]
    v_exp_f32 v84, v84
    v_exp_f32 v85, v85
    s_nop 0
    v_pk_add_f32 v[84:85], v[84:85], 1.0 op_sel_hi:[1,0]
    v_rcp_f32 v84, v84
    v_rcp_f32 v85, v85
    s_nop 0
    v_cvt_pk_bf16_f32 v86, v84, v85
    v_lshlrev_b32 v84, 16, v86
    v_and_b32 v85, 0xffff0000, v86
    v_sub_f32 v86, 1.0, v84
    v_sub_f32 v87, 1.0, v85
    v_cvt_pk_bf16_f32 v87, v86, v87
    v_lshlrev_b32_e64 v86, 16, v87
    v_and_b32 v87, 0xffff0000, v87
    s_add_u32 s8, s62, 23068672
    s_addc_u32 s9, s63, 0
    s_mov_b32 s10, 0x40000
    v_accvgpr_read_b32 v68, a16
    v_accvgpr_read_b32 v69, a17
    v_accvgpr_read_b32 v70, a18
    v_accvgpr_read_b32 v71, a19
    v_accvgpr_read_b32 v72, a48
    v_accvgpr_read_b32 v73, a49
    v_accvgpr_read_b32 v74, a50
    v_pk_add_f32 v[144:145], v[144:145], 1.0 op_sel_hi:[1,0]
    v_pk_add_f32 v[146:147], v[146:147], 1.0 op_sel_hi:[1,0]
    v_pk_add_f32 v[176:177], v[176:177], 1.0 op_sel_hi:[1,0]
    v_pk_add_f32 v[178:179], v[178:179], 1.0 op_sel_hi:[1,0]
    v_rcp_f32 v144, v144
    v_rcp_f32 v145, v145
    v_rcp_f32 v146, v146
    v_rcp_f32 v147, v147
    v_rcp_f32 v176, v176
    v_rcp_f32 v177, v177
    v_rcp_f32 v178, v178
    v_rcp_f32 v179, v179
    v_accvgpr_read_b32 v75, a51
    v_pk_mul_f32 v[144:145], v[144:145], v[68:69]
    v_pk_mul_f32 v[146:147], v[146:147], v[70:71]
    v_pk_mul_f32 v[176:177], v[176:177], v[72:73]
    v_pk_mul_f32 v[178:179], v[178:179], v[74:75]
    v_cvt_pk_bf16_f32 v179, v178, v179
    v_cvt_pk_bf16_f32 v178, v176, v177
    v_cvt_pk_bf16_f32 v177, v146, v147
    v_cvt_pk_bf16_f32 v176, v144, v145
    v_accvgpr_read_b32 v76, a80
    v_accvgpr_read_b32 v77, a81
    v_accvgpr_read_b32 v78, a82
    v_pk_add_f32 v[208:209], v[208:209], 1.0 op_sel_hi:[1,0]
    v_pk_add_f32 v[210:211], v[210:211], 1.0 op_sel_hi:[1,0]
    v_rcp_f32 v208, v208
    v_rcp_f32 v209, v209
    v_rcp_f32 v210, v210
    v_rcp_f32 v211, v211
    v_accvgpr_read_b32 v79, a83
    v_pk_mul_f32 v[208:209], v[208:209], v[76:77]
    v_pk_mul_f32 v[210:211], v[210:211], v[78:79]
    v_cvt_pk_bf16_f32 v208, v208, v209
    v_cvt_pk_bf16_f32 v209, v210, v211
    v_pk_mul_f32 v[180:181], v[180:181], s[0:1]
    v_pk_mul_f32 v[182:183], v[182:183], s[0:1]
    v_exp_f32 v180, v180
    v_exp_f32 v181, v181
    v_exp_f32 v182, v182
    v_exp_f32 v183, v183
    v_accvgpr_read_b32 v68, a20
    v_accvgpr_read_b32 v69, a21
    v_accvgpr_read_b32 v70, a22
    v_accvgpr_read_b32 v71, a23
    v_accvgpr_read_b32 v72, a52
    v_accvgpr_read_b32 v73, a53
    v_accvgpr_read_b32 v74, a54
    v_pk_add_f32 v[148:149], v[148:149], 1.0 op_sel_hi:[1,0]
    v_pk_add_f32 v[150:151], v[150:151], 1.0 op_sel_hi:[1,0]
    v_pk_add_f32 v[180:181], v[180:181], 1.0 op_sel_hi:[1,0]
    v_pk_add_f32 v[182:183], v[182:183], 1.0 op_sel_hi:[1,0]
    v_rcp_f32 v148, v148
    v_rcp_f32 v149, v149
    v_rcp_f32 v150, v150
    v_rcp_f32 v151, v151
    v_rcp_f32 v180, v180
    v_rcp_f32 v181, v181
    v_rcp_f32 v182, v182
    v_rcp_f32 v183, v183
    v_accvgpr_read_b32 v75, a55
    v_pk_mul_f32 v[148:149], v[148:149], v[68:69]
    v_pk_mul_f32 v[150:151], v[150:151], v[70:71]
    v_pk_mul_f32 v[180:181], v[180:181], v[72:73]
    v_pk_mul_f32 v[182:183], v[182:183], v[74:75]
    v_cvt_pk_bf16_f32 v183, v182, v183
    v_cvt_pk_bf16_f32 v182, v180, v181
    v_cvt_pk_bf16_f32 v181, v150, v151
    v_cvt_pk_bf16_f32 v180, v148, v149
    v_pk_mul_f32 v[212:213], v[212:213], s[0:1]
    v_pk_mul_f32 v[214:215], v[214:215], s[0:1]
    v_exp_f32 v212, v212
    v_exp_f32 v213, v213
    v_exp_f32 v214, v214
    v_exp_f32 v215, v215
    v_accvgpr_read_b32 v76, a84
    v_accvgpr_read_b32 v77, a85
    v_accvgpr_read_b32 v78, a86
    v_pk_add_f32 v[212:213], v[212:213], 1.0 op_sel_hi:[1,0]
    v_pk_add_f32 v[214:215], v[214:215], 1.0 op_sel_hi:[1,0]
    v_rcp_f32 v212, v212
    v_rcp_f32 v213, v213
    v_rcp_f32 v214, v214
    v_rcp_f32 v215, v215
    v_accvgpr_read_b32 v79, a87
    v_pk_mul_f32 v[212:213], v[212:213], v[76:77]
    v_pk_mul_f32 v[214:215], v[214:215], v[78:79]
    v_cvt_pk_bf16_f32 v212, v212, v213
    v_cvt_pk_bf16_f32 v213, v214, v215
    v_pk_mul_f32 v[152:153], v[152:153], s[0:1]
    v_pk_mul_f32 v[154:155], v[154:155], s[0:1]
    v_pk_mul_f32 v[184:185], v[184:185], s[0:1]
    v_pk_mul_f32 v[186:187], v[186:187], s[0:1]
    v_exp_f32 v152, v152
    v_exp_f32 v153, v153
    v_exp_f32 v154, v154
    v_exp_f32 v155, v155
    v_exp_f32 v184, v184
    v_exp_f32 v185, v185
    v_exp_f32 v186, v186
    v_exp_f32 v187, v187
    v_accvgpr_read_b32 v68, a24
    v_accvgpr_read_b32 v69, a25
    v_accvgpr_read_b32 v70, a26
    v_accvgpr_read_b32 v71, a27
    v_accvgpr_read_b32 v72, a56
    v_accvgpr_read_b32 v73, a57
    v_accvgpr_read_b32 v74, a58
    v_pk_add_f32 v[152:153], v[152:153], 1.0 op_sel_hi:[1,0]
    v_pk_add_f32 v[154:155], v[154:155], 1.0 op_sel_hi:[1,0]
    v_pk_add_f32 v[184:185], v[184:185], 1.0 op_sel_hi:[1,0]
    v_pk_add_f32 v[186:187], v[186:187], 1.0 op_sel_hi:[1,0]
    v_rcp_f32 v152, v152
    v_rcp_f32 v153, v153
    v_rcp_f32 v154, v154
    v_rcp_f32 v155, v155
    v_rcp_f32 v184, v184
    v_rcp_f32 v185, v185
    v_rcp_f32 v186, v186
    v_rcp_f32 v187, v187
    v_accvgpr_read_b32 v75, a59
    v_pk_mul_f32 v[152:153], v[152:153], v[68:69]
    v_pk_mul_f32 v[154:155], v[154:155], v[70:71]
    v_pk_mul_f32 v[184:185], v[184:185], v[72:73]
    v_pk_mul_f32 v[186:187], v[186:187], v[74:75]
    v_cvt_pk_bf16_f32 v187, v186, v187
    v_cvt_pk_bf16_f32 v186, v184, v185
    v_cvt_pk_bf16_f32 v185, v154, v155
    v_cvt_pk_bf16_f32 v184, v152, v153
    v_pk_mul_f32 v[216:217], v[216:217], s[0:1]
    v_pk_mul_f32 v[218:219], v[218:219], s[0:1]
    v_exp_f32 v216, v216
    v_exp_f32 v217, v217
    v_exp_f32 v218, v218
    v_exp_f32 v219, v219
    v_accvgpr_read_b32 v76, a88
    v_accvgpr_read_b32 v77, a89
    v_accvgpr_read_b32 v78, a90
    v_pk_add_f32 v[216:217], v[216:217], 1.0 op_sel_hi:[1,0]
    v_pk_add_f32 v[218:219], v[218:219], 1.0 op_sel_hi:[1,0]
    v_rcp_f32 v216, v216
    v_rcp_f32 v217, v217
    v_rcp_f32 v218, v218
    v_rcp_f32 v219, v219
    v_accvgpr_read_b32 v79, a91
    v_pk_mul_f32 v[216:217], v[216:217], v[76:77]
    v_pk_mul_f32 v[218:219], v[218:219], v[78:79]
    v_cvt_pk_bf16_f32 v216, v216, v217
    v_cvt_pk_bf16_f32 v217, v218, v219
    v_pk_mul_f32 v[156:157], v[156:157], s[0:1]
    v_pk_mul_f32 v[158:159], v[158:159], s[0:1]
    v_pk_mul_f32 v[188:189], v[188:189], s[0:1]
    v_pk_mul_f32 v[190:191], v[190:191], s[0:1]
    v_exp_f32 v156, v156
    v_exp_f32 v157, v157
    v_exp_f32 v158, v158
    v_exp_f32 v159, v159
    v_exp_f32 v188, v188
    v_exp_f32 v189, v189
    v_exp_f32 v190, v190
    v_exp_f32 v191, v191
    v_accvgpr_read_b32 v68, a28
    v_accvgpr_read_b32 v69, a29
    v_accvgpr_read_b32 v70, a30
    v_accvgpr_read_b32 v71, a31
    v_accvgpr_read_b32 v72, a60
    v_accvgpr_read_b32 v73, a61
    v_accvgpr_read_b32 v74, a62
    v_pk_add_f32 v[156:157], v[156:157], 1.0 op_sel_hi:[1,0]
    v_pk_add_f32 v[158:159], v[158:159], 1.0 op_sel_hi:[1,0]
    v_pk_add_f32 v[188:189], v[188:189], 1.0 op_sel_hi:[1,0]
    v_pk_add_f32 v[190:191], v[190:191], 1.0 op_sel_hi:[1,0]
    v_rcp_f32 v156, v156
    v_rcp_f32 v157, v157
    v_rcp_f32 v158, v158
    v_rcp_f32 v159, v159
    v_rcp_f32 v188, v188
    v_rcp_f32 v189, v189
    v_rcp_f32 v190, v190
    v_rcp_f32 v191, v191
    v_accvgpr_read_b32 v75, a63
    v_pk_mul_f32 v[156:157], v[156:157], v[68:69]
    v_pk_mul_f32 v[158:159], v[158:159], v[70:71]
    v_pk_mul_f32 v[188:189], v[188:189], v[72:73]
    v_pk_mul_f32 v[190:191], v[190:191], v[74:75]
    v_cvt_pk_bf16_f32 v191, v190, v191
    v_cvt_pk_bf16_f32 v190, v188, v189
    v_cvt_pk_bf16_f32 v189, v158, v159
    v_cvt_pk_bf16_f32 v188, v156, v157
    buffer_load_dwordx4 v[88:91], v92, s[20:23], s59 offen sc1
    v_pk_mul_f32 v[220:221], v[220:221], s[0:1]
    v_pk_mul_f32 v[222:223], v[222:223], s[0:1]
    v_exp_f32 v220, v220
    v_exp_f32 v221, v221
    v_exp_f32 v222, v222
    v_exp_f32 v223, v223
    v_accvgpr_read_b32 v76, a92
    v_accvgpr_read_b32 v77, a93
    v_accvgpr_read_b32 v78, a94
    v_pk_add_f32 v[220:221], v[220:221], 1.0 op_sel_hi:[1,0]
    v_pk_add_f32 v[222:223], v[222:223], 1.0 op_sel_hi:[1,0]
    v_rcp_f32 v220, v220
    v_rcp_f32 v221, v221
    v_rcp_f32 v222, v222
    v_rcp_f32 v223, v223
    v_accvgpr_read_b32 v79, a95
    v_pk_mul_f32 v[220:221], v[220:221], v[76:77]
    v_pk_mul_f32 v[222:223], v[222:223], v[78:79]
    v_cvt_pk_bf16_f32 v220, v220, v221
    v_cvt_pk_bf16_f32 v221, v222, v223
    s_mov_b32 s4, 0x3e8293ee
    s_mov_b32 s5, 0x3e8293ee
    s_lshr_b32 s6, s28, 1
    s_lshl_b32 s6, s6, 13
    v_accvgpr_read_b32 v68, a96
    v_accvgpr_read_b32 v69, a97
    v_accvgpr_read_b32 v70, a98
    v_accvgpr_read_b32 v71, a99
    s_xor_b32 s3, s31, 0
    s_lshr_b32 s7, s3, 1
    s_lshl_b32 s7, s7, 11
    s_and_b32 s3, s3, 1
    s_lshl_b32 s3, s3, 8
    s_add_u32 s3, s3, s7
    s_add_u32 s3, s3, s6
    v_add_u32 v72, s3, v119
    v_pk_mul_f32 v[224:225], v[224:225], s[4:5]
    v_pk_mul_f32 v[68:69], v[68:69], s[4:5]
    v_pk_mul_f32 v[226:227], v[226:227], s[4:5]
    v_pk_mul_f32 v[70:71], v[70:71], s[4:5]
    v_cvt_pk_bf16_f32 v224, v224, v225
    v_cvt_pk_bf16_f32 v225, v226, v227
    v_cvt_pk_bf16_f32 v226, v68, v69
    v_cvt_pk_bf16_f32 v227, v70, v71
    ds_write_b128 v72, v[224:227]
    v_accvgpr_read_b32 v76, a100
    v_accvgpr_read_b32 v77, a101
    v_accvgpr_read_b32 v78, a102
    v_accvgpr_read_b32 v79, a103
    s_xor_b32 s3, s31, 1
    s_lshr_b32 s7, s3, 1
    s_lshl_b32 s7, s7, 11
    s_and_b32 s3, s3, 1
    s_lshl_b32 s3, s3, 8
    s_add_u32 s3, s3, s7
    s_add_u32 s3, s3, s6
    v_add_u32 v80, s3, v119
    v_pk_mul_f32 v[228:229], v[228:229], s[4:5]
    v_pk_mul_f32 v[76:77], v[76:77], s[4:5]
    v_pk_mul_f32 v[230:231], v[230:231], s[4:5]
    v_pk_mul_f32 v[78:79], v[78:79], s[4:5]
    v_cvt_pk_bf16_f32 v228, v228, v229
    v_cvt_pk_bf16_f32 v229, v230, v231
    v_cvt_pk_bf16_f32 v230, v76, v77
    v_cvt_pk_bf16_f32 v231, v78, v79
    ds_write_b128 v80, v[228:231]
    v_accvgpr_read_b32 v68, a104
    v_accvgpr_read_b32 v69, a105
    v_accvgpr_read_b32 v70, a106
    v_accvgpr_read_b32 v71, a107
    s_xor_b32 s3, s31, 2
    s_lshr_b32 s7, s3, 1
    s_lshl_b32 s7, s7, 11
    s_and_b32 s3, s3, 1
    s_lshl_b32 s3, s3, 8
    s_add_u32 s3, s3, s7
    s_add_u32 s3, s3, s6
    v_add_u32 v72, s3, v119
    v_pk_mul_f32 v[232:233], v[232:233], s[4:5]
    v_pk_mul_f32 v[68:69], v[68:69], s[4:5]
    v_pk_mul_f32 v[234:235], v[234:235], s[4:5]
    v_pk_mul_f32 v[70:71], v[70:71], s[4:5]
    v_cvt_pk_bf16_f32 v232, v232, v233
    v_cvt_pk_bf16_f32 v233, v234, v235
    v_cvt_pk_bf16_f32 v234, v68, v69
    v_cvt_pk_bf16_f32 v235, v70, v71
    ds_write_b128 v72, v[232:235]
    v_accvgpr_read_b32 v76, a108
    v_accvgpr_read_b32 v77, a109
    v_accvgpr_read_b32 v78, a110
    v_accvgpr_read_b32 v79, a111
    s_xor_b32 s3, s31, 3
    s_lshr_b32 s7, s3, 1
    s_lshl_b32 s7, s7, 11
    s_and_b32 s3, s3, 1
    s_lshl_b32 s3, s3, 8
    s_add_u32 s3, s3, s7
    s_add_u32 s3, s3, s6
    v_add_u32 v80, s3, v119
    v_pk_mul_f32 v[236:237], v[236:237], s[4:5]
    v_pk_mul_f32 v[76:77], v[76:77], s[4:5]
    v_pk_mul_f32 v[238:239], v[238:239], s[4:5]
    v_pk_mul_f32 v[78:79], v[78:79], s[4:5]
    v_cvt_pk_bf16_f32 v236, v236, v237
    v_cvt_pk_bf16_f32 v237, v238, v239
    v_cvt_pk_bf16_f32 v238, v76, v77
    v_cvt_pk_bf16_f32 v239, v78, v79
    ds_write_b128 v80, v[236:239]
    s_mov_b32 s3, 0
    s_waitcnt vmcnt(0)
K_SPIN_KV1:
    v_cmp_ne_u64 vcc, s[46:47], v[88:89]
    v_cmp_ne_u64 s[4:5], s[46:47], v[90:91]
    s_nop 4
    s_or_b64 vcc, vcc, s[4:5]
    s_cmp_eq_u64 vcc, 0
    s_cbranch_scc0 K_SPIN_KV1_RETRY
K_SPIN_KV1_OK:
    s_add_u32 m0, s25, 32768
    s_nop 0
    buffer_load_dwordx4 v92, s[8:11], s24 offen offset:0 sc1 lds
    buffer_load_dwordx4 v92, s[8:11], s24 offen offset:1024 sc1 lds
    buffer_load_dwordx4 v92, s[8:11], s24 offen offset:2048 sc1 lds
    buffer_load_dwordx4 v92, s[8:11], s24 offen offset:3072 sc1 lds
    s_add_u32 s24, s24, 16384
    s_add_u32 s25, s25, 16384
    s_and_b32 s25, s25, 131071
    s_add_u32 m0, s25, 32768
    s_nop 0
    buffer_load_dwordx4 v92, s[8:11], s24 offen offset:0 sc1 lds
    buffer_load_dwordx4 v92, s[8:11], s24 offen offset:1024 sc1 lds
    buffer_load_dwordx4 v92, s[8:11], s24 offen offset:2048 sc1 lds
    buffer_load_dwordx4 v92, s[8:11], s24 offen offset:3072 sc1 lds
    s_add_u32 s24, s24, 16384
    s_add_u32 s25, s25, 16384
    s_and_b32 s25, s25, 131071
    s_mov_b32 s4, 0x3e8293ee
    s_mov_b32 s5, 0x3e8293ee
    v_accvgpr_read_b32 v68, a112
    v_accvgpr_read_b32 v69, a113
    v_accvgpr_read_b32 v70, a114
    v_accvgpr_read_b32 v71, a115
    s_xor_b32 s3, s31, 4
    s_lshr_b32 s7, s3, 1
    s_lshl_b32 s7, s7, 11
    s_and_b32 s3, s3, 1
    s_lshl_b32 s3, s3, 8
    s_add_u32 s3, s3, s7
    s_add_u32 s3, s3, s6
    v_add_u32_e64 v72, s3, v119
    v_pk_mul_f32 v[240:241], v[240:241], s[4:5]
    v_pk_mul_f32 v[68:69], v[68:69], s[4:5]
    v_pk_mul_f32 v[242:243], v[242:243], s[4:5]
    v_pk_mul_f32 v[70:71], v[70:71], s[4:5]
    v_cvt_pk_bf16_f32 v240, v240, v241
    v_cvt_pk_bf16_f32 v241, v242, v243
    v_cvt_pk_bf16_f32 v242, v68, v69
    v_cvt_pk_bf16_f32 v243, v70, v71
    ds_write_b128 v72, v[240:243]
    v_accvgpr_read_b32 v76, a116
    v_accvgpr_read_b32 v77, a117
    v_accvgpr_read_b32 v78, a118
    v_accvgpr_read_b32 v79, a119
    s_xor_b32 s3, s31, 5
    s_lshr_b32 s7, s3, 1
    s_lshl_b32 s7, s7, 11
    s_and_b32 s3, s3, 1
    s_lshl_b32 s3, s3, 8
    s_add_u32 s3, s3, s7
    s_add_u32 s3, s3, s6
    v_add_u32 v80, s3, v119
    v_pk_mul_f32 v[244:245], v[244:245], s[4:5]
    v_pk_mul_f32 v[76:77], v[76:77], s[4:5]
    v_pk_mul_f32 v[246:247], v[246:247], s[4:5]
    v_pk_mul_f32 v[78:79], v[78:79], s[4:5]
    v_cvt_pk_bf16_f32 v244, v244, v245
    v_cvt_pk_bf16_f32 v245, v246, v247
    v_cvt_pk_bf16_f32 v246, v76, v77
    v_cvt_pk_bf16_f32 v247, v78, v79
    ds_write_b128 v80, v[244:247]
    v_accvgpr_read_b32 v68, a120
    v_accvgpr_read_b32 v69, a121
    v_accvgpr_read_b32 v70, a122
    v_accvgpr_read_b32 v71, a123
    s_xor_b32 s3, s31, 6
    s_lshr_b32 s7, s3, 1
    s_lshl_b32 s7, s7, 11
    s_and_b32 s3, s3, 1
    s_lshl_b32 s3, s3, 8
    s_add_u32 s3, s3, s7
    s_add_u32 s3, s3, s6
    v_add_u32 v72, s3, v119
    v_pk_mul_f32 v[248:249], v[248:249], s[4:5]
    v_pk_mul_f32 v[68:69], v[68:69], s[4:5]
    v_pk_mul_f32 v[250:251], v[250:251], s[4:5]
    v_pk_mul_f32 v[70:71], v[70:71], s[4:5]
    v_cvt_pk_bf16_f32 v248, v248, v249
    v_cvt_pk_bf16_f32 v249, v250, v251
    v_cvt_pk_bf16_f32 v250, v68, v69
    v_cvt_pk_bf16_f32 v251, v70, v71
    ds_write_b128 v72, v[248:251]
    v_accvgpr_read_b32 v76, a124
    v_accvgpr_read_b32 v77, a125
    v_accvgpr_read_b32 v78, a126
    v_accvgpr_read_b32 v79, a127
    s_xor_b32 s3, s31, 7
    s_lshr_b32 s7, s3, 1
    s_lshl_b32 s7, s7, 11
    s_and_b32 s3, s3, 1
    s_lshl_b32 s3, s3, 8
    s_add_u32 s3, s3, s7
    s_add_u32 s3, s3, s6
    v_add_u32 v80, s3, v119
    v_pk_mul_f32 v[252:253], v[252:253], s[4:5]
    v_pk_mul_f32 v[76:77], v[76:77], s[4:5]
    v_pk_mul_f32 v[254:255], v[254:255], s[4:5]
    v_pk_mul_f32 v[78:79], v[78:79], s[4:5]
    v_cvt_pk_bf16_f32 v252, v252, v253
    v_cvt_pk_bf16_f32 v253, v254, v255
    v_cvt_pk_bf16_f32 v254, v76, v77
    v_cvt_pk_bf16_f32 v255, v78, v79
    ds_write_b128 v80, v[252:255]
K_P2:
    s_waitcnt vmcnt(4)
    s_waitcnt lgkmcnt(0)
    s_barrier
    ds_read_b128 v[20:23], v93 offset:0
    ds_read_b128 v[24:27], v93 offset:1024
    ds_read_b128 v[28:31], v93 offset:2048
    ds_read_b128 v[32:35], v93 offset:3072
    ds_read_b128 v[36:39], v94
    ds_read_b128 v[40:43], v94 offset:1024
    v_add_u32 v19, 0x10000, v94
    s_waitcnt lgkmcnt(0)
    v_mfma_f32_32x32x16_bf16 v[68:83], v[36:39], v[20:23], 0
    ds_read_b128 v[44:47], v94 offset:4096
    v_mfma_f32_32x32x16_bf16 v[68:83], v[40:43], v[24:27], v[68:83]
    ds_read_b128 v[48:51], v94 offset:5120
    s_add_u32 m0, s25, 32768
    s_nop 0
    buffer_load_dwordx4 v92, s[8:11], s24 offen offset:0 sc1 lds
    buffer_load_dwordx4 v92, s[8:11], s24 offen offset:1024 sc1 lds
    buffer_load_dwordx4 v92, s[8:11], s24 offen offset:2048 sc1 lds
    buffer_load_dwordx4 v92, s[8:11], s24 offen offset:3072 sc1 lds
    s_add_u32 s24, s24, 16384
    s_nop 7
    v_mfma_f32_32x32x16_bf16 v[224:239], v[36:39], v[28:31], 0
    ds_read_b128 v[52:55], v94 offset:2048
    v_exp_f32 v68, v68
    v_exp_f32 v69, v69
    v_exp_f32 v70, v70
    v_mfma_f32_32x32x16_bf16 v[224:239], v[40:43], v[32:35], v[224:239]
    ds_read_b128 v[56:59], v94 offset:3072
    v_cvt_pk_bf16_f32 v240, v68, v69
    v_exp_f32 v71, v71
    v_exp_f32 v72, v72
    v_cvt_pk_bf16_f32 v241, v70, v71
    v_exp_f32 v73, v73
    s_add_u32 m0, s25, 49152
    s_nop 0
    buffer_load_dwordx4 v92, s[8:11], s24 offen offset:0 sc1 lds
    v_exp_f32 v74, v74
    buffer_load_dwordx4 v92, s[8:11], s24 offen offset:1024 sc1 lds
    v_exp_f32 v75, v75
    v_cvt_pk_bf16_f32 v242, v72, v73
    v_cvt_pk_bf16_f32 v243, v74, v75
    buffer_load_dwordx4 v92, s[8:11], s24 offen offset:2048 sc1 lds
    v_exp_f32 v76, v76
    v_exp_f32 v77, v77
    v_exp_f32 v78, v78
    s_waitcnt lgkmcnt(0)
    buffer_load_dwordx4 v92, s[8:11], s24 offen offset:3072 sc1 lds
    s_add_u32 s24, s24, 16384
    v_cvt_pk_bf16_f32 v244, v76, v77
    v_exp_f32 v79, v79
    v_exp_f32 v80, v80
    v_cvt_pk_bf16_f32 v245, v78, v79
    v_exp_f32 v81, v81
    v_exp_f32 v82, v82
    v_exp_f32 v83, v83
    v_cvt_pk_bf16_f32 v246, v80, v81
    v_cvt_pk_bf16_f32 v247, v82, v83
    v_mfma_f32_32x32x16_bf16 v[68:83], v[44:47], v[20:23], 0
    ds_read_b128 v[36:39], v94 offset:8192
    v_exp_f32 v224, v224
    v_exp_f32 v225, v225
    v_exp_f32 v226, v226
    v_mfma_f32_32x32x16_bf16 v[68:83], v[48:51], v[24:27], v[68:83]
    ds_read_b128 v[40:43], v94 offset:9216
    v_cvt_pk_bf16_f32 v248, v224, v225
    v_exp_f32 v227, v227
    v_exp_f32 v228, v228
    v_cvt_pk_bf16_f32 v249, v226, v227
    v_exp_f32 v229, v229
    v_mfma_f32_16x16x32_bf16 v[8:11], v[96:99], v[240:243], 0
    s_add_u32 m0, s25, 65536
    s_nop 0
    buffer_load_dwordx4 v92, s[8:11], s24 offen offset:0 sc1 lds
    v_exp_f32 v230, v230
    v_mfma_f32_16x16x32_bf16 v[8:11], v[96:99], v[244:247], v[8:11]
    buffer_load_dwordx4 v92, s[8:11], s24 offen offset:1024 sc1 lds
    v_exp_f32 v231, v231
    v_cvt_pk_bf16_f32 v250, v228, v229
    v_cvt_pk_bf16_f32 v251, v230, v231
    v_mfma_f32_32x32x16_bf16 v[128:143], v[52:55], v[240:243], 0
    buffer_load_dwordx4 v92, s[8:11], s24 offen offset:2048 sc1 lds
    v_exp_f32 v232, v232
    v_exp_f32 v233, v233
    v_exp_f32 v234, v234
    v_mfma_f32_32x32x16_bf16 v[128:143], v[56:59], v[244:247], v[128:143]
    buffer_load_dwordx4 v92, s[8:11], s24 offen offset:3072 sc1 lds
    s_add_u32 s24, s24, 16384
    v_cvt_pk_bf16_f32 v252, v232, v233
    v_exp_f32 v235, v235
    v_exp_f32 v236, v236
    v_cvt_pk_bf16_f32 v253, v234, v235
    v_exp_f32 v237, v237
    v_exp_f32 v238, v238
    v_exp_f32 v239, v239
    v_cvt_pk_bf16_f32 v254, v236, v237
    v_cvt_pk_bf16_f32 v255, v238, v239
    v_mfma_f32_32x32x16_bf16 v[224:239], v[44:47], v[28:31], 0
    ds_read_b128 v[60:63], v94 offset:6144
    v_exp_f32 v68, v68
    v_exp_f32 v69, v69
    v_exp_f32 v70, v70
    v_mfma_f32_32x32x16_bf16 v[224:239], v[48:51], v[32:35], v[224:239]
    ds_read_b128 v[64:67], v94 offset:7168
    v_cvt_pk_bf16_f32 v240, v68, v69
    v_exp_f32 v71, v71
    v_exp_f32 v72, v72
    v_cvt_pk_bf16_f32 v241, v70, v71
    v_exp_f32 v73, v73
    v_mfma_f32_16x16x32_bf16 v[12:15], v[96:99], v[248:251], 0
    s_add_u32 m0, s25, 81920
    s_nop 0
    buffer_load_dwordx4 v92, s[8:11], s24 offen offset:0 sc1 lds
    v_exp_f32 v74, v74
    v_mfma_f32_16x16x32_bf16 v[12:15], v[96:99], v[252:255], v[12:15]
    buffer_load_dwordx4 v92, s[8:11], s24 offen offset:1024 sc1 lds
    v_exp_f32 v75, v75
    v_cvt_pk_bf16_f32 v242, v72, v73
    v_cvt_pk_bf16_f32 v243, v74, v75
    v_mfma_f32_32x32x16_bf16 v[144:159], v[52:55], v[248:251], 0
    buffer_load_dwordx4 v92, s[8:11], s24 offen offset:2048 sc1 lds
    v_exp_f32 v76, v76
    v_exp_f32 v77, v77
    v_exp_f32 v78, v78
    v_mfma_f32_32x32x16_bf16 v[144:159], v[56:59], v[252:255], v[144:159]
    s_waitcnt lgkmcnt(0)
    buffer_load_dwordx4 v92, s[8:11], s24 offen offset:3072 sc1 lds
    s_add_u32 s24, s24, 16384
    v_cvt_pk_bf16_f32 v244, v76, v77
    v_exp_f32 v79, v79
    v_exp_f32 v80, v80
    v_cvt_pk_bf16_f32 v245, v78, v79
    v_exp_f32 v81, v81
    v_exp_f32 v82, v82
    v_exp_f32 v83, v83
    v_cvt_pk_bf16_f32 v246, v80, v81
    v_cvt_pk_bf16_f32 v247, v82, v83
    v_mfma_f32_32x32x16_bf16 v[68:83], v[36:39], v[20:23], 0
    ds_read_b128 v[44:47], v94 offset:12288
    v_exp_f32 v224, v224
    v_exp_f32 v225, v225
    v_exp_f32 v226, v226
    v_mfma_f32_32x32x16_bf16 v[68:83], v[40:43], v[24:27], v[68:83]
    ds_read_b128 v[48:51], v94 offset:13312
    v_cvt_pk_bf16_f32 v248, v224, v225
    v_exp_f32 v227, v227
    v_exp_f32 v228, v228
    v_cvt_pk_bf16_f32 v249, v226, v227
    v_exp_f32 v229, v229
    v_mfma_f32_16x16x32_bf16 v[8:11], v[96:99], v[240:243], v[8:11]
    s_add_u32 m0, s25, 98304
    s_nop 0
    buffer_load_dwordx4 v92, s[8:11], s24 offen offset:0 sc1 lds
    v_exp_f32 v230, v230
    v_mfma_f32_16x16x32_bf16 v[8:11], v[96:99], v[244:247], v[8:11]
    buffer_load_dwordx4 v92, s[8:11], s24 offen offset:1024 sc1 lds
    v_exp_f32 v231, v231
    v_cvt_pk_bf16_f32 v250, v228, v229
    v_cvt_pk_bf16_f32 v251, v230, v231
    v_mfma_f32_32x32x16_bf16 v[128:143], v[60:63], v[240:243], v[128:143]
    buffer_load_dwordx4 v92, s[8:11], s24 offen offset:2048 sc1 lds
    v_exp_f32 v232, v232
    v_exp_f32 v233, v233
    v_exp_f32 v234, v234
    v_mfma_f32_32x32x16_bf16 v[128:143], v[64:67], v[244:247], v[128:143]
    buffer_load_dwordx4 v92, s[8:11], s24 offen offset:3072 sc1 lds
    s_add_u32 s24, s24, 16384
    v_cvt_pk_bf16_f32 v252, v232, v233
    v_exp_f32 v235, v235
    v_exp_f32 v236, v236
    v_cvt_pk_bf16_f32 v253, v234, v235
    v_exp_f32 v237, v237
    v_exp_f32 v238, v238
    v_exp_f32 v239, v239
    v_cvt_pk_bf16_f32 v254, v236, v237
    v_cvt_pk_bf16_f32 v255, v238, v239
    v_mfma_f32_32x32x16_bf16 v[224:239], v[36:39], v[28:31], 0
    ds_read_b128 v[52:55], v94 offset:10240
    v_exp_f32 v68, v68
    v_exp_f32 v69, v69
    v_exp_f32 v70, v70
    v_mfma_f32_32x32x16_bf16 v[224:239], v[40:43], v[32:35], v[224:239]
    ds_read_b128 v[56:59], v94 offset:11264
    v_cvt_pk_bf16_f32 v240, v68, v69
    v_exp_f32 v71, v71
    v_exp_f32 v72, v72
    v_cvt_pk_bf16_f32 v241, v70, v71
    v_exp_f32 v73, v73
    v_mfma_f32_16x16x32_bf16 v[12:15], v[96:99], v[248:251], v[12:15]
    s_sub_u32 s25, s25, 32768
    v_exp_f32 v74, v74
    v_mfma_f32_16x16x32_bf16 v[12:15], v[96:99], v[252:255], v[12:15]
    v_exp_f32 v75, v75
    v_cvt_pk_bf16_f32 v242, v72, v73
    v_cvt_pk_bf16_f32 v243, v74, v75
    v_mfma_f32_32x32x16_bf16 v[144:159], v[60:63], v[248:251], v[144:159]
    v_exp_f32 v76, v76
    v_exp_f32 v77, v77
    v_exp_f32 v78, v78
    v_mfma_f32_32x32x16_bf16 v[144:159], v[64:67], v[252:255], v[144:159]
    s_waitcnt lgkmcnt(0)
    v_cvt_pk_bf16_f32 v244, v76, v77
    v_exp_f32 v79, v79
    v_exp_f32 v80, v80
    v_cvt_pk_bf16_f32 v245, v78, v79
    v_exp_f32 v81, v81
    v_exp_f32 v82, v82
    v_exp_f32 v83, v83
    v_cvt_pk_bf16_f32 v246, v80, v81
    v_cvt_pk_bf16_f32 v247, v82, v83
    s_waitcnt vmcnt(16)
    s_barrier
    v_mfma_f32_32x32x16_bf16 v[68:83], v[44:47], v[20:23], 0
    ds_read_b128 v[36:39], v94 offset:16384
    v_exp_f32 v224, v224
    v_exp_f32 v225, v225
    v_exp_f32 v226, v226
    v_mfma_f32_32x32x16_bf16 v[68:83], v[48:51], v[24:27], v[68:83]
    ds_read_b128 v[40:43], v94 offset:17408
    s_add_u32 m0, s25, 147456
    v_cvt_pk_bf16_f32 v248, v224, v225
    v_exp_f32 v227, v227
    v_exp_f32 v228, v228
    v_cvt_pk_bf16_f32 v249, v226, v227
    v_exp_f32 v229, v229
    v_mfma_f32_16x16x32_bf16 v[8:11], v[96:99], v[240:243], v[8:11]
    buffer_load_dwordx4 v92, s[8:11], s24 offen offset:0 sc1 lds
    v_exp_f32 v230, v230
    v_mfma_f32_16x16x32_bf16 v[8:11], v[96:99], v[244:247], v[8:11]
    buffer_load_dwordx4 v92, s[8:11], s24 offen offset:1024 sc1 lds
    v_exp_f32 v231, v231
    v_cvt_pk_bf16_f32 v250, v228, v229
    v_cvt_pk_bf16_f32 v251, v230, v231
    v_mfma_f32_32x32x16_bf16 v[128:143], v[52:55], v[240:243], v[128:143]
    buffer_load_dwordx4 v92, s[8:11], s24 offen offset:2048 sc1 lds
    v_exp_f32 v232, v232
    v_exp_f32 v233, v233
    v_exp_f32 v234, v234
    v_mfma_f32_32x32x16_bf16 v[128:143], v[56:59], v[244:247], v[128:143]
    buffer_load_dwordx4 v92, s[8:11], s24 offen offset:3072 sc1 lds
    s_add_u32 s24, s24, 16384
    v_cvt_pk_bf16_f32 v252, v232, v233
    v_exp_f32 v235, v235
    v_exp_f32 v236, v236
    v_cvt_pk_bf16_f32 v253, v234, v235
    v_exp_f32 v237, v237
    v_exp_f32 v238, v238
    v_exp_f32 v239, v239
    v_cvt_pk_bf16_f32 v254, v236, v237
    v_cvt_pk_bf16_f32 v255, v238, v239
    v_mfma_f32_32x32x16_bf16 v[224:239], v[44:47], v[28:31], 0
    ds_read_b128 v[60:63], v94 offset:14336
    v_exp_f32 v68, v68
    v_exp_f32 v69, v69
    v_exp_f32 v70, v70
    v_mfma_f32_32x32x16_bf16 v[224:239], v[48:51], v[32:35], v[224:239]
    ds_read_b128 v[64:67], v94 offset:15360
    v_cvt_pk_bf16_f32 v240, v68, v69
    v_exp_f32 v71, v71
    v_exp_f32 v72, v72
    v_cvt_pk_bf16_f32 v241, v70, v71
    v_exp_f32 v73, v73
    v_mfma_f32_16x16x32_bf16 v[12:15], v[96:99], v[248:251], v[12:15]
    v_exp_f32 v74, v74
    v_mfma_f32_16x16x32_bf16 v[12:15], v[96:99], v[252:255], v[12:15]
    v_exp_f32 v75, v75
    v_cvt_pk_bf16_f32 v242, v72, v73
    v_cvt_pk_bf16_f32 v243, v74, v75
    v_mfma_f32_32x32x16_bf16 v[144:159], v[52:55], v[248:251], v[144:159]
    v_exp_f32 v76, v76
    v_exp_f32 v77, v77
    v_exp_f32 v78, v78
    v_mfma_f32_32x32x16_bf16 v[144:159], v[56:59], v[252:255], v[144:159]
    s_waitcnt lgkmcnt(0)
    v_cvt_pk_bf16_f32 v244, v76, v77
    v_exp_f32 v79, v79
    v_exp_f32 v80, v80
    v_cvt_pk_bf16_f32 v245, v78, v79
    v_exp_f32 v81, v81
    v_exp_f32 v82, v82
    v_exp_f32 v83, v83
    v_cvt_pk_bf16_f32 v246, v80, v81
    v_cvt_pk_bf16_f32 v247, v82, v83
    v_mfma_f32_32x32x16_bf16 v[68:83], v[36:39], v[20:23], 0
    ds_read_b128 v[44:47], v94 offset:20480
    v_exp_f32 v224, v224
    v_exp_f32 v225, v225
    v_exp_f32 v226, v226
    v_mfma_f32_32x32x16_bf16 v[68:83], v[40:43], v[24:27], v[68:83]
    ds_read_b128 v[48:51], v94 offset:21504
    v_cvt_pk_bf16_f32 v248, v224, v225
    v_exp_f32 v227, v227
    v_exp_f32 v228, v228
    v_cvt_pk_bf16_f32 v249, v226, v227
    v_exp_f32 v229, v229
    v_mfma_f32_16x16x32_bf16 v[8:11], v[96:99], v[240:243], v[8:11]
    s_xor_b32 s3, s31, 0
    v_exp_f32 v230, v230
    v_mfma_f32_16x16x32_bf16 v[8:11], v[96:99], v[244:247], v[8:11]
    s_add_u32 s3, s3, s85
    v_exp_f32 v231, v231
    v_cvt_pk_bf16_f32 v250, v228, v229
    v_cvt_pk_bf16_f32 v251, v230, v231
    v_mfma_f32_32x32x16_bf16 v[128:143], v[60:63], v[240:243], v[128:143]
    s_mul_i32 s3, s3, 147456
    s_add_u32 s3, s3, s48
    v_exp_f32 v232, v232
    v_exp_f32 v233, v233
    v_exp_f32 v234, v234
    v_mfma_f32_32x32x16_bf16 v[128:143], v[64:67], v[244:247], v[128:143]
    buffer_store_dwordx4 v[160:163], v92, s[20:23], s3 offen sc1
    v_cvt_pk_bf16_f32 v252, v232, v233
    v_exp_f32 v235, v235
    v_exp_f32 v236, v236
    v_cvt_pk_bf16_f32 v253, v234, v235
    v_exp_f32 v237, v237
    v_exp_f32 v238, v238
    v_exp_f32 v239, v239
    v_cvt_pk_bf16_f32 v254, v236, v237
    v_cvt_pk_bf16_f32 v255, v238, v239
    v_mfma_f32_32x32x16_bf16 v[224:239], v[36:39], v[28:31], 0
    ds_read_b128 v[52:55], v94 offset:18432
    v_exp_f32 v68, v68
    v_exp_f32 v69, v69
    v_exp_f32 v70, v70
    v_mfma_f32_32x32x16_bf16 v[224:239], v[40:43], v[32:35], v[224:239]
    ds_read_b128 v[56:59], v94 offset:19456
    v_cvt_pk_bf16_f32 v240, v68, v69
    v_exp_f32 v71, v71
    v_exp_f32 v72, v72
    v_cvt_pk_bf16_f32 v241, v70, v71
    v_exp_f32 v73, v73
    v_mfma_f32_16x16x32_bf16 v[12:15], v[96:99], v[248:251], v[12:15]
    s_add_u32 s4, s3, s49
    v_exp_f32 v74, v74
    v_mfma_f32_16x16x32_bf16 v[12:15], v[96:99], v[252:255], v[12:15]
    s_add_u32 s5, s3, s50
    v_exp_f32 v75, v75
    v_cvt_pk_bf16_f32 v242, v72, v73
    v_cvt_pk_bf16_f32 v243, v74, v75
    v_mfma_f32_32x32x16_bf16 v[144:159], v[60:63], v[248:251], v[144:159]
    s_lshl_b32 s26, s29, 2
    v_exp_f32 v76, v76
    v_exp_f32 v77, v77
    v_exp_f32 v78, v78
    v_mfma_f32_32x32x16_bf16 v[144:159], v[64:67], v[252:255], v[144:159]
    s_waitcnt lgkmcnt(0)
    buffer_store_dwordx4 v[192:195], v92, s[20:23], s4 offen sc1
    v_cvt_pk_bf16_f32 v244, v76, v77
    v_exp_f32 v79, v79
    v_exp_f32 v80, v80
    v_cvt_pk_bf16_f32 v245, v78, v79
    v_exp_f32 v81, v81
    v_exp_f32 v82, v82
    v_exp_f32 v83, v83
    v_cvt_pk_bf16_f32 v246, v80, v81
    v_cvt_pk_bf16_f32 v247, v82, v83
    v_mfma_f32_32x32x16_bf16 v[68:83], v[44:47], v[20:23], 0
    ds_read_b128 v[36:39], v94 offset:24576
    v_exp_f32 v224, v224
    v_exp_f32 v225, v225
    v_exp_f32 v226, v226
    v_mfma_f32_32x32x16_bf16 v[68:83], v[48:51], v[24:27], v[68:83]
    ds_read_b128 v[40:43], v94 offset:25600
    v_cvt_pk_bf16_f32 v248, v224, v225
    v_exp_f32 v227, v227
    v_exp_f32 v228, v228
    v_cvt_pk_bf16_f32 v249, v226, v227
    v_exp_f32 v229, v229
    v_mfma_f32_16x16x32_bf16 v[8:11], v[96:99], v[240:243], v[8:11]
    s_add_u32 s26, s26, s28
    v_exp_f32 v230, v230
    v_mfma_f32_16x16x32_bf16 v[8:11], v[96:99], v[244:247], v[8:11]
    buffer_store_dwordx2 v[192:193], v92, s[20:23], s5 offen sc1
    v_exp_f32 v231, v231
    v_cvt_pk_bf16_f32 v250, v228, v229
    v_cvt_pk_bf16_f32 v251, v230, v231
    v_mfma_f32_32x32x16_bf16 v[128:143], v[52:55], v[240:243], v[128:143]
    buffer_store_dwordx2 v[84:85], v107, s[20:23], s51 offen sc1
    s_add_u32 s51, s51, 0x2000
    v_exp_f32 v232, v232
    v_exp_f32 v233, v233
    v_exp_f32 v234, v234
    v_mfma_f32_32x32x16_bf16 v[128:143], v[56:59], v[244:247], v[128:143]
    s_mul_i32 s36, s26, 589824
    v_cvt_pk_bf16_f32 v252, v232, v233
    v_exp_f32 v235, v235
    v_exp_f32 v236, v236
    v_cvt_pk_bf16_f32 v253, v234, v235
    v_exp_f32 v237, v237
    v_exp_f32 v238, v238
    v_exp_f32 v239, v239
    v_cvt_pk_bf16_f32 v254, v236, v237
    v_cvt_pk_bf16_f32 v255, v238, v239
    v_mfma_f32_32x32x16_bf16 v[224:239], v[44:47], v[28:31], 0
    ds_read_b128 v[60:63], v94 offset:22528
    v_exp_f32 v68, v68
    v_exp_f32 v69, v69
    v_exp_f32 v70, v70
    v_mfma_f32_32x32x16_bf16 v[224:239], v[48:51], v[32:35], v[224:239]
    ds_read_b128 v[64:67], v94 offset:23552
    v_cvt_pk_bf16_f32 v240, v68, v69
    v_exp_f32 v71, v71
    v_exp_f32 v72, v72
    v_cvt_pk_bf16_f32 v241, v70, v71
    v_exp_f32 v73, v73
    v_mfma_f32_16x16x32_bf16 v[12:15], v[96:99], v[248:251], v[12:15]
    s_xor_b32 s3, s31, 1
    v_exp_f32 v74, v74
    v_mfma_f32_16x16x32_bf16 v[12:15], v[96:99], v[252:255], v[12:15]
    s_add_u32 s3, s3, s85
    v_exp_f32 v75, v75
    v_cvt_pk_bf16_f32 v242, v72, v73
    v_cvt_pk_bf16_f32 v243, v74, v75
    v_mfma_f32_32x32x16_bf16 v[144:159], v[52:55], v[248:251], v[144:159]
    s_mul_i32 s3, s3, 147456
    s_add_u32 s3, s3, s48
    v_exp_f32 v76, v76
    v_exp_f32 v77, v77
    v_exp_f32 v78, v78
    v_mfma_f32_32x32x16_bf16 v[144:159], v[56:59], v[252:255], v[144:159]
    s_waitcnt lgkmcnt(0)
    buffer_store_dwordx4 v[164:167], v92, s[20:23], s3 offen sc1
    v_cvt_pk_bf16_f32 v244, v76, v77
    v_exp_f32 v79, v79
    v_exp_f32 v80, v80
    v_cvt_pk_bf16_f32 v245, v78, v79
    v_exp_f32 v81, v81
    v_exp_f32 v82, v82
    v_exp_f32 v83, v83
    v_cvt_pk_bf16_f32 v246, v80, v81
    v_cvt_pk_bf16_f32 v247, v82, v83
    v_mfma_f32_32x32x16_bf16 v[68:83], v[36:39], v[20:23], 0
    ds_read_b128 v[44:47], v94 offset:28672
    v_exp_f32 v224, v224
    v_exp_f32 v225, v225
    v_exp_f32 v226, v226
    v_mfma_f32_32x32x16_bf16 v[68:83], v[40:43], v[24:27], v[68:83]
    ds_read_b128 v[48:51], v94 offset:29696
    v_cvt_pk_bf16_f32 v248, v224, v225
    v_exp_f32 v227, v227
    v_exp_f32 v228, v228
    v_cvt_pk_bf16_f32 v249, v226, v227
    v_exp_f32 v229, v229
    v_mfma_f32_16x16x32_bf16 v[8:11], v[96:99], v[240:243], v[8:11]
    s_add_u32 s4, s3, s49
    v_exp_f32 v230, v230
    v_mfma_f32_16x16x32_bf16 v[8:11], v[96:99], v[244:247], v[8:11]
    s_add_u32 s5, s3, s50
    v_exp_f32 v231, v231
    v_cvt_pk_bf16_f32 v250, v228, v229
    v_cvt_pk_bf16_f32 v251, v230, v231
    v_mfma_f32_32x32x16_bf16 v[128:143], v[60:63], v[240:243], v[128:143]
    s_lshl_b32 s0, s30, 10
    v_exp_f32 v232, v232
    v_exp_f32 v233, v233
    v_exp_f32 v234, v234
    v_mfma_f32_32x32x16_bf16 v[128:143], v[64:67], v[244:247], v[128:143]
    buffer_store_dwordx4 v[196:199], v92, s[20:23], s4 offen sc1
    v_cvt_pk_bf16_f32 v252, v232, v233
    v_exp_f32 v235, v235
    v_exp_f32 v236, v236
    v_cvt_pk_bf16_f32 v253, v234, v235
    v_exp_f32 v237, v237
    v_exp_f32 v238, v238
    v_exp_f32 v239, v239
    v_cvt_pk_bf16_f32 v254, v236, v237
    v_cvt_pk_bf16_f32 v255, v238, v239
    v_mfma_f32_32x32x16_bf16 v[224:239], v[36:39], v[28:31], 0
    ds_read_b128 v[52:55], v94 offset:26624
    v_exp_f32 v68, v68
    v_exp_f32 v69, v69
    v_exp_f32 v70, v70
    v_mfma_f32_32x32x16_bf16 v[224:239], v[40:43], v[32:35], v[224:239]
    ds_read_b128 v[56:59], v94 offset:27648
    v_cvt_pk_bf16_f32 v240, v68, v69
    v_exp_f32 v71, v71
    v_exp_f32 v72, v72
    v_cvt_pk_bf16_f32 v241, v70, v71
    v_exp_f32 v73, v73
    v_mfma_f32_16x16x32_bf16 v[12:15], v[96:99], v[248:251], v[12:15]
    v_exp_f32 v74, v74
    v_mfma_f32_16x16x32_bf16 v[12:15], v[96:99], v[252:255], v[12:15]
    buffer_store_dwordx2 v[196:197], v92, s[20:23], s5 offen sc1
    v_exp_f32 v75, v75
    v_cvt_pk_bf16_f32 v242, v72, v73
    v_cvt_pk_bf16_f32 v243, v74, v75
    v_mfma_f32_32x32x16_bf16 v[144:159], v[60:63], v[248:251], v[144:159]
    v_exp_f32 v76, v76
    v_exp_f32 v77, v77
    v_exp_f32 v78, v78
    v_mfma_f32_32x32x16_bf16 v[144:159], v[64:67], v[252:255], v[144:159]
    s_waitcnt lgkmcnt(0)
    buffer_store_dwordx2 v[86:87], v107, s[20:23], s51 offen sc1
    v_cvt_pk_bf16_f32 v244, v76, v77
    v_exp_f32 v79, v79
    v_exp_f32 v80, v80
    v_cvt_pk_bf16_f32 v245, v78, v79
    v_exp_f32 v81, v81
    v_exp_f32 v82, v82
    v_exp_f32 v83, v83
    v_cvt_pk_bf16_f32 v246, v80, v81
    v_cvt_pk_bf16_f32 v247, v82, v83
    v_mfma_f32_32x32x16_bf16 v[68:83], v[44:47], v[20:23], 0
    ds_read_b128 v[36:39], v94 offset:32768
    v_exp_f32 v224, v224
    v_exp_f32 v225, v225
    v_exp_f32 v226, v226
    v_mfma_f32_32x32x16_bf16 v[68:83], v[48:51], v[24:27], v[68:83]
    ds_read_b128 v[40:43], v94 offset:33792
    v_cvt_pk_bf16_f32 v248, v224, v225
    v_exp_f32 v227, v227
    v_exp_f32 v228, v228
    v_cvt_pk_bf16_f32 v249, v226, v227
    v_exp_f32 v229, v229
    v_mfma_f32_16x16x32_bf16 v[8:11], v[96:99], v[240:243], v[8:11]
    v_exp_f32 v230, v230
    v_mfma_f32_16x16x32_bf16 v[8:11], v[96:99], v[244:247], v[8:11]
    v_exp_f32 v231, v231
    v_cvt_pk_bf16_f32 v250, v228, v229
    v_cvt_pk_bf16_f32 v251, v230, v231
    v_mfma_f32_32x32x16_bf16 v[128:143], v[52:55], v[240:243], v[128:143]
    v_exp_f32 v232, v232
    v_exp_f32 v233, v233
    v_exp_f32 v234, v234
    v_mfma_f32_32x32x16_bf16 v[128:143], v[56:59], v[244:247], v[128:143]
    v_cvt_pk_bf16_f32 v252, v232, v233
    v_exp_f32 v235, v235
    v_exp_f32 v236, v236
    v_cvt_pk_bf16_f32 v253, v234, v235
    v_exp_f32 v237, v237
    v_exp_f32 v238, v238
    v_exp_f32 v239, v239
    v_cvt_pk_bf16_f32 v254, v236, v237
    v_cvt_pk_bf16_f32 v255, v238, v239
    v_mfma_f32_32x32x16_bf16 v[224:239], v[44:47], v[28:31], 0
    ds_read_b128 v[60:63], v94 offset:30720
    v_exp_f32 v68, v68
    v_exp_f32 v69, v69
    v_exp_f32 v70, v70
    v_mfma_f32_32x32x16_bf16 v[224:239], v[48:51], v[32:35], v[224:239]
    ds_read_b128 v[64:67], v94 offset:31744
    v_cvt_pk_bf16_f32 v240, v68, v69
    v_exp_f32 v71, v71
    v_exp_f32 v72, v72
    v_cvt_pk_bf16_f32 v241, v70, v71
    v_exp_f32 v73, v73
    v_mfma_f32_16x16x32_bf16 v[12:15], v[96:99], v[248:251], v[12:15]
    v_exp_f32 v74, v74
    v_mfma_f32_16x16x32_bf16 v[12:15], v[96:99], v[252:255], v[12:15]
    v_exp_f32 v75, v75
    v_cvt_pk_bf16_f32 v242, v72, v73
    v_cvt_pk_bf16_f32 v243, v74, v75
    v_mfma_f32_32x32x16_bf16 v[144:159], v[52:55], v[248:251], v[144:159]
    v_exp_f32 v76, v76
    v_exp_f32 v77, v77
    v_exp_f32 v78, v78
    v_mfma_f32_32x32x16_bf16 v[144:159], v[56:59], v[252:255], v[144:159]
    s_waitcnt lgkmcnt(0)
    s_add_u32 s36, s36, s0
    v_cvt_pk_bf16_f32 v244, v76, v77
    v_exp_f32 v79, v79
    v_exp_f32 v80, v80
    v_cvt_pk_bf16_f32 v245, v78, v79
    v_exp_f32 v81, v81
    v_exp_f32 v82, v82
    v_exp_f32 v83, v83
    v_cvt_pk_bf16_f32 v246, v80, v81
    v_cvt_pk_bf16_f32 v247, v82, v83
    v_mfma_f32_32x32x16_bf16 v[68:83], v[36:39], v[20:23], 0
    ds_read_b128 v[44:47], v94 offset:36864
    v_exp_f32 v224, v224
    v_exp_f32 v225, v225
    v_exp_f32 v226, v226
    v_mfma_f32_32x32x16_bf16 v[68:83], v[40:43], v[24:27], v[68:83]
    ds_read_b128 v[48:51], v94 offset:37888
    v_cvt_pk_bf16_f32 v248, v224, v225
    v_exp_f32 v227, v227
    v_exp_f32 v228, v228
    v_cvt_pk_bf16_f32 v249, v226, v227
    v_exp_f32 v229, v229
    v_mfma_f32_16x16x32_bf16 v[8:11], v[96:99], v[240:243], v[8:11]
    s_xor_b32 s3, s31, 2
    v_exp_f32 v230, v230
    v_mfma_f32_16x16x32_bf16 v[8:11], v[96:99], v[244:247], v[8:11]
    s_add_u32 s3, s3, s85
    v_exp_f32 v231, v231
    v_cvt_pk_bf16_f32 v250, v228, v229
    v_cvt_pk_bf16_f32 v251, v230, v231
    v_mfma_f32_32x32x16_bf16 v[128:143], v[60:63], v[240:243], v[128:143]
    s_mul_i32 s3, s3, 147456
    s_add_u32 s3, s3, s48
    v_exp_f32 v232, v232
    v_exp_f32 v233, v233
    v_exp_f32 v234, v234
    v_mfma_f32_32x32x16_bf16 v[128:143], v[64:67], v[244:247], v[128:143]
    buffer_store_dwordx4 v[168:171], v92, s[20:23], s3 offen sc1
    v_cvt_pk_bf16_f32 v252, v232, v233
    v_exp_f32 v235, v235
    v_exp_f32 v236, v236
    v_cvt_pk_bf16_f32 v253, v234, v235
    v_exp_f32 v237, v237
    v_exp_f32 v238, v238
    v_exp_f32 v239, v239
    v_cvt_pk_bf16_f32 v254, v236, v237
    v_cvt_pk_bf16_f32 v255, v238, v239
    v_mfma_f32_32x32x16_bf16 v[224:239], v[36:39], v[28:31], 0
    ds_read_b128 v[52:55], v94 offset:34816
    v_exp_f32 v68, v68
    v_exp_f32 v69, v69
    v_exp_f32 v70, v70
    v_mfma_f32_32x32x16_bf16 v[224:239], v[40:43], v[32:35], v[224:239]
    ds_read_b128 v[56:59], v94 offset:35840
    v_cvt_pk_bf16_f32 v240, v68, v69
    v_exp_f32 v71, v71
    v_exp_f32 v72, v72
    v_cvt_pk_bf16_f32 v241, v70, v71
    v_exp_f32 v73, v73
    v_mfma_f32_16x16x32_bf16 v[12:15], v[96:99], v[248:251], v[12:15]
    s_add_u32 s44, s36, 294912
    v_exp_f32 v74, v74
    v_mfma_f32_16x16x32_bf16 v[12:15], v[96:99], v[252:255], v[12:15]
    s_lshl_b32 s43, s26, 8
    v_exp_f32 v75, v75
    v_cvt_pk_bf16_f32 v242, v72, v73
    v_cvt_pk_bf16_f32 v243, v74, v75
    v_mfma_f32_32x32x16_bf16 v[144:159], v[60:63], v[248:251], v[144:159]
    s_add_u32 s33, s43, 23330816
    v_exp_f32 v76, v76
    v_exp_f32 v77, v77
    v_exp_f32 v78, v78
    v_mfma_f32_32x32x16_bf16 v[144:159], v[64:67], v[252:255], v[144:159]
    s_waitcnt lgkmcnt(0)
    s_lshl_b32 s0, s30, 3
    v_cvt_pk_bf16_f32 v244, v76, v77
    v_exp_f32 v79, v79
    v_exp_f32 v80, v80
    v_cvt_pk_bf16_f32 v245, v78, v79
    v_exp_f32 v81, v81
    v_exp_f32 v82, v82
    v_exp_f32 v83, v83
    v_cvt_pk_bf16_f32 v246, v80, v81
    v_cvt_pk_bf16_f32 v247, v82, v83
    v_mfma_f32_32x32x16_bf16 v[68:83], v[44:47], v[20:23], 0
    ds_read_b128 v[36:39], v94 offset:40960
    v_exp_f32 v224, v224
    v_exp_f32 v225, v225
    v_exp_f32 v226, v226
    v_mfma_f32_32x32x16_bf16 v[68:83], v[48:51], v[24:27], v[68:83]
    ds_read_b128 v[40:43], v94 offset:41984
    v_cvt_pk_bf16_f32 v248, v224, v225
    v_exp_f32 v227, v227
    v_exp_f32 v228, v228
    v_cvt_pk_bf16_f32 v249, v226, v227
    v_exp_f32 v229, v229
    v_mfma_f32_16x16x32_bf16 v[8:11], v[96:99], v[240:243], v[8:11]
    s_add_u32 s4, s3, s49
    v_exp_f32 v230, v230
    v_mfma_f32_16x16x32_bf16 v[8:11], v[96:99], v[244:247], v[8:11]
    s_add_u32 s5, s3, s50
    v_exp_f32 v231, v231
    v_cvt_pk_bf16_f32 v250, v228, v229
    v_cvt_pk_bf16_f32 v251, v230, v231
    v_mfma_f32_32x32x16_bf16 v[128:143], v[52:55], v[240:243], v[128:143]
    s_add_u32 s43, s43, s0
    v_exp_f32 v232, v232
    v_exp_f32 v233, v233
    v_exp_f32 v234, v234
    v_mfma_f32_32x32x16_bf16 v[128:143], v[56:59], v[244:247], v[128:143]
    buffer_store_dwordx4 v[200:203], v92, s[20:23], s4 offen sc1
    v_cvt_pk_bf16_f32 v252, v232, v233
    v_exp_f32 v235, v235
    v_exp_f32 v236, v236
    v_cvt_pk_bf16_f32 v253, v234, v235
    v_exp_f32 v237, v237
    v_exp_f32 v238, v238
    v_exp_f32 v239, v239
    v_cvt_pk_bf16_f32 v254, v236, v237
    v_cvt_pk_bf16_f32 v255, v238, v239
    v_mfma_f32_32x32x16_bf16 v[224:239], v[44:47], v[28:31], 0
    ds_read_b128 v[60:63], v94 offset:38912
    v_exp_f32 v68, v68
    v_exp_f32 v69, v69
    v_exp_f32 v70, v70
    v_mfma_f32_32x32x16_bf16 v[224:239], v[48:51], v[32:35], v[224:239]
    ds_read_b128 v[64:67], v94 offset:39936
    v_cvt_pk_bf16_f32 v240, v68, v69
    v_exp_f32 v71, v71
    v_exp_f32 v72, v72
    v_cvt_pk_bf16_f32 v241, v70, v71
    v_exp_f32 v73, v73
    v_mfma_f32_16x16x32_bf16 v[12:15], v[96:99], v[248:251], v[12:15]
    s_add_u32 s43, s43, 24125440
    v_exp_f32 v74, v74
    v_mfma_f32_16x16x32_bf16 v[12:15], v[96:99], v[252:255], v[12:15]
    s_lshl_b32 s45, s29, 8
    v_exp_f32 v75, v75
    v_cvt_pk_bf16_f32 v242, v72, v73
    v_cvt_pk_bf16_f32 v243, v74, v75
    v_mfma_f32_32x32x16_bf16 v[144:159], v[52:55], v[248:251], v[144:159]
    s_add_u32 s45, s45, s0
    v_exp_f32 v76, v76
    v_exp_f32 v77, v77
    v_exp_f32 v78, v78
    v_mfma_f32_32x32x16_bf16 v[144:159], v[56:59], v[252:255], v[144:159]
    s_waitcnt lgkmcnt(0)
    s_add_u32 s45, s45, 24121344
    v_cvt_pk_bf16_f32 v244, v76, v77
    v_exp_f32 v79, v79
    v_exp_f32 v80, v80
    v_cvt_pk_bf16_f32 v245, v78, v79
    v_exp_f32 v81, v81
    v_exp_f32 v82, v82
    v_exp_f32 v83, v83
    v_cvt_pk_bf16_f32 v246, v80, v81
    v_cvt_pk_bf16_f32 v247, v82, v83
    v_mfma_f32_32x32x16_bf16 v[68:83], v[36:39], v[20:23], 0
    ds_read_b128 v[44:47], v94 offset:45056
    v_exp_f32 v224, v224
    v_exp_f32 v225, v225
    v_exp_f32 v226, v226
    v_mfma_f32_32x32x16_bf16 v[68:83], v[40:43], v[24:27], v[68:83]
    ds_read_b128 v[48:51], v94 offset:46080
    v_cvt_pk_bf16_f32 v248, v224, v225
    v_exp_f32 v227, v227
    v_exp_f32 v228, v228
    v_cvt_pk_bf16_f32 v249, v226, v227
    v_exp_f32 v229, v229
    v_mfma_f32_16x16x32_bf16 v[8:11], v[96:99], v[240:243], v[8:11]
    s_lshl_b32 s59, s28, 13
    v_exp_f32 v230, v230
    v_mfma_f32_16x16x32_bf16 v[8:11], v[96:99], v[244:247], v[8:11]
    s_mul_i32 s60, s53, 40960
    v_exp_f32 v231, v231
    v_cvt_pk_bf16_f32 v250, v228, v229
    v_cvt_pk_bf16_f32 v251, v230, v231
    v_mfma_f32_32x32x16_bf16 v[128:143], v[60:63], v[240:243], v[128:143]
    buffer_store_dwordx2 v[200:201], v92, s[20:23], s5 offen sc1
    v_exp_f32 v232, v232
    v_exp_f32 v233, v233
    v_exp_f32 v234, v234
    v_mfma_f32_32x32x16_bf16 v[128:143], v[64:67], v[244:247], v[128:143]
    s_add_u32 s60, s60, 32768
    v_cvt_pk_bf16_f32 v252, v232, v233
    v_exp_f32 v235, v235
    v_exp_f32 v236, v236
    v_cvt_pk_bf16_f32 v253, v234, v235
    v_exp_f32 v237, v237
    v_exp_f32 v238, v238
    v_exp_f32 v239, v239
    v_cvt_pk_bf16_f32 v254, v236, v237
    v_cvt_pk_bf16_f32 v255, v238, v239
    v_mfma_f32_32x32x16_bf16 v[224:239], v[36:39], v[28:31], 0
    ds_read_b128 v[52:55], v94 offset:43008
    v_exp_f32 v68, v68
    v_exp_f32 v69, v69
    v_exp_f32 v70, v70
    v_mfma_f32_32x32x16_bf16 v[224:239], v[40:43], v[32:35], v[224:239]
    ds_read_b128 v[56:59], v94 offset:44032
    v_cvt_pk_bf16_f32 v240, v68, v69
    v_exp_f32 v71, v71
    v_exp_f32 v72, v72
    v_cvt_pk_bf16_f32 v241, v70, v71
    v_exp_f32 v73, v73
    v_mfma_f32_16x16x32_bf16 v[12:15], v[96:99], v[248:251], v[12:15]
    v_exp_f32 v74, v74
    v_mfma_f32_16x16x32_bf16 v[12:15], v[96:99], v[252:255], v[12:15]
    s_cmp_eq_u32 s53, 0
    s_cselect_b32 s38, 2, 63
    s_cselect_b32 s39, 3, 3
    s_cselect_b32 s42, s39, 63
    v_exp_f32 v75, v75
    v_cvt_pk_bf16_f32 v242, v72, v73
    v_cvt_pk_bf16_f32 v243, v74, v75
    v_mfma_f32_32x32x16_bf16 v[144:159], v[60:63], v[248:251], v[144:159]
    v_exp_f32 v76, v76
    v_exp_f32 v77, v77
    v_exp_f32 v78, v78
    v_mfma_f32_32x32x16_bf16 v[144:159], v[64:67], v[252:255], v[144:159]
    s_waitcnt lgkmcnt(0)
    s_add_u32 s40, s38, 1
    v_cvt_pk_bf16_f32 v244, v76, v77
    v_exp_f32 v79, v79
    v_exp_f32 v80, v80
    v_cvt_pk_bf16_f32 v245, v78, v79
    v_exp_f32 v81, v81
    v_exp_f32 v82, v82
    v_exp_f32 v83, v83
    v_cvt_pk_bf16_f32 v246, v80, v81
    v_cvt_pk_bf16_f32 v247, v82, v83
    s_waitcnt vmcnt(23)
    s_barrier
    v_mfma_f32_32x32x16_bf16 v[68:83], v[44:47], v[20:23], 0
    ds_read_b128 v[36:39], v94 offset:49152
    v_exp_f32 v224, v224
    v_exp_f32 v225, v225
    v_exp_f32 v226, v226
    v_mfma_f32_32x32x16_bf16 v[68:83], v[48:51], v[24:27], v[68:83]
    ds_read_b128 v[40:43], v94 offset:50176
    s_add_u32 m0, s25, 32768
    v_cvt_pk_bf16_f32 v248, v224, v225
    v_exp_f32 v227, v227
    v_exp_f32 v228, v228
    v_cvt_pk_bf16_f32 v249, v226, v227
    v_exp_f32 v229, v229
    v_mfma_f32_16x16x32_bf16 v[8:11], v[96:99], v[240:243], v[8:11]
    buffer_load_dwordx4 v92, s[8:11], s24 offen offset:0 sc1 lds
    v_exp_f32 v230, v230
    v_mfma_f32_16x16x32_bf16 v[8:11], v[96:99], v[244:247], v[8:11]
    buffer_load_dwordx4 v92, s[8:11], s24 offen offset:1024 sc1 lds
    v_exp_f32 v231, v231
    v_cvt_pk_bf16_f32 v250, v228, v229
    v_cvt_pk_bf16_f32 v251, v230, v231
    v_mfma_f32_32x32x16_bf16 v[128:143], v[52:55], v[240:243], v[128:143]
    buffer_load_dwordx4 v92, s[8:11], s24 offen offset:2048 sc1 lds
    v_exp_f32 v232, v232
    v_exp_f32 v233, v233
    v_exp_f32 v234, v234
    v_mfma_f32_32x32x16_bf16 v[128:143], v[56:59], v[244:247], v[128:143]
    buffer_load_dwordx4 v92, s[8:11], s24 offen offset:3072 sc1 lds
    s_add_u32 s24, s24, 16384
    v_cvt_pk_bf16_f32 v252, v232, v233
    v_exp_f32 v235, v235
    v_exp_f32 v236, v236
    v_cvt_pk_bf16_f32 v253, v234, v235
    v_exp_f32 v237, v237
    v_exp_f32 v238, v238
    v_exp_f32 v239, v239
    v_cvt_pk_bf16_f32 v254, v236, v237
    v_cvt_pk_bf16_f32 v255, v238, v239
    v_mfma_f32_32x32x16_bf16 v[224:239], v[44:47], v[28:31], 0
    ds_read_b128 v[60:63], v94 offset:47104
    v_exp_f32 v68, v68
    v_exp_f32 v69, v69
    v_exp_f32 v70, v70
    v_mfma_f32_32x32x16_bf16 v[224:239], v[48:51], v[32:35], v[224:239]
    ds_read_b128 v[64:67], v94 offset:48128
    s_add_u32 m0, s25, 49152
    v_cvt_pk_bf16_f32 v240, v68, v69
    v_exp_f32 v71, v71
    v_exp_f32 v72, v72
    v_cvt_pk_bf16_f32 v241, v70, v71
    v_exp_f32 v73, v73
    v_mfma_f32_16x16x32_bf16 v[12:15], v[96:99], v[248:251], v[12:15]
    buffer_load_dwordx4 v92, s[8:11], s24 offen offset:0 sc1 lds
    v_exp_f32 v74, v74
    v_mfma_f32_16x16x32_bf16 v[12:15], v[96:99], v[252:255], v[12:15]
    buffer_load_dwordx4 v92, s[8:11], s24 offen offset:1024 sc1 lds
    v_exp_f32 v75, v75
    v_cvt_pk_bf16_f32 v242, v72, v73
    v_cvt_pk_bf16_f32 v243, v74, v75
    v_mfma_f32_32x32x16_bf16 v[144:159], v[52:55], v[248:251], v[144:159]
    buffer_load_dwordx4 v92, s[8:11], s24 offen offset:2048 sc1 lds
    v_exp_f32 v76, v76
    v_exp_f32 v77, v77
    v_exp_f32 v78, v78
    v_mfma_f32_32x32x16_bf16 v[144:159], v[56:59], v[252:255], v[144:159]
    s_waitcnt lgkmcnt(0)
    s_lshl_b32 s57, s56, 7
    buffer_load_dwordx4 v92, s[8:11], s24 offen offset:3072 sc1 lds
    s_add_u32 s24, s24, 16384
    v_cvt_pk_bf16_f32 v244, v76, v77
    v_exp_f32 v79, v79
    v_exp_f32 v80, v80
    v_cvt_pk_bf16_f32 v245, v78, v79
    v_exp_f32 v81, v81
    v_exp_f32 v82, v82
    v_exp_f32 v83, v83
    v_cvt_pk_bf16_f32 v246, v80, v81
    v_cvt_pk_bf16_f32 v247, v82, v83
    v_mfma_f32_32x32x16_bf16 v[68:83], v[36:39], v[20:23], 0
    ds_read_b128 v[44:47], v94 offset:53248
    v_exp_f32 v224, v224
    v_exp_f32 v225, v225
    v_exp_f32 v226, v226
    v_mfma_f32_32x32x16_bf16 v[68:83], v[40:43], v[24:27], v[68:83]
    ds_read_b128 v[48:51], v94 offset:54272
    v_cvt_pk_bf16_f32 v248, v224, v225
    v_exp_f32 v227, v227
    v_exp_f32 v228, v228
    v_cvt_pk_bf16_f32 v249, v226, v227
    v_exp_f32 v229, v229
    v_mfma_f32_16x16x32_bf16 v[8:11], v[96:99], v[240:243], v[8:11]
    s_xor_b32 s3, s31, 3
    v_exp_f32 v230, v230
    v_mfma_f32_16x16x32_bf16 v[8:11], v[96:99], v[244:247], v[8:11]
    s_add_u32 s3, s3, s85
    v_exp_f32 v231, v231
    v_cvt_pk_bf16_f32 v250, v228, v229
    v_cvt_pk_bf16_f32 v251, v230, v231
    v_mfma_f32_32x32x16_bf16 v[128:143], v[60:63], v[240:243], v[128:143]
    s_mul_i32 s3, s3, 147456
    s_add_u32 s3, s3, s48
    v_exp_f32 v232, v232
    v_exp_f32 v233, v233
    v_exp_f32 v234, v234
    v_mfma_f32_32x32x16_bf16 v[128:143], v[64:67], v[244:247], v[128:143]
    buffer_store_dwordx4 v[172:175], v92, s[20:23], s3 offen sc1
    v_cvt_pk_bf16_f32 v252, v232, v233
    v_exp_f32 v235, v235
    v_exp_f32 v236, v236
    v_cvt_pk_bf16_f32 v253, v234, v235
    v_exp_f32 v237, v237
    v_exp_f32 v238, v238
    v_exp_f32 v239, v239
    v_cvt_pk_bf16_f32 v254, v236, v237
    v_cvt_pk_bf16_f32 v255, v238, v239
    v_mfma_f32_32x32x16_bf16 v[224:239], v[36:39], v[28:31], 0
    ds_read_b128 v[52:55], v94 offset:51200
    v_exp_f32 v68, v68
    v_exp_f32 v69, v69
    v_exp_f32 v70, v70
    v_mfma_f32_32x32x16_bf16 v[224:239], v[40:43], v[32:35], v[224:239]
    ds_read_b128 v[56:59], v94 offset:52224
    v_cvt_pk_bf16_f32 v240, v68, v69
    v_exp_f32 v71, v71
    v_exp_f32 v72, v72
    v_cvt_pk_bf16_f32 v241, v70, v71
    v_exp_f32 v73, v73
    v_mfma_f32_16x16x32_bf16 v[12:15], v[96:99], v[248:251], v[12:15]
    s_add_u32 s57, s57, 23339008
    v_exp_f32 v74, v74
    v_mfma_f32_16x16x32_bf16 v[12:15], v[96:99], v[252:255], v[12:15]
    s_lshr_b32 s61, s56, 1
    v_exp_f32 v75, v75
    v_cvt_pk_bf16_f32 v242, v72, v73
    v_cvt_pk_bf16_f32 v243, v74, v75
    v_mfma_f32_32x32x16_bf16 v[144:159], v[60:63], v[248:251], v[144:159]
    s_lshl_b32 s61, s61, 8
    v_exp_f32 v76, v76
    v_exp_f32 v77, v77
    v_exp_f32 v78, v78
    v_mfma_f32_32x32x16_bf16 v[144:159], v[64:67], v[252:255], v[144:159]
    s_waitcnt lgkmcnt(0)
    s_add_u32 s61, s61, 24125440
    v_cvt_pk_bf16_f32 v244, v76, v77
    v_exp_f32 v79, v79
    v_exp_f32 v80, v80
    v_cvt_pk_bf16_f32 v245, v78, v79
    v_exp_f32 v81, v81
    v_exp_f32 v82, v82
    v_exp_f32 v83, v83
    v_cvt_pk_bf16_f32 v246, v80, v81
    v_cvt_pk_bf16_f32 v247, v82, v83
    v_mfma_f32_32x32x16_bf16 v[68:83], v[44:47], v[20:23], 0
    ds_read_b128 v[36:39], v94 offset:57344
    v_exp_f32 v224, v224
    v_exp_f32 v225, v225
    v_exp_f32 v226, v226
    v_mfma_f32_32x32x16_bf16 v[68:83], v[48:51], v[24:27], v[68:83]
    ds_read_b128 v[40:43], v94 offset:58368
    v_cvt_pk_bf16_f32 v248, v224, v225
    v_exp_f32 v227, v227
    v_exp_f32 v228, v228
    v_cvt_pk_bf16_f32 v249, v226, v227
    v_exp_f32 v229, v229
    v_mfma_f32_16x16x32_bf16 v[8:11], v[96:99], v[240:243], v[8:11]
    s_add_u32 s4, s3, s49
    v_exp_f32 v230, v230
    v_mfma_f32_16x16x32_bf16 v[8:11], v[96:99], v[244:247], v[8:11]
    s_add_u32 s5, s3, s50
    v_exp_f32 v231, v231
    v_cvt_pk_bf16_f32 v250, v228, v229
    v_cvt_pk_bf16_f32 v251, v230, v231
    v_mfma_f32_32x32x16_bf16 v[128:143], v[52:55], v[240:243], v[128:143]
    s_mov_b32 s64, s62
    v_exp_f32 v232, v232
    v_exp_f32 v233, v233
    v_exp_f32 v234, v234
    v_mfma_f32_32x32x16_bf16 v[128:143], v[56:59], v[244:247], v[128:143]
    buffer_store_dwordx4 v[204:207], v92, s[20:23], s4 offen sc1
    v_cvt_pk_bf16_f32 v252, v232, v233
    v_exp_f32 v235, v235
    v_exp_f32 v236, v236
    v_cvt_pk_bf16_f32 v253, v234, v235
    v_exp_f32 v237, v237
    v_exp_f32 v238, v238
    v_exp_f32 v239, v239
    v_cvt_pk_bf16_f32 v254, v236, v237
    v_cvt_pk_bf16_f32 v255, v238, v239
    v_mfma_f32_32x32x16_bf16 v[224:239], v[44:47], v[28:31], 0
    ds_read_b128 v[60:63], v94 offset:55296
    v_exp_f32 v68, v68
    v_exp_f32 v69, v69
    v_exp_f32 v70, v70
    v_mfma_f32_32x32x16_bf16 v[224:239], v[48:51], v[32:35], v[224:239]
    ds_read_b128 v[64:67], v94 offset:56320
    v_cvt_pk_bf16_f32 v240, v68, v69
    v_exp_f32 v71, v71
    v_exp_f32 v72, v72
    v_cvt_pk_bf16_f32 v241, v70, v71
    v_exp_f32 v73, v73
    v_mfma_f32_16x16x32_bf16 v[12:15], v[96:99], v[248:251], v[12:15]
    s_mov_b32 s65, s63
    v_exp_f32 v74, v74
    v_mfma_f32_16x16x32_bf16 v[12:15], v[96:99], v[252:255], v[12:15]
    s_mov_b32 s66, 268435456
    v_exp_f32 v75, v75
    v_cvt_pk_bf16_f32 v242, v72, v73
    v_cvt_pk_bf16_f32 v243, v74, v75
    v_mfma_f32_32x32x16_bf16 v[144:159], v[52:55], v[248:251], v[144:159]
    s_mov_b32 s16, s94
    v_exp_f32 v76, v76
    v_exp_f32 v77, v77
    v_exp_f32 v78, v78
    v_mfma_f32_32x32x16_bf16 v[144:159], v[56:59], v[252:255], v[144:159]
    s_waitcnt lgkmcnt(0)
    s_mov_b32 s17, s95
    v_cvt_pk_bf16_f32 v244, v76, v77
    v_exp_f32 v79, v79
    v_exp_f32 v80, v80
    v_cvt_pk_bf16_f32 v245, v78, v79
    v_exp_f32 v81, v81
    v_exp_f32 v82, v82
    v_exp_f32 v83, v83
    v_cvt_pk_bf16_f32 v246, v80, v81
    v_cvt_pk_bf16_f32 v247, v82, v83
    v_mfma_f32_32x32x16_bf16 v[68:83], v[36:39], v[20:23], 0
    ds_read_b128 v[44:47], v94 offset:61440
    v_exp_f32 v224, v224
    v_exp_f32 v225, v225
    v_exp_f32 v226, v226
    v_mfma_f32_32x32x16_bf16 v[68:83], v[40:43], v[24:27], v[68:83]
    ds_read_b128 v[48:51], v94 offset:62464
    v_cvt_pk_bf16_f32 v248, v224, v225
    v_exp_f32 v227, v227
    v_exp_f32 v228, v228
    v_cvt_pk_bf16_f32 v249, v226, v227
    v_exp_f32 v229, v229
    v_mfma_f32_16x16x32_bf16 v[8:11], v[96:99], v[240:243], v[8:11]
    s_mov_b32 s18, 4194304
    v_exp_f32 v230, v230
    v_mfma_f32_16x16x32_bf16 v[8:11], v[96:99], v[244:247], v[8:11]
    s_lshl_b32 s37, s56, 16
    v_exp_f32 v231, v231
    v_cvt_pk_bf16_f32 v250, v228, v229
    v_cvt_pk_bf16_f32 v251, v230, v231
    v_mfma_f32_32x32x16_bf16 v[128:143], v[60:63], v[240:243], v[128:143]
    buffer_store_dwordx2 v[204:205], v92, s[20:23], s5 offen sc1
    v_exp_f32 v232, v232
    v_exp_f32 v233, v233
    v_exp_f32 v234, v234
    v_mfma_f32_32x32x16_bf16 v[128:143], v[64:67], v[244:247], v[128:143]
    s_lshl_b32 s0, s55, 8
    v_cvt_pk_bf16_f32 v252, v232, v233
    v_exp_f32 v235, v235
    v_exp_f32 v236, v236
    v_cvt_pk_bf16_f32 v253, v234, v235
    v_exp_f32 v237, v237
    v_exp_f32 v238, v238
    v_exp_f32 v239, v239
    v_cvt_pk_bf16_f32 v254, v236, v237
    v_cvt_pk_bf16_f32 v255, v238, v239
    v_mfma_f32_32x32x16_bf16 v[224:239], v[36:39], v[28:31], 0
    ds_read_b128 v[52:55], v94 offset:59392
    v_exp_f32 v68, v68
    v_exp_f32 v69, v69
    v_exp_f32 v70, v70
    v_mfma_f32_32x32x16_bf16 v[224:239], v[40:43], v[32:35], v[224:239]
    ds_read_b128 v[56:59], v94 offset:60416
    v_cvt_pk_bf16_f32 v240, v68, v69
    v_exp_f32 v71, v71
    v_exp_f32 v72, v72
    v_cvt_pk_bf16_f32 v241, v70, v71
    v_exp_f32 v73, v73
    v_mfma_f32_16x16x32_bf16 v[12:15], v[96:99], v[248:251], v[12:15]
    v_exp_f32 v74, v74
    v_mfma_f32_16x16x32_bf16 v[12:15], v[96:99], v[252:255], v[12:15]
    s_add_u32 s37, s37, s0
    v_exp_f32 v75, v75
    v_cvt_pk_bf16_f32 v242, v72, v73
    v_cvt_pk_bf16_f32 v243, v74, v75
    v_mfma_f32_32x32x16_bf16 v[144:159], v[60:63], v[248:251], v[144:159]
    v_exp_f32 v76, v76
    v_exp_f32 v77, v77
    v_exp_f32 v78, v78
    v_mfma_f32_32x32x16_bf16 v[144:159], v[64:67], v[252:255], v[144:159]
    s_waitcnt lgkmcnt(0)
    s_xor_b32 s0, s53, 1
    v_cvt_pk_bf16_f32 v244, v76, v77
    v_exp_f32 v79, v79
    v_exp_f32 v80, v80
    v_cvt_pk_bf16_f32 v245, v78, v79
    v_exp_f32 v81, v81
    v_exp_f32 v82, v82
    v_exp_f32 v83, v83
    v_cvt_pk_bf16_f32 v246, v80, v81
    v_cvt_pk_bf16_f32 v247, v82, v83
    v_mfma_f32_32x32x16_bf16 v[68:83], v[44:47], v[20:23], 0
    ds_read_b128 v[36:39], v19 offset:0
    v_exp_f32 v224, v224
    v_exp_f32 v225, v225
    v_exp_f32 v226, v226
    v_mfma_f32_32x32x16_bf16 v[68:83], v[48:51], v[24:27], v[68:83]
    ds_read_b128 v[40:43], v19 offset:1024
    v_cvt_pk_bf16_f32 v248, v224, v225
    v_exp_f32 v227, v227
    v_exp_f32 v228, v228
    v_cvt_pk_bf16_f32 v249, v226, v227
    v_exp_f32 v229, v229
    v_mfma_f32_16x16x32_bf16 v[8:11], v[96:99], v[240:243], v[8:11]
    v_exp_f32 v230, v230
    v_mfma_f32_16x16x32_bf16 v[8:11], v[96:99], v[244:247], v[8:11]
    v_exp_f32 v231, v231
    v_cvt_pk_bf16_f32 v250, v228, v229
    v_cvt_pk_bf16_f32 v251, v230, v231
    v_mfma_f32_32x32x16_bf16 v[128:143], v[52:55], v[240:243], v[128:143]
    v_exp_f32 v232, v232
    v_exp_f32 v233, v233
    v_exp_f32 v234, v234
    v_mfma_f32_32x32x16_bf16 v[128:143], v[56:59], v[244:247], v[128:143]
    v_cvt_pk_bf16_f32 v252, v232, v233
    v_exp_f32 v235, v235
    v_exp_f32 v236, v236
    v_cvt_pk_bf16_f32 v253, v234, v235
    v_exp_f32 v237, v237
    v_exp_f32 v238, v238
    v_exp_f32 v239, v239
    v_cvt_pk_bf16_f32 v254, v236, v237
    v_cvt_pk_bf16_f32 v255, v238, v239
    v_mfma_f32_32x32x16_bf16 v[224:239], v[44:47], v[28:31], 0
    ds_read_b128 v[60:63], v94 offset:63488
    v_exp_f32 v68, v68
    v_exp_f32 v69, v69
    v_exp_f32 v70, v70
    v_mfma_f32_32x32x16_bf16 v[224:239], v[48:51], v[32:35], v[224:239]
    ds_read_b128 v[64:67], v94 offset:64512
    v_cvt_pk_bf16_f32 v240, v68, v69
    v_exp_f32 v71, v71
    v_exp_f32 v72, v72
    v_cvt_pk_bf16_f32 v241, v70, v71
    v_exp_f32 v73, v73
    v_mfma_f32_16x16x32_bf16 v[12:15], v[96:99], v[248:251], v[12:15]
    v_exp_f32 v74, v74
    v_mfma_f32_16x16x32_bf16 v[12:15], v[96:99], v[252:255], v[12:15]
    v_exp_f32 v75, v75
    v_cvt_pk_bf16_f32 v242, v72, v73
    v_cvt_pk_bf16_f32 v243, v74, v75
    v_mfma_f32_32x32x16_bf16 v[144:159], v[52:55], v[248:251], v[144:159]
    v_exp_f32 v76, v76
    v_exp_f32 v77, v77
    v_exp_f32 v78, v78
    v_mfma_f32_32x32x16_bf16 v[144:159], v[56:59], v[252:255], v[144:159]
    s_waitcnt lgkmcnt(0)
    s_lshl_b32 s0, s0, 7
    v_cvt_pk_bf16_f32 v244, v76, v77
    v_exp_f32 v79, v79
    v_exp_f32 v80, v80
    v_cvt_pk_bf16_f32 v245, v78, v79
    v_exp_f32 v81, v81
    v_exp_f32 v82, v82
    v_exp_f32 v83, v83
    v_cvt_pk_bf16_f32 v246, v80, v81
    v_cvt_pk_bf16_f32 v247, v82, v83
    v_mfma_f32_32x32x16_bf16 v[68:83], v[36:39], v[20:23], 0
    ds_read_b128 v[44:47], v19 offset:4096
    v_exp_f32 v224, v224
    v_exp_f32 v225, v225
    v_exp_f32 v226, v226
    v_mfma_f32_32x32x16_bf16 v[68:83], v[40:43], v[24:27], v[68:83]
    ds_read_b128 v[48:51], v19 offset:5120
    v_cvt_pk_bf16_f32 v248, v224, v225
    v_exp_f32 v227, v227
    v_exp_f32 v228, v228
    v_cvt_pk_bf16_f32 v249, v226, v227
    v_exp_f32 v229, v229
    v_mfma_f32_16x16x32_bf16 v[8:11], v[96:99], v[240:243], v[8:11]
    s_xor_b32 s3, s31, 4
    v_exp_f32 v230, v230
    v_mfma_f32_16x16x32_bf16 v[8:11], v[96:99], v[244:247], v[8:11]
    s_add_u32 s3, s3, s85
    v_exp_f32 v231, v231
    v_cvt_pk_bf16_f32 v250, v228, v229
    v_cvt_pk_bf16_f32 v251, v230, v231
    v_mfma_f32_32x32x16_bf16 v[128:143], v[60:63], v[240:243], v[128:143]
    s_mul_i32 s3, s3, 147456
    s_add_u32 s3, s3, s48
    v_exp_f32 v232, v232
    v_exp_f32 v233, v233
    v_exp_f32 v234, v234
    v_mfma_f32_32x32x16_bf16 v[128:143], v[64:67], v[244:247], v[128:143]
    buffer_store_dwordx4 v[176:179], v92, s[20:23], s3 offen sc1
    v_cvt_pk_bf16_f32 v252, v232, v233
    v_exp_f32 v235, v235
    v_exp_f32 v236, v236
    v_cvt_pk_bf16_f32 v253, v234, v235
    v_exp_f32 v237, v237
    v_exp_f32 v238, v238
    v_exp_f32 v239, v239
    v_cvt_pk_bf16_f32 v254, v236, v237
    v_cvt_pk_bf16_f32 v255, v238, v239
    v_mfma_f32_32x32x16_bf16 v[224:239], v[36:39], v[28:31], 0
    ds_read_b128 v[52:55], v19 offset:2048
    v_exp_f32 v68, v68
    v_exp_f32 v69, v69
    v_exp_f32 v70, v70
    v_mfma_f32_32x32x16_bf16 v[224:239], v[40:43], v[32:35], v[224:239]
    ds_read_b128 v[56:59], v19 offset:3072
    v_cvt_pk_bf16_f32 v240, v68, v69
    v_exp_f32 v71, v71
    v_exp_f32 v72, v72
    v_cvt_pk_bf16_f32 v241, v70, v71
    v_exp_f32 v73, v73
    v_mfma_f32_16x16x32_bf16 v[12:15], v[96:99], v[248:251], v[12:15]
    s_add_u32 s37, s37, s0
    v_exp_f32 v74, v74
    v_mfma_f32_16x16x32_bf16 v[12:15], v[96:99], v[252:255], v[12:15]
    s_lshl_b32 s41, s54, 3
    v_exp_f32 v75, v75
    v_cvt_pk_bf16_f32 v242, v72, v73
    v_cvt_pk_bf16_f32 v243, v74, v75
    v_mfma_f32_32x32x16_bf16 v[144:159], v[60:63], v[248:251], v[144:159]
    s_add_u32 s41, s41, s55
    v_exp_f32 v76, v76
    v_exp_f32 v77, v77
    v_exp_f32 v78, v78
    v_mfma_f32_32x32x16_bf16 v[144:159], v[64:67], v[252:255], v[144:159]
    s_waitcnt lgkmcnt(0)
    s_lshl_b32 s41, s41, 4
    v_cvt_pk_bf16_f32 v244, v76, v77
    v_exp_f32 v79, v79
    v_exp_f32 v80, v80
    v_cvt_pk_bf16_f32 v245, v78, v79
    v_exp_f32 v81, v81
    v_exp_f32 v82, v82
    v_exp_f32 v83, v83
    v_cvt_pk_bf16_f32 v246, v80, v81
    v_cvt_pk_bf16_f32 v247, v82, v83
    v_mfma_f32_32x32x16_bf16 v[68:83], v[44:47], v[20:23], 0
    ds_read_b128 v[36:39], v19 offset:8192
    v_exp_f32 v224, v224
    v_exp_f32 v225, v225
    v_exp_f32 v226, v226
    v_mfma_f32_32x32x16_bf16 v[68:83], v[48:51], v[24:27], v[68:83]
    ds_read_b128 v[40:43], v19 offset:9216
    v_cvt_pk_bf16_f32 v248, v224, v225
    v_exp_f32 v227, v227
    v_exp_f32 v228, v228
    v_cvt_pk_bf16_f32 v249, v226, v227
    v_exp_f32 v229, v229
    v_mfma_f32_16x16x32_bf16 v[8:11], v[96:99], v[240:243], v[8:11]
    s_add_u32 s4, s3, s49
    v_exp_f32 v230, v230
    v_mfma_f32_16x16x32_bf16 v[8:11], v[96:99], v[244:247], v[8:11]
    s_add_u32 s5, s3, s50
    v_exp_f32 v231, v231
    v_cvt_pk_bf16_f32 v250, v228, v229
    v_cvt_pk_bf16_f32 v251, v230, v231
    v_mfma_f32_32x32x16_bf16 v[128:143], v[52:55], v[240:243], v[128:143]
    s_add_u32 s41, s41, s28
    v_exp_f32 v232, v232
    v_exp_f32 v233, v233
    v_exp_f32 v234, v234
    v_mfma_f32_32x32x16_bf16 v[128:143], v[56:59], v[244:247], v[128:143]
    buffer_store_dwordx4 v[208:211], v92, s[20:23], s4 offen sc1
    v_cvt_pk_bf16_f32 v252, v232, v233
    v_exp_f32 v235, v235
    v_exp_f32 v236, v236
    v_cvt_pk_bf16_f32 v253, v234, v235
    v_exp_f32 v237, v237
    v_exp_f32 v238, v238
    v_exp_f32 v239, v239
    v_cvt_pk_bf16_f32 v254, v236, v237
    v_cvt_pk_bf16_f32 v255, v238, v239
    v_mfma_f32_32x32x16_bf16 v[224:239], v[44:47], v[28:31], 0
    ds_read_b128 v[60:63], v19 offset:6144
    v_exp_f32 v68, v68
    v_exp_f32 v69, v69
    v_exp_f32 v70, v70
    v_mfma_f32_32x32x16_bf16 v[224:239], v[48:51], v[32:35], v[224:239]
    ds_read_b128 v[64:67], v19 offset:7168
    v_cvt_pk_bf16_f32 v240, v68, v69
    v_exp_f32 v71, v71
    v_exp_f32 v72, v72
    v_cvt_pk_bf16_f32 v241, v70, v71
    v_exp_f32 v73, v73
    v_mfma_f32_16x16x32_bf16 v[12:15], v[96:99], v[248:251], v[12:15]
    s_lshl_b32 s41, s41, 3
    v_exp_f32 v74, v74
    v_mfma_f32_16x16x32_bf16 v[12:15], v[96:99], v[252:255], v[12:15]
    s_add_u32 s41, s41, 24133632
    v_exp_f32 v75, v75
    v_cvt_pk_bf16_f32 v242, v72, v73
    v_cvt_pk_bf16_f32 v243, v74, v75
    v_mfma_f32_32x32x16_bf16 v[144:159], v[52:55], v[248:251], v[144:159]
    s_lshl_b32 s27, s2, 2
    v_exp_f32 v76, v76
    v_exp_f32 v77, v77
    v_exp_f32 v78, v78
    v_mfma_f32_32x32x16_bf16 v[144:159], v[56:59], v[252:255], v[144:159]
    s_waitcnt lgkmcnt(0)
    s_add_u32 s27, s27, s28
    v_cvt_pk_bf16_f32 v244, v76, v77
    v_exp_f32 v79, v79
    v_exp_f32 v80, v80
    v_cvt_pk_bf16_f32 v245, v78, v79
    v_exp_f32 v81, v81
    v_exp_f32 v82, v82
    v_exp_f32 v83, v83
    v_cvt_pk_bf16_f32 v246, v80, v81
    v_cvt_pk_bf16_f32 v247, v82, v83
    v_mfma_f32_32x32x16_bf16 v[68:83], v[36:39], v[20:23], 0
    ds_read_b128 v[44:47], v19 offset:12288
    v_exp_f32 v224, v224
    v_exp_f32 v225, v225
    v_exp_f32 v226, v226
    v_mfma_f32_32x32x16_bf16 v[68:83], v[40:43], v[24:27], v[68:83]
    ds_read_b128 v[48:51], v19 offset:13312
    v_cvt_pk_bf16_f32 v248, v224, v225
    v_exp_f32 v227, v227
    v_exp_f32 v228, v228
    v_cvt_pk_bf16_f32 v249, v226, v227
    v_exp_f32 v229, v229
    v_mfma_f32_16x16x32_bf16 v[8:11], v[96:99], v[240:243], v[8:11]
    s_mov_b32 s12, s92
    v_exp_f32 v230, v230
    v_mfma_f32_16x16x32_bf16 v[8:11], v[96:99], v[244:247], v[8:11]
    s_mov_b32 s13, s93
    v_exp_f32 v231, v231
    v_cvt_pk_bf16_f32 v250, v228, v229
    v_cvt_pk_bf16_f32 v251, v230, v231
    v_mfma_f32_32x32x16_bf16 v[128:143], v[60:63], v[240:243], v[128:143]
    buffer_store_dwordx2 v[208:209], v92, s[20:23], s5 offen sc1
    v_exp_f32 v232, v232
    v_exp_f32 v233, v233
    v_exp_f32 v234, v234
    v_mfma_f32_32x32x16_bf16 v[128:143], v[64:67], v[244:247], v[128:143]
    s_mov_b32 s14, 7340032
    v_cvt_pk_bf16_f32 v252, v232, v233
    v_exp_f32 v235, v235
    v_exp_f32 v236, v236
    v_cvt_pk_bf16_f32 v253, v234, v235
    v_exp_f32 v237, v237
    v_exp_f32 v238, v238
    v_exp_f32 v239, v239
    v_cvt_pk_bf16_f32 v254, v236, v237
    v_cvt_pk_bf16_f32 v255, v238, v239
    v_mfma_f32_32x32x16_bf16 v[224:239], v[36:39], v[28:31], 0
    ds_read_b128 v[52:55], v19 offset:10240
    v_exp_f32 v68, v68
    v_exp_f32 v69, v69
    v_exp_f32 v70, v70
    v_mfma_f32_32x32x16_bf16 v[224:239], v[40:43], v[32:35], v[224:239]
    ds_read_b128 v[56:59], v19 offset:11264
    v_cvt_pk_bf16_f32 v240, v68, v69
    v_exp_f32 v71, v71
    v_exp_f32 v72, v72
    v_cvt_pk_bf16_f32 v241, v70, v71
    v_exp_f32 v73, v73
    v_mfma_f32_16x16x32_bf16 v[12:15], v[96:99], v[248:251], v[12:15]
    v_exp_f32 v74, v74
    v_mfma_f32_16x16x32_bf16 v[12:15], v[96:99], v[252:255], v[12:15]
    s_mul_i32 s58, s53, 2621440
    v_exp_f32 v75, v75
    v_cvt_pk_bf16_f32 v242, v72, v73
    v_cvt_pk_bf16_f32 v243, v74, v75
    v_mfma_f32_32x32x16_bf16 v[144:159], v[60:63], v[248:251], v[144:159]
    v_exp_f32 v76, v76
    v_exp_f32 v77, v77
    v_exp_f32 v78, v78
    v_mfma_f32_32x32x16_bf16 v[144:159], v[64:67], v[252:255], v[144:159]
    s_waitcnt lgkmcnt(0)
    s_and_b32 s52, s54, 7
    v_cvt_pk_bf16_f32 v244, v76, v77
    v_exp_f32 v79, v79
    v_exp_f32 v80, v80
    v_cvt_pk_bf16_f32 v245, v78, v79
    v_exp_f32 v81, v81
    v_exp_f32 v82, v82
    v_exp_f32 v83, v83
    v_cvt_pk_bf16_f32 v246, v80, v81
    v_cvt_pk_bf16_f32 v247, v82, v83
    s_waitcnt vmcnt(29)
    s_barrier
    v_mfma_f32_32x32x16_bf16 v[68:83], v[44:47], v[20:23], 0
    ds_read_b128 v[36:39], v19 offset:16384
    v_exp_f32 v224, v224
    v_exp_f32 v225, v225
    v_exp_f32 v226, v226
    v_mfma_f32_32x32x16_bf16 v[68:83], v[48:51], v[24:27], v[68:83]
    ds_read_b128 v[40:43], v19 offset:17408
    s_add_u32 m0, s25, 65536
    v_cvt_pk_bf16_f32 v248, v224, v225
    v_exp_f32 v227, v227
    v_exp_f32 v228, v228
    v_cvt_pk_bf16_f32 v249, v226, v227
    v_exp_f32 v229, v229
    v_mfma_f32_16x16x32_bf16 v[8:11], v[96:99], v[240:243], v[8:11]
    buffer_load_dwordx4 v92, s[8:11], s24 offen offset:0 sc1 lds
    v_exp_f32 v230, v230
    v_mfma_f32_16x16x32_bf16 v[8:11], v[96:99], v[244:247], v[8:11]
    buffer_load_dwordx4 v92, s[8:11], s24 offen offset:1024 sc1 lds
    v_exp_f32 v231, v231
    v_cvt_pk_bf16_f32 v250, v228, v229
    v_cvt_pk_bf16_f32 v251, v230, v231
    v_mfma_f32_32x32x16_bf16 v[128:143], v[52:55], v[240:243], v[128:143]
    buffer_load_dwordx4 v92, s[8:11], s24 offen offset:2048 sc1 lds
    v_exp_f32 v232, v232
    v_exp_f32 v233, v233
    v_exp_f32 v234, v234
    v_mfma_f32_32x32x16_bf16 v[128:143], v[56:59], v[244:247], v[128:143]
    buffer_load_dwordx4 v92, s[8:11], s24 offen offset:3072 sc1 lds
    s_add_u32 s24, s24, 16384
    v_cvt_pk_bf16_f32 v252, v232, v233
    v_exp_f32 v235, v235
    v_exp_f32 v236, v236
    v_cvt_pk_bf16_f32 v253, v234, v235
    v_exp_f32 v237, v237
    v_exp_f32 v238, v238
    v_exp_f32 v239, v239
    v_cvt_pk_bf16_f32 v254, v236, v237
    v_cvt_pk_bf16_f32 v255, v238, v239
    v_mfma_f32_32x32x16_bf16 v[224:239], v[44:47], v[28:31], 0
    ds_read_b128 v[60:63], v19 offset:14336
    v_exp_f32 v68, v68
    v_exp_f32 v69, v69
    v_exp_f32 v70, v70
    v_mfma_f32_32x32x16_bf16 v[224:239], v[48:51], v[32:35], v[224:239]
    ds_read_b128 v[64:67], v19 offset:15360
    s_add_u32 m0, s25, 81920
    v_cvt_pk_bf16_f32 v240, v68, v69
    v_exp_f32 v71, v71
    v_exp_f32 v72, v72
    v_cvt_pk_bf16_f32 v241, v70, v71
    v_exp_f32 v73, v73
    v_mfma_f32_16x16x32_bf16 v[12:15], v[96:99], v[248:251], v[12:15]
    buffer_load_dwordx4 v92, s[8:11], s24 offen offset:0 sc1 lds
    v_exp_f32 v74, v74
    v_mfma_f32_16x16x32_bf16 v[12:15], v[96:99], v[252:255], v[12:15]
    buffer_load_dwordx4 v92, s[8:11], s24 offen offset:1024 sc1 lds
    v_exp_f32 v75, v75
    v_cvt_pk_bf16_f32 v242, v72, v73
    v_cvt_pk_bf16_f32 v243, v74, v75
    v_mfma_f32_32x32x16_bf16 v[144:159], v[52:55], v[248:251], v[144:159]
    buffer_load_dwordx4 v92, s[8:11], s24 offen offset:2048 sc1 lds
    v_exp_f32 v76, v76
    v_exp_f32 v77, v77
    v_exp_f32 v78, v78
    v_mfma_f32_32x32x16_bf16 v[144:159], v[56:59], v[252:255], v[144:159]
    s_waitcnt lgkmcnt(0)
    s_lshl_b32 s52, s52, 2
    buffer_load_dwordx4 v92, s[8:11], s24 offen offset:3072 sc1 lds
    s_add_u32 s24, s24, 16384
    v_cvt_pk_bf16_f32 v244, v76, v77
    v_exp_f32 v79, v79
    v_exp_f32 v80, v80
    v_cvt_pk_bf16_f32 v245, v78, v79
    v_exp_f32 v81, v81
    v_exp_f32 v82, v82
    v_exp_f32 v83, v83
    v_cvt_pk_bf16_f32 v246, v80, v81
    v_cvt_pk_bf16_f32 v247, v82, v83
    v_mfma_f32_32x32x16_bf16 v[68:83], v[36:39], v[20:23], 0
    ds_read_b128 v[44:47], v19 offset:20480
    v_exp_f32 v224, v224
    v_exp_f32 v225, v225
    v_exp_f32 v226, v226
    v_mfma_f32_32x32x16_bf16 v[68:83], v[40:43], v[24:27], v[68:83]
    ds_read_b128 v[48:51], v19 offset:21504
    v_cvt_pk_bf16_f32 v248, v224, v225
    v_exp_f32 v227, v227
    v_exp_f32 v228, v228
    v_cvt_pk_bf16_f32 v249, v226, v227
    v_exp_f32 v229, v229
    v_mfma_f32_16x16x32_bf16 v[8:11], v[96:99], v[240:243], v[8:11]
    s_xor_b32 s3, s31, 5
    v_exp_f32 v230, v230
    v_mfma_f32_16x16x32_bf16 v[8:11], v[96:99], v[244:247], v[8:11]
    s_add_u32 s3, s3, s85
    v_exp_f32 v231, v231
    v_cvt_pk_bf16_f32 v250, v228, v229
    v_cvt_pk_bf16_f32 v251, v230, v231
    v_mfma_f32_32x32x16_bf16 v[128:143], v[60:63], v[240:243], v[128:143]
    s_mul_i32 s3, s3, 147456
    s_add_u32 s3, s3, s48
    v_exp_f32 v232, v232
    v_exp_f32 v233, v233
    v_exp_f32 v234, v234
    v_mfma_f32_32x32x16_bf16 v[128:143], v[64:67], v[244:247], v[128:143]
    buffer_store_dwordx4 v[180:183], v92, s[20:23], s3 offen sc1
    v_cvt_pk_bf16_f32 v252, v232, v233
    v_exp_f32 v235, v235
    v_exp_f32 v236, v236
    v_cvt_pk_bf16_f32 v253, v234, v235
    v_exp_f32 v237, v237
    v_exp_f32 v238, v238
    v_exp_f32 v239, v239
    v_cvt_pk_bf16_f32 v254, v236, v237
    v_cvt_pk_bf16_f32 v255, v238, v239
    v_mfma_f32_32x32x16_bf16 v[224:239], v[36:39], v[28:31], 0
    ds_read_b128 v[52:55], v19 offset:18432
    v_exp_f32 v68, v68
    v_exp_f32 v69, v69
    v_exp_f32 v70, v70
    v_mfma_f32_32x32x16_bf16 v[224:239], v[40:43], v[32:35], v[224:239]
    ds_read_b128 v[56:59], v19 offset:19456
    v_cvt_pk_bf16_f32 v240, v68, v69
    v_exp_f32 v71, v71
    v_exp_f32 v72, v72
    v_cvt_pk_bf16_f32 v241, v70, v71
    v_exp_f32 v73, v73
    v_mfma_f32_16x16x32_bf16 v[12:15], v[96:99], v[248:251], v[12:15]
    s_add_u32 s52, s52, s28
    v_exp_f32 v74, v74
    v_mfma_f32_16x16x32_bf16 v[12:15], v[96:99], v[252:255], v[12:15]
    s_lshl_b32 s52, s52, 15
    v_exp_f32 v75, v75
    v_cvt_pk_bf16_f32 v242, v72, v73
    v_cvt_pk_bf16_f32 v243, v74, v75
    v_mfma_f32_32x32x16_bf16 v[144:159], v[60:63], v[248:251], v[144:159]
    s_lshl_b32 s0, s55, 8
    v_exp_f32 v76, v76
    v_exp_f32 v77, v77
    v_exp_f32 v78, v78
    v_mfma_f32_32x32x16_bf16 v[144:159], v[64:67], v[252:255], v[144:159]
    s_waitcnt lgkmcnt(0)
    s_add_u32 s52, s52, s0
    v_cvt_pk_bf16_f32 v244, v76, v77
    v_exp_f32 v79, v79
    v_exp_f32 v80, v80
    v_cvt_pk_bf16_f32 v245, v78, v79
    v_exp_f32 v81, v81
    v_exp_f32 v82, v82
    v_exp_f32 v83, v83
    v_cvt_pk_bf16_f32 v246, v80, v81
    v_cvt_pk_bf16_f32 v247, v82, v83
    v_mfma_f32_32x32x16_bf16 v[68:83], v[44:47], v[20:23], 0
    ds_read_b128 v[36:39], v19 offset:24576
    v_exp_f32 v224, v224
    v_exp_f32 v225, v225
    v_exp_f32 v226, v226
    v_mfma_f32_32x32x16_bf16 v[68:83], v[48:51], v[24:27], v[68:83]
    ds_read_b128 v[40:43], v19 offset:25600
    v_cvt_pk_bf16_f32 v248, v224, v225
    v_exp_f32 v227, v227
    v_exp_f32 v228, v228
    v_cvt_pk_bf16_f32 v249, v226, v227
    v_exp_f32 v229, v229
    v_mfma_f32_16x16x32_bf16 v[8:11], v[96:99], v[240:243], v[8:11]
    s_add_u32 s4, s3, s49
    v_exp_f32 v230, v230
    v_mfma_f32_16x16x32_bf16 v[8:11], v[96:99], v[244:247], v[8:11]
    s_add_u32 s5, s3, s50
    v_exp_f32 v231, v231
    v_cvt_pk_bf16_f32 v250, v228, v229
    v_cvt_pk_bf16_f32 v251, v230, v231
    v_mfma_f32_32x32x16_bf16 v[128:143], v[52:55], v[240:243], v[128:143]
    s_add_u32 s34, s52, s58
    v_exp_f32 v232, v232
    v_exp_f32 v233, v233
    v_exp_f32 v234, v234
    v_mfma_f32_32x32x16_bf16 v[128:143], v[56:59], v[244:247], v[128:143]
    buffer_store_dwordx4 v[212:215], v92, s[20:23], s4 offen sc1
    v_cvt_pk_bf16_f32 v252, v232, v233
    v_exp_f32 v235, v235
    v_exp_f32 v236, v236
    v_cvt_pk_bf16_f32 v253, v234, v235
    v_exp_f32 v237, v237
    v_exp_f32 v238, v238
    v_exp_f32 v239, v239
    v_cvt_pk_bf16_f32 v254, v236, v237
    v_cvt_pk_bf16_f32 v255, v238, v239
    v_mfma_f32_32x32x16_bf16 v[224:239], v[44:47], v[28:31], 0
    ds_read_b128 v[60:63], v19 offset:22528
    v_exp_f32 v68, v68
    v_exp_f32 v69, v69
    v_exp_f32 v70, v70
    v_mfma_f32_32x32x16_bf16 v[224:239], v[48:51], v[32:35], v[224:239]
    ds_read_b128 v[64:67], v19 offset:23552
    v_cvt_pk_bf16_f32 v240, v68, v69
    v_exp_f32 v71, v71
    v_exp_f32 v72, v72
    v_cvt_pk_bf16_f32 v241, v70, v71
    v_exp_f32 v73, v73
    v_mfma_f32_16x16x32_bf16 v[12:15], v[96:99], v[248:251], v[12:15]
    s_mul_i32 s27, s53, 96
    v_exp_f32 v74, v74
    v_mfma_f32_16x16x32_bf16 v[12:15], v[96:99], v[252:255], v[12:15]
    s_add_u32 s27, s27, 3
    v_exp_f32 v75, v75
    v_cvt_pk_bf16_f32 v242, v72, v73
    v_cvt_pk_bf16_f32 v243, v74, v75
    v_mfma_f32_32x32x16_bf16 v[144:159], v[52:55], v[248:251], v[144:159]
    s_mov_b32 s32, 6
    v_exp_f32 v76, v76
    v_exp_f32 v77, v77
    v_exp_f32 v78, v78
    v_mfma_f32_32x32x16_bf16 v[144:159], v[56:59], v[252:255], v[144:159]
    s_waitcnt lgkmcnt(0)
    s_mov_b32 s35, 16384
    v_cvt_pk_bf16_f32 v244, v76, v77
    v_exp_f32 v79, v79
    v_exp_f32 v80, v80
    v_cvt_pk_bf16_f32 v245, v78, v79
    v_exp_f32 v81, v81
    v_exp_f32 v82, v82
    v_exp_f32 v83, v83
    v_cvt_pk_bf16_f32 v246, v80, v81
    v_cvt_pk_bf16_f32 v247, v82, v83
    v_mfma_f32_32x32x16_bf16 v[68:83], v[36:39], v[20:23], 0
    ds_read_b128 v[44:47], v19 offset:28672
    v_exp_f32 v224, v224
    v_exp_f32 v225, v225
    v_exp_f32 v226, v226
    v_mfma_f32_32x32x16_bf16 v[68:83], v[40:43], v[24:27], v[68:83]
    ds_read_b128 v[48:51], v19 offset:29696
    v_cvt_pk_bf16_f32 v248, v224, v225
    v_exp_f32 v227, v227
    v_exp_f32 v228, v228
    v_cvt_pk_bf16_f32 v249, v226, v227
    v_exp_f32 v229, v229
    v_mfma_f32_16x16x32_bf16 v[8:11], v[96:99], v[240:243], v[8:11]
    v_add_u32 v95, 16384, v94
    v_exp_f32 v230, v230
    v_mfma_f32_16x16x32_bf16 v[8:11], v[96:99], v[244:247], v[8:11]
    v_exp_f32 v231, v231
    v_cvt_pk_bf16_f32 v250, v228, v229
    v_cvt_pk_bf16_f32 v251, v230, v231
    v_mfma_f32_32x32x16_bf16 v[128:143], v[60:63], v[240:243], v[128:143]
    buffer_store_dwordx2 v[212:213], v92, s[20:23], s5 offen sc1
    v_exp_f32 v232, v232
    v_exp_f32 v233, v233
    v_exp_f32 v234, v234
    v_mfma_f32_32x32x16_bf16 v[128:143], v[64:67], v[244:247], v[128:143]
    v_cvt_pk_bf16_f32 v252, v232, v233
    v_exp_f32 v235, v235
    v_exp_f32 v236, v236
    v_cvt_pk_bf16_f32 v253, v234, v235
    v_exp_f32 v237, v237
    v_exp_f32 v238, v238
    v_exp_f32 v239, v239
    v_cvt_pk_bf16_f32 v254, v236, v237
    v_cvt_pk_bf16_f32 v255, v238, v239
    v_mfma_f32_32x32x16_bf16 v[224:239], v[36:39], v[28:31], 0
    ds_read_b128 v[52:55], v19 offset:26624
    v_exp_f32 v68, v68
    v_exp_f32 v69, v69
    v_exp_f32 v70, v70
    v_mfma_f32_32x32x16_bf16 v[224:239], v[40:43], v[32:35], v[224:239]
    ds_read_b128 v[56:59], v19 offset:27648
    v_cvt_pk_bf16_f32 v240, v68, v69
    v_exp_f32 v71, v71
    v_exp_f32 v72, v72
    v_cvt_pk_bf16_f32 v241, v70, v71
    v_exp_f32 v73, v73
    v_mfma_f32_16x16x32_bf16 v[12:15], v[96:99], v[248:251], v[12:15]
    v_exp_f32 v74, v74
    v_mfma_f32_16x16x32_bf16 v[12:15], v[96:99], v[252:255], v[12:15]
    v_exp_f32 v75, v75
    v_cvt_pk_bf16_f32 v242, v72, v73
    v_cvt_pk_bf16_f32 v243, v74, v75
    v_mfma_f32_32x32x16_bf16 v[144:159], v[60:63], v[248:251], v[144:159]
    v_exp_f32 v76, v76
    v_exp_f32 v77, v77
    v_exp_f32 v78, v78
    v_mfma_f32_32x32x16_bf16 v[144:159], v[64:67], v[252:255], v[144:159]
    s_waitcnt lgkmcnt(0)
    v_cvt_pk_bf16_f32 v244, v76, v77
    v_exp_f32 v79, v79
    v_exp_f32 v80, v80
    v_cvt_pk_bf16_f32 v245, v78, v79
    v_exp_f32 v81, v81
    v_exp_f32 v82, v82
    v_exp_f32 v83, v83
    v_cvt_pk_bf16_f32 v246, v80, v81
    v_cvt_pk_bf16_f32 v247, v82, v83
    v_mfma_f32_32x32x16_bf16 v[68:83], v[44:47], v[20:23], 0
    ds_read_b128 v[36:39], v19 offset:32768
    v_exp_f32 v224, v224
    v_exp_f32 v225, v225
    v_exp_f32 v226, v226
    v_mfma_f32_32x32x16_bf16 v[68:83], v[48:51], v[24:27], v[68:83]
    ds_read_b128 v[40:43], v19 offset:33792
    v_cvt_pk_bf16_f32 v248, v224, v225
    v_exp_f32 v227, v227
    v_exp_f32 v228, v228
    v_cvt_pk_bf16_f32 v249, v226, v227
    v_exp_f32 v229, v229
    v_mfma_f32_16x16x32_bf16 v[8:11], v[96:99], v[240:243], v[8:11]
    v_exp_f32 v230, v230
    v_mfma_f32_16x16x32_bf16 v[8:11], v[96:99], v[244:247], v[8:11]
    v_exp_f32 v231, v231
    v_cvt_pk_bf16_f32 v250, v228, v229
    v_cvt_pk_bf16_f32 v251, v230, v231
    v_mfma_f32_32x32x16_bf16 v[128:143], v[52:55], v[240:243], v[128:143]
    v_exp_f32 v232, v232
    v_exp_f32 v233, v233
    v_exp_f32 v234, v234
    v_mfma_f32_32x32x16_bf16 v[128:143], v[56:59], v[244:247], v[128:143]
    v_cvt_pk_bf16_f32 v252, v232, v233
    v_exp_f32 v235, v235
    v_exp_f32 v236, v236
    v_cvt_pk_bf16_f32 v253, v234, v235
    v_exp_f32 v237, v237
    v_exp_f32 v238, v238
    v_exp_f32 v239, v239
    v_cvt_pk_bf16_f32 v254, v236, v237
    v_cvt_pk_bf16_f32 v255, v238, v239
    v_mfma_f32_32x32x16_bf16 v[224:239], v[44:47], v[28:31], 0
    ds_read_b128 v[60:63], v19 offset:30720
    v_exp_f32 v68, v68
    v_exp_f32 v69, v69
    v_exp_f32 v70, v70
    v_mfma_f32_32x32x16_bf16 v[224:239], v[48:51], v[32:35], v[224:239]
    ds_read_b128 v[64:67], v19 offset:31744
    v_cvt_pk_bf16_f32 v240, v68, v69
    v_exp_f32 v71, v71
    v_exp_f32 v72, v72
    v_cvt_pk_bf16_f32 v241, v70, v71
    v_exp_f32 v73, v73
    v_mfma_f32_16x16x32_bf16 v[12:15], v[96:99], v[248:251], v[12:15]
    v_exp_f32 v74, v74
    v_mfma_f32_16x16x32_bf16 v[12:15], v[96:99], v[252:255], v[12:15]
    v_exp_f32 v75, v75
    v_cvt_pk_bf16_f32 v242, v72, v73
    v_cvt_pk_bf16_f32 v243, v74, v75
    v_mfma_f32_32x32x16_bf16 v[144:159], v[52:55], v[248:251], v[144:159]
    v_exp_f32 v76, v76
    v_exp_f32 v77, v77
    v_exp_f32 v78, v78
    v_mfma_f32_32x32x16_bf16 v[144:159], v[56:59], v[252:255], v[144:159]
    s_waitcnt lgkmcnt(0)
    v_cvt_pk_bf16_f32 v244, v76, v77
    v_exp_f32 v79, v79
    v_exp_f32 v80, v80
    v_cvt_pk_bf16_f32 v245, v78, v79
    v_exp_f32 v81, v81
    v_exp_f32 v82, v82
    v_exp_f32 v83, v83
    v_cvt_pk_bf16_f32 v246, v80, v81
    v_cvt_pk_bf16_f32 v247, v82, v83
    v_mfma_f32_32x32x16_bf16 v[68:83], v[36:39], v[20:23], 0
    ds_read_b128 v[44:47], v19 offset:36864
    v_exp_f32 v224, v224
    v_exp_f32 v225, v225
    v_exp_f32 v226, v226
    v_mfma_f32_32x32x16_bf16 v[68:83], v[40:43], v[24:27], v[68:83]
    ds_read_b128 v[48:51], v19 offset:37888
    v_cvt_pk_bf16_f32 v248, v224, v225
    v_exp_f32 v227, v227
    v_exp_f32 v228, v228
    v_cvt_pk_bf16_f32 v249, v226, v227
    v_exp_f32 v229, v229
    v_mfma_f32_16x16x32_bf16 v[8:11], v[96:99], v[240:243], v[8:11]
    s_xor_b32 s3, s31, 6
    v_exp_f32 v230, v230
    v_mfma_f32_16x16x32_bf16 v[8:11], v[96:99], v[244:247], v[8:11]
    s_add_u32 s3, s3, s85
    v_exp_f32 v231, v231
    v_cvt_pk_bf16_f32 v250, v228, v229
    v_cvt_pk_bf16_f32 v251, v230, v231
    v_mfma_f32_32x32x16_bf16 v[128:143], v[60:63], v[240:243], v[128:143]
    s_mul_i32 s3, s3, 147456
    s_add_u32 s3, s3, s48
    v_exp_f32 v232, v232
    v_exp_f32 v233, v233
    v_exp_f32 v234, v234
    v_mfma_f32_32x32x16_bf16 v[128:143], v[64:67], v[244:247], v[128:143]
    buffer_store_dwordx4 v[184:187], v92, s[20:23], s3 offen sc1
    v_cvt_pk_bf16_f32 v252, v232, v233
    v_exp_f32 v235, v235
    v_exp_f32 v236, v236
    v_cvt_pk_bf16_f32 v253, v234, v235
    v_exp_f32 v237, v237
    v_exp_f32 v238, v238
    v_exp_f32 v239, v239
    v_cvt_pk_bf16_f32 v254, v236, v237
    v_cvt_pk_bf16_f32 v255, v238, v239
    v_mfma_f32_32x32x16_bf16 v[224:239], v[36:39], v[28:31], 0
    ds_read_b128 v[52:55], v19 offset:34816
    v_exp_f32 v68, v68
    v_exp_f32 v69, v69
    v_exp_f32 v70, v70
    v_mfma_f32_32x32x16_bf16 v[224:239], v[40:43], v[32:35], v[224:239]
    ds_read_b128 v[56:59], v19 offset:35840
    v_cvt_pk_bf16_f32 v240, v68, v69
    v_exp_f32 v71, v71
    v_exp_f32 v72, v72
    v_cvt_pk_bf16_f32 v241, v70, v71
    v_exp_f32 v73, v73
    v_mfma_f32_16x16x32_bf16 v[12:15], v[96:99], v[248:251], v[12:15]
    v_exp_f32 v74, v74
    v_mfma_f32_16x16x32_bf16 v[12:15], v[96:99], v[252:255], v[12:15]
    v_exp_f32 v75, v75
    v_cvt_pk_bf16_f32 v242, v72, v73
    v_cvt_pk_bf16_f32 v243, v74, v75
    v_mfma_f32_32x32x16_bf16 v[144:159], v[60:63], v[248:251], v[144:159]
    v_exp_f32 v76, v76
    v_exp_f32 v77, v77
    v_exp_f32 v78, v78
    v_mfma_f32_32x32x16_bf16 v[144:159], v[64:67], v[252:255], v[144:159]
    s_waitcnt lgkmcnt(0)
    v_cvt_pk_bf16_f32 v244, v76, v77
    v_exp_f32 v79, v79
    v_exp_f32 v80, v80
    v_cvt_pk_bf16_f32 v245, v78, v79
    v_exp_f32 v81, v81
    v_exp_f32 v82, v82
    v_exp_f32 v83, v83
    v_cvt_pk_bf16_f32 v246, v80, v81
    v_cvt_pk_bf16_f32 v247, v82, v83
    v_mfma_f32_32x32x16_bf16 v[68:83], v[44:47], v[20:23], 0
    ds_read_b128 v[36:39], v19 offset:40960
    v_exp_f32 v224, v224
    v_exp_f32 v225, v225
    v_exp_f32 v226, v226
    v_mfma_f32_32x32x16_bf16 v[68:83], v[48:51], v[24:27], v[68:83]
    ds_read_b128 v[40:43], v19 offset:41984
    v_cvt_pk_bf16_f32 v248, v224, v225
    v_exp_f32 v227, v227
    v_exp_f32 v228, v228
    v_cvt_pk_bf16_f32 v249, v226, v227
    v_exp_f32 v229, v229
    v_mfma_f32_16x16x32_bf16 v[8:11], v[96:99], v[240:243], v[8:11]
    s_add_u32 s4, s3, s49
    v_exp_f32 v230, v230
    v_mfma_f32_16x16x32_bf16 v[8:11], v[96:99], v[244:247], v[8:11]
    s_add_u32 s5, s3, s50
    v_exp_f32 v231, v231
    v_cvt_pk_bf16_f32 v250, v228, v229
    v_cvt_pk_bf16_f32 v251, v230, v231
    v_mfma_f32_32x32x16_bf16 v[128:143], v[52:55], v[240:243], v[128:143]
    v_exp_f32 v232, v232
    v_exp_f32 v233, v233
    v_exp_f32 v234, v234
    v_mfma_f32_32x32x16_bf16 v[128:143], v[56:59], v[244:247], v[128:143]
    buffer_store_dwordx4 v[216:219], v92, s[20:23], s4 offen sc1
    v_cvt_pk_bf16_f32 v252, v232, v233
    v_exp_f32 v235, v235
    v_exp_f32 v236, v236
    v_cvt_pk_bf16_f32 v253, v234, v235
    v_exp_f32 v237, v237
    v_exp_f32 v238, v238
    v_exp_f32 v239, v239
    v_cvt_pk_bf16_f32 v254, v236, v237
    v_cvt_pk_bf16_f32 v255, v238, v239
    v_mfma_f32_32x32x16_bf16 v[224:239], v[44:47], v[28:31], 0
    ds_read_b128 v[60:63], v19 offset:38912
    v_exp_f32 v68, v68
    v_exp_f32 v69, v69
    v_exp_f32 v70, v70
    v_mfma_f32_32x32x16_bf16 v[224:239], v[48:51], v[32:35], v[224:239]
    ds_read_b128 v[64:67], v19 offset:39936
    v_cvt_pk_bf16_f32 v240, v68, v69
    v_exp_f32 v71, v71
    v_exp_f32 v72, v72
    v_cvt_pk_bf16_f32 v241, v70, v71
    v_exp_f32 v73, v73
    v_mfma_f32_16x16x32_bf16 v[12:15], v[96:99], v[248:251], v[12:15]
    v_exp_f32 v74, v74
    v_mfma_f32_16x16x32_bf16 v[12:15], v[96:99], v[252:255], v[12:15]
    v_exp_f32 v75, v75
    v_cvt_pk_bf16_f32 v242, v72, v73
    v_cvt_pk_bf16_f32 v243, v74, v75
    v_mfma_f32_32x32x16_bf16 v[144:159], v[52:55], v[248:251], v[144:159]
    v_exp_f32 v76, v76
    v_exp_f32 v77, v77
    v_exp_f32 v78, v78
    v_mfma_f32_32x32x16_bf16 v[144:159], v[56:59], v[252:255], v[144:159]
    s_waitcnt lgkmcnt(0)
    v_cvt_pk_bf16_f32 v244, v76, v77
    v_exp_f32 v79, v79
    v_exp_f32 v80, v80
    v_cvt_pk_bf16_f32 v245, v78, v79
    v_exp_f32 v81, v81
    v_exp_f32 v82, v82
    v_exp_f32 v83, v83
    v_cvt_pk_bf16_f32 v246, v80, v81
    v_cvt_pk_bf16_f32 v247, v82, v83
    v_mfma_f32_32x32x16_bf16 v[68:83], v[36:39], v[20:23], 0
    ds_read_b128 v[44:47], v19 offset:45056
    v_exp_f32 v224, v224
    v_exp_f32 v225, v225
    v_exp_f32 v226, v226
    v_mfma_f32_32x32x16_bf16 v[68:83], v[40:43], v[24:27], v[68:83]
    ds_read_b128 v[48:51], v19 offset:46080
    v_cvt_pk_bf16_f32 v248, v224, v225
    v_exp_f32 v227, v227
    v_exp_f32 v228, v228
    v_cvt_pk_bf16_f32 v249, v226, v227
    v_exp_f32 v229, v229
    v_mfma_f32_16x16x32_bf16 v[8:11], v[96:99], v[240:243], v[8:11]
    v_exp_f32 v230, v230
    v_mfma_f32_16x16x32_bf16 v[8:11], v[96:99], v[244:247], v[8:11]
    v_exp_f32 v231, v231
    v_cvt_pk_bf16_f32 v250, v228, v229
    v_cvt_pk_bf16_f32 v251, v230, v231
    v_mfma_f32_32x32x16_bf16 v[128:143], v[60:63], v[240:243], v[128:143]
    buffer_store_dwordx2 v[216:217], v92, s[20:23], s5 offen sc1
    v_exp_f32 v232, v232
    v_exp_f32 v233, v233
    v_exp_f32 v234, v234
    v_mfma_f32_32x32x16_bf16 v[128:143], v[64:67], v[244:247], v[128:143]
    v_cvt_pk_bf16_f32 v252, v232, v233
    v_exp_f32 v235, v235
    v_exp_f32 v236, v236
    v_cvt_pk_bf16_f32 v253, v234, v235
    v_exp_f32 v237, v237
    v_exp_f32 v238, v238
    v_exp_f32 v239, v239
    v_cvt_pk_bf16_f32 v254, v236, v237
    v_cvt_pk_bf16_f32 v255, v238, v239
    v_mfma_f32_32x32x16_bf16 v[224:239], v[36:39], v[28:31], 0
    ds_read_b128 v[52:55], v19 offset:43008
    v_exp_f32 v68, v68
    v_exp_f32 v69, v69
    v_exp_f32 v70, v70
    v_mfma_f32_32x32x16_bf16 v[224:239], v[40:43], v[32:35], v[224:239]
    ds_read_b128 v[56:59], v19 offset:44032
    v_cvt_pk_bf16_f32 v240, v68, v69
    v_exp_f32 v71, v71
    v_exp_f32 v72, v72
    v_cvt_pk_bf16_f32 v241, v70, v71
    v_exp_f32 v73, v73
    v_mfma_f32_16x16x32_bf16 v[12:15], v[96:99], v[248:251], v[12:15]
    v_exp_f32 v74, v74
    v_mfma_f32_16x16x32_bf16 v[12:15], v[96:99], v[252:255], v[12:15]
    v_exp_f32 v75, v75
    v_cvt_pk_bf16_f32 v242, v72, v73
    v_cvt_pk_bf16_f32 v243, v74, v75
    v_mfma_f32_32x32x16_bf16 v[144:159], v[60:63], v[248:251], v[144:159]
    v_exp_f32 v76, v76
    v_exp_f32 v77, v77
    v_exp_f32 v78, v78
    v_mfma_f32_32x32x16_bf16 v[144:159], v[64:67], v[252:255], v[144:159]
    s_waitcnt lgkmcnt(0)
    v_cvt_pk_bf16_f32 v244, v76, v77
    v_exp_f32 v79, v79
    v_exp_f32 v80, v80
    v_cvt_pk_bf16_f32 v245, v78, v79
    v_exp_f32 v81, v81
    v_exp_f32 v82, v82
    v_exp_f32 v83, v83
    v_cvt_pk_bf16_f32 v246, v80, v81
    v_cvt_pk_bf16_f32 v247, v82, v83
    s_waitcnt vmcnt(24)
    s_barrier
    v_mfma_f32_32x32x16_bf16 v[68:83], v[44:47], v[20:23], 0
    ds_read_b128 v[36:39], v19 offset:49152
    v_exp_f32 v224, v224
    v_exp_f32 v225, v225
    v_exp_f32 v226, v226
    v_mfma_f32_32x32x16_bf16 v[68:83], v[48:51], v[24:27], v[68:83]
    ds_read_b128 v[40:43], v19 offset:50176
    s_add_u32 m0, s25, 98304
    v_cvt_pk_bf16_f32 v248, v224, v225
    v_exp_f32 v227, v227
    v_exp_f32 v228, v228
    v_cvt_pk_bf16_f32 v249, v226, v227
    v_exp_f32 v229, v229
    v_mfma_f32_16x16x32_bf16 v[8:11], v[96:99], v[240:243], v[8:11]
    buffer_load_dwordx4 v92, s[8:11], s24 offen offset:0 sc1 lds
    v_exp_f32 v230, v230
    v_mfma_f32_16x16x32_bf16 v[8:11], v[96:99], v[244:247], v[8:11]
    buffer_load_dwordx4 v92, s[8:11], s24 offen offset:1024 sc1 lds
    v_exp_f32 v231, v231
    v_cvt_pk_bf16_f32 v250, v228, v229
    v_cvt_pk_bf16_f32 v251, v230, v231
    v_mfma_f32_32x32x16_bf16 v[128:143], v[52:55], v[240:243], v[128:143]
    buffer_load_dwordx4 v92, s[8:11], s24 offen offset:2048 sc1 lds
    v_exp_f32 v232, v232
    v_exp_f32 v233, v233
    v_exp_f32 v234, v234
    v_mfma_f32_32x32x16_bf16 v[128:143], v[56:59], v[244:247], v[128:143]
    buffer_load_dwordx4 v92, s[8:11], s24 offen offset:3072 sc1 lds
    s_add_u32 s24, s24, 16384
    v_cvt_pk_bf16_f32 v252, v232, v233
    v_exp_f32 v235, v235
    v_exp_f32 v236, v236
    v_cvt_pk_bf16_f32 v253, v234, v235
    v_exp_f32 v237, v237
    v_exp_f32 v238, v238
    v_exp_f32 v239, v239
    v_cvt_pk_bf16_f32 v254, v236, v237
    v_cvt_pk_bf16_f32 v255, v238, v239
    v_mfma_f32_32x32x16_bf16 v[224:239], v[44:47], v[28:31], 0
    ds_read_b128 v[60:63], v19 offset:47104
    v_exp_f32 v68, v68
    v_exp_f32 v69, v69
    v_exp_f32 v70, v70
    v_mfma_f32_32x32x16_bf16 v[224:239], v[48:51], v[32:35], v[224:239]
    ds_read_b128 v[64:67], v19 offset:48128
    s_add_u32 m0, s25, 114688
    v_cvt_pk_bf16_f32 v240, v68, v69
    v_exp_f32 v71, v71
    v_exp_f32 v72, v72
    v_cvt_pk_bf16_f32 v241, v70, v71
    v_exp_f32 v73, v73
    v_mfma_f32_16x16x32_bf16 v[12:15], v[96:99], v[248:251], v[12:15]
    buffer_load_dwordx4 v92, s[8:11], s24 offen offset:0 sc1 lds
    v_exp_f32 v74, v74
    v_mfma_f32_16x16x32_bf16 v[12:15], v[96:99], v[252:255], v[12:15]
    buffer_load_dwordx4 v92, s[8:11], s24 offen offset:1024 sc1 lds
    v_exp_f32 v75, v75
    v_cvt_pk_bf16_f32 v242, v72, v73
    v_cvt_pk_bf16_f32 v243, v74, v75
    v_mfma_f32_32x32x16_bf16 v[144:159], v[52:55], v[248:251], v[144:159]
    buffer_load_dwordx4 v92, s[8:11], s24 offen offset:2048 sc1 lds
    v_exp_f32 v76, v76
    v_exp_f32 v77, v77
    v_exp_f32 v78, v78
    v_mfma_f32_32x32x16_bf16 v[144:159], v[56:59], v[252:255], v[144:159]
    s_waitcnt lgkmcnt(0)
    buffer_load_dwordx4 v92, s[8:11], s24 offen offset:3072 sc1 lds
    s_add_u32 s24, s24, 16384
    v_cvt_pk_bf16_f32 v244, v76, v77
    v_exp_f32 v79, v79
    v_exp_f32 v80, v80
    v_cvt_pk_bf16_f32 v245, v78, v79
    v_exp_f32 v81, v81
    v_exp_f32 v82, v82
    v_exp_f32 v83, v83
    v_cvt_pk_bf16_f32 v246, v80, v81
    v_cvt_pk_bf16_f32 v247, v82, v83
    v_mfma_f32_32x32x16_bf16 v[68:83], v[36:39], v[20:23], 0
    ds_read_b128 v[44:47], v19 offset:53248
    v_exp_f32 v224, v224
    v_exp_f32 v225, v225
    v_exp_f32 v226, v226
    v_mfma_f32_32x32x16_bf16 v[68:83], v[40:43], v[24:27], v[68:83]
    ds_read_b128 v[48:51], v19 offset:54272
    v_cvt_pk_bf16_f32 v248, v224, v225
    v_exp_f32 v227, v227
    v_exp_f32 v228, v228
    v_cvt_pk_bf16_f32 v249, v226, v227
    v_exp_f32 v229, v229
    v_mfma_f32_16x16x32_bf16 v[8:11], v[96:99], v[240:243], v[8:11]
    s_xor_b32 s3, s31, 7
    v_exp_f32 v230, v230
    v_mfma_f32_16x16x32_bf16 v[8:11], v[96:99], v[244:247], v[8:11]
    s_add_u32 s3, s3, s85
    v_exp_f32 v231, v231
    v_cvt_pk_bf16_f32 v250, v228, v229
    v_cvt_pk_bf16_f32 v251, v230, v231
    v_mfma_f32_32x32x16_bf16 v[128:143], v[60:63], v[240:243], v[128:143]
    s_mul_i32 s3, s3, 147456
    s_add_u32 s3, s3, s48
    v_exp_f32 v232, v232
    v_exp_f32 v233, v233
    v_exp_f32 v234, v234
    v_mfma_f32_32x32x16_bf16 v[128:143], v[64:67], v[244:247], v[128:143]
    buffer_store_dwordx4 v[188:191], v92, s[20:23], s3 offen sc1
    v_cvt_pk_bf16_f32 v252, v232, v233
    v_exp_f32 v235, v235
    v_exp_f32 v236, v236
    v_cvt_pk_bf16_f32 v253, v234, v235
    v_exp_f32 v237, v237
    v_exp_f32 v238, v238
    v_exp_f32 v239, v239
    v_cvt_pk_bf16_f32 v254, v236, v237
    v_cvt_pk_bf16_f32 v255, v238, v239
    v_mfma_f32_32x32x16_bf16 v[224:239], v[36:39], v[28:31], 0
    ds_read_b128 v[52:55], v19 offset:51200
    v_exp_f32 v68, v68
    v_exp_f32 v69, v69
    v_exp_f32 v70, v70
    v_mfma_f32_32x32x16_bf16 v[224:239], v[40:43], v[32:35], v[224:239]
    ds_read_b128 v[56:59], v19 offset:52224
    v_cvt_pk_bf16_f32 v240, v68, v69
    v_exp_f32 v71, v71
    v_exp_f32 v72, v72
    v_cvt_pk_bf16_f32 v241, v70, v71
    v_exp_f32 v73, v73
    v_mfma_f32_16x16x32_bf16 v[12:15], v[96:99], v[248:251], v[12:15]
    v_exp_f32 v74, v74
    v_mfma_f32_16x16x32_bf16 v[12:15], v[96:99], v[252:255], v[12:15]
    v_exp_f32 v75, v75
    v_cvt_pk_bf16_f32 v242, v72, v73
    v_cvt_pk_bf16_f32 v243, v74, v75
    v_mfma_f32_32x32x16_bf16 v[144:159], v[60:63], v[248:251], v[144:159]
    v_exp_f32 v76, v76
    v_exp_f32 v77, v77
    v_exp_f32 v78, v78
    v_mfma_f32_32x32x16_bf16 v[144:159], v[64:67], v[252:255], v[144:159]
    s_waitcnt lgkmcnt(0)
    v_cvt_pk_bf16_f32 v244, v76, v77
    v_exp_f32 v79, v79
    v_exp_f32 v80, v80
    v_cvt_pk_bf16_f32 v245, v78, v79
    v_exp_f32 v81, v81
    v_exp_f32 v82, v82
    v_exp_f32 v83, v83
    v_cvt_pk_bf16_f32 v246, v80, v81
    v_cvt_pk_bf16_f32 v247, v82, v83
    v_mfma_f32_32x32x16_bf16 v[68:83], v[44:47], v[20:23], 0
    ds_read_b128 v[36:39], v19 offset:57344
    v_exp_f32 v224, v224
    v_exp_f32 v225, v225
    v_exp_f32 v226, v226
    v_mfma_f32_32x32x16_bf16 v[68:83], v[48:51], v[24:27], v[68:83]
    ds_read_b128 v[40:43], v19 offset:58368
    v_cvt_pk_bf16_f32 v248, v224, v225
    v_exp_f32 v227, v227
    v_exp_f32 v228, v228
    v_cvt_pk_bf16_f32 v249, v226, v227
    v_exp_f32 v229, v229
    v_mfma_f32_16x16x32_bf16 v[8:11], v[96:99], v[240:243], v[8:11]
    s_add_u32 s4, s3, s49
    v_exp_f32 v230, v230
    v_mfma_f32_16x16x32_bf16 v[8:11], v[96:99], v[244:247], v[8:11]
    s_add_u32 s5, s3, s50
    v_exp_f32 v231, v231
    v_cvt_pk_bf16_f32 v250, v228, v229
    v_cvt_pk_bf16_f32 v251, v230, v231
    v_mfma_f32_32x32x16_bf16 v[128:143], v[52:55], v[240:243], v[128:143]
    v_exp_f32 v232, v232
    v_exp_f32 v233, v233
    v_exp_f32 v234, v234
    v_mfma_f32_32x32x16_bf16 v[128:143], v[56:59], v[244:247], v[128:143]
    buffer_store_dwordx4 v[220:223], v92, s[20:23], s4 offen sc1
    v_cvt_pk_bf16_f32 v252, v232, v233
    v_exp_f32 v235, v235
    v_exp_f32 v236, v236
    v_cvt_pk_bf16_f32 v253, v234, v235
    v_exp_f32 v237, v237
    v_exp_f32 v238, v238
    v_exp_f32 v239, v239
    v_cvt_pk_bf16_f32 v254, v236, v237
    v_cvt_pk_bf16_f32 v255, v238, v239
    v_mfma_f32_32x32x16_bf16 v[224:239], v[44:47], v[28:31], 0
    ds_read_b128 v[60:63], v19 offset:55296
    v_exp_f32 v68, v68
    v_exp_f32 v69, v69
    v_exp_f32 v70, v70
    v_mfma_f32_32x32x16_bf16 v[224:239], v[48:51], v[32:35], v[224:239]
    ds_read_b128 v[64:67], v19 offset:56320
    v_cvt_pk_bf16_f32 v240, v68, v69
    v_exp_f32 v71, v71
    v_exp_f32 v72, v72
    v_cvt_pk_bf16_f32 v241, v70, v71
    v_exp_f32 v73, v73
    v_mfma_f32_16x16x32_bf16 v[12:15], v[96:99], v[248:251], v[12:15]
    v_exp_f32 v74, v74
    v_mfma_f32_16x16x32_bf16 v[12:15], v[96:99], v[252:255], v[12:15]
    v_exp_f32 v75, v75
    v_cvt_pk_bf16_f32 v242, v72, v73
    v_cvt_pk_bf16_f32 v243, v74, v75
    v_mfma_f32_32x32x16_bf16 v[144:159], v[52:55], v[248:251], v[144:159]
    v_exp_f32 v76, v76
    v_exp_f32 v77, v77
    v_exp_f32 v78, v78
    v_mfma_f32_32x32x16_bf16 v[144:159], v[56:59], v[252:255], v[144:159]
    s_waitcnt lgkmcnt(0)
    v_cvt_pk_bf16_f32 v244, v76, v77
    v_exp_f32 v79, v79
    v_exp_f32 v80, v80
    v_cvt_pk_bf16_f32 v245, v78, v79
    v_exp_f32 v81, v81
    v_exp_f32 v82, v82
    v_exp_f32 v83, v83
    v_cvt_pk_bf16_f32 v246, v80, v81
    v_cvt_pk_bf16_f32 v247, v82, v83
    v_mfma_f32_32x32x16_bf16 v[68:83], v[36:39], v[20:23], 0
    ds_read_b128 v[44:47], v19 offset:61440
    v_exp_f32 v224, v224
    v_exp_f32 v225, v225
    v_exp_f32 v226, v226
    v_mfma_f32_32x32x16_bf16 v[68:83], v[40:43], v[24:27], v[68:83]
    ds_read_b128 v[48:51], v19 offset:62464
    v_cvt_pk_bf16_f32 v248, v224, v225
    v_exp_f32 v227, v227
    v_exp_f32 v228, v228
    v_cvt_pk_bf16_f32 v249, v226, v227
    v_exp_f32 v229, v229
    v_mfma_f32_16x16x32_bf16 v[8:11], v[96:99], v[240:243], v[8:11]
    v_exp_f32 v230, v230
    v_mfma_f32_16x16x32_bf16 v[8:11], v[96:99], v[244:247], v[8:11]
    v_exp_f32 v231, v231
    v_cvt_pk_bf16_f32 v250, v228, v229
    v_cvt_pk_bf16_f32 v251, v230, v231
    v_mfma_f32_32x32x16_bf16 v[128:143], v[60:63], v[240:243], v[128:143]
    buffer_store_dwordx2 v[220:221], v92, s[20:23], s5 offen sc1
    v_exp_f32 v232, v232
    v_exp_f32 v233, v233
    v_exp_f32 v234, v234
    v_mfma_f32_32x32x16_bf16 v[128:143], v[64:67], v[244:247], v[128:143]
    v_cvt_pk_bf16_f32 v252, v232, v233
    v_exp_f32 v235, v235
    v_exp_f32 v236, v236
    v_cvt_pk_bf16_f32 v253, v234, v235
    v_exp_f32 v237, v237
    v_exp_f32 v238, v238
    v_exp_f32 v239, v239
    v_cvt_pk_bf16_f32 v254, v236, v237
    v_cvt_pk_bf16_f32 v255, v238, v239
    v_mfma_f32_32x32x16_bf16 v[224:239], v[36:39], v[28:31], 0
    ds_read_b128 v[52:55], v19 offset:59392
    v_exp_f32 v68, v68
    v_exp_f32 v69, v69
    v_exp_f32 v70, v70
    v_mfma_f32_32x32x16_bf16 v[224:239], v[40:43], v[32:35], v[224:239]
    ds_read_b128 v[56:59], v19 offset:60416
    v_cvt_pk_bf16_f32 v240, v68, v69
    v_exp_f32 v71, v71
    v_exp_f32 v72, v72
    v_cvt_pk_bf16_f32 v241, v70, v71
    v_exp_f32 v73, v73
    v_mfma_f32_16x16x32_bf16 v[12:15], v[96:99], v[248:251], v[12:15]
    v_exp_f32 v74, v74
    v_mfma_f32_16x16x32_bf16 v[12:15], v[96:99], v[252:255], v[12:15]
    v_exp_f32 v75, v75
    v_cvt_pk_bf16_f32 v242, v72, v73
    v_cvt_pk_bf16_f32 v243, v74, v75
    v_mfma_f32_32x32x16_bf16 v[144:159], v[60:63], v[248:251], v[144:159]
    v_exp_f32 v76, v76
    v_exp_f32 v77, v77
    v_exp_f32 v78, v78
    v_mfma_f32_32x32x16_bf16 v[144:159], v[64:67], v[252:255], v[144:159]
    s_waitcnt lgkmcnt(0)
    v_cvt_pk_bf16_f32 v244, v76, v77
    v_exp_f32 v79, v79
    v_exp_f32 v80, v80
    v_cvt_pk_bf16_f32 v245, v78, v79
    v_exp_f32 v81, v81
    v_exp_f32 v82, v82
    v_exp_f32 v83, v83
    v_cvt_pk_bf16_f32 v246, v80, v81
    v_cvt_pk_bf16_f32 v247, v82, v83
    v_mfma_f32_32x32x16_bf16 v[68:83], v[44:47], v[20:23], 0
    ds_read_b128 v[36:39], v94 offset:0
    v_exp_f32 v224, v224
    v_exp_f32 v225, v225
    v_exp_f32 v226, v226
    v_mfma_f32_32x32x16_bf16 v[68:83], v[48:51], v[24:27], v[68:83]
    ds_read_b128 v[40:43], v94 offset:1024
    v_cvt_pk_bf16_f32 v248, v224, v225
    v_exp_f32 v227, v227
    v_exp_f32 v228, v228
    v_cvt_pk_bf16_f32 v249, v226, v227
    v_exp_f32 v229, v229
    v_mfma_f32_16x16x32_bf16 v[8:11], v[96:99], v[240:243], v[8:11]
    v_exp_f32 v230, v230
    v_mfma_f32_16x16x32_bf16 v[8:11], v[96:99], v[244:247], v[8:11]
    v_exp_f32 v231, v231
    v_cvt_pk_bf16_f32 v250, v228, v229
    v_cvt_pk_bf16_f32 v251, v230, v231
    v_mfma_f32_32x32x16_bf16 v[128:143], v[52:55], v[240:243], v[128:143]
    v_exp_f32 v232, v232
    v_exp_f32 v233, v233
    v_exp_f32 v234, v234
    v_mfma_f32_32x32x16_bf16 v[128:143], v[56:59], v[244:247], v[128:143]
    v_cvt_pk_bf16_f32 v252, v232, v233
    v_exp_f32 v235, v235
    v_exp_f32 v236, v236
    v_cvt_pk_bf16_f32 v253, v234, v235
    v_exp_f32 v237, v237
    v_exp_f32 v238, v238
    v_exp_f32 v239, v239
    v_cvt_pk_bf16_f32 v254, v236, v237
    v_cvt_pk_bf16_f32 v255, v238, v239
    v_mfma_f32_32x32x16_bf16 v[224:239], v[44:47], v[28:31], 0
    ds_read_b128 v[60:63], v19 offset:63488
    v_exp_f32 v68, v68
    v_exp_f32 v69, v69
    v_exp_f32 v70, v70
    v_mfma_f32_32x32x16_bf16 v[224:239], v[48:51], v[32:35], v[224:239]
    ds_read_b128 v[64:67], v19 offset:64512
    v_cvt_pk_bf16_f32 v240, v68, v69
    v_exp_f32 v71, v71
    v_exp_f32 v72, v72
    v_cvt_pk_bf16_f32 v241, v70, v71
    v_exp_f32 v73, v73
    v_mfma_f32_16x16x32_bf16 v[12:15], v[96:99], v[248:251], v[12:15]
    v_exp_f32 v74, v74
    v_mfma_f32_16x16x32_bf16 v[12:15], v[96:99], v[252:255], v[12:15]
    v_exp_f32 v75, v75
    v_cvt_pk_bf16_f32 v242, v72, v73
    v_cvt_pk_bf16_f32 v243, v74, v75
    v_mfma_f32_32x32x16_bf16 v[144:159], v[52:55], v[248:251], v[144:159]
    v_exp_f32 v76, v76
    v_exp_f32 v77, v77
    v_exp_f32 v78, v78
    v_mfma_f32_32x32x16_bf16 v[144:159], v[56:59], v[252:255], v[144:159]
    s_waitcnt lgkmcnt(0)
    v_cvt_pk_bf16_f32 v244, v76, v77
    v_exp_f32 v79, v79
    v_exp_f32 v80, v80
    v_cvt_pk_bf16_f32 v245, v78, v79
    v_exp_f32 v81, v81
    v_exp_f32 v82, v82
    v_exp_f32 v83, v83
    v_cvt_pk_bf16_f32 v246, v80, v81
    v_cvt_pk_bf16_f32 v247, v82, v83
    v_mfma_f32_32x32x16_bf16 v[68:83], v[36:39], v[20:23], 0
    ds_read_b128 v[44:47], v94 offset:4096
    v_exp_f32 v224, v224
    v_exp_f32 v225, v225
    v_exp_f32 v226, v226
    v_mfma_f32_32x32x16_bf16 v[68:83], v[40:43], v[24:27], v[68:83]
    ds_read_b128 v[48:51], v94 offset:5120
    v_cvt_pk_bf16_f32 v248, v224, v225
    v_exp_f32 v227, v227
    v_exp_f32 v228, v228
    v_cvt_pk_bf16_f32 v249, v226, v227
    v_exp_f32 v229, v229
    v_mfma_f32_16x16x32_bf16 v[8:11], v[96:99], v[240:243], v[8:11]
    v_exp_f32 v230, v230
    v_mfma_f32_16x16x32_bf16 v[8:11], v[96:99], v[244:247], v[8:11]
    global_load_dword v127, v[122:123], off
    v_exp_f32 v231, v231
    v_cvt_pk_bf16_f32 v250, v228, v229
    v_cvt_pk_bf16_f32 v251, v230, v231
    v_mfma_f32_32x32x16_bf16 v[128:143], v[60:63], v[240:243], v[128:143]
    v_exp_f32 v232, v232
    v_exp_f32 v233, v233
    v_exp_f32 v234, v234
    v_mfma_f32_32x32x16_bf16 v[128:143], v[64:67], v[244:247], v[128:143]
    v_cvt_pk_bf16_f32 v252, v232, v233
    v_exp_f32 v235, v235
    v_exp_f32 v236, v236
    v_cvt_pk_bf16_f32 v253, v234, v235
    v_exp_f32 v237, v237
    v_exp_f32 v238, v238
    v_exp_f32 v239, v239
    v_cvt_pk_bf16_f32 v254, v236, v237
    v_cvt_pk_bf16_f32 v255, v238, v239
    v_mfma_f32_32x32x16_bf16 v[224:239], v[36:39], v[28:31], 0
    ds_read_b128 v[52:55], v94 offset:2048
    v_exp_f32 v68, v68
    v_exp_f32 v69, v69
    v_exp_f32 v70, v70
    v_mfma_f32_32x32x16_bf16 v[224:239], v[40:43], v[32:35], v[224:239]
    ds_read_b128 v[56:59], v94 offset:3072
    v_cvt_pk_bf16_f32 v240, v68, v69
    v_exp_f32 v71, v71
    v_exp_f32 v72, v72
    v_cvt_pk_bf16_f32 v241, v70, v71
    v_exp_f32 v73, v73
    v_mfma_f32_16x16x32_bf16 v[12:15], v[96:99], v[248:251], v[12:15]
    v_exp_f32 v74, v74
    v_mfma_f32_16x16x32_bf16 v[12:15], v[96:99], v[252:255], v[12:15]
    v_exp_f32 v75, v75
    v_cvt_pk_bf16_f32 v242, v72, v73
    v_cvt_pk_bf16_f32 v243, v74, v75
    v_mfma_f32_32x32x16_bf16 v[144:159], v[60:63], v[248:251], v[144:159]
    v_exp_f32 v76, v76
    v_exp_f32 v77, v77
    v_exp_f32 v78, v78
    v_mfma_f32_32x32x16_bf16 v[144:159], v[64:67], v[252:255], v[144:159]
    s_waitcnt lgkmcnt(0)
    v_cvt_pk_bf16_f32 v244, v76, v77
    v_exp_f32 v79, v79
    v_exp_f32 v80, v80
    v_cvt_pk_bf16_f32 v245, v78, v79
    v_exp_f32 v81, v81
    v_exp_f32 v82, v82
    v_exp_f32 v83, v83
    v_cvt_pk_bf16_f32 v246, v80, v81
    v_cvt_pk_bf16_f32 v247, v82, v83
    v_mfma_f32_32x32x16_bf16 v[68:83], v[44:47], v[20:23], 0
    ds_read_b128 v[36:39], v94 offset:8192
    v_exp_f32 v224, v224
    v_exp_f32 v225, v225
    v_exp_f32 v226, v226
    v_mfma_f32_32x32x16_bf16 v[68:83], v[48:51], v[24:27], v[68:83]
    ds_read_b128 v[40:43], v94 offset:9216
    v_cvt_pk_bf16_f32 v248, v224, v225
    v_exp_f32 v227, v227
    v_exp_f32 v228, v228
    v_cvt_pk_bf16_f32 v249, v226, v227
    v_exp_f32 v229, v229
    v_mfma_f32_16x16x32_bf16 v[8:11], v[96:99], v[240:243], v[8:11]
    v_exp_f32 v230, v230
    v_mfma_f32_16x16x32_bf16 v[8:11], v[96:99], v[244:247], v[8:11]
    v_exp_f32 v231, v231
    v_cvt_pk_bf16_f32 v250, v228, v229
    v_cvt_pk_bf16_f32 v251, v230, v231
    v_mfma_f32_32x32x16_bf16 v[128:143], v[52:55], v[240:243], v[128:143]
    v_exp_f32 v232, v232
    v_exp_f32 v233, v233
    v_exp_f32 v234, v234
    v_mfma_f32_32x32x16_bf16 v[128:143], v[56:59], v[244:247], v[128:143]
    v_cvt_pk_bf16_f32 v252, v232, v233
    v_exp_f32 v235, v235
    v_exp_f32 v236, v236
    v_cvt_pk_bf16_f32 v253, v234, v235
    v_exp_f32 v237, v237
    v_exp_f32 v238, v238
    v_exp_f32 v239, v239
    v_cvt_pk_bf16_f32 v254, v236, v237
    v_cvt_pk_bf16_f32 v255, v238, v239
    v_mfma_f32_32x32x16_bf16 v[224:239], v[44:47], v[28:31], 0
    ds_read_b128 v[60:63], v94 offset:6144
    v_exp_f32 v68, v68
    v_exp_f32 v69, v69
    v_exp_f32 v70, v70
    v_mfma_f32_32x32x16_bf16 v[224:239], v[48:51], v[32:35], v[224:239]
    ds_read_b128 v[64:67], v94 offset:7168
    v_cvt_pk_bf16_f32 v240, v68, v69
    v_exp_f32 v71, v71
    v_exp_f32 v72, v72
    v_cvt_pk_bf16_f32 v241, v70, v71
    v_exp_f32 v73, v73
    v_mfma_f32_16x16x32_bf16 v[12:15], v[96:99], v[248:251], v[12:15]
    v_exp_f32 v74, v74
    v_mfma_f32_16x16x32_bf16 v[12:15], v[96:99], v[252:255], v[12:15]
    v_exp_f32 v75, v75
    v_cvt_pk_bf16_f32 v242, v72, v73
    v_cvt_pk_bf16_f32 v243, v74, v75
    v_mfma_f32_32x32x16_bf16 v[144:159], v[52:55], v[248:251], v[144:159]
    v_exp_f32 v76, v76
    v_exp_f32 v77, v77
    v_exp_f32 v78, v78
    v_mfma_f32_32x32x16_bf16 v[144:159], v[56:59], v[252:255], v[144:159]
    s_waitcnt lgkmcnt(0)
    v_cvt_pk_bf16_f32 v244, v76, v77
    v_exp_f32 v79, v79
    v_exp_f32 v80, v80
    v_cvt_pk_bf16_f32 v245, v78, v79
    v_exp_f32 v81, v81
    v_exp_f32 v82, v82
    v_exp_f32 v83, v83
    v_cvt_pk_bf16_f32 v246, v80, v81
    v_cvt_pk_bf16_f32 v247, v82, v83
    v_mfma_f32_32x32x16_bf16 v[68:83], v[36:39], v[20:23], 0
    ds_read_b128 v[44:47], v94 offset:12288
    v_exp_f32 v224, v224
    v_exp_f32 v225, v225
    v_exp_f32 v226, v226
    v_mfma_f32_32x32x16_bf16 v[68:83], v[40:43], v[24:27], v[68:83]
    ds_read_b128 v[48:51], v94 offset:13312
    v_cvt_pk_bf16_f32 v248, v224, v225
    v_exp_f32 v227, v227
    v_exp_f32 v228, v228
    v_cvt_pk_bf16_f32 v249, v226, v227
    v_exp_f32 v229, v229
    v_mfma_f32_16x16x32_bf16 v[8:11], v[96:99], v[240:243], v[8:11]
    v_exp_f32 v230, v230
    v_mfma_f32_16x16x32_bf16 v[8:11], v[96:99], v[244:247], v[8:11]
    v_exp_f32 v231, v231
    v_cvt_pk_bf16_f32 v250, v228, v229
    v_cvt_pk_bf16_f32 v251, v230, v231
    v_mfma_f32_32x32x16_bf16 v[128:143], v[60:63], v[240:243], v[128:143]
    v_exp_f32 v232, v232
    v_exp_f32 v233, v233
    v_exp_f32 v234, v234
    v_mfma_f32_32x32x16_bf16 v[128:143], v[64:67], v[244:247], v[128:143]
    v_cvt_pk_bf16_f32 v252, v232, v233
    v_exp_f32 v235, v235
    v_exp_f32 v236, v236
    v_cvt_pk_bf16_f32 v253, v234, v235
    v_exp_f32 v237, v237
    v_exp_f32 v238, v238
    v_exp_f32 v239, v239
    v_cvt_pk_bf16_f32 v254, v236, v237
    v_cvt_pk_bf16_f32 v255, v238, v239
    v_mfma_f32_32x32x16_bf16 v[224:239], v[36:39], v[28:31], 0
    ds_read_b128 v[52:55], v94 offset:10240
    v_exp_f32 v68, v68
    v_exp_f32 v69, v69
    v_exp_f32 v70, v70
    v_mfma_f32_32x32x16_bf16 v[224:239], v[40:43], v[32:35], v[224:239]
    ds_read_b128 v[56:59], v94 offset:11264
    v_cvt_pk_bf16_f32 v240, v68, v69
    v_exp_f32 v71, v71
    v_exp_f32 v72, v72
    v_cvt_pk_bf16_f32 v241, v70, v71
    v_exp_f32 v73, v73
    v_mfma_f32_16x16x32_bf16 v[12:15], v[96:99], v[248:251], v[12:15]
    v_exp_f32 v74, v74
    v_mfma_f32_16x16x32_bf16 v[12:15], v[96:99], v[252:255], v[12:15]
    v_exp_f32 v75, v75
    v_cvt_pk_bf16_f32 v242, v72, v73
    v_cvt_pk_bf16_f32 v243, v74, v75
    v_mfma_f32_32x32x16_bf16 v[144:159], v[60:63], v[248:251], v[144:159]
    v_exp_f32 v76, v76
    v_exp_f32 v77, v77
    v_exp_f32 v78, v78
    v_mfma_f32_32x32x16_bf16 v[144:159], v[64:67], v[252:255], v[144:159]
    s_waitcnt lgkmcnt(0)
    v_cvt_pk_bf16_f32 v244, v76, v77
    v_exp_f32 v79, v79
    v_exp_f32 v80, v80
    v_cvt_pk_bf16_f32 v245, v78, v79
    v_exp_f32 v81, v81
    v_exp_f32 v82, v82
    v_exp_f32 v83, v83
    v_cvt_pk_bf16_f32 v246, v80, v81
    v_cvt_pk_bf16_f32 v247, v82, v83
    s_waitcnt vmcnt(32)
    s_barrier
    v_mfma_f32_32x32x16_bf16 v[68:83], v[44:47], v[20:23], 0
    ds_read_b128 v[36:39], v94 offset:16384
    v_exp_f32 v224, v224
    v_exp_f32 v225, v225
    v_exp_f32 v226, v226
    v_mfma_f32_32x32x16_bf16 v[68:83], v[48:51], v[24:27], v[68:83]
    ds_read_b128 v[40:43], v94 offset:17408
    s_add_u32 m0, s25, 131072
    v_cvt_pk_bf16_f32 v248, v224, v225
    v_exp_f32 v227, v227
    v_exp_f32 v228, v228
    v_cvt_pk_bf16_f32 v249, v226, v227
    v_exp_f32 v229, v229
    v_mfma_f32_16x16x32_bf16 v[8:11], v[96:99], v[240:243], v[8:11]
    buffer_load_dwordx4 v92, s[8:11], s24 offen offset:0 sc1 lds
    v_exp_f32 v230, v230
    v_mfma_f32_16x16x32_bf16 v[8:11], v[96:99], v[244:247], v[8:11]
    buffer_load_dwordx4 v92, s[8:11], s24 offen offset:1024 sc1 lds
    v_exp_f32 v231, v231
    v_cvt_pk_bf16_f32 v250, v228, v229
    v_cvt_pk_bf16_f32 v251, v230, v231
    v_mfma_f32_32x32x16_bf16 v[128:143], v[52:55], v[240:243], v[128:143]
    buffer_load_dwordx4 v92, s[8:11], s24 offen offset:2048 sc1 lds
    v_exp_f32 v232, v232
    v_exp_f32 v233, v233
    v_exp_f32 v234, v234
    v_mfma_f32_32x32x16_bf16 v[128:143], v[56:59], v[244:247], v[128:143]
    buffer_load_dwordx4 v92, s[8:11], s24 offen offset:3072 sc1 lds
    s_add_u32 s24, s24, 16384
    v_cvt_pk_bf16_f32 v252, v232, v233
    v_exp_f32 v235, v235
    v_exp_f32 v236, v236
    v_cvt_pk_bf16_f32 v253, v234, v235
    v_exp_f32 v237, v237
    v_exp_f32 v238, v238
    v_exp_f32 v239, v239
    v_cvt_pk_bf16_f32 v254, v236, v237
    v_cvt_pk_bf16_f32 v255, v238, v239
    v_mfma_f32_32x32x16_bf16 v[224:239], v[44:47], v[28:31], 0
    ds_read_b128 v[60:63], v94 offset:14336
    v_exp_f32 v68, v68
    v_exp_f32 v69, v69
    v_exp_f32 v70, v70
    v_mfma_f32_32x32x16_bf16 v[224:239], v[48:51], v[32:35], v[224:239]
    ds_read_b128 v[64:67], v94 offset:15360
    s_add_u32 m0, s25, 147456
    v_cvt_pk_bf16_f32 v240, v68, v69
    v_exp_f32 v71, v71
    v_exp_f32 v72, v72
    v_cvt_pk_bf16_f32 v241, v70, v71
    v_exp_f32 v73, v73
    v_mfma_f32_16x16x32_bf16 v[12:15], v[96:99], v[248:251], v[12:15]
    buffer_load_dwordx4 v92, s[8:11], s24 offen offset:0 sc1 lds
    v_exp_f32 v74, v74
    v_mfma_f32_16x16x32_bf16 v[12:15], v[96:99], v[252:255], v[12:15]
    buffer_load_dwordx4 v92, s[8:11], s24 offen offset:1024 sc1 lds
    v_exp_f32 v75, v75
    v_cvt_pk_bf16_f32 v242, v72, v73
    v_cvt_pk_bf16_f32 v243, v74, v75
    v_mfma_f32_32x32x16_bf16 v[144:159], v[52:55], v[248:251], v[144:159]
    buffer_load_dwordx4 v92, s[8:11], s24 offen offset:2048 sc1 lds
    v_exp_f32 v76, v76
    v_exp_f32 v77, v77
    v_exp_f32 v78, v78
    v_mfma_f32_32x32x16_bf16 v[144:159], v[56:59], v[252:255], v[144:159]
    s_waitcnt lgkmcnt(0)
    buffer_load_dwordx4 v92, s[8:11], s24 offen offset:3072 sc1 lds
    s_add_u32 s24, s24, 16384
    v_cvt_pk_bf16_f32 v244, v76, v77
    v_exp_f32 v79, v79
    v_exp_f32 v80, v80
    v_cvt_pk_bf16_f32 v245, v78, v79
    v_exp_f32 v81, v81
    v_exp_f32 v82, v82
    v_exp_f32 v83, v83
    v_cvt_pk_bf16_f32 v246, v80, v81
    v_cvt_pk_bf16_f32 v247, v82, v83
.p2align 6
K2_LOOPB:
    v_mfma_f32_32x32x16_bf16 v[68:83], v[36:39], v[20:23], 0
    ds_read_b128 v[44:47], v95 offset:4096
    v_exp_f32 v224, v224
    v_exp_f32 v225, v225
    v_exp_f32 v226, v226
    v_mfma_f32_32x32x16_bf16 v[68:83], v[40:43], v[24:27], v[68:83]
    ds_read_b128 v[48:51], v95 offset:5120
    v_cvt_pk_bf16_f32 v248, v224, v225
    v_exp_f32 v227, v227
    v_exp_f32 v228, v228
    v_cvt_pk_bf16_f32 v249, v226, v227
    v_exp_f32 v229, v229
    v_mfma_f32_16x16x32_bf16 v[8:11], v[96:99], v[240:243], v[8:11]
    s_cmp_eq_u32 s32, s27
    v_exp_f32 v230, v230
    v_mfma_f32_16x16x32_bf16 v[8:11], v[96:99], v[244:247], v[8:11]
    s_cselect_b32 s80, s90, s80
    v_exp_f32 v231, v231
    v_cvt_pk_bf16_f32 v250, v228, v229
    v_cvt_pk_bf16_f32 v251, v230, v231
    v_mfma_f32_32x32x16_bf16 v[128:143], v[60:63], v[240:243], v[128:143]
    s_cselect_b32 s81, s91, s81
    v_exp_f32 v232, v232
    v_exp_f32 v233, v233
    v_exp_f32 v234, v234
    v_mfma_f32_32x32x16_bf16 v[128:143], v[64:67], v[244:247], v[128:143]
    s_cselect_b32 s82, 2097152, s82
    v_cvt_pk_bf16_f32 v252, v232, v233
    v_exp_f32 v235, v235
    v_exp_f32 v236, v236
    v_cvt_pk_bf16_f32 v253, v234, v235
    v_exp_f32 v237, v237
    v_exp_f32 v238, v238
    v_exp_f32 v239, v239
    v_cvt_pk_bf16_f32 v254, v236, v237
    v_cvt_pk_bf16_f32 v255, v238, v239
    v_mfma_f32_32x32x16_bf16 v[224:239], v[36:39], v[28:31], 0
    ds_read_b128 v[52:55], v95 offset:2048
    v_exp_f32 v68, v68
    v_exp_f32 v69, v69
    v_exp_f32 v70, v70
    v_mfma_f32_32x32x16_bf16 v[224:239], v[40:43], v[32:35], v[224:239]
    ds_read_b128 v[56:59], v95 offset:3072
    v_cvt_pk_bf16_f32 v240, v68, v69
    v_exp_f32 v71, v71
    v_exp_f32 v72, v72
    v_cvt_pk_bf16_f32 v241, v70, v71
    v_exp_f32 v73, v73
    v_mfma_f32_16x16x32_bf16 v[12:15], v[96:99], v[248:251], v[12:15]
    s_cselect_b32 s34, s52, s34
    v_exp_f32 v74, v74
    v_mfma_f32_16x16x32_bf16 v[12:15], v[96:99], v[252:255], v[12:15]
    buffer_load_dword v124, v108, s[80:83], s34 offen
    v_exp_f32 v75, v75
    v_cvt_pk_bf16_f32 v242, v72, v73
    v_cvt_pk_bf16_f32 v243, v74, v75
    v_mfma_f32_32x32x16_bf16 v[144:159], v[60:63], v[248:251], v[144:159]
    s_add_u32 s34, s34, 1048576
    v_exp_f32 v76, v76
    v_exp_f32 v77, v77
    v_exp_f32 v78, v78
    v_mfma_f32_32x32x16_bf16 v[144:159], v[64:67], v[252:255], v[144:159]
    s_waitcnt lgkmcnt(0)
    v_cvt_pk_bf16_f32 v244, v76, v77
    v_exp_f32 v79, v79
    v_exp_f32 v80, v80
    v_cvt_pk_bf16_f32 v245, v78, v79
    v_exp_f32 v81, v81
    v_exp_f32 v82, v82
    v_exp_f32 v83, v83
    v_cvt_pk_bf16_f32 v246, v80, v81
    v_cvt_pk_bf16_f32 v247, v82, v83
    v_mfma_f32_32x32x16_bf16 v[68:83], v[44:47], v[20:23], 0
    ds_read_b128 v[36:39], v95 offset:8192
    v_exp_f32 v224, v224
    v_exp_f32 v225, v225
    v_exp_f32 v226, v226
    v_mfma_f32_32x32x16_bf16 v[68:83], v[48:51], v[24:27], v[68:83]
    ds_read_b128 v[40:43], v95 offset:9216
    v_cvt_pk_bf16_f32 v248, v224, v225
    v_exp_f32 v227, v227
    v_exp_f32 v228, v228
    v_cvt_pk_bf16_f32 v249, v226, v227
    v_exp_f32 v229, v229
    v_mfma_f32_16x16x32_bf16 v[8:11], v[96:99], v[240:243], v[8:11]
    v_exp_f32 v230, v230
    v_mfma_f32_16x16x32_bf16 v[8:11], v[96:99], v[244:247], v[8:11]
    v_exp_f32 v231, v231
    v_cvt_pk_bf16_f32 v250, v228, v229
    v_cvt_pk_bf16_f32 v251, v230, v231
    v_mfma_f32_32x32x16_bf16 v[128:143], v[52:55], v[240:243], v[128:143]
    v_exp_f32 v232, v232
    v_exp_f32 v233, v233
    v_exp_f32 v234, v234
    v_mfma_f32_32x32x16_bf16 v[128:143], v[56:59], v[244:247], v[128:143]
    v_cvt_pk_bf16_f32 v252, v232, v233
    v_exp_f32 v235, v235
    v_exp_f32 v236, v236
    v_cvt_pk_bf16_f32 v253, v234, v235
    v_exp_f32 v237, v237
    v_exp_f32 v238, v238
    v_exp_f32 v239, v239
    v_cvt_pk_bf16_f32 v254, v236, v237
    v_cvt_pk_bf16_f32 v255, v238, v239
    v_mfma_f32_32x32x16_bf16 v[224:239], v[44:47], v[28:31], 0
    ds_read_b128 v[60:63], v95 offset:6144
    v_exp_f32 v68, v68
    v_exp_f32 v69, v69
    v_exp_f32 v70, v70
    v_mfma_f32_32x32x16_bf16 v[224:239], v[48:51], v[32:35], v[224:239]
    ds_read_b128 v[64:67], v95 offset:7168
    v_cvt_pk_bf16_f32 v240, v68, v69
    v_exp_f32 v71, v71
    v_exp_f32 v72, v72
    v_cvt_pk_bf16_f32 v241, v70, v71
    v_exp_f32 v73, v73
    v_mfma_f32_16x16x32_bf16 v[12:15], v[96:99], v[248:251], v[12:15]
    v_exp_f32 v74, v74
    v_mfma_f32_16x16x32_bf16 v[12:15], v[96:99], v[252:255], v[12:15]
    v_exp_f32 v75, v75
    v_cvt_pk_bf16_f32 v242, v72, v73
    v_cvt_pk_bf16_f32 v243, v74, v75
    v_mfma_f32_32x32x16_bf16 v[144:159], v[52:55], v[248:251], v[144:159]
    v_exp_f32 v76, v76
    v_exp_f32 v77, v77
    v_exp_f32 v78, v78
    v_mfma_f32_32x32x16_bf16 v[144:159], v[56:59], v[252:255], v[144:159]
    s_waitcnt lgkmcnt(0)
    v_cvt_pk_bf16_f32 v244, v76, v77
    v_exp_f32 v79, v79
    v_exp_f32 v80, v80
    v_cvt_pk_bf16_f32 v245, v78, v79
    v_exp_f32 v81, v81
    v_exp_f32 v82, v82
    v_exp_f32 v83, v83
    v_cvt_pk_bf16_f32 v246, v80, v81
    v_cvt_pk_bf16_f32 v247, v82, v83
    v_mfma_f32_32x32x16_bf16 v[68:83], v[36:39], v[20:23], 0
    ds_read_b128 v[44:47], v95 offset:12288
    s_add_u32 s35, s35, 16384
    v_exp_f32 v224, v224
    v_exp_f32 v225, v225
    v_exp_f32 v226, v226
    v_mfma_f32_32x32x16_bf16 v[68:83], v[40:43], v[24:27], v[68:83]
    ds_read_b128 v[48:51], v95 offset:13312
    s_and_b32 s35, s35, 131071
    v_cvt_pk_bf16_f32 v248, v224, v225
    v_exp_f32 v227, v227
    v_exp_f32 v228, v228
    v_cvt_pk_bf16_f32 v249, v226, v227
    v_exp_f32 v229, v229
    v_mfma_f32_16x16x32_bf16 v[8:11], v[96:99], v[240:243], v[8:11]
    v_exp_f32 v230, v230
    v_mfma_f32_16x16x32_bf16 v[8:11], v[96:99], v[244:247], v[8:11]
    v_exp_f32 v231, v231
    v_cvt_pk_bf16_f32 v250, v228, v229
    v_cvt_pk_bf16_f32 v251, v230, v231
    v_mfma_f32_32x32x16_bf16 v[128:143], v[60:63], v[240:243], v[128:143]
    v_exp_f32 v232, v232
    v_exp_f32 v233, v233
    v_exp_f32 v234, v234
    v_mfma_f32_32x32x16_bf16 v[128:143], v[64:67], v[244:247], v[128:143]
    v_cvt_pk_bf16_f32 v252, v232, v233
    v_exp_f32 v235, v235
    v_exp_f32 v236, v236
    v_cvt_pk_bf16_f32 v253, v234, v235
    v_exp_f32 v237, v237
    v_exp_f32 v238, v238
    v_exp_f32 v239, v239
    v_cvt_pk_bf16_f32 v254, v236, v237
    v_cvt_pk_bf16_f32 v255, v238, v239
    v_mfma_f32_32x32x16_bf16 v[224:239], v[36:39], v[28:31], 0
    ds_read_b128 v[52:55], v95 offset:10240
    v_exp_f32 v68, v68
    v_exp_f32 v69, v69
    v_exp_f32 v70, v70
    v_mfma_f32_32x32x16_bf16 v[224:239], v[40:43], v[32:35], v[224:239]
    ds_read_b128 v[56:59], v95 offset:11264
    v_cvt_pk_bf16_f32 v240, v68, v69
    v_exp_f32 v71, v71
    v_exp_f32 v72, v72
    v_cvt_pk_bf16_f32 v241, v70, v71
    v_exp_f32 v73, v73
    v_mfma_f32_16x16x32_bf16 v[12:15], v[96:99], v[248:251], v[12:15]
    v_mov_b32 v18, v95
    v_exp_f32 v74, v74
    v_mfma_f32_16x16x32_bf16 v[12:15], v[96:99], v[252:255], v[12:15]
    v_exp_f32 v75, v75
    v_cvt_pk_bf16_f32 v242, v72, v73
    v_cvt_pk_bf16_f32 v243, v74, v75
    v_mfma_f32_32x32x16_bf16 v[144:159], v[60:63], v[248:251], v[144:159]
    v_add_u32 v95, s35, v94
    v_exp_f32 v76, v76
    v_exp_f32 v77, v77
    v_exp_f32 v78, v78
    v_mfma_f32_32x32x16_bf16 v[144:159], v[64:67], v[252:255], v[144:159]
    s_waitcnt lgkmcnt(0)
    s_cmp_lg_u32 s32, 6
    v_cvt_pk_bf16_f32 v244, v76, v77
    v_exp_f32 v79, v79
    v_exp_f32 v80, v80
    v_cvt_pk_bf16_f32 v245, v78, v79
    v_exp_f32 v81, v81
    v_exp_f32 v82, v82
    v_exp_f32 v83, v83
    v_cvt_pk_bf16_f32 v246, v80, v81
    v_cvt_pk_bf16_f32 v247, v82, v83
    s_cbranch_scc0 K2_SYNC
K2_NOSYNC:
    v_mfma_f32_32x32x16_bf16 v[68:83], v[44:47], v[20:23], 0
    ds_read_b128 v[36:39], v95 offset:0
    v_exp_f32 v224, v224
    v_exp_f32 v225, v225
    v_exp_f32 v226, v226
    v_mfma_f32_32x32x16_bf16 v[68:83], v[48:51], v[24:27], v[68:83]
    ds_read_b128 v[40:43], v95 offset:1024
    v_cvt_pk_bf16_f32 v248, v224, v225
    v_exp_f32 v227, v227
    v_exp_f32 v228, v228
    v_cvt_pk_bf16_f32 v249, v226, v227
    v_exp_f32 v229, v229
    v_mfma_f32_16x16x32_bf16 v[8:11], v[96:99], v[240:243], v[8:11]
    v_exp_f32 v230, v230
    v_mfma_f32_16x16x32_bf16 v[8:11], v[96:99], v[244:247], v[8:11]
    v_exp_f32 v231, v231
    v_cvt_pk_bf16_f32 v250, v228, v229
    v_cvt_pk_bf16_f32 v251, v230, v231
    v_mfma_f32_32x32x16_bf16 v[128:143], v[52:55], v[240:243], v[128:143]
    v_exp_f32 v232, v232
    v_exp_f32 v233, v233
    v_exp_f32 v234, v234
    v_mfma_f32_32x32x16_bf16 v[128:143], v[56:59], v[244:247], v[128:143]
    v_cvt_pk_bf16_f32 v252, v232, v233
    v_exp_f32 v235, v235
    v_exp_f32 v236, v236
    v_cvt_pk_bf16_f32 v253, v234, v235
    v_exp_f32 v237, v237
    v_exp_f32 v238, v238
    v_exp_f32 v239, v239
    v_cvt_pk_bf16_f32 v254, v236, v237
    v_cvt_pk_bf16_f32 v255, v238, v239
    v_mfma_f32_32x32x16_bf16 v[224:239], v[44:47], v[28:31], 0
    ds_read_b128 v[60:63], v18 offset:14336
    v_exp_f32 v68, v68
    v_exp_f32 v69, v69
    v_exp_f32 v70, v70
    v_mfma_f32_32x32x16_bf16 v[224:239], v[48:51], v[32:35], v[224:239]
    ds_read_b128 v[64:67], v18 offset:15360
    v_cvt_pk_bf16_f32 v240, v68, v69
    v_exp_f32 v71, v71
    v_exp_f32 v72, v72
    v_cvt_pk_bf16_f32 v241, v70, v71
    v_exp_f32 v73, v73
    v_mfma_f32_16x16x32_bf16 v[12:15], v[96:99], v[248:251], v[12:15]
    v_exp_f32 v74, v74
    v_mfma_f32_16x16x32_bf16 v[12:15], v[96:99], v[252:255], v[12:15]
    v_exp_f32 v75, v75
    v_cvt_pk_bf16_f32 v242, v72, v73
    v_cvt_pk_bf16_f32 v243, v74, v75
    v_mfma_f32_32x32x16_bf16 v[144:159], v[52:55], v[248:251], v[144:159]
    s_sub_u32 s32, s32, 1
    v_exp_f32 v76, v76
    v_exp_f32 v77, v77
    v_exp_f32 v78, v78
    v_mfma_f32_32x32x16_bf16 v[144:159], v[56:59], v[252:255], v[144:159]
    s_waitcnt lgkmcnt(0)
    s_cmp_lg_u32 s32, 1
    v_cvt_pk_bf16_f32 v244, v76, v77
    v_exp_f32 v79, v79
    v_exp_f32 v80, v80
    v_cvt_pk_bf16_f32 v245, v78, v79
    v_exp_f32 v81, v81
    v_exp_f32 v82, v82
    v_exp_f32 v83, v83
    v_cvt_pk_bf16_f32 v246, v80, v81
    v_cvt_pk_bf16_f32 v247, v82, v83
    s_cbranch_scc1 K2_LOOPB
    v_mfma_f32_32x32x16_bf16 v[68:83], v[36:39], v[20:23], 0
    ds_read_b128 v[44:47], v19 offset:36864
    v_exp_f32 v224, v224
    v_exp_f32 v225, v225
    v_exp_f32 v226, v226
    v_mfma_f32_32x32x16_bf16 v[68:83], v[40:43], v[24:27], v[68:83]
    ds_read_b128 v[48:51], v19 offset:37888
    v_cvt_pk_bf16_f32 v248, v224, v225
    v_exp_f32 v227, v227
    v_exp_f32 v228, v228
    v_cvt_pk_bf16_f32 v249, v226, v227
    v_exp_f32 v229, v229
    v_mfma_f32_16x16x32_bf16 v[8:11], v[96:99], v[240:243], v[8:11]
    buffer_load_dwordx2 v[88:89], v104, s[20:23], 0 offen sc1
    v_exp_f32 v230, v230
    v_mfma_f32_16x16x32_bf16 v[8:11], v[96:99], v[244:247], v[8:11]
    v_exp_f32 v231, v231
    v_cvt_pk_bf16_f32 v250, v228, v229
    v_cvt_pk_bf16_f32 v251, v230, v231
    v_mfma_f32_32x32x16_bf16 v[128:143], v[60:63], v[240:243], v[128:143]
    v_exp_f32 v232, v232
    v_exp_f32 v233, v233
    v_exp_f32 v234, v234
    v_mfma_f32_32x32x16_bf16 v[128:143], v[64:67], v[244:247], v[128:143]
    v_cvt_pk_bf16_f32 v252, v232, v233
    v_exp_f32 v235, v235
    v_exp_f32 v236, v236
    v_cvt_pk_bf16_f32 v253, v234, v235
    v_exp_f32 v237, v237
    v_exp_f32 v238, v238
    v_exp_f32 v239, v239
    v_cvt_pk_bf16_f32 v254, v236, v237
    v_cvt_pk_bf16_f32 v255, v238, v239
    v_mfma_f32_32x32x16_bf16 v[224:239], v[36:39], v[28:31], 0
    ds_read_b128 v[52:55], v19 offset:34816
    v_exp_f32 v68, v68
    v_exp_f32 v69, v69
    v_exp_f32 v70, v70
    v_mfma_f32_32x32x16_bf16 v[224:239], v[40:43], v[32:35], v[224:239]
    ds_read_b128 v[56:59], v19 offset:35840
    v_cvt_pk_bf16_f32 v240, v68, v69
    v_exp_f32 v71, v71
    v_exp_f32 v72, v72
    v_cvt_pk_bf16_f32 v241, v70, v71
    v_exp_f32 v73, v73
    v_mfma_f32_16x16x32_bf16 v[12:15], v[96:99], v[248:251], v[12:15]
    v_exp_f32 v74, v74
    v_mfma_f32_16x16x32_bf16 v[12:15], v[96:99], v[252:255], v[12:15]
    v_exp_f32 v75, v75
    v_cvt_pk_bf16_f32 v242, v72, v73
    v_cvt_pk_bf16_f32 v243, v74, v75
    v_mfma_f32_32x32x16_bf16 v[144:159], v[60:63], v[248:251], v[144:159]
    v_exp_f32 v76, v76
    v_exp_f32 v77, v77
    v_exp_f32 v78, v78
    v_mfma_f32_32x32x16_bf16 v[144:159], v[64:67], v[252:255], v[144:159]
    s_waitcnt lgkmcnt(0)
    v_cvt_pk_bf16_f32 v244, v76, v77
    v_exp_f32 v79, v79
    v_exp_f32 v80, v80
    v_cvt_pk_bf16_f32 v245, v78, v79
    v_exp_f32 v81, v81
    v_exp_f32 v82, v82
    v_exp_f32 v83, v83
    v_cvt_pk_bf16_f32 v246, v80, v81
    v_cvt_pk_bf16_f32 v247, v82, v83
    s_mov_b32 s3, 0
    s_waitcnt vmcnt(0)
K_SPIN_H:
    v_cmp_ne_u64 vcc, s[46:47], v[88:89]
    s_nop 4
    s_cmp_eq_u64 vcc, 0
    s_cbranch_scc0 K_SPIN_H_RETRY
K_SPIN_H_OK:
    s_barrier
    v_mfma_f32_32x32x16_bf16 v[68:83], v[44:47], v[20:23], 0
    ds_read_b128 v[36:39], v19 offset:40960
    v_exp_f32 v224, v224
    v_exp_f32 v225, v225
    v_exp_f32 v226, v226
    v_mfma_f32_32x32x16_bf16 v[68:83], v[48:51], v[24:27], v[68:83]
    ds_read_b128 v[40:43], v19 offset:41984
    v_cvt_pk_bf16_f32 v248, v224, v225
    v_exp_f32 v227, v227
    v_exp_f32 v228, v228
    v_cvt_pk_bf16_f32 v249, v226, v227
    v_exp_f32 v229, v229
    v_mfma_f32_16x16x32_bf16 v[8:11], v[96:99], v[240:243], v[8:11]
    buffer_load_dword v16, v105, s[20:23], s33 offen offset:0 sc1
    v_exp_f32 v230, v230
    v_mfma_f32_16x16x32_bf16 v[8:11], v[96:99], v[244:247], v[8:11]
    buffer_load_dword v17, v105, s[20:23], s33 offen offset:128 sc1
    v_exp_f32 v231, v231
    v_cvt_pk_bf16_f32 v250, v228, v229
    v_cvt_pk_bf16_f32 v251, v230, v231
    v_mfma_f32_32x32x16_bf16 v[128:143], v[52:55], v[240:243], v[128:143]
    buffer_load_dword v90, v106, s[20:23], s57 offen offset:0 sc1
    v_exp_f32 v232, v232
    v_exp_f32 v233, v233
    v_exp_f32 v234, v234
    v_mfma_f32_32x32x16_bf16 v[128:143], v[56:59], v[244:247], v[128:143]
    buffer_load_dword v91, v106, s[20:23], s57 offen offset:64 sc1
    s_add_u32 m0, s59, 65536
    v_cvt_pk_bf16_f32 v252, v232, v233
    v_exp_f32 v235, v235
    v_exp_f32 v236, v236
    v_cvt_pk_bf16_f32 v253, v234, v235
    v_exp_f32 v237, v237
    v_exp_f32 v238, v238
    v_exp_f32 v239, v239
    v_cvt_pk_bf16_f32 v254, v236, v237
    v_cvt_pk_bf16_f32 v255, v238, v239
    v_mfma_f32_32x32x16_bf16 v[224:239], v[44:47], v[28:31], 0
    ds_read_b128 v[60:63], v19 offset:38912
    v_exp_f32 v68, v68
    v_exp_f32 v69, v69
    v_exp_f32 v70, v70
    v_mfma_f32_32x32x16_bf16 v[224:239], v[48:51], v[32:35], v[224:239]
    ds_read_b128 v[64:67], v19 offset:39936
    v_cvt_pk_bf16_f32 v240, v68, v69
    v_exp_f32 v71, v71
    v_exp_f32 v72, v72
    v_cvt_pk_bf16_f32 v241, v70, v71
    v_exp_f32 v73, v73
    v_mfma_f32_16x16x32_bf16 v[12:15], v[96:99], v[248:251], v[12:15]
    buffer_load_dwordx4 v110, s[12:15], s58 offen offset:0 lds
    v_exp_f32 v74, v74
    v_mfma_f32_16x16x32_bf16 v[12:15], v[96:99], v[252:255], v[12:15]
    buffer_load_dwordx4 v111, s[12:15], s58 offen offset:1024 lds
    v_exp_f32 v75, v75
    v_cvt_pk_bf16_f32 v242, v72, v73
    v_cvt_pk_bf16_f32 v243, v74, v75
    v_mfma_f32_32x32x16_bf16 v[144:159], v[52:55], v[248:251], v[144:159]
    buffer_load_dwordx4 v112, s[12:15], s58 offen offset:2048 lds
    v_exp_f32 v76, v76
    v_exp_f32 v77, v77
    v_exp_f32 v78, v78
    v_mfma_f32_32x32x16_bf16 v[144:159], v[56:59], v[252:255], v[144:159]
    s_waitcnt lgkmcnt(0)
    buffer_load_dwordx4 v113, s[12:15], s58 offen offset:3072 lds
    s_add_u32 m0, s59, 69632
    v_cvt_pk_bf16_f32 v244, v76, v77
    v_exp_f32 v79, v79
    v_exp_f32 v80, v80
    v_cvt_pk_bf16_f32 v245, v78, v79
    v_exp_f32 v81, v81
    v_exp_f32 v82, v82
    v_exp_f32 v83, v83
    v_cvt_pk_bf16_f32 v246, v80, v81
    v_cvt_pk_bf16_f32 v247, v82, v83
    v_mfma_f32_32x32x16_bf16 v[68:83], v[36:39], v[20:23], 0
    ds_read_b128 v[44:47], v19 offset:45056
    v_exp_f32 v224, v224
    v_exp_f32 v225, v225
    v_exp_f32 v226, v226
    v_mfma_f32_32x32x16_bf16 v[68:83], v[40:43], v[24:27], v[68:83]
    ds_read_b128 v[48:51], v19 offset:46080
    v_cvt_pk_bf16_f32 v248, v224, v225
    v_exp_f32 v227, v227
    v_exp_f32 v228, v228
    v_cvt_pk_bf16_f32 v249, v226, v227
    v_exp_f32 v229, v229
    v_mfma_f32_16x16x32_bf16 v[8:11], v[96:99], v[240:243], v[8:11]
    v_exp_f32 v230, v230
    v_mfma_f32_16x16x32_bf16 v[8:11], v[96:99], v[244:247], v[8:11]
    buffer_load_dwordx4 v114, s[12:15], s58 offen offset:0 lds
    v_exp_f32 v231, v231
    v_cvt_pk_bf16_f32 v250, v228, v229
    v_cvt_pk_bf16_f32 v251, v230, v231
    v_mfma_f32_32x32x16_bf16 v[128:143], v[60:63], v[240:243], v[128:143]
    buffer_load_dwordx4 a[64:67], v101, s[64:67], s60 offen offset:0 sc1
    v_exp_f32 v232, v232
    v_exp_f32 v233, v233
    v_exp_f32 v234, v234
    v_mfma_f32_32x32x16_bf16 v[128:143], v[64:67], v[244:247], v[128:143]
    buffer_load_dwordx4 v115, s[12:15], s58 offen offset:1024 lds
    v_cvt_pk_bf16_f32 v252, v232, v233
    v_exp_f32 v235, v235
    v_exp_f32 v236, v236
    v_cvt_pk_bf16_f32 v253, v234, v235
    v_exp_f32 v237, v237
    v_exp_f32 v238, v238
    v_exp_f32 v239, v239
    v_cvt_pk_bf16_f32 v254, v236, v237
    v_cvt_pk_bf16_f32 v255, v238, v239
    v_mfma_f32_32x32x16_bf16 v[224:239], v[36:39], v[28:31], 0
    ds_read_b128 v[52:55], v19 offset:43008
    v_exp_f32 v68, v68
    v_exp_f32 v69, v69
    v_exp_f32 v70, v70
    v_mfma_f32_32x32x16_bf16 v[224:239], v[40:43], v[32:35], v[224:239]
    ds_read_b128 v[56:59], v19 offset:44032
    v_cvt_pk_bf16_f32 v240, v68, v69
    v_exp_f32 v71, v71
    v_exp_f32 v72, v72
    v_cvt_pk_bf16_f32 v241, v70, v71
    v_exp_f32 v73, v73
    v_mfma_f32_16x16x32_bf16 v[12:15], v[96:99], v[248:251], v[12:15]
    v_exp_f32 v74, v74
    v_mfma_f32_16x16x32_bf16 v[12:15], v[96:99], v[252:255], v[12:15]
    buffer_load_dwordx4 a[68:71], v102, s[64:67], s60 offen offset:0 sc1
    v_exp_f32 v75, v75
    v_cvt_pk_bf16_f32 v242, v72, v73
    v_cvt_pk_bf16_f32 v243, v74, v75
    v_mfma_f32_32x32x16_bf16 v[144:159], v[60:63], v[248:251], v[144:159]
    v_exp_f32 v76, v76
    v_exp_f32 v77, v77
    v_exp_f32 v78, v78
    v_mfma_f32_32x32x16_bf16 v[144:159], v[64:67], v[252:255], v[144:159]
    s_waitcnt lgkmcnt(0)
    buffer_load_dwordx4 v116, s[12:15], s58 offen offset:2048 lds
    v_cvt_pk_bf16_f32 v244, v76, v77
    v_exp_f32 v79, v79
    v_exp_f32 v80, v80
    v_cvt_pk_bf16_f32 v245, v78, v79
    v_exp_f32 v81, v81
    v_exp_f32 v82, v82
    v_exp_f32 v83, v83
    v_cvt_pk_bf16_f32 v246, v80, v81
    v_cvt_pk_bf16_f32 v247, v82, v83
    v_mfma_f32_32x32x16_bf16 v[68:83], v[44:47], v[20:23], 0
    ds_read_b128 v[36:39], v19 offset:49152
    v_exp_f32 v224, v224
    v_exp_f32 v225, v225
    v_exp_f32 v226, v226
    v_mfma_f32_32x32x16_bf16 v[68:83], v[48:51], v[24:27], v[68:83]
    ds_read_b128 v[40:43], v19 offset:50176
    v_cvt_pk_bf16_f32 v248, v224, v225
    v_exp_f32 v227, v227
    v_exp_f32 v228, v228
    v_cvt_pk_bf16_f32 v249, v226, v227
    v_exp_f32 v229, v229
    v_mfma_f32_16x16x32_bf16 v[8:11], v[96:99], v[240:243], v[8:11]
    buffer_load_dwordx4 a[72:75], v101, s[64:67], s60 offen offset:1024 sc1
    v_exp_f32 v230, v230
    v_mfma_f32_16x16x32_bf16 v[8:11], v[96:99], v[244:247], v[8:11]
    buffer_load_dwordx4 v117, s[12:15], s58 offen offset:3072 lds
    s_add_u32 s58, s58, 262144
    v_exp_f32 v231, v231
    v_cvt_pk_bf16_f32 v250, v228, v229
    v_cvt_pk_bf16_f32 v251, v230, v231
    v_mfma_f32_32x32x16_bf16 v[128:143], v[52:55], v[240:243], v[128:143]
    buffer_load_dwordx4 a[76:79], v102, s[64:67], s60 offen offset:1024 sc1
    s_add_u32 m0, s59, 98304
    v_exp_f32 v232, v232
    v_exp_f32 v233, v233
    v_exp_f32 v234, v234
    v_mfma_f32_32x32x16_bf16 v[128:143], v[56:59], v[244:247], v[128:143]
    v_cvt_pk_bf16_f32 v252, v232, v233
    v_exp_f32 v235, v235
    v_exp_f32 v236, v236
    v_cvt_pk_bf16_f32 v253, v234, v235
    v_exp_f32 v237, v237
    v_exp_f32 v238, v238
    v_exp_f32 v239, v239
    v_cvt_pk_bf16_f32 v254, v236, v237
    v_cvt_pk_bf16_f32 v255, v238, v239
    v_mfma_f32_32x32x16_bf16 v[224:239], v[44:47], v[28:31], 0
    ds_read_b128 v[60:63], v19 offset:47104
    v_exp_f32 v68, v68
    v_exp_f32 v69, v69
    v_exp_f32 v70, v70
    v_mfma_f32_32x32x16_bf16 v[224:239], v[48:51], v[32:35], v[224:239]
    ds_read_b128 v[64:67], v19 offset:48128
    v_cvt_pk_bf16_f32 v240, v68, v69
    v_exp_f32 v71, v71
    v_exp_f32 v72, v72
    v_cvt_pk_bf16_f32 v241, v70, v71
    v_exp_f32 v73, v73
    v_mfma_f32_16x16x32_bf16 v[12:15], v[96:99], v[248:251], v[12:15]
    buffer_load_dwordx4 v110, s[12:15], s58 offen offset:0 lds
    v_exp_f32 v74, v74
    v_mfma_f32_16x16x32_bf16 v[12:15], v[96:99], v[252:255], v[12:15]
    buffer_load_dwordx4 a[80:83], v101, s[64:67], s60 offen offset:2048 sc1
    v_exp_f32 v75, v75
    v_cvt_pk_bf16_f32 v242, v72, v73
    v_cvt_pk_bf16_f32 v243, v74, v75
    v_mfma_f32_32x32x16_bf16 v[144:159], v[52:55], v[248:251], v[144:159]
    buffer_load_dwordx4 v111, s[12:15], s58 offen offset:1024 lds
    v_exp_f32 v76, v76
    v_exp_f32 v77, v77
    v_exp_f32 v78, v78
    v_mfma_f32_32x32x16_bf16 v[144:159], v[56:59], v[252:255], v[144:159]
    s_waitcnt lgkmcnt(0)
    buffer_load_dwordx4 a[84:87], v102, s[64:67], s60 offen offset:2048 sc1
    v_cvt_pk_bf16_f32 v244, v76, v77
    v_exp_f32 v79, v79
    v_exp_f32 v80, v80
    v_cvt_pk_bf16_f32 v245, v78, v79
    v_exp_f32 v81, v81
    v_exp_f32 v82, v82
    v_exp_f32 v83, v83
    v_cvt_pk_bf16_f32 v246, v80, v81
    v_cvt_pk_bf16_f32 v247, v82, v83
    v_mfma_f32_32x32x16_bf16 v[68:83], v[36:39], v[20:23], 0
    ds_read_b128 v[44:47], v19 offset:53248
    v_exp_f32 v224, v224
    v_exp_f32 v225, v225
    v_exp_f32 v226, v226
    v_mfma_f32_32x32x16_bf16 v[68:83], v[40:43], v[24:27], v[68:83]
    ds_read_b128 v[48:51], v19 offset:54272
    v_cvt_pk_bf16_f32 v248, v224, v225
    v_exp_f32 v227, v227
    v_exp_f32 v228, v228
    v_cvt_pk_bf16_f32 v249, v226, v227
    v_exp_f32 v229, v229
    v_mfma_f32_16x16x32_bf16 v[8:11], v[96:99], v[240:243], v[8:11]
    buffer_load_dwordx4 v112, s[12:15], s58 offen offset:2048 lds
    v_exp_f32 v230, v230
    v_mfma_f32_16x16x32_bf16 v[8:11], v[96:99], v[244:247], v[8:11]
    buffer_load_dwordx4 a[88:91], v101, s[64:67], s60 offen offset:3072 sc1
    v_exp_f32 v231, v231
    v_cvt_pk_bf16_f32 v250, v228, v229
    v_cvt_pk_bf16_f32 v251, v230, v231
    v_mfma_f32_32x32x16_bf16 v[128:143], v[60:63], v[240:243], v[128:143]
    buffer_load_dwordx4 v113, s[12:15], s58 offen offset:3072 lds
    v_exp_f32 v232, v232
    v_exp_f32 v233, v233
    v_exp_f32 v234, v234
    v_mfma_f32_32x32x16_bf16 v[128:143], v[64:67], v[244:247], v[128:143]
    buffer_load_dwordx4 a[92:95], v102, s[64:67], s60 offen offset:3072 sc1
    s_add_u32 s60, s60, 4096
    s_add_u32 m0, s59, 102400
    v_cvt_pk_bf16_f32 v252, v232, v233
    v_exp_f32 v235, v235
    v_exp_f32 v236, v236
    v_cvt_pk_bf16_f32 v253, v234, v235
    v_exp_f32 v237, v237
    v_exp_f32 v238, v238
    v_exp_f32 v239, v239
    v_cvt_pk_bf16_f32 v254, v236, v237
    v_cvt_pk_bf16_f32 v255, v238, v239
    v_mfma_f32_32x32x16_bf16 v[224:239], v[36:39], v[28:31], 0
    ds_read_b128 v[52:55], v19 offset:51200
    v_exp_f32 v68, v68
    v_exp_f32 v69, v69
    v_exp_f32 v70, v70
    v_mfma_f32_32x32x16_bf16 v[224:239], v[40:43], v[32:35], v[224:239]
    ds_read_b128 v[56:59], v19 offset:52224
    v_cvt_pk_bf16_f32 v240, v68, v69
    v_exp_f32 v71, v71
    v_exp_f32 v72, v72
    v_cvt_pk_bf16_f32 v241, v70, v71
    v_exp_f32 v73, v73
    v_mfma_f32_16x16x32_bf16 v[12:15], v[96:99], v[248:251], v[12:15]
    v_exp_f32 v74, v74
    v_mfma_f32_16x16x32_bf16 v[12:15], v[96:99], v[252:255], v[12:15]
    buffer_load_dwordx4 v114, s[12:15], s58 offen offset:0 lds
    v_exp_f32 v75, v75
    v_cvt_pk_bf16_f32 v242, v72, v73
    v_cvt_pk_bf16_f32 v243, v74, v75
    v_mfma_f32_32x32x16_bf16 v[144:159], v[60:63], v[248:251], v[144:159]
    buffer_load_dwordx4 a[96:99], v101, s[64:67], s60 offen offset:0 sc1
    v_exp_f32 v76, v76
    v_exp_f32 v77, v77
    v_exp_f32 v78, v78
    v_mfma_f32_32x32x16_bf16 v[144:159], v[64:67], v[252:255], v[144:159]
    s_waitcnt lgkmcnt(0)
    buffer_load_dwordx4 v115, s[12:15], s58 offen offset:1024 lds
    v_cvt_pk_bf16_f32 v244, v76, v77
    v_exp_f32 v79, v79
    v_exp_f32 v80, v80
    v_cvt_pk_bf16_f32 v245, v78, v79
    v_exp_f32 v81, v81
    v_exp_f32 v82, v82
    v_exp_f32 v83, v83
    v_cvt_pk_bf16_f32 v246, v80, v81
    v_cvt_pk_bf16_f32 v247, v82, v83
    v_mfma_f32_32x32x16_bf16 v[68:83], v[44:47], v[20:23], 0
    ds_read_b128 v[36:39], v19 offset:57344
    v_exp_f32 v224, v224
    v_exp_f32 v225, v225
    v_exp_f32 v226, v226
    v_mfma_f32_32x32x16_bf16 v[68:83], v[48:51], v[24:27], v[68:83]
    ds_read_b128 v[40:43], v19 offset:58368
    v_cvt_pk_bf16_f32 v248, v224, v225
    v_exp_f32 v227, v227
    v_exp_f32 v228, v228
    v_cvt_pk_bf16_f32 v249, v226, v227
    v_exp_f32 v229, v229
    v_mfma_f32_16x16x32_bf16 v[8:11], v[96:99], v[240:243], v[8:11]
    buffer_load_dwordx4 a[100:103], v102, s[64:67], s60 offen offset:0 sc1
    v_exp_f32 v230, v230
    v_mfma_f32_16x16x32_bf16 v[8:11], v[96:99], v[244:247], v[8:11]
    buffer_load_dwordx4 v116, s[12:15], s58 offen offset:2048 lds
    v_exp_f32 v231, v231
    v_cvt_pk_bf16_f32 v250, v228, v229
    v_cvt_pk_bf16_f32 v251, v230, v231
    v_mfma_f32_32x32x16_bf16 v[128:143], v[52:55], v[240:243], v[128:143]
    buffer_load_dwordx4 a[104:107], v101, s[64:67], s60 offen offset:1024 sc1
    v_exp_f32 v232, v232
    v_exp_f32 v233, v233
    v_exp_f32 v234, v234
    v_mfma_f32_32x32x16_bf16 v[128:143], v[56:59], v[244:247], v[128:143]
    buffer_load_dwordx4 v117, s[12:15], s58 offen offset:3072 lds
    s_add_u32 s58, s58, 262144
    v_cvt_pk_bf16_f32 v252, v232, v233
    v_exp_f32 v235, v235
    v_exp_f32 v236, v236
    v_cvt_pk_bf16_f32 v253, v234, v235
    v_exp_f32 v237, v237
    v_exp_f32 v238, v238
    v_exp_f32 v239, v239
    v_cvt_pk_bf16_f32 v254, v236, v237
    v_cvt_pk_bf16_f32 v255, v238, v239
    v_mfma_f32_32x32x16_bf16 v[224:239], v[44:47], v[28:31], 0
    ds_read_b128 v[60:63], v19 offset:55296
    v_exp_f32 v68, v68
    v_exp_f32 v69, v69
    v_exp_f32 v70, v70
    v_mfma_f32_32x32x16_bf16 v[224:239], v[48:51], v[32:35], v[224:239]
    ds_read_b128 v[64:67], v19 offset:56320
    v_cvt_pk_bf16_f32 v240, v68, v69
    v_exp_f32 v71, v71
    v_exp_f32 v72, v72
    v_cvt_pk_bf16_f32 v241, v70, v71
    v_exp_f32 v73, v73
    v_mfma_f32_16x16x32_bf16 v[12:15], v[96:99], v[248:251], v[12:15]
    buffer_load_dwordx4 a[108:111], v102, s[64:67], s60 offen offset:1024 sc1
    s_add_u32 m0, s59, 0
    v_exp_f32 v74, v74
    v_mfma_f32_16x16x32_bf16 v[12:15], v[96:99], v[252:255], v[12:15]
    v_exp_f32 v75, v75
    v_cvt_pk_bf16_f32 v242, v72, v73
    v_cvt_pk_bf16_f32 v243, v74, v75
    v_mfma_f32_32x32x16_bf16 v[144:159], v[52:55], v[248:251], v[144:159]
    buffer_load_dwordx4 v110, s[12:15], s58 offen offset:0 lds
    v_exp_f32 v76, v76
    v_exp_f32 v77, v77
    v_exp_f32 v78, v78
    v_mfma_f32_32x32x16_bf16 v[144:159], v[56:59], v[252:255], v[144:159]
    s_waitcnt lgkmcnt(0)
    buffer_load_dwordx4 a[112:115], v101, s[64:67], s60 offen offset:2048 sc1
    v_cvt_pk_bf16_f32 v244, v76, v77
    v_exp_f32 v79, v79
    v_exp_f32 v80, v80
    v_cvt_pk_bf16_f32 v245, v78, v79
    v_exp_f32 v81, v81
    v_exp_f32 v82, v82
    v_exp_f32 v83, v83
    v_cvt_pk_bf16_f32 v246, v80, v81
    v_cvt_pk_bf16_f32 v247, v82, v83
    v_mfma_f32_32x32x16_bf16 v[68:83], v[36:39], v[20:23], 0
    ds_read_b128 v[44:47], v19 offset:61440
    v_exp_f32 v224, v224
    v_exp_f32 v225, v225
    v_exp_f32 v226, v226
    v_mfma_f32_32x32x16_bf16 v[68:83], v[40:43], v[24:27], v[68:83]
    ds_read_b128 v[48:51], v19 offset:62464
    v_cvt_pk_bf16_f32 v248, v224, v225
    v_exp_f32 v227, v227
    v_exp_f32 v228, v228
    v_cvt_pk_bf16_f32 v249, v226, v227
    v_exp_f32 v229, v229
    v_mfma_f32_16x16x32_bf16 v[8:11], v[96:99], v[240:243], v[8:11]
    buffer_load_dwordx4 v111, s[12:15], s58 offen offset:1024 lds
    v_exp_f32 v230, v230
    v_mfma_f32_16x16x32_bf16 v[8:11], v[96:99], v[244:247], v[8:11]
    buffer_load_dwordx4 a[116:119], v102, s[64:67], s60 offen offset:2048 sc1
    v_exp_f32 v231, v231
    v_cvt_pk_bf16_f32 v250, v228, v229
    v_cvt_pk_bf16_f32 v251, v230, v231
    v_mfma_f32_32x32x16_bf16 v[128:143], v[60:63], v[240:243], v[128:143]
    buffer_load_dwordx4 v112, s[12:15], s58 offen offset:2048 lds
    v_exp_f32 v232, v232
    v_exp_f32 v233, v233
    v_exp_f32 v234, v234
    v_mfma_f32_32x32x16_bf16 v[128:143], v[64:67], v[244:247], v[128:143]
    buffer_load_dwordx4 a[120:123], v101, s[64:67], s60 offen offset:3072 sc1
    v_cvt_pk_bf16_f32 v252, v232, v233
    v_exp_f32 v235, v235
    v_exp_f32 v236, v236
    v_cvt_pk_bf16_f32 v253, v234, v235
    v_exp_f32 v237, v237
    v_exp_f32 v238, v238
    v_exp_f32 v239, v239
    v_cvt_pk_bf16_f32 v254, v236, v237
    v_cvt_pk_bf16_f32 v255, v238, v239
    v_mfma_f32_32x32x16_bf16 v[224:239], v[36:39], v[28:31], 0
    ds_read_b128 v[52:55], v19 offset:59392
    v_exp_f32 v68, v68
    v_exp_f32 v69, v69
    v_exp_f32 v70, v70
    v_mfma_f32_32x32x16_bf16 v[224:239], v[40:43], v[32:35], v[224:239]
    ds_read_b128 v[56:59], v19 offset:60416
    v_cvt_pk_bf16_f32 v240, v68, v69
    v_exp_f32 v71, v71
    v_exp_f32 v72, v72
    v_cvt_pk_bf16_f32 v241, v70, v71
    v_exp_f32 v73, v73
    v_mfma_f32_16x16x32_bf16 v[12:15], v[96:99], v[248:251], v[12:15]
    buffer_load_dwordx4 v113, s[12:15], s58 offen offset:3072 lds
    v_exp_f32 v74, v74
    v_mfma_f32_16x16x32_bf16 v[12:15], v[96:99], v[252:255], v[12:15]
    buffer_load_dwordx4 a[124:127], v102, s[64:67], s60 offen offset:3072 sc1
    s_add_u32 s60, s60, 4096
    s_add_u32 m0, s59, 4096
    v_exp_f32 v75, v75
    v_cvt_pk_bf16_f32 v242, v72, v73
    v_cvt_pk_bf16_f32 v243, v74, v75
    v_mfma_f32_32x32x16_bf16 v[144:159], v[60:63], v[248:251], v[144:159]
    v_exp_f32 v76, v76
    v_exp_f32 v77, v77
    v_exp_f32 v78, v78
    v_mfma_f32_32x32x16_bf16 v[144:159], v[64:67], v[252:255], v[144:159]
    s_waitcnt lgkmcnt(0)
    buffer_load_dwordx4 v114, s[12:15], s58 offen offset:0 lds
    v_cvt_pk_bf16_f32 v244, v76, v77
    v_exp_f32 v79, v79
    v_exp_f32 v80, v80
    v_cvt_pk_bf16_f32 v245, v78, v79
    v_exp_f32 v81, v81
    v_exp_f32 v82, v82
    v_exp_f32 v83, v83
    v_cvt_pk_bf16_f32 v246, v80, v81
    v_cvt_pk_bf16_f32 v247, v82, v83
    v_mfma_f32_32x32x16_bf16 v[68:83], v[44:47], v[20:23], 0
    v_exp_f32 v224, v224
    v_exp_f32 v225, v225
    v_exp_f32 v226, v226
    v_mfma_f32_32x32x16_bf16 v[68:83], v[48:51], v[24:27], v[68:83]
    v_cvt_pk_bf16_f32 v248, v224, v225
    v_exp_f32 v227, v227
    v_exp_f32 v228, v228
    v_cvt_pk_bf16_f32 v249, v226, v227
    v_exp_f32 v229, v229
    v_mfma_f32_16x16x32_bf16 v[8:11], v[96:99], v[240:243], v[8:11]
    buffer_load_dwordx4 a[0:3], v101, s[64:67], s60 offen offset:0 sc1
    v_exp_f32 v230, v230
    v_mfma_f32_16x16x32_bf16 v[8:11], v[96:99], v[244:247], v[8:11]
    buffer_load_dwordx4 v115, s[12:15], s58 offen offset:1024 lds
    v_exp_f32 v231, v231
    v_cvt_pk_bf16_f32 v250, v228, v229
    v_cvt_pk_bf16_f32 v251, v230, v231
    v_mfma_f32_32x32x16_bf16 v[128:143], v[52:55], v[240:243], v[128:143]
    buffer_load_dwordx4 a[4:7], v102, s[64:67], s60 offen offset:0 sc1
    v_exp_f32 v232, v232
    v_exp_f32 v233, v233
    v_exp_f32 v234, v234
    v_mfma_f32_32x32x16_bf16 v[128:143], v[56:59], v[244:247], v[128:143]
    buffer_load_dwordx4 v116, s[12:15], s58 offen offset:2048 lds
    v_cvt_pk_bf16_f32 v252, v232, v233
    v_exp_f32 v235, v235
    v_exp_f32 v236, v236
    v_cvt_pk_bf16_f32 v253, v234, v235
    v_exp_f32 v237, v237
    v_exp_f32 v238, v238
    v_exp_f32 v239, v239
    v_cvt_pk_bf16_f32 v254, v236, v237
    v_cvt_pk_bf16_f32 v255, v238, v239
    v_mfma_f32_32x32x16_bf16 v[224:239], v[44:47], v[28:31], 0
    ds_read_b128 v[60:63], v19 offset:63488
    v_exp_f32 v68, v68
    v_exp_f32 v69, v69
    v_exp_f32 v70, v70
    v_mfma_f32_32x32x16_bf16 v[224:239], v[48:51], v[32:35], v[224:239]
    ds_read_b128 v[64:67], v19 offset:64512
    v_cvt_pk_bf16_f32 v240, v68, v69
    v_exp_f32 v71, v71
    v_exp_f32 v72, v72
    v_cvt_pk_bf16_f32 v241, v70, v71
    v_exp_f32 v73, v73
    v_mfma_f32_16x16x32_bf16 v[12:15], v[96:99], v[248:251], v[12:15]
    buffer_load_dwordx4 a[8:11], v101, s[64:67], s60 offen offset:1024 sc1
    v_exp_f32 v74, v74
    v_mfma_f32_16x16x32_bf16 v[12:15], v[96:99], v[252:255], v[12:15]
    buffer_load_dwordx4 v117, s[12:15], s58 offen offset:3072 lds
    s_add_u32 s58, s58, 262144
    v_exp_f32 v75, v75
    v_cvt_pk_bf16_f32 v242, v72, v73
    v_cvt_pk_bf16_f32 v243, v74, v75
    v_mfma_f32_32x32x16_bf16 v[144:159], v[52:55], v[248:251], v[144:159]
    buffer_load_dwordx4 a[12:15], v102, s[64:67], s60 offen offset:1024 sc1
    v_exp_f32 v76, v76
    v_exp_f32 v77, v77
    v_exp_f32 v78, v78
    v_mfma_f32_32x32x16_bf16 v[144:159], v[56:59], v[252:255], v[144:159]
    s_waitcnt lgkmcnt(0)
    v_cvt_pk_bf16_f32 v244, v76, v77
    v_exp_f32 v79, v79
    v_exp_f32 v80, v80
    v_cvt_pk_bf16_f32 v245, v78, v79
    v_exp_f32 v81, v81
    v_exp_f32 v82, v82
    v_exp_f32 v83, v83
    v_cvt_pk_bf16_f32 v246, v80, v81
    v_cvt_pk_bf16_f32 v247, v82, v83
    v_exp_f32 v224, v224
    v_exp_f32 v225, v225
    v_exp_f32 v226, v226
    v_cvt_pk_bf16_f32 v248, v224, v225
    v_exp_f32 v227, v227
    v_exp_f32 v228, v228
    v_cvt_pk_bf16_f32 v249, v226, v227
    v_exp_f32 v229, v229
    v_mfma_f32_16x16x32_bf16 v[8:11], v[96:99], v[240:243], v[8:11]
    v_exp_f32 v230, v230
    v_mfma_f32_16x16x32_bf16 v[8:11], v[96:99], v[244:247], v[8:11]
    v_exp_f32 v231, v231
    v_cvt_pk_bf16_f32 v250, v228, v229
    v_cvt_pk_bf16_f32 v251, v230, v231
    v_mfma_f32_32x32x16_bf16 v[128:143], v[60:63], v[240:243], v[128:143]
    v_exp_f32 v232, v232
    v_exp_f32 v233, v233
    v_exp_f32 v234, v234
    v_mfma_f32_32x32x16_bf16 v[128:143], v[64:67], v[244:247], v[128:143]
    v_cvt_pk_bf16_f32 v252, v232, v233
    v_exp_f32 v235, v235
    v_exp_f32 v236, v236
    v_cvt_pk_bf16_f32 v253, v234, v235
    v_exp_f32 v237, v237
    v_exp_f32 v238, v238
    v_exp_f32 v239, v239
    v_cvt_pk_bf16_f32 v254, v236, v237
    v_cvt_pk_bf16_f32 v255, v238, v239
    s_nop 1
    v_mfma_f32_16x16x32_bf16 v[12:15], v[96:99], v[248:251], v[12:15]
    v_mfma_f32_16x16x32_bf16 v[12:15], v[96:99], v[252:255], v[12:15]
    v_mfma_f32_32x32x16_bf16 v[144:159], v[60:63], v[248:251], v[144:159]
    v_mfma_f32_32x32x16_bf16 v[144:159], v[64:67], v[252:255], v[144:159]
    v_mov_b32 v36, v109
    v_xor_b32 v37, 32, v109
    v_xor_b32_e64 v38, 64, v109
    v_xor_b32 v39, 96, v109
    v_xor_b32 v40, 128, v109
    v_xor_b32 v41, 160, v109
    v_xor_b32 v42, 192, v109
    v_xor_b32 v43, 224, v109
    v_add_u32 v44, 65536, v36
    v_add_u32 v45, 65536, v37
    v_add_u32 v46, 65536, v38
    v_add_u32 v47, 65536, v39
    v_add_u32 v48, 65536, v40
    v_add_u32 v49, 65536, v41
    v_add_u32 v50, 65536, v42
    v_add_u32 v51, 65536, v43
    s_waitcnt vmcnt(33)
    s_barrier
    s_add_u32 m0, s59, 32768
    s_mov_b32 s32, 0
    ds_read_b64_tr_b16 a[128:129], v44 offset:0
    ds_read_b64_tr_b16 a[130:131], v44 offset:4096
    ds_read_b64_tr_b16 a[132:133], v44 offset:8192
    ds_read_b64_tr_b16 a[134:135], v44 offset:12288
    ds_read_b64_tr_b16 a[136:137], v45 offset:0
    ds_read_b64_tr_b16 a[138:139], v45 offset:4096
    ds_read_b64_tr_b16 a[140:141], v45 offset:8192
    ds_read_b64_tr_b16 a[142:143], v45 offset:12288
    buffer_load_dwordx4 v110, s[12:15], s58 offen offset:0 lds
    buffer_load_dwordx4 a[16:19], v101, s[64:67], s60 offen offset:2048 sc1
    ds_read_b64_tr_b16 a[144:145], v46 offset:0
    ds_read_b64_tr_b16 a[146:147], v46 offset:4096
    ds_read_b64_tr_b16 a[148:149], v46 offset:8192
    ds_read_b64_tr_b16 a[150:151], v46 offset:12288
    ds_read_b64_tr_b16 a[152:153], v47 offset:0
    ds_read_b64_tr_b16 a[154:155], v47 offset:4096
    ds_read_b64_tr_b16 a[156:157], v47 offset:8192
    ds_read_b64_tr_b16 a[158:159], v47 offset:12288
    buffer_load_dwordx4 v111, s[12:15], s58 offen offset:1024 lds
    buffer_load_dwordx4 a[20:23], v102, s[64:67], s60 offen offset:2048 sc1
    ds_read_b64_tr_b16 a[160:161], v48 offset:0
    ds_read_b64_tr_b16 a[162:163], v48 offset:4096
    ds_read_b64_tr_b16 a[164:165], v48 offset:8192
    ds_read_b64_tr_b16 a[166:167], v48 offset:12288
    ds_read_b64_tr_b16 a[168:169], v49 offset:0
    ds_read_b64_tr_b16 a[170:171], v49 offset:4096
    ds_read_b64_tr_b16 a[172:173], v49 offset:8192
    ds_read_b64_tr_b16 a[174:175], v49 offset:12288
    buffer_load_dwordx4 v112, s[12:15], s58 offen offset:2048 lds
    buffer_load_dwordx4 a[24:27], v101, s[64:67], s60 offen offset:3072 sc1
    ds_read_b64_tr_b16 a[176:177], v50 offset:0
    ds_read_b64_tr_b16 a[178:179], v50 offset:4096
    ds_read_b64_tr_b16 a[180:181], v50 offset:8192
    ds_read_b64_tr_b16 a[182:183], v50 offset:12288
    ds_read_b64_tr_b16 a[184:185], v51 offset:0
    ds_read_b64_tr_b16 a[186:187], v51 offset:4096
    ds_read_b64_tr_b16 a[188:189], v51 offset:8192
    ds_read_b64_tr_b16 a[190:191], v51 offset:12288
    buffer_load_dwordx4 v113, s[12:15], s58 offen offset:3072 lds
    buffer_load_dwordx4 a[28:31], v102, s[64:67], s60 offen offset:3072 sc1
    s_add_u32 s60, s60, 4096
    s_nop 0
    v_pk_mul_f32 v[2:3], v[128:129], 0 op_sel_hi:[1,0]
    v_pk_fma_f32 v[2:3], v[130:131], 0, v[2:3] op_sel_hi:[1,0,1]
    v_pk_fma_f32 v[2:3], v[132:133], 0, v[2:3] op_sel_hi:[1,0,1]
    v_pk_fma_f32 v[2:3], v[134:135], 0, v[2:3] op_sel_hi:[1,0,1]
    v_pk_fma_f32 v[2:3], v[136:137], 0, v[2:3] op_sel_hi:[1,0,1]
    v_pk_fma_f32 v[2:3], v[138:139], 0, v[2:3] op_sel_hi:[1,0,1]
    v_pk_fma_f32 v[2:3], v[140:141], 0, v[2:3] op_sel_hi:[1,0,1]
    v_pk_fma_f32 v[2:3], v[142:143], 0, v[2:3] op_sel_hi:[1,0,1]
    v_mov_b32 v5, 0x5f800000
    v_pk_fma_f32 v[2:3], v[144:145], 0, v[2:3] op_sel_hi:[1,0,1]
    v_pk_fma_f32 v[2:3], v[146:147], 0, v[2:3] op_sel_hi:[1,0,1]
    v_pk_fma_f32 v[2:3], v[148:149], 0, v[2:3] op_sel_hi:[1,0,1]
    v_pk_fma_f32 v[2:3], v[150:151], 0, v[2:3] op_sel_hi:[1,0,1]
    v_pk_fma_f32 v[2:3], v[152:153], 0, v[2:3] op_sel_hi:[1,0,1]
    v_pk_fma_f32 v[2:3], v[154:155], 0, v[2:3] op_sel_hi:[1,0,1]
    v_pk_fma_f32 v[2:3], v[156:157], 0, v[2:3] op_sel_hi:[1,0,1]
    v_pk_fma_f32 v[2:3], v[158:159], 0, v[2:3] op_sel_hi:[1,0,1]
    v_min_f32 v6, v8, v12
    v_max_f32 v4, v8, v12
    v_add_f32 v2, v2, v8
    v_add_f32 v3, v3, v12
    v_cmp_le_f32 vcc, 0x1f800000, v6
    v_cmp_le_f32 s[6:7], v4, v5
    v_cmp_o_f32 s[4:5], v2, v3
    s_nop 1
    s_and_b64 vcc, vcc, s[6:7]
    s_and_b64 vcc, vcc, s[4:5]
    s_cmp_eq_u64 vcc, -1
    s_cbranch_scc0 K2_SLOW
K2_FIN:
    v_rcp_f32 v2, v8
    v_rcp_f32 v3, v12
    s_waitcnt vmcnt(52)
    v_pk_mul_f32 v[2:3], v[2:3], v[16:17]
    v_pk_mul_f32 v[128:129], v[128:129], v[2:3] op_sel:[0,0] op_sel_hi:[1,0]
    v_pk_mul_f32 v[130:131], v[130:131], v[2:3] op_sel:[0,0] op_sel_hi:[1,0]
    v_pk_mul_f32 v[132:133], v[132:133], v[2:3] op_sel:[0,0] op_sel_hi:[1,0]
    v_pk_mul_f32 v[134:135], v[134:135], v[2:3] op_sel:[0,0] op_sel_hi:[1,0]
    v_pk_mul_f32 v[136:137], v[136:137], v[2:3] op_sel:[0,0] op_sel_hi:[1,0]
    v_pk_mul_f32 v[138:139], v[138:139], v[2:3] op_sel:[0,0] op_sel_hi:[1,0]
    v_pk_mul_f32 v[140:141], v[140:141], v[2:3] op_sel:[0,0] op_sel_hi:[1,0]
    v_pk_mul_f32 v[142:143], v[142:143], v[2:3] op_sel:[0,0] op_sel_hi:[1,0]
    v_cvt_pk_bf16_f32 v224, v128, v129
    v_cvt_pk_bf16_f32 v225, v130, v131
    v_cvt_pk_bf16_f32 v226, v132, v133
    v_cvt_pk_bf16_f32 v227, v134, v135
    buffer_store_dwordx4 v[224:227], v100, s[20:23], s36 offen offset:0 sc1
    v_cvt_pk_bf16_f32 v228, v136, v137
    v_cvt_pk_bf16_f32 v229, v138, v139
    v_cvt_pk_bf16_f32 v230, v140, v141
    v_cvt_pk_bf16_f32 v231, v142, v143
    buffer_store_dwordx4 v[228:231], v100, s[20:23], s36 offen offset:512 sc1
    v_pk_mul_f32 v[144:145], v[144:145], v[2:3] op_sel:[0,1] op_sel_hi:[1,1]
    v_pk_mul_f32 v[146:147], v[146:147], v[2:3] op_sel:[0,1] op_sel_hi:[1,1]
    v_pk_mul_f32 v[148:149], v[148:149], v[2:3] op_sel:[0,1] op_sel_hi:[1,1]
    v_pk_mul_f32 v[150:151], v[150:151], v[2:3] op_sel:[0,1] op_sel_hi:[1,1]
    v_pk_mul_f32 v[152:153], v[152:153], v[2:3] op_sel:[0,1] op_sel_hi:[1,1]
    v_pk_mul_f32 v[154:155], v[154:155], v[2:3] op_sel:[0,1] op_sel_hi:[1,1]
    v_pk_mul_f32 v[156:157], v[156:157], v[2:3] op_sel:[0,1] op_sel_hi:[1,1]
    v_pk_mul_f32 v[158:159], v[158:159], v[2:3] op_sel:[0,1] op_sel_hi:[1,1]
    v_cvt_pk_bf16_f32 v232, v144, v145
    v_cvt_pk_bf16_f32 v233, v146, v147
    v_cvt_pk_bf16_f32 v234, v148, v149
    v_cvt_pk_bf16_f32 v235, v150, v151
    buffer_store_dwordx4 v[232:235], v100, s[20:23], s44 offen offset:0 sc1
    v_cvt_pk_bf16_f32 v236, v152, v153
    v_cvt_pk_bf16_f32 v237, v154, v155
    v_cvt_pk_bf16_f32 v238, v156, v157
    v_cvt_pk_bf16_f32 v239, v158, v159
    buffer_store_dwordx4 v[236:239], v100, s[20:23], s44 offen offset:512 sc1
    s_waitcnt vmcnt(40) lgkmcnt(8)
    v_mfma_f32_16x16x32_bf16 v[160:163], a[128:131], a[64:67], 0
    ds_read_b64_tr_b16 a[192:193], v44 offset:16384
    ds_read_b64_tr_b16 a[194:195], v44 offset:20480
    v_mfma_f32_16x16x32_bf16 v[160:163], a[132:135], a[72:75], v[160:163]
    ds_read_b64_tr_b16 a[196:197], v44 offset:24576
    v_mfma_f32_16x16x32_bf16 v[164:167], a[132:135], a[76:79], 0
    ds_read_b64_tr_b16 a[198:199], v44 offset:28672
    ds_read_b64_tr_b16 a[200:201], v45 offset:16384
    s_add_u32 m0, s59, 36864
    v_mfma_f32_16x16x32_bf16 v[164:167], a[128:131], a[68:71], v[164:167]
    buffer_load_dwordx4 v114, s[12:15], s58 offen offset:0 lds
    v_mfma_f32_16x16x32_bf16 v[172:175], a[136:139], a[68:71], 0
    ds_read_b64_tr_b16 a[202:203], v45 offset:20480
    v_mfma_f32_16x16x32_bf16 v[172:175], a[140:143], a[76:79], v[172:175]
    ds_read_b64_tr_b16 a[204:205], v45 offset:24576
    ds_read_b64_tr_b16 a[206:207], v45 offset:28672
    v_mfma_f32_16x16x32_bf16 v[168:171], a[140:143], a[72:75], 0
    ds_read_b64_tr_b16 a[208:209], v46 offset:16384
    v_mfma_f32_16x16x32_bf16 v[168:171], a[136:139], a[64:67], v[168:171]
    buffer_load_dwordx4 a[32:35], v101, s[64:67], s60 offen offset:0 sc1
    v_mfma_f32_16x16x32_bf16 v[176:179], a[144:147], a[64:67], 0
    ds_read_b64_tr_b16 a[210:211], v46 offset:20480
    ds_read_b64_tr_b16 a[212:213], v46 offset:24576
    s_waitcnt lgkmcnt(8)
    v_mfma_f32_16x16x32_bf16 v[176:179], a[148:151], a[72:75], v[176:179]
    ds_read_b64_tr_b16 a[214:215], v46 offset:28672
    v_mfma_f32_16x16x32_bf16 v[180:183], a[148:151], a[76:79], 0
    ds_read_b64_tr_b16 a[216:217], v47 offset:16384
    ds_read_b64_tr_b16 a[218:219], v47 offset:20480
    v_mfma_f32_16x16x32_bf16 v[180:183], a[144:147], a[68:71], v[180:183]
    buffer_load_dwordx4 v115, s[12:15], s58 offen offset:1024 lds
    v_mfma_f32_16x16x32_bf16 v[188:191], a[152:155], a[68:71], 0
    ds_read_b64_tr_b16 a[220:221], v47 offset:24576
    v_mfma_f32_16x16x32_bf16 v[188:191], a[156:159], a[76:79], v[188:191]
    ds_read_b64_tr_b16 a[222:223], v47 offset:28672
    ds_read_b64_tr_b16 a[224:225], v48 offset:16384
    v_mfma_f32_16x16x32_bf16 v[184:187], a[156:159], a[72:75], 0
    ds_read_b64_tr_b16 a[226:227], v48 offset:20480
    v_mfma_f32_16x16x32_bf16 v[184:187], a[152:155], a[64:67], v[184:187]
    buffer_load_dwordx4 a[36:39], v102, s[64:67], s60 offen offset:0 sc1
    v_mfma_f32_16x16x32_bf16 v[192:195], a[160:163], a[64:67], 0
    ds_read_b64_tr_b16 a[228:229], v48 offset:24576
    ds_read_b64_tr_b16 a[230:231], v48 offset:28672
    v_mfma_f32_16x16x32_bf16 v[192:195], a[164:167], a[72:75], v[192:195]
    ds_read_b64_tr_b16 a[232:233], v49 offset:16384
    v_mfma_f32_16x16x32_bf16 v[196:199], a[164:167], a[76:79], 0
    ds_read_b64_tr_b16 a[234:235], v49 offset:20480
    ds_read_b64_tr_b16 a[236:237], v49 offset:24576
    v_mfma_f32_16x16x32_bf16 v[196:199], a[160:163], a[68:71], v[196:199]
    buffer_load_dwordx4 v116, s[12:15], s58 offen offset:2048 lds
    v_mfma_f32_16x16x32_bf16 v[204:207], a[168:171], a[68:71], 0
    ds_read_b64_tr_b16 a[238:239], v49 offset:28672
    v_mfma_f32_16x16x32_bf16 v[204:207], a[172:175], a[76:79], v[204:207]
    ds_read_b64_tr_b16 a[240:241], v50 offset:16384
    ds_read_b64_tr_b16 a[242:243], v50 offset:20480
    v_mfma_f32_16x16x32_bf16 v[200:203], a[172:175], a[72:75], 0
    ds_read_b64_tr_b16 a[244:245], v50 offset:24576
    v_mfma_f32_16x16x32_bf16 v[200:203], a[168:171], a[64:67], v[200:203]
    buffer_load_dwordx4 a[40:43], v101, s[64:67], s60 offen offset:1024 sc1
    v_mfma_f32_16x16x32_bf16 v[208:211], a[176:179], a[64:67], 0
    ds_read_b64_tr_b16 a[246:247], v50 offset:28672
    ds_read_b64_tr_b16 a[248:249], v51 offset:16384
    v_mfma_f32_16x16x32_bf16 v[208:211], a[180:183], a[72:75], v[208:211]
    ds_read_b64_tr_b16 a[250:251], v51 offset:20480
    v_mfma_f32_16x16x32_bf16 v[212:215], a[180:183], a[76:79], 0
    ds_read_b64_tr_b16 a[252:253], v51 offset:24576
    v_mfma_f32_16x16x32_bf16 v[212:215], a[176:179], a[68:71], v[212:215]
    buffer_load_dwordx4 v117, s[12:15], s58 offen offset:3072 lds
    s_add_u32 s58, s58, 262144
    v_mfma_f32_16x16x32_bf16 v[220:223], a[184:187], a[68:71], 0
    ds_read_b64_tr_b16 a[254:255], v51 offset:28672
    v_mfma_f32_16x16x32_bf16 v[220:223], a[188:191], a[76:79], v[220:223]
    v_mfma_f32_16x16x32_bf16 v[216:219], a[188:191], a[72:75], 0
    v_mfma_f32_16x16x32_bf16 v[216:219], a[184:187], a[64:67], v[216:219]
    buffer_load_dwordx4 a[44:47], v102, s[64:67], s60 offen offset:1024 sc1
K3_LOOP:
    s_waitcnt vmcnt(33) lgkmcnt(0)
    s_barrier
    v_mfma_f32_16x16x32_bf16 v[160:163], a[192:195], a[80:83], v[160:163]
    ds_read_b64_tr_b16 a[128:129], v44 offset:32768
    ds_read_b64_tr_b16 a[130:131], v44 offset:36864
    v_mfma_f32_16x16x32_bf16 v[160:163], a[196:199], a[88:91], v[160:163]
    ds_read_b64_tr_b16 a[132:133], v44 offset:40960
    v_mfma_f32_16x16x32_bf16 v[164:167], a[196:199], a[92:95], v[164:167]
    ds_read_b64_tr_b16 a[134:135], v44 offset:45056
    s_add_u32 m0, s59, 65536
    v_mfma_f32_16x16x32_bf16 v[164:167], a[192:195], a[84:87], v[164:167]
    buffer_load_dwordx4 v110, s[12:15], s58 offen offset:0 lds
    v_mfma_f32_16x16x32_bf16 v[172:175], a[200:203], a[84:87], v[172:175]
    ds_read_b64_tr_b16 a[136:137], v45 offset:32768
    ds_read_b64_tr_b16 a[138:139], v45 offset:36864
    v_mfma_f32_16x16x32_bf16 v[172:175], a[204:207], a[92:95], v[172:175]
    ds_read_b64_tr_b16 a[140:141], v45 offset:40960
    v_mfma_f32_16x16x32_bf16 v[168:171], a[204:207], a[88:91], v[168:171]
    ds_read_b64_tr_b16 a[142:143], v45 offset:45056
    v_mfma_f32_16x16x32_bf16 v[168:171], a[200:203], a[80:83], v[168:171]
    buffer_load_dwordx4 a[48:51], v101, s[64:67], s60 offen offset:2048 sc1
    v_mfma_f32_16x16x32_bf16 v[176:179], a[208:211], a[80:83], v[176:179]
    ds_read_b64_tr_b16 a[144:145], v46 offset:32768
    ds_read_b64_tr_b16 a[146:147], v46 offset:36864
    v_mfma_f32_16x16x32_bf16 v[176:179], a[212:215], a[88:91], v[176:179]
    ds_read_b64_tr_b16 a[148:149], v46 offset:40960
    v_mfma_f32_16x16x32_bf16 v[180:183], a[212:215], a[92:95], v[180:183]
    ds_read_b64_tr_b16 a[150:151], v46 offset:45056
    v_mfma_f32_16x16x32_bf16 v[180:183], a[208:211], a[84:87], v[180:183]
    buffer_load_dwordx4 v111, s[12:15], s58 offen offset:1024 lds
    v_mfma_f32_16x16x32_bf16 v[188:191], a[216:219], a[84:87], v[188:191]
    ds_read_b64_tr_b16 a[152:153], v47 offset:32768
    ds_read_b64_tr_b16 a[154:155], v47 offset:36864
    v_mfma_f32_16x16x32_bf16 v[188:191], a[220:223], a[92:95], v[188:191]
    ds_read_b64_tr_b16 a[156:157], v47 offset:40960
    v_mfma_f32_16x16x32_bf16 v[184:187], a[220:223], a[88:91], v[184:187]
    ds_read_b64_tr_b16 a[158:159], v47 offset:45056
    v_mfma_f32_16x16x32_bf16 v[184:187], a[216:219], a[80:83], v[184:187]
    buffer_load_dwordx4 a[52:55], v102, s[64:67], s60 offen offset:2048 sc1
    v_mfma_f32_16x16x32_bf16 v[192:195], a[224:227], a[80:83], v[192:195]
    ds_read_b64_tr_b16 a[160:161], v48 offset:32768
    ds_read_b64_tr_b16 a[162:163], v48 offset:36864
    v_mfma_f32_16x16x32_bf16 v[192:195], a[228:231], a[88:91], v[192:195]
    ds_read_b64_tr_b16 a[164:165], v48 offset:40960
    v_mfma_f32_16x16x32_bf16 v[196:199], a[228:231], a[92:95], v[196:199]
    ds_read_b64_tr_b16 a[166:167], v48 offset:45056
    v_mfma_f32_16x16x32_bf16 v[196:199], a[224:227], a[84:87], v[196:199]
    buffer_load_dwordx4 v112, s[12:15], s58 offen offset:2048 lds
    v_mfma_f32_16x16x32_bf16 v[204:207], a[232:235], a[84:87], v[204:207]
    ds_read_b64_tr_b16 a[168:169], v49 offset:32768
    ds_read_b64_tr_b16 a[170:171], v49 offset:36864
    v_mfma_f32_16x16x32_bf16 v[204:207], a[236:239], a[92:95], v[204:207]
    ds_read_b64_tr_b16 a[172:173], v49 offset:40960
    v_mfma_f32_16x16x32_bf16 v[200:203], a[236:239], a[88:91], v[200:203]
    ds_read_b64_tr_b16 a[174:175], v49 offset:45056
    v_mfma_f32_16x16x32_bf16 v[200:203], a[232:235], a[80:83], v[200:203]
    buffer_load_dwordx4 a[56:59], v101, s[64:67], s60 offen offset:3072 sc1
    v_mfma_f32_16x16x32_bf16 v[208:211], a[240:243], a[80:83], v[208:211]
    ds_read_b64_tr_b16 a[176:177], v50 offset:32768
    ds_read_b64_tr_b16 a[178:179], v50 offset:36864
    v_mfma_f32_16x16x32_bf16 v[208:211], a[244:247], a[88:91], v[208:211]
    ds_read_b64_tr_b16 a[180:181], v50 offset:40960
    v_mfma_f32_16x16x32_bf16 v[212:215], a[244:247], a[92:95], v[212:215]
    ds_read_b64_tr_b16 a[182:183], v50 offset:45056
    v_mfma_f32_16x16x32_bf16 v[212:215], a[240:243], a[84:87], v[212:215]
    buffer_load_dwordx4 v113, s[12:15], s58 offen offset:3072 lds
    v_mfma_f32_16x16x32_bf16 v[220:223], a[248:251], a[84:87], v[220:223]
    ds_read_b64_tr_b16 a[184:185], v51 offset:32768
    ds_read_b64_tr_b16 a[186:187], v51 offset:36864
    v_mfma_f32_16x16x32_bf16 v[220:223], a[252:255], a[92:95], v[220:223]
    ds_read_b64_tr_b16 a[188:189], v51 offset:40960
    v_mfma_f32_16x16x32_bf16 v[216:219], a[252:255], a[88:91], v[216:219]
    ds_read_b64_tr_b16 a[190:191], v51 offset:45056
    v_mfma_f32_16x16x32_bf16 v[216:219], a[248:251], a[80:83], v[216:219]
    buffer_load_dwordx4 a[60:63], v102, s[64:67], s60 offen offset:3072 sc1
    s_add_u32 s60, s60, 4096
    s_waitcnt vmcnt(40) lgkmcnt(8)
    v_mfma_f32_16x16x32_bf16 v[160:163], a[128:131], a[96:99], v[160:163]
    ds_read_b64_tr_b16 a[192:193], v44 offset:49152
    ds_read_b64_tr_b16 a[194:195], v44 offset:53248
    v_mfma_f32_16x16x32_bf16 v[160:163], a[132:135], a[104:107], v[160:163]
    ds_read_b64_tr_b16 a[196:197], v44 offset:57344
    v_mfma_f32_16x16x32_bf16 v[164:167], a[132:135], a[108:111], v[164:167]
    ds_read_b64_tr_b16 a[198:199], v44 offset:61440
    ds_read_b64_tr_b16 a[200:201], v45 offset:49152
    s_add_u32 m0, s59, 69632
    v_mfma_f32_16x16x32_bf16 v[164:167], a[128:131], a[100:103], v[164:167]
    buffer_load_dwordx4 v114, s[12:15], s58 offen offset:0 lds
    v_mfma_f32_16x16x32_bf16 v[172:175], a[136:139], a[100:103], v[172:175]
    ds_read_b64_tr_b16 a[202:203], v45 offset:53248
    v_mfma_f32_16x16x32_bf16 v[172:175], a[140:143], a[108:111], v[172:175]
    ds_read_b64_tr_b16 a[204:205], v45 offset:57344
    ds_read_b64_tr_b16 a[206:207], v45 offset:61440
    v_mfma_f32_16x16x32_bf16 v[168:171], a[140:143], a[104:107], v[168:171]
    ds_read_b64_tr_b16 a[208:209], v46 offset:49152
    v_mfma_f32_16x16x32_bf16 v[168:171], a[136:139], a[96:99], v[168:171]
    buffer_load_dwordx4 a[64:67], v101, s[64:67], s60 offen offset:0 sc1
    v_mfma_f32_16x16x32_bf16 v[176:179], a[144:147], a[96:99], v[176:179]
    ds_read_b64_tr_b16 a[210:211], v46 offset:53248
    ds_read_b64_tr_b16 a[212:213], v46 offset:57344
    s_waitcnt lgkmcnt(8)
    v_mfma_f32_16x16x32_bf16 v[176:179], a[148:151], a[104:107], v[176:179]
    ds_read_b64_tr_b16 a[214:215], v46 offset:61440
    v_mfma_f32_16x16x32_bf16 v[180:183], a[148:151], a[108:111], v[180:183]
    ds_read_b64_tr_b16 a[216:217], v47 offset:49152
    ds_read_b64_tr_b16 a[218:219], v47 offset:53248
    v_mfma_f32_16x16x32_bf16 v[180:183], a[144:147], a[100:103], v[180:183]
    buffer_load_dwordx4 v115, s[12:15], s58 offen offset:1024 lds
    v_mfma_f32_16x16x32_bf16 v[188:191], a[152:155], a[100:103], v[188:191]
    ds_read_b64_tr_b16 a[220:221], v47 offset:57344
    v_mfma_f32_16x16x32_bf16 v[188:191], a[156:159], a[108:111], v[188:191]
    ds_read_b64_tr_b16 a[222:223], v47 offset:61440
    ds_read_b64_tr_b16 a[224:225], v48 offset:49152
    v_mfma_f32_16x16x32_bf16 v[184:187], a[156:159], a[104:107], v[184:187]
    ds_read_b64_tr_b16 a[226:227], v48 offset:53248
    v_mfma_f32_16x16x32_bf16 v[184:187], a[152:155], a[96:99], v[184:187]
    buffer_load_dwordx4 a[68:71], v102, s[64:67], s60 offen offset:0 sc1
    v_mfma_f32_16x16x32_bf16 v[192:195], a[160:163], a[96:99], v[192:195]
    ds_read_b64_tr_b16 a[228:229], v48 offset:57344
    ds_read_b64_tr_b16 a[230:231], v48 offset:61440
    v_mfma_f32_16x16x32_bf16 v[192:195], a[164:167], a[104:107], v[192:195]
    ds_read_b64_tr_b16 a[232:233], v49 offset:49152
    v_mfma_f32_16x16x32_bf16 v[196:199], a[164:167], a[108:111], v[196:199]
    ds_read_b64_tr_b16 a[234:235], v49 offset:53248
    ds_read_b64_tr_b16 a[236:237], v49 offset:57344
    v_mfma_f32_16x16x32_bf16 v[196:199], a[160:163], a[100:103], v[196:199]
    buffer_load_dwordx4 v116, s[12:15], s58 offen offset:2048 lds
    v_mfma_f32_16x16x32_bf16 v[204:207], a[168:171], a[100:103], v[204:207]
    ds_read_b64_tr_b16 a[238:239], v49 offset:61440
    v_mfma_f32_16x16x32_bf16 v[204:207], a[172:175], a[108:111], v[204:207]
    ds_read_b64_tr_b16 a[240:241], v50 offset:49152
    ds_read_b64_tr_b16 a[242:243], v50 offset:53248
    v_mfma_f32_16x16x32_bf16 v[200:203], a[172:175], a[104:107], v[200:203]
    ds_read_b64_tr_b16 a[244:245], v50 offset:57344
    v_mfma_f32_16x16x32_bf16 v[200:203], a[168:171], a[96:99], v[200:203]
    buffer_load_dwordx4 a[72:75], v101, s[64:67], s60 offen offset:1024 sc1
    v_mfma_f32_16x16x32_bf16 v[208:211], a[176:179], a[96:99], v[208:211]
    ds_read_b64_tr_b16 a[246:247], v50 offset:61440
    ds_read_b64_tr_b16 a[248:249], v51 offset:49152
    v_mfma_f32_16x16x32_bf16 v[208:211], a[180:183], a[104:107], v[208:211]
    ds_read_b64_tr_b16 a[250:251], v51 offset:53248
    v_mfma_f32_16x16x32_bf16 v[212:215], a[180:183], a[108:111], v[212:215]
    ds_read_b64_tr_b16 a[252:253], v51 offset:57344
    v_mfma_f32_16x16x32_bf16 v[212:215], a[176:179], a[100:103], v[212:215]
    buffer_load_dwordx4 v117, s[12:15], s58 offen offset:3072 lds
    s_add_u32 s58, s58, 262144
    v_mfma_f32_16x16x32_bf16 v[220:223], a[184:187], a[100:103], v[220:223]
    ds_read_b64_tr_b16 a[254:255], v51 offset:61440
    v_mfma_f32_16x16x32_bf16 v[220:223], a[188:191], a[108:111], v[220:223]
    v_mfma_f32_16x16x32_bf16 v[216:219], a[188:191], a[104:107], v[216:219]
    v_mfma_f32_16x16x32_bf16 v[216:219], a[184:187], a[96:99], v[216:219]
    buffer_load_dwordx4 a[76:79], v102, s[64:67], s60 offen offset:1024 sc1
    s_waitcnt vmcnt(33) lgkmcnt(0)
    s_barrier
    v_mfma_f32_16x16x32_bf16 v[160:163], a[192:195], a[112:115], v[160:163]
    ds_read_b64_tr_b16 a[128:129], v36 offset:0
    ds_read_b64_tr_b16 a[130:131], v36 offset:4096
    v_mfma_f32_16x16x32_bf16 v[160:163], a[196:199], a[120:123], v[160:163]
    ds_read_b64_tr_b16 a[132:133], v36 offset:8192
    v_mfma_f32_16x16x32_bf16 v[164:167], a[196:199], a[124:127], v[164:167]
    ds_read_b64_tr_b16 a[134:135], v36 offset:12288
    s_add_u32 m0, s59, 98304
    v_mfma_f32_16x16x32_bf16 v[164:167], a[192:195], a[116:119], v[164:167]
    buffer_load_dwordx4 v110, s[12:15], s58 offen offset:0 lds
    v_mfma_f32_16x16x32_bf16 v[172:175], a[200:203], a[116:119], v[172:175]
    ds_read_b64_tr_b16 a[136:137], v37 offset:0
    ds_read_b64_tr_b16 a[138:139], v37 offset:4096
    v_mfma_f32_16x16x32_bf16 v[172:175], a[204:207], a[124:127], v[172:175]
    ds_read_b64_tr_b16 a[140:141], v37 offset:8192
    v_mfma_f32_16x16x32_bf16 v[168:171], a[204:207], a[120:123], v[168:171]
    ds_read_b64_tr_b16 a[142:143], v37 offset:12288
    v_mfma_f32_16x16x32_bf16 v[168:171], a[200:203], a[112:115], v[168:171]
    buffer_load_dwordx4 a[80:83], v101, s[64:67], s60 offen offset:2048 sc1
    v_mfma_f32_16x16x32_bf16 v[176:179], a[208:211], a[112:115], v[176:179]
    ds_read_b64_tr_b16 a[144:145], v38 offset:0
    ds_read_b64_tr_b16 a[146:147], v38 offset:4096
    v_mfma_f32_16x16x32_bf16 v[176:179], a[212:215], a[120:123], v[176:179]
    ds_read_b64_tr_b16 a[148:149], v38 offset:8192
    v_mfma_f32_16x16x32_bf16 v[180:183], a[212:215], a[124:127], v[180:183]
    ds_read_b64_tr_b16 a[150:151], v38 offset:12288
    v_mfma_f32_16x16x32_bf16 v[180:183], a[208:211], a[116:119], v[180:183]
    buffer_load_dwordx4 v111, s[12:15], s58 offen offset:1024 lds
    v_mfma_f32_16x16x32_bf16 v[188:191], a[216:219], a[116:119], v[188:191]
    ds_read_b64_tr_b16 a[152:153], v39 offset:0
    ds_read_b64_tr_b16 a[154:155], v39 offset:4096
    v_mfma_f32_16x16x32_bf16 v[188:191], a[220:223], a[124:127], v[188:191]
    ds_read_b64_tr_b16 a[156:157], v39 offset:8192
    v_mfma_f32_16x16x32_bf16 v[184:187], a[220:223], a[120:123], v[184:187]
    ds_read_b64_tr_b16 a[158:159], v39 offset:12288
    v_mfma_f32_16x16x32_bf16 v[184:187], a[216:219], a[112:115], v[184:187]
    buffer_load_dwordx4 a[84:87], v102, s[64:67], s60 offen offset:2048 sc1
    v_mfma_f32_16x16x32_bf16 v[192:195], a[224:227], a[112:115], v[192:195]
    ds_read_b64_tr_b16 a[160:161], v40 offset:0
    ds_read_b64_tr_b16 a[162:163], v40 offset:4096
    v_mfma_f32_16x16x32_bf16 v[192:195], a[228:231], a[120:123], v[192:195]
    ds_read_b64_tr_b16 a[164:165], v40 offset:8192
    v_mfma_f32_16x16x32_bf16 v[196:199], a[228:231], a[124:127], v[196:199]
    ds_read_b64_tr_b16 a[166:167], v40 offset:12288
    v_mfma_f32_16x16x32_bf16 v[196:199], a[224:227], a[116:119], v[196:199]
    buffer_load_dwordx4 v112, s[12:15], s58 offen offset:2048 lds
    v_mfma_f32_16x16x32_bf16 v[204:207], a[232:235], a[116:119], v[204:207]
    ds_read_b64_tr_b16 a[168:169], v41 offset:0
    ds_read_b64_tr_b16 a[170:171], v41 offset:4096
    v_mfma_f32_16x16x32_bf16 v[204:207], a[236:239], a[124:127], v[204:207]
    ds_read_b64_tr_b16 a[172:173], v41 offset:8192
    v_mfma_f32_16x16x32_bf16 v[200:203], a[236:239], a[120:123], v[200:203]
    ds_read_b64_tr_b16 a[174:175], v41 offset:12288
    v_mfma_f32_16x16x32_bf16 v[200:203], a[232:235], a[112:115], v[200:203]
    buffer_load_dwordx4 a[88:91], v101, s[64:67], s60 offen offset:3072 sc1
    v_mfma_f32_16x16x32_bf16 v[208:211], a[240:243], a[112:115], v[208:211]
    ds_read_b64_tr_b16 a[176:177], v42 offset:0
    ds_read_b64_tr_b16 a[178:179], v42 offset:4096
    v_mfma_f32_16x16x32_bf16 v[208:211], a[244:247], a[120:123], v[208:211]
    ds_read_b64_tr_b16 a[180:181], v42 offset:8192
    v_mfma_f32_16x16x32_bf16 v[212:215], a[244:247], a[124:127], v[212:215]
    ds_read_b64_tr_b16 a[182:183], v42 offset:12288
    v_mfma_f32_16x16x32_bf16 v[212:215], a[240:243], a[116:119], v[212:215]
    buffer_load_dwordx4 v113, s[12:15], s58 offen offset:3072 lds
    v_mfma_f32_16x16x32_bf16 v[220:223], a[248:251], a[116:119], v[220:223]
    ds_read_b64_tr_b16 a[184:185], v43 offset:0
    ds_read_b64_tr_b16 a[186:187], v43 offset:4096
    v_mfma_f32_16x16x32_bf16 v[220:223], a[252:255], a[124:127], v[220:223]
    ds_read_b64_tr_b16 a[188:189], v43 offset:8192
    v_mfma_f32_16x16x32_bf16 v[216:219], a[252:255], a[120:123], v[216:219]
    ds_read_b64_tr_b16 a[190:191], v43 offset:12288
    v_mfma_f32_16x16x32_bf16 v[216:219], a[248:251], a[112:115], v[216:219]
    buffer_load_dwordx4 a[92:95], v102, s[64:67], s60 offen offset:3072 sc1
    s_add_u32 s60, s60, 4096
    s_add_u32 s32, s32, 1
    s_cmp_gt_u32 s32, s39
    s_cbranch_scc1 K3_EXIT
    s_cmp_eq_u32 s32, s40
    s_cbranch_scc1 K3_SCALE
K3_SCALE_BACK:
    s_waitcnt vmcnt(40) lgkmcnt(8)
    v_mfma_f32_16x16x32_bf16 v[160:163], a[128:131], a[0:3], v[160:163]
    ds_read_b64_tr_b16 a[192:193], v36 offset:16384
    ds_read_b64_tr_b16 a[194:195], v36 offset:20480
    v_mfma_f32_16x16x32_bf16 v[160:163], a[132:135], a[8:11], v[160:163]
    ds_read_b64_tr_b16 a[196:197], v36 offset:24576
    v_mfma_f32_16x16x32_bf16 v[164:167], a[132:135], a[12:15], v[164:167]
    ds_read_b64_tr_b16 a[198:199], v36 offset:28672
    ds_read_b64_tr_b16 a[200:201], v37 offset:16384
    s_add_u32 m0, s59, 102400
    v_mfma_f32_16x16x32_bf16 v[164:167], a[128:131], a[4:7], v[164:167]
    buffer_load_dwordx4 v114, s[12:15], s58 offen offset:0 lds
    v_mfma_f32_16x16x32_bf16 v[172:175], a[136:139], a[4:7], v[172:175]
    ds_read_b64_tr_b16 a[202:203], v37 offset:20480
    v_mfma_f32_16x16x32_bf16 v[172:175], a[140:143], a[12:15], v[172:175]
    ds_read_b64_tr_b16 a[204:205], v37 offset:24576
    ds_read_b64_tr_b16 a[206:207], v37 offset:28672
    v_mfma_f32_16x16x32_bf16 v[168:171], a[140:143], a[8:11], v[168:171]
    ds_read_b64_tr_b16 a[208:209], v38 offset:16384
    v_mfma_f32_16x16x32_bf16 v[168:171], a[136:139], a[0:3], v[168:171]
    buffer_load_dwordx4 a[96:99], v101, s[64:67], s60 offen offset:0 sc1
    v_mfma_f32_16x16x32_bf16 v[176:179], a[144:147], a[0:3], v[176:179]
    ds_read_b64_tr_b16 a[210:211], v38 offset:20480
    ds_read_b64_tr_b16 a[212:213], v38 offset:24576
    s_waitcnt lgkmcnt(8)
    v_mfma_f32_16x16x32_bf16 v[176:179], a[148:151], a[8:11], v[176:179]
    ds_read_b64_tr_b16 a[214:215], v38 offset:28672
    v_mfma_f32_16x16x32_bf16 v[180:183], a[148:151], a[12:15], v[180:183]
    ds_read_b64_tr_b16 a[216:217], v39 offset:16384
    ds_read_b64_tr_b16 a[218:219], v39 offset:20480
    v_mfma_f32_16x16x32_bf16 v[180:183], a[144:147], a[4:7], v[180:183]
    buffer_load_dwordx4 v115, s[12:15], s58 offen offset:1024 lds
    v_mfma_f32_16x16x32_bf16 v[188:191], a[152:155], a[4:7], v[188:191]
    ds_read_b64_tr_b16 a[220:221], v39 offset:24576
    v_mfma_f32_16x16x32_bf16 v[188:191], a[156:159], a[12:15], v[188:191]
    ds_read_b64_tr_b16 a[222:223], v39 offset:28672
    ds_read_b64_tr_b16 a[224:225], v40 offset:16384
    v_mfma_f32_16x16x32_bf16 v[184:187], a[156:159], a[8:11], v[184:187]
    ds_read_b64_tr_b16 a[226:227], v40 offset:20480
    v_mfma_f32_16x16x32_bf16 v[184:187], a[152:155], a[0:3], v[184:187]
    buffer_load_dwordx4 a[100:103], v102, s[64:67], s60 offen offset:0 sc1
    v_mfma_f32_16x16x32_bf16 v[192:195], a[160:163], a[0:3], v[192:195]
    ds_read_b64_tr_b16 a[228:229], v40 offset:24576
    ds_read_b64_tr_b16 a[230:231], v40 offset:28672
    v_mfma_f32_16x16x32_bf16 v[192:195], a[164:167], a[8:11], v[192:195]
    ds_read_b64_tr_b16 a[232:233], v41 offset:16384
    v_mfma_f32_16x16x32_bf16 v[196:199], a[164:167], a[12:15], v[196:199]
    ds_read_b64_tr_b16 a[234:235], v41 offset:20480
    ds_read_b64_tr_b16 a[236:237], v41 offset:24576
    v_mfma_f32_16x16x32_bf16 v[196:199], a[160:163], a[4:7], v[196:199]
    buffer_load_dwordx4 v116, s[12:15], s58 offen offset:2048 lds
    v_mfma_f32_16x16x32_bf16 v[204:207], a[168:171], a[4:7], v[204:207]
    ds_read_b64_tr_b16 a[238:239], v41 offset:28672
    v_mfma_f32_16x16x32_bf16 v[204:207], a[172:175], a[12:15], v[204:207]
    ds_read_b64_tr_b16 a[240:241], v42 offset:16384
    ds_read_b64_tr_b16 a[242:243], v42 offset:20480
    v_mfma_f32_16x16x32_bf16 v[200:203], a[172:175], a[8:11], v[200:203]
    ds_read_b64_tr_b16 a[244:245], v42 offset:24576
    v_mfma_f32_16x16x32_bf16 v[200:203], a[168:171], a[0:3], v[200:203]
    buffer_load_dwordx4 a[104:107], v101, s[64:67], s60 offen offset:1024 sc1
    v_mfma_f32_16x16x32_bf16 v[208:211], a[176:179], a[0:3], v[208:211]
    ds_read_b64_tr_b16 a[246:247], v42 offset:28672
    ds_read_b64_tr_b16 a[248:249], v43 offset:16384
    v_mfma_f32_16x16x32_bf16 v[208:211], a[180:183], a[8:11], v[208:211]
    ds_read_b64_tr_b16 a[250:251], v43 offset:20480
    v_mfma_f32_16x16x32_bf16 v[212:215], a[180:183], a[12:15], v[212:215]
    ds_read_b64_tr_b16 a[252:253], v43 offset:24576
    v_mfma_f32_16x16x32_bf16 v[212:215], a[176:179], a[4:7], v[212:215]
    buffer_load_dwordx4 v117, s[12:15], s58 offen offset:3072 lds
    s_add_u32 s58, s58, 262144
    v_mfma_f32_16x16x32_bf16 v[220:223], a[184:187], a[4:7], v[220:223]
    ds_read_b64_tr_b16 a[254:255], v43 offset:28672
    v_mfma_f32_16x16x32_bf16 v[220:223], a[188:191], a[12:15], v[220:223]
    v_mfma_f32_16x16x32_bf16 v[216:219], a[188:191], a[8:11], v[216:219]
    v_mfma_f32_16x16x32_bf16 v[216:219], a[184:187], a[0:3], v[216:219]
    buffer_load_dwordx4 a[108:111], v102, s[64:67], s60 offen offset:1024 sc1
    s_cmp_eq_u32 s32, s38
    s_cbranch_scc1 K3_SW
K3_SW_BACK:
    s_waitcnt vmcnt(33) lgkmcnt(0)
    s_barrier
    v_mfma_f32_16x16x32_bf16 v[160:163], a[192:195], a[16:19], v[160:163]
    ds_read_b64_tr_b16 a[128:129], v36 offset:32768
    ds_read_b64_tr_b16 a[130:131], v36 offset:36864
    v_mfma_f32_16x16x32_bf16 v[160:163], a[196:199], a[24:27], v[160:163]
    ds_read_b64_tr_b16 a[132:133], v36 offset:40960
    v_mfma_f32_16x16x32_bf16 v[164:167], a[196:199], a[28:31], v[164:167]
    ds_read_b64_tr_b16 a[134:135], v36 offset:45056
    s_add_u32 m0, s59, 0
    v_mfma_f32_16x16x32_bf16 v[164:167], a[192:195], a[20:23], v[164:167]
    buffer_load_dwordx4 v110, s[12:15], s58 offen offset:0 lds
    v_mfma_f32_16x16x32_bf16 v[172:175], a[200:203], a[20:23], v[172:175]
    ds_read_b64_tr_b16 a[136:137], v37 offset:32768
    ds_read_b64_tr_b16 a[138:139], v37 offset:36864
    v_mfma_f32_16x16x32_bf16 v[172:175], a[204:207], a[28:31], v[172:175]
    ds_read_b64_tr_b16 a[140:141], v37 offset:40960
    v_mfma_f32_16x16x32_bf16 v[168:171], a[204:207], a[24:27], v[168:171]
    ds_read_b64_tr_b16 a[142:143], v37 offset:45056
    v_mfma_f32_16x16x32_bf16 v[168:171], a[200:203], a[16:19], v[168:171]
    buffer_load_dwordx4 a[112:115], v101, s[64:67], s60 offen offset:2048 sc1
    v_mfma_f32_16x16x32_bf16 v[176:179], a[208:211], a[16:19], v[176:179]
    ds_read_b64_tr_b16 a[144:145], v38 offset:32768
    ds_read_b64_tr_b16 a[146:147], v38 offset:36864
    v_mfma_f32_16x16x32_bf16 v[176:179], a[212:215], a[24:27], v[176:179]
    ds_read_b64_tr_b16 a[148:149], v38 offset:40960
    v_mfma_f32_16x16x32_bf16 v[180:183], a[212:215], a[28:31], v[180:183]
    ds_read_b64_tr_b16 a[150:151], v38 offset:45056
    v_mfma_f32_16x16x32_bf16 v[180:183], a[208:211], a[20:23], v[180:183]
    buffer_load_dwordx4 v111, s[12:15], s58 offen offset:1024 lds
    v_mfma_f32_16x16x32_bf16 v[188:191], a[216:219], a[20:23], v[188:191]
    ds_read_b64_tr_b16 a[152:153], v39 offset:32768
    ds_read_b64_tr_b16 a[154:155], v39 offset:36864
    v_mfma_f32_16x16x32_bf16 v[188:191], a[220:223], a[28:31], v[188:191]
    ds_read_b64_tr_b16 a[156:157], v39 offset:40960
    v_mfma_f32_16x16x32_bf16 v[184:187], a[220:223], a[24:27], v[184:187]
    ds_read_b64_tr_b16 a[158:159], v39 offset:45056
    v_mfma_f32_16x16x32_bf16 v[184:187], a[216:219], a[16:19], v[184:187]
    buffer_load_dwordx4 a[116:119], v102, s[64:67], s60 offen offset:2048 sc1
    v_mfma_f32_16x16x32_bf16 v[192:195], a[224:227], a[16:19], v[192:195]
    ds_read_b64_tr_b16 a[160:161], v40 offset:32768
    ds_read_b64_tr_b16 a[162:163], v40 offset:36864
    v_mfma_f32_16x16x32_bf16 v[192:195], a[228:231], a[24:27], v[192:195]
    ds_read_b64_tr_b16 a[164:165], v40 offset:40960
    v_mfma_f32_16x16x32_bf16 v[196:199], a[228:231], a[28:31], v[196:199]
    ds_read_b64_tr_b16 a[166:167], v40 offset:45056
    v_mfma_f32_16x16x32_bf16 v[196:199], a[224:227], a[20:23], v[196:199]
    buffer_load_dwordx4 v112, s[12:15], s58 offen offset:2048 lds
    v_mfma_f32_16x16x32_bf16 v[204:207], a[232:235], a[20:23], v[204:207]
    ds_read_b64_tr_b16 a[168:169], v41 offset:32768
    ds_read_b64_tr_b16 a[170:171], v41 offset:36864
    v_mfma_f32_16x16x32_bf16 v[204:207], a[236:239], a[28:31], v[204:207]
    ds_read_b64_tr_b16 a[172:173], v41 offset:40960
    v_mfma_f32_16x16x32_bf16 v[200:203], a[236:239], a[24:27], v[200:203]
    ds_read_b64_tr_b16 a[174:175], v41 offset:45056
    v_mfma_f32_16x16x32_bf16 v[200:203], a[232:235], a[16:19], v[200:203]
    buffer_load_dwordx4 a[120:123], v101, s[64:67], s60 offen offset:3072 sc1
    v_mfma_f32_16x16x32_bf16 v[208:211], a[240:243], a[16:19], v[208:211]
    ds_read_b64_tr_b16 a[176:177], v42 offset:32768
    ds_read_b64_tr_b16 a[178:179], v42 offset:36864
    v_mfma_f32_16x16x32_bf16 v[208:211], a[244:247], a[24:27], v[208:211]
    ds_read_b64_tr_b16 a[180:181], v42 offset:40960
    v_mfma_f32_16x16x32_bf16 v[212:215], a[244:247], a[28:31], v[212:215]
    ds_read_b64_tr_b16 a[182:183], v42 offset:45056
    v_mfma_f32_16x16x32_bf16 v[212:215], a[240:243], a[20:23], v[212:215]
    buffer_load_dwordx4 v113, s[12:15], s58 offen offset:3072 lds
    v_mfma_f32_16x16x32_bf16 v[220:223], a[248:251], a[20:23], v[220:223]
    ds_read_b64_tr_b16 a[184:185], v43 offset:32768
    ds_read_b64_tr_b16 a[186:187], v43 offset:36864
    v_mfma_f32_16x16x32_bf16 v[220:223], a[252:255], a[28:31], v[220:223]
    ds_read_b64_tr_b16 a[188:189], v43 offset:40960
    v_mfma_f32_16x16x32_bf16 v[216:219], a[252:255], a[24:27], v[216:219]
    ds_read_b64_tr_b16 a[190:191], v43 offset:45056
    v_mfma_f32_16x16x32_bf16 v[216:219], a[248:251], a[16:19], v[216:219]
    buffer_load_dwordx4 a[124:127], v102, s[64:67], s60 offen offset:3072 sc1
    s_add_u32 s60, s60, 4096
    s_cmp_eq_u32 s32, 1
    s_cbranch_scc1 K3_FLAG
K3_FLAG_BACK:
    s_cmp_eq_u32 s32, s38
    s_cbranch_scc1 K3_WRAP
K3_WRAP_BACK:
    s_waitcnt vmcnt(40) lgkmcnt(8)
    v_mfma_f32_16x16x32_bf16 v[160:163], a[128:131], a[32:35], v[160:163]
    ds_read_b64_tr_b16 a[192:193], v36 offset:49152
    ds_read_b64_tr_b16 a[194:195], v36 offset:53248
    v_mfma_f32_16x16x32_bf16 v[160:163], a[132:135], a[40:43], v[160:163]
    ds_read_b64_tr_b16 a[196:197], v36 offset:57344
    global_load_dword v127, v[122:123], off
    v_mfma_f32_16x16x32_bf16 v[164:167], a[132:135], a[44:47], v[164:167]
    ds_read_b64_tr_b16 a[198:199], v36 offset:61440
    ds_read_b64_tr_b16 a[200:201], v37 offset:49152
    s_add_u32 m0, s59, 4096
    v_mfma_f32_16x16x32_bf16 v[164:167], a[128:131], a[36:39], v[164:167]
    buffer_load_dwordx4 v114, s[12:15], s58 offen offset:0 lds
    v_mfma_f32_16x16x32_bf16 v[172:175], a[136:139], a[36:39], v[172:175]
    ds_read_b64_tr_b16 a[202:203], v37 offset:53248
    v_mfma_f32_16x16x32_bf16 v[172:175], a[140:143], a[44:47], v[172:175]
    ds_read_b64_tr_b16 a[204:205], v37 offset:57344
    ds_read_b64_tr_b16 a[206:207], v37 offset:61440
    v_mfma_f32_16x16x32_bf16 v[168:171], a[140:143], a[40:43], v[168:171]
    ds_read_b64_tr_b16 a[208:209], v38 offset:49152
    v_mfma_f32_16x16x32_bf16 v[168:171], a[136:139], a[32:35], v[168:171]
    buffer_load_dwordx4 a[0:3], v101, s[64:67], s60 offen offset:0 sc1
    v_mfma_f32_16x16x32_bf16 v[176:179], a[144:147], a[32:35], v[176:179]
    ds_read_b64_tr_b16 a[210:211], v38 offset:53248
    ds_read_b64_tr_b16 a[212:213], v38 offset:57344
    s_waitcnt lgkmcnt(8)
    v_mfma_f32_16x16x32_bf16 v[176:179], a[148:151], a[40:43], v[176:179]
    ds_read_b64_tr_b16 a[214:215], v38 offset:61440
    v_mfma_f32_16x16x32_bf16 v[180:183], a[148:151], a[44:47], v[180:183]
    ds_read_b64_tr_b16 a[216:217], v39 offset:49152
    ds_read_b64_tr_b16 a[218:219], v39 offset:53248
    v_mfma_f32_16x16x32_bf16 v[180:183], a[144:147], a[36:39], v[180:183]
    buffer_load_dwordx4 v115, s[12:15], s58 offen offset:1024 lds
    v_mfma_f32_16x16x32_bf16 v[188:191], a[152:155], a[36:39], v[188:191]
    ds_read_b64_tr_b16 a[220:221], v39 offset:57344
    v_mfma_f32_16x16x32_bf16 v[188:191], a[156:159], a[44:47], v[188:191]
    ds_read_b64_tr_b16 a[222:223], v39 offset:61440
    ds_read_b64_tr_b16 a[224:225], v40 offset:49152
    v_mfma_f32_16x16x32_bf16 v[184:187], a[156:159], a[40:43], v[184:187]
    ds_read_b64_tr_b16 a[226:227], v40 offset:53248
    v_mfma_f32_16x16x32_bf16 v[184:187], a[152:155], a[32:35], v[184:187]
    buffer_load_dwordx4 a[4:7], v102, s[64:67], s60 offen offset:0 sc1
    v_mfma_f32_16x16x32_bf16 v[192:195], a[160:163], a[32:35], v[192:195]
    ds_read_b64_tr_b16 a[228:229], v40 offset:57344
    ds_read_b64_tr_b16 a[230:231], v40 offset:61440
    v_mfma_f32_16x16x32_bf16 v[192:195], a[164:167], a[40:43], v[192:195]
    ds_read_b64_tr_b16 a[232:233], v41 offset:49152
    v_mfma_f32_16x16x32_bf16 v[196:199], a[164:167], a[44:47], v[196:199]
    ds_read_b64_tr_b16 a[234:235], v41 offset:53248
    ds_read_b64_tr_b16 a[236:237], v41 offset:57344
    v_mfma_f32_16x16x32_bf16 v[196:199], a[160:163], a[36:39], v[196:199]
    buffer_load_dwordx4 v116, s[12:15], s58 offen offset:2048 lds
    v_mfma_f32_16x16x32_bf16 v[204:207], a[168:171], a[36:39], v[204:207]
    ds_read_b64_tr_b16 a[238:239], v41 offset:61440
    v_mfma_f32_16x16x32_bf16 v[204:207], a[172:175], a[44:47], v[204:207]
    ds_read_b64_tr_b16 a[240:241], v42 offset:49152
    ds_read_b64_tr_b16 a[242:243], v42 offset:53248
    v_mfma_f32_16x16x32_bf16 v[200:203], a[172:175], a[40:43], v[200:203]
    ds_read_b64_tr_b16 a[244:245], v42 offset:57344
    v_mfma_f32_16x16x32_bf16 v[200:203], a[168:171], a[32:35], v[200:203]
    buffer_load_dwordx4 a[8:11], v101, s[64:67], s60 offen offset:1024 sc1
    v_mfma_f32_16x16x32_bf16 v[208:211], a[176:179], a[32:35], v[208:211]
    ds_read_b64_tr_b16 a[246:247], v42 offset:61440
    ds_read_b64_tr_b16 a[248:249], v43 offset:49152
    v_mfma_f32_16x16x32_bf16 v[208:211], a[180:183], a[40:43], v[208:211]
    ds_read_b64_tr_b16 a[250:251], v43 offset:53248
    v_mfma_f32_16x16x32_bf16 v[212:215], a[180:183], a[44:47], v[212:215]
    ds_read_b64_tr_b16 a[252:253], v43 offset:57344
    v_mfma_f32_16x16x32_bf16 v[212:215], a[176:179], a[36:39], v[212:215]
    buffer_load_dwordx4 v117, s[12:15], s58 offen offset:3072 lds
    s_add_u32 s58, s58, 262144
    v_mfma_f32_16x16x32_bf16 v[220:223], a[184:187], a[36:39], v[220:223]
    ds_read_b64_tr_b16 a[254:255], v43 offset:61440
    v_mfma_f32_16x16x32_bf16 v[220:223], a[188:191], a[44:47], v[220:223]
    v_mfma_f32_16x16x32_bf16 v[216:219], a[188:191], a[40:43], v[216:219]
    v_mfma_f32_16x16x32_bf16 v[216:219], a[184:187], a[32:35], v[216:219]
    buffer_load_dwordx4 a[12:15], v102, s[64:67], s60 offen offset:1024 sc1
    s_waitcnt vmcnt(33) lgkmcnt(0)
    s_barrier
    v_mfma_f32_16x16x32_bf16 v[160:163], a[192:195], a[48:51], v[160:163]
    ds_read_b64_tr_b16 a[128:129], v44 offset:0
    ds_read_b64_tr_b16 a[130:131], v44 offset:4096
    v_mfma_f32_16x16x32_bf16 v[160:163], a[196:199], a[56:59], v[160:163]
    ds_read_b64_tr_b16 a[132:133], v44 offset:8192
    v_mfma_f32_16x16x32_bf16 v[164:167], a[196:199], a[60:63], v[164:167]
    ds_read_b64_tr_b16 a[134:135], v44 offset:12288
    s_add_u32 m0, s59, 32768
    v_mfma_f32_16x16x32_bf16 v[164:167], a[192:195], a[52:55], v[164:167]
    buffer_load_dwordx4 v110, s[12:15], s58 offen offset:0 lds
    v_mfma_f32_16x16x32_bf16 v[172:175], a[200:203], a[52:55], v[172:175]
    ds_read_b64_tr_b16 a[136:137], v45 offset:0
    ds_read_b64_tr_b16 a[138:139], v45 offset:4096
    v_mfma_f32_16x16x32_bf16 v[172:175], a[204:207], a[60:63], v[172:175]
    ds_read_b64_tr_b16 a[140:141], v45 offset:8192
    v_mfma_f32_16x16x32_bf16 v[168:171], a[204:207], a[56:59], v[168:171]
    ds_read_b64_tr_b16 a[142:143], v45 offset:12288
    v_mfma_f32_16x16x32_bf16 v[168:171], a[200:203], a[48:51], v[168:171]
    buffer_load_dwordx4 a[16:19], v101, s[64:67], s60 offen offset:2048 sc1
    v_mfma_f32_16x16x32_bf16 v[176:179], a[208:211], a[48:51], v[176:179]
    ds_read_b64_tr_b16 a[144:145], v46 offset:0
    ds_read_b64_tr_b16 a[146:147], v46 offset:4096
    v_mfma_f32_16x16x32_bf16 v[176:179], a[212:215], a[56:59], v[176:179]
    ds_read_b64_tr_b16 a[148:149], v46 offset:8192
    v_mfma_f32_16x16x32_bf16 v[180:183], a[212:215], a[60:63], v[180:183]
    ds_read_b64_tr_b16 a[150:151], v46 offset:12288
    v_mfma_f32_16x16x32_bf16 v[180:183], a[208:211], a[52:55], v[180:183]
    buffer_load_dwordx4 v111, s[12:15], s58 offen offset:1024 lds
    v_mfma_f32_16x16x32_bf16 v[188:191], a[216:219], a[52:55], v[188:191]
    ds_read_b64_tr_b16 a[152:153], v47 offset:0
    ds_read_b64_tr_b16 a[154:155], v47 offset:4096
    v_mfma_f32_16x16x32_bf16 v[188:191], a[220:223], a[60:63], v[188:191]
    ds_read_b64_tr_b16 a[156:157], v47 offset:8192
    v_mfma_f32_16x16x32_bf16 v[184:187], a[220:223], a[56:59], v[184:187]
    ds_read_b64_tr_b16 a[158:159], v47 offset:12288
    v_mfma_f32_16x16x32_bf16 v[184:187], a[216:219], a[48:51], v[184:187]
    buffer_load_dwordx4 a[20:23], v102, s[64:67], s60 offen offset:2048 sc1
    v_mfma_f32_16x16x32_bf16 v[192:195], a[224:227], a[48:51], v[192:195]
    ds_read_b64_tr_b16 a[160:161], v48 offset:0
    ds_read_b64_tr_b16 a[162:163], v48 offset:4096
    v_mfma_f32_16x16x32_bf16 v[192:195], a[228:231], a[56:59], v[192:195]
    ds_read_b64_tr_b16 a[164:165], v48 offset:8192
    v_mfma_f32_16x16x32_bf16 v[196:199], a[228:231], a[60:63], v[196:199]
    ds_read_b64_tr_b16 a[166:167], v48 offset:12288
    v_mfma_f32_16x16x32_bf16 v[196:199], a[224:227], a[52:55], v[196:199]
    buffer_load_dwordx4 v112, s[12:15], s58 offen offset:2048 lds
    v_mfma_f32_16x16x32_bf16 v[204:207], a[232:235], a[52:55], v[204:207]
    ds_read_b64_tr_b16 a[168:169], v49 offset:0
    ds_read_b64_tr_b16 a[170:171], v49 offset:4096
    v_mfma_f32_16x16x32_bf16 v[204:207], a[236:239], a[60:63], v[204:207]
    ds_read_b64_tr_b16 a[172:173], v49 offset:8192
    v_mfma_f32_16x16x32_bf16 v[200:203], a[236:239], a[56:59], v[200:203]
    ds_read_b64_tr_b16 a[174:175], v49 offset:12288
    v_mfma_f32_16x16x32_bf16 v[200:203], a[232:235], a[48:51], v[200:203]
    buffer_load_dwordx4 a[24:27], v101, s[64:67], s60 offen offset:3072 sc1
    v_mfma_f32_16x16x32_bf16 v[208:211], a[240:243], a[48:51], v[208:211]
    ds_read_b64_tr_b16 a[176:177], v50 offset:0
    ds_read_b64_tr_b16 a[178:179], v50 offset:4096
    v_mfma_f32_16x16x32_bf16 v[208:211], a[244:247], a[56:59], v[208:211]
    ds_read_b64_tr_b16 a[180:181], v50 offset:8192
    v_mfma_f32_16x16x32_bf16 v[212:215], a[244:247], a[60:63], v[212:215]
    ds_read_b64_tr_b16 a[182:183], v50 offset:12288
    v_mfma_f32_16x16x32_bf16 v[212:215], a[240:243], a[52:55], v[212:215]
    buffer_load_dwordx4 v113, s[12:15], s58 offen offset:3072 lds
    v_mfma_f32_16x16x32_bf16 v[220:223], a[248:251], a[52:55], v[220:223]
    ds_read_b64_tr_b16 a[184:185], v51 offset:0
    ds_read_b64_tr_b16 a[186:187], v51 offset:4096
    v_mfma_f32_16x16x32_bf16 v[220:223], a[252:255], a[60:63], v[220:223]
    ds_read_b64_tr_b16 a[188:189], v51 offset:8192
    v_mfma_f32_16x16x32_bf16 v[216:219], a[252:255], a[56:59], v[216:219]
    ds_read_b64_tr_b16 a[190:191], v51 offset:12288
    v_mfma_f32_16x16x32_bf16 v[216:219], a[248:251], a[48:51], v[216:219]
    buffer_load_dwordx4 a[28:31], v102, s[64:67], s60 offen offset:3072 sc1
    s_add_u32 s60, s60, 4096
    s_waitcnt vmcnt(40) lgkmcnt(8)
    v_mfma_f32_16x16x32_bf16 v[160:163], a[128:131], a[64:67], v[160:163]
    ds_read_b64_tr_b16 a[192:193], v44 offset:16384
    ds_read_b64_tr_b16 a[194:195], v44 offset:20480
    v_mfma_f32_16x16x32_bf16 v[160:163], a[132:135], a[72:75], v[160:163]
    ds_read_b64_tr_b16 a[196:197], v44 offset:24576
    v_mfma_f32_16x16x32_bf16 v[164:167], a[132:135], a[76:79], v[164:167]
    ds_read_b64_tr_b16 a[198:199], v44 offset:28672
    ds_read_b64_tr_b16 a[200:201], v45 offset:16384
    s_add_u32 m0, s59, 36864
    v_mfma_f32_16x16x32_bf16 v[164:167], a[128:131], a[68:71], v[164:167]
    buffer_load_dwordx4 v114, s[12:15], s58 offen offset:0 lds
    v_mfma_f32_16x16x32_bf16 v[172:175], a[136:139], a[68:71], v[172:175]
    ds_read_b64_tr_b16 a[202:203], v45 offset:20480
    v_mfma_f32_16x16x32_bf16 v[172:175], a[140:143], a[76:79], v[172:175]
    ds_read_b64_tr_b16 a[204:205], v45 offset:24576
    ds_read_b64_tr_b16 a[206:207], v45 offset:28672
    v_mfma_f32_16x16x32_bf16 v[168:171], a[140:143], a[72:75], v[168:171]
    ds_read_b64_tr_b16 a[208:209], v46 offset:16384
    v_mfma_f32_16x16x32_bf16 v[168:171], a[136:139], a[64:67], v[168:171]
    buffer_load_dwordx4 a[32:35], v101, s[64:67], s60 offen offset:0 sc1
    v_mfma_f32_16x16x32_bf16 v[176:179], a[144:147], a[64:67], v[176:179]
    ds_read_b64_tr_b16 a[210:211], v46 offset:20480
    ds_read_b64_tr_b16 a[212:213], v46 offset:24576
    s_waitcnt lgkmcnt(8)
    v_mfma_f32_16x16x32_bf16 v[176:179], a[148:151], a[72:75], v[176:179]
    ds_read_b64_tr_b16 a[214:215], v46 offset:28672
    v_mfma_f32_16x16x32_bf16 v[180:183], a[148:151], a[76:79], v[180:183]
    ds_read_b64_tr_b16 a[216:217], v47 offset:16384
    ds_read_b64_tr_b16 a[218:219], v47 offset:20480
    v_mfma_f32_16x16x32_bf16 v[180:183], a[144:147], a[68:71], v[180:183]
    buffer_load_dwordx4 v115, s[12:15], s58 offen offset:1024 lds
    v_mfma_f32_16x16x32_bf16 v[188:191], a[152:155], a[68:71], v[188:191]
    ds_read_b64_tr_b16 a[220:221], v47 offset:24576
    v_mfma_f32_16x16x32_bf16 v[188:191], a[156:159], a[76:79], v[188:191]
    ds_read_b64_tr_b16 a[222:223], v47 offset:28672
    ds_read_b64_tr_b16 a[224:225], v48 offset:16384
    v_mfma_f32_16x16x32_bf16 v[184:187], a[156:159], a[72:75], v[184:187]
    ds_read_b64_tr_b16 a[226:227], v48 offset:20480
    v_mfma_f32_16x16x32_bf16 v[184:187], a[152:155], a[64:67], v[184:187]
    buffer_load_dwordx4 a[36:39], v102, s[64:67], s60 offen offset:0 sc1
    v_mfma_f32_16x16x32_bf16 v[192:195], a[160:163], a[64:67], v[192:195]
    ds_read_b64_tr_b16 a[228:229], v48 offset:24576
    ds_read_b64_tr_b16 a[230:231], v48 offset:28672
    v_mfma_f32_16x16x32_bf16 v[192:195], a[164:167], a[72:75], v[192:195]
    ds_read_b64_tr_b16 a[232:233], v49 offset:16384
    v_mfma_f32_16x16x32_bf16 v[196:199], a[164:167], a[76:79], v[196:199]
    ds_read_b64_tr_b16 a[234:235], v49 offset:20480
    ds_read_b64_tr_b16 a[236:237], v49 offset:24576
    v_mfma_f32_16x16x32_bf16 v[196:199], a[160:163], a[68:71], v[196:199]
    buffer_load_dwordx4 v116, s[12:15], s58 offen offset:2048 lds
    v_mfma_f32_16x16x32_bf16 v[204:207], a[168:171], a[68:71], v[204:207]
    ds_read_b64_tr_b16 a[238:239], v49 offset:28672
    v_mfma_f32_16x16x32_bf16 v[204:207], a[172:175], a[76:79], v[204:207]
    ds_read_b64_tr_b16 a[240:241], v50 offset:16384
    ds_read_b64_tr_b16 a[242:243], v50 offset:20480
    v_mfma_f32_16x16x32_bf16 v[200:203], a[172:175], a[72:75], v[200:203]
    ds_read_b64_tr_b16 a[244:245], v50 offset:24576
    v_mfma_f32_16x16x32_bf16 v[200:203], a[168:171], a[64:67], v[200:203]
    buffer_load_dwordx4 a[40:43], v101, s[64:67], s60 offen offset:1024 sc1
    v_mfma_f32_16x16x32_bf16 v[208:211], a[176:179], a[64:67], v[208:211]
    ds_read_b64_tr_b16 a[246:247], v50 offset:28672
    ds_read_b64_tr_b16 a[248:249], v51 offset:16384
    v_mfma_f32_16x16x32_bf16 v[208:211], a[180:183], a[72:75], v[208:211]
    ds_read_b64_tr_b16 a[250:251], v51 offset:20480
    v_mfma_f32_16x16x32_bf16 v[212:215], a[180:183], a[76:79], v[212:215]
    ds_read_b64_tr_b16 a[252:253], v51 offset:24576
    v_mfma_f32_16x16x32_bf16 v[212:215], a[176:179], a[68:71], v[212:215]
    buffer_load_dwordx4 v117, s[12:15], s58 offen offset:3072 lds
    s_add_u32 s58, s58, 262144
    v_mfma_f32_16x16x32_bf16 v[220:223], a[184:187], a[68:71], v[220:223]
    ds_read_b64_tr_b16 a[254:255], v51 offset:28672
    v_mfma_f32_16x16x32_bf16 v[220:223], a[188:191], a[76:79], v[220:223]
    v_mfma_f32_16x16x32_bf16 v[216:219], a[188:191], a[72:75], v[216:219]
    v_mfma_f32_16x16x32_bf16 v[216:219], a[184:187], a[64:67], v[216:219]
    buffer_load_dwordx4 a[44:47], v102, s[64:67], s60 offen offset:1024 sc1
    s_branch K3_LOOP
K3_EXIT:
    s_cmp_eq_u32 s53, 0
    s_cselect_b64 vcc, -1, 0
    v_cndmask_b32 v6, v90, 1.0, vcc
    v_cndmask_b32 v7, v91, 1.0, vcc
    v_mov_b32 v131, s46
    v_mov_b32 v135, s46
    v_mov_b32 v139, s46
    v_mov_b32 v143, s46
    v_mov_b32 v147, s46
    v_mov_b32 v151, s46
    v_mov_b32 v149, 0
    v_mov_b32_e64 v150, 0
    v_xor_b32 v19, 8192, v118
    v_add_u32 v18, 4096, v118
    v_add_u32 v17, 4096, v19
    s_waitcnt vmcnt(40)
    s_waitcnt lgkmcnt(0)
    v_mfma_f32_16x16x32_bf16 v[160:163], a[128:131], a[0:3], v[160:163]
    s_add_u32 m0, s59, 102400
    ds_read_b64_tr_b16 a[192:193], v36 offset:16384
    v_mfma_f32_16x16x32_bf16 v[160:163], a[132:135], a[8:11], v[160:163]
    ds_read_b64_tr_b16 a[194:195], v36 offset:20480
    buffer_load_dwordx4 v114, s[12:15], s58 offen offset:0 lds
    v_mfma_f32_16x16x32_bf16 v[164:167], a[132:135], a[12:15], v[164:167]
    ds_read_b64_tr_b16 a[196:197], v36 offset:24576
    buffer_load_dwordx4 a[96:99], v101, s[64:67], s60 offen offset:0 sc1
    v_mfma_f32_16x16x32_bf16 v[164:167], a[128:131], a[4:7], v[164:167]
    ds_read_b64_tr_b16 a[198:199], v36 offset:28672
    v_mfma_f32_16x16x32_bf16 v[172:175], a[136:139], a[4:7], v[172:175]
    ds_read_b64_tr_b16 a[200:201], v37 offset:16384
    buffer_load_dwordx4 v115, s[12:15], s58 offen offset:1024 lds
    v_mfma_f32_16x16x32_bf16 v[172:175], a[140:143], a[12:15], v[172:175]
    ds_read_b64_tr_b16 a[202:203], v37 offset:20480
    v_mfma_f32_16x16x32_bf16 v[168:171], a[140:143], a[8:11], v[168:171]
    ds_read_b64_tr_b16 a[204:205], v37 offset:24576
    buffer_load_dwordx4 a[100:103], v102, s[64:67], s60 offen offset:0 sc1
    v_mfma_f32_16x16x32_bf16 v[168:171], a[136:139], a[0:3], v[168:171]
    ds_read_b64_tr_b16 a[206:207], v37 offset:28672
    s_waitcnt lgkmcnt(8)
    v_mfma_f32_16x16x32_bf16 v[176:179], a[144:147], a[0:3], v[176:179]
    ds_read_b64_tr_b16 a[208:209], v38 offset:16384
    buffer_load_dwordx4 v116, s[12:15], s58 offen offset:2048 lds
    v_mfma_f32_16x16x32_bf16 v[176:179], a[148:151], a[8:11], v[176:179]
    ds_read_b64_tr_b16 a[210:211], v38 offset:20480
    v_mfma_f32_16x16x32_bf16 v[180:183], a[148:151], a[12:15], v[180:183]
    ds_read_b64_tr_b16 a[212:213], v38 offset:24576
    buffer_load_dwordx4 a[104:107], v101, s[64:67], s60 offen offset:1024 sc1
    v_mfma_f32_16x16x32_bf16 v[180:183], a[144:147], a[4:7], v[180:183]
    ds_read_b64_tr_b16 a[214:215], v38 offset:28672
    v_mfma_f32_16x16x32_bf16 v[188:191], a[152:155], a[4:7], v[188:191]
    ds_read_b64_tr_b16 a[216:217], v39 offset:16384
    buffer_load_dwordx4 v117, s[12:15], s58 offen offset:3072 lds
    s_add_u32 s58, s58, 262144
    v_mfma_f32_16x16x32_bf16 v[188:191], a[156:159], a[12:15], v[188:191]
    ds_read_b64_tr_b16 a[218:219], v39 offset:20480
    v_mfma_f32_16x16x32_bf16 v[184:187], a[156:159], a[8:11], v[184:187]
    ds_read_b64_tr_b16 a[220:221], v39 offset:24576
    buffer_load_dwordx4 a[108:111], v102, s[64:67], s60 offen offset:1024 sc1
    v_mfma_f32_16x16x32_bf16 v[184:187], a[152:155], a[0:3], v[184:187]
    ds_read_b64_tr_b16 a[222:223], v39 offset:28672
    s_waitcnt vmcnt(40)
    s_waitcnt lgkmcnt(8)
    s_waitcnt vmcnt(33)
    s_barrier
    v_mfma_f32_16x16x32_bf16 v[160:163], a[192:195], a[16:19], v[160:163]
    ds_read_b64_tr_b16 a[128:129], v36 offset:32768
    v_mfma_f32_16x16x32_bf16 v[160:163], a[196:199], a[24:27], v[160:163]
    ds_read_b64_tr_b16 a[130:131], v36 offset:36864
    buffer_load_dwordx4 a[112:115], v101, s[64:67], s60 offen offset:2048 sc1
    v_mfma_f32_16x16x32_bf16 v[164:167], a[196:199], a[28:31], v[164:167]
    ds_read_b64_tr_b16 a[132:133], v36 offset:40960
    v_mfma_f32_16x16x32_bf16 v[164:167], a[192:195], a[20:23], v[164:167]
    ds_read_b64_tr_b16 a[134:135], v36 offset:45056
    v_mfma_f32_16x16x32_bf16 v[172:175], a[200:203], a[20:23], v[172:175]
    ds_read_b64_tr_b16 a[136:137], v37 offset:32768
    buffer_load_dwordx4 a[116:119], v102, s[64:67], s60 offen offset:2048 sc1
    v_mfma_f32_16x16x32_bf16 v[172:175], a[204:207], a[28:31], v[172:175]
    ds_read_b64_tr_b16 a[138:139], v37 offset:36864
    v_mfma_f32_16x16x32_bf16 v[168:171], a[204:207], a[24:27], v[168:171]
    ds_read_b64_tr_b16 a[140:141], v37 offset:40960
    v_mfma_f32_16x16x32_bf16 v[168:171], a[200:203], a[16:19], v[168:171]
    ds_read_b64_tr_b16 a[142:143], v37 offset:45056
    s_waitcnt lgkmcnt(8)
    v_mfma_f32_16x16x32_bf16 v[176:179], a[208:211], a[16:19], v[176:179]
    ds_read_b64_tr_b16 a[144:145], v38 offset:32768
    buffer_load_dwordx4 a[120:123], v101, s[64:67], s60 offen offset:3072 sc1
    v_mfma_f32_16x16x32_bf16 v[176:179], a[212:215], a[24:27], v[176:179]
    ds_read_b64_tr_b16 a[146:147], v38 offset:36864
    v_mfma_f32_16x16x32_bf16 v[180:183], a[212:215], a[28:31], v[180:183]
    ds_read_b64_tr_b16 a[148:149], v38 offset:40960
    v_mfma_f32_16x16x32_bf16 v[180:183], a[208:211], a[20:23], v[180:183]
    ds_read_b64_tr_b16 a[150:151], v38 offset:45056
    v_mfma_f32_16x16x32_bf16 v[188:191], a[216:219], a[20:23], v[188:191]
    ds_read_b64_tr_b16 a[152:153], v39 offset:32768
    buffer_load_dwordx4 a[124:127], v102, s[64:67], s60 offen offset:3072 sc1
    s_add_u32 s60, s60, 4096
    v_mfma_f32_16x16x32_bf16 v[188:191], a[220:223], a[28:31], v[188:191]
    ds_read_b64_tr_b16 a[154:155], v39 offset:36864
    v_mfma_f32_16x16x32_bf16 v[184:187], a[220:223], a[24:27], v[184:187]
    ds_read_b64_tr_b16 a[156:157], v39 offset:40960
    v_mfma_f32_16x16x32_bf16 v[184:187], a[216:219], a[16:19], v[184:187]
    ds_read_b64_tr_b16 a[158:159], v39 offset:45056
    s_waitcnt vmcnt(36)
    s_waitcnt lgkmcnt(8)
    v_mfma_f32_16x16x32_bf16 v[160:163], a[128:131], a[32:35], v[160:163]
    ds_read_b64_tr_b16 a[192:193], v36 offset:49152
    v_mfma_f32_16x16x32_bf16 v[160:163], a[132:135], a[40:43], v[160:163]
    ds_read_b64_tr_b16 a[194:195], v36 offset:53248
    v_mfma_f32_16x16x32_bf16 v[164:167], a[132:135], a[44:47], v[164:167]
    ds_read_b64_tr_b16 a[196:197], v36 offset:57344
    v_mfma_f32_16x16x32_bf16 v[164:167], a[128:131], a[36:39], v[164:167]
    ds_read_b64_tr_b16 a[198:199], v36 offset:61440
    v_mfma_f32_16x16x32_bf16 v[172:175], a[136:139], a[36:39], v[172:175]
    ds_read_b64_tr_b16 a[200:201], v37 offset:49152
    v_mfma_f32_16x16x32_bf16 v[172:175], a[140:143], a[44:47], v[172:175]
    ds_read_b64_tr_b16 a[202:203], v37 offset:53248
    v_mfma_f32_16x16x32_bf16 v[168:171], a[140:143], a[40:43], v[168:171]
    ds_read_b64_tr_b16 a[204:205], v37 offset:57344
    v_mfma_f32_16x16x32_bf16 v[168:171], a[136:139], a[32:35], v[168:171]
    ds_read_b64_tr_b16 a[206:207], v37 offset:61440
    s_waitcnt lgkmcnt(8)
    v_mfma_f32_16x16x32_bf16 v[176:179], a[144:147], a[32:35], v[176:179]
    ds_read_b64_tr_b16 a[208:209], v38 offset:49152
    v_mfma_f32_16x16x32_bf16 v[176:179], a[148:151], a[40:43], v[176:179]
    ds_read_b64_tr_b16 a[210:211], v38 offset:53248
    v_mfma_f32_16x16x32_bf16 v[180:183], a[148:151], a[44:47], v[180:183]
    ds_read_b64_tr_b16 a[212:213], v38 offset:57344
    v_mfma_f32_16x16x32_bf16 v[180:183], a[144:147], a[36:39], v[180:183]
    ds_read_b64_tr_b16 a[214:215], v38 offset:61440
    v_mfma_f32_16x16x32_bf16 v[188:191], a[152:155], a[36:39], v[188:191]
    ds_read_b64_tr_b16 a[216:217], v39 offset:49152
    v_mfma_f32_16x16x32_bf16 v[188:191], a[156:159], a[44:47], v[188:191]
    ds_read_b64_tr_b16 a[218:219], v39 offset:53248
    v_mfma_f32_16x16x32_bf16 v[184:187], a[156:159], a[40:43], v[184:187]
    ds_read_b64_tr_b16 a[220:221], v39 offset:57344
    v_mfma_f32_16x16x32_bf16 v[184:187], a[152:155], a[32:35], v[184:187]
    ds_read_b64_tr_b16 a[222:223], v39 offset:61440
    s_waitcnt vmcnt(28)
    s_waitcnt lgkmcnt(8)
    s_waitcnt vmcnt(21)
    s_barrier
    v_mfma_f32_16x16x32_bf16 v[160:163], a[192:195], a[48:51], v[160:163]
    ds_read_b64_tr_b16 a[128:129], v44 offset:0
    v_mfma_f32_16x16x32_bf16 v[160:163], a[196:199], a[56:59], v[160:163]
    ds_read_b64_tr_b16 a[130:131], v44 offset:4096
    v_mfma_f32_16x16x32_bf16 v[164:167], a[196:199], a[60:63], v[164:167]
    ds_read_b64_tr_b16 a[132:133], v44 offset:8192
    v_mfma_f32_16x16x32_bf16 v[164:167], a[192:195], a[52:55], v[164:167]
    ds_read_b64_tr_b16 a[134:135], v44 offset:12288
    v_mfma_f32_16x16x32_bf16 v[172:175], a[200:203], a[52:55], v[172:175]
    ds_read_b64_tr_b16 a[136:137], v45 offset:0
    v_mfma_f32_16x16x32_bf16 v[172:175], a[204:207], a[60:63], v[172:175]
    ds_read_b64_tr_b16 a[138:139], v45 offset:4096
    v_mfma_f32_16x16x32_bf16 v[168:171], a[204:207], a[56:59], v[168:171]
    ds_read_b64_tr_b16 a[140:141], v45 offset:8192
    v_mfma_f32_16x16x32_bf16 v[168:171], a[200:203], a[48:51], v[168:171]
    ds_read_b64_tr_b16 a[142:143], v45 offset:12288
    s_waitcnt lgkmcnt(8)
    v_mfma_f32_16x16x32_bf16 v[176:179], a[208:211], a[48:51], v[176:179]
    ds_read_b64_tr_b16 a[144:145], v46 offset:0
    v_mfma_f32_16x16x32_bf16 v[176:179], a[212:215], a[56:59], v[176:179]
    ds_read_b64_tr_b16 a[146:147], v46 offset:4096
    v_mfma_f32_16x16x32_bf16 v[180:183], a[212:215], a[60:63], v[180:183]
    ds_read_b64_tr_b16 a[148:149], v46 offset:8192
    v_mfma_f32_16x16x32_bf16 v[180:183], a[208:211], a[52:55], v[180:183]
    ds_read_b64_tr_b16 a[150:151], v46 offset:12288
    v_mfma_f32_16x16x32_bf16 v[188:191], a[216:219], a[52:55], v[188:191]
    ds_read_b64_tr_b16 a[152:153], v47 offset:0
    v_mfma_f32_16x16x32_bf16 v[188:191], a[220:223], a[60:63], v[188:191]
    ds_read_b64_tr_b16 a[154:155], v47 offset:4096
    v_mfma_f32_16x16x32_bf16 v[184:187], a[220:223], a[56:59], v[184:187]
    ds_read_b64_tr_b16 a[156:157], v47 offset:8192
    v_mfma_f32_16x16x32_bf16 v[184:187], a[216:219], a[48:51], v[184:187]
    ds_read_b64_tr_b16 a[158:159], v47 offset:12288
    s_waitcnt vmcnt(20)
    s_waitcnt lgkmcnt(8)
    v_mfma_f32_16x16x32_bf16 v[160:163], a[128:131], a[64:67], v[160:163]
    ds_read_b64_tr_b16 a[192:193], v44 offset:16384
    v_mfma_f32_16x16x32_bf16 v[160:163], a[132:135], a[72:75], v[160:163]
    ds_read_b64_tr_b16 a[194:195], v44 offset:20480
    v_mfma_f32_16x16x32_bf16 v[164:167], a[132:135], a[76:79], v[164:167]
    ds_read_b64_tr_b16 a[196:197], v44 offset:24576
    v_mfma_f32_16x16x32_bf16 v[164:167], a[128:131], a[68:71], v[164:167]
    ds_read_b64_tr_b16 a[198:199], v44 offset:28672
    v_mfma_f32_16x16x32_bf16 v[172:175], a[136:139], a[68:71], v[172:175]
    ds_read_b64_tr_b16 a[200:201], v45 offset:16384
    v_mfma_f32_16x16x32_bf16 v[172:175], a[140:143], a[76:79], v[172:175]
    ds_read_b64_tr_b16 a[202:203], v45 offset:20480
    v_mfma_f32_16x16x32_bf16 v[168:171], a[140:143], a[72:75], v[168:171]
    ds_read_b64_tr_b16 a[204:205], v45 offset:24576
    v_mfma_f32_16x16x32_bf16 v[168:171], a[136:139], a[64:67], v[168:171]
    ds_read_b64_tr_b16 a[206:207], v45 offset:28672
    s_waitcnt lgkmcnt(8)
    v_mfma_f32_16x16x32_bf16 v[176:179], a[144:147], a[64:67], v[176:179]
    ds_read_b64_tr_b16 a[208:209], v46 offset:16384
    v_mfma_f32_16x16x32_bf16 v[176:179], a[148:151], a[72:75], v[176:179]
    ds_read_b64_tr_b16 a[210:211], v46 offset:20480
    v_mfma_f32_16x16x32_bf16 v[180:183], a[148:151], a[76:79], v[180:183]
    ds_read_b64_tr_b16 a[212:213], v46 offset:24576
    v_mfma_f32_16x16x32_bf16 v[180:183], a[144:147], a[68:71], v[180:183]
    ds_read_b64_tr_b16 a[214:215], v46 offset:28672
    v_mfma_f32_16x16x32_bf16 v[188:191], a[152:155], a[68:71], v[188:191]
    ds_read_b64_tr_b16 a[216:217], v47 offset:16384
    v_mfma_f32_16x16x32_bf16 v[188:191], a[156:159], a[76:79], v[188:191]
    ds_read_b64_tr_b16 a[218:219], v47 offset:20480
    v_mfma_f32_16x16x32_bf16 v[184:187], a[156:159], a[72:75], v[184:187]
    ds_read_b64_tr_b16 a[220:221], v47 offset:24576
    v_mfma_f32_16x16x32_bf16 v[184:187], a[152:155], a[64:67], v[184:187]
    ds_read_b64_tr_b16 a[222:223], v47 offset:28672
    s_waitcnt vmcnt(12)
    s_waitcnt lgkmcnt(8)
    s_waitcnt vmcnt(5)
    s_barrier
    v_mfma_f32_16x16x32_bf16 v[160:163], a[192:195], a[80:83], v[160:163]
    ds_read_b64_tr_b16 a[128:129], v44 offset:32768
    v_mfma_f32_16x16x32_bf16 v[160:163], a[196:199], a[88:91], v[160:163]
    ds_read_b64_tr_b16 a[130:131], v44 offset:36864
    v_mfma_f32_16x16x32_bf16 v[164:167], a[196:199], a[92:95], v[164:167]
    ds_read_b64_tr_b16 a[132:133], v44 offset:40960
    v_mfma_f32_16x16x32_bf16 v[164:167], a[192:195], a[84:87], v[164:167]
    ds_read_b64_tr_b16 a[134:135], v44 offset:45056
    v_mfma_f32_16x16x32_bf16 v[172:175], a[200:203], a[84:87], v[172:175]
    ds_read_b64_tr_b16 a[136:137], v45 offset:32768
    v_mfma_f32_16x16x32_bf16 v[172:175], a[204:207], a[92:95], v[172:175]
    ds_read_b64_tr_b16 a[138:139], v45 offset:36864
    v_mfma_f32_16x16x32_bf16 v[168:171], a[204:207], a[88:91], v[168:171]
    ds_read_b64_tr_b16 a[140:141], v45 offset:40960
    v_mfma_f32_16x16x32_bf16 v[168:171], a[200:203], a[80:83], v[168:171]
    ds_read_b64_tr_b16 a[142:143], v45 offset:45056
    s_waitcnt lgkmcnt(8)
    v_mfma_f32_16x16x32_bf16 v[176:179], a[208:211], a[80:83], v[176:179]
    ds_read_b64_tr_b16 a[144:145], v46 offset:32768
    v_mfma_f32_16x16x32_bf16 v[176:179], a[212:215], a[88:91], v[176:179]
    ds_read_b64_tr_b16 a[146:147], v46 offset:36864
    v_mfma_f32_16x16x32_bf16 v[180:183], a[212:215], a[92:95], v[180:183]
    ds_read_b64_tr_b16 a[148:149], v46 offset:40960
    v_mfma_f32_16x16x32_bf16 v[180:183], a[208:211], a[84:87], v[180:183]
    ds_read_b64_tr_b16 a[150:151], v46 offset:45056
    v_mfma_f32_16x16x32_bf16 v[188:191], a[216:219], a[84:87], v[188:191]
    ds_read_b64_tr_b16 a[152:153], v47 offset:32768
    v_mfma_f32_16x16x32_bf16 v[188:191], a[220:223], a[92:95], v[188:191]
    ds_read_b64_tr_b16 a[154:155], v47 offset:36864
    v_mfma_f32_16x16x32_bf16 v[184:187], a[220:223], a[88:91], v[184:187]
    ds_read_b64_tr_b16 a[156:157], v47 offset:40960
    v_mfma_f32_16x16x32_bf16 v[184:187], a[216:219], a[80:83], v[184:187]
    ds_read_b64_tr_b16 a[158:159], v47 offset:45056
    s_waitcnt vmcnt(4)
    s_waitcnt lgkmcnt(8)
    v_mfma_f32_16x16x32_bf16 v[160:163], a[128:131], a[96:99], v[160:163]
    ds_read_b64_tr_b16 a[192:193], v44 offset:49152
    v_mfma_f32_16x16x32_bf16 v[160:163], a[132:135], a[104:107], v[160:163]
    ds_read_b64_tr_b16 a[194:195], v44 offset:53248
    v_mfma_f32_16x16x32_bf16 v[164:167], a[132:135], a[108:111], v[164:167]
    ds_read_b64_tr_b16 a[196:197], v44 offset:57344
    v_mfma_f32_16x16x32_bf16 v[164:167], a[128:131], a[100:103], v[164:167]
    ds_read_b64_tr_b16 a[198:199], v44 offset:61440
    v_mfma_f32_16x16x32_bf16 v[172:175], a[136:139], a[100:103], v[172:175]
    ds_read_b64_tr_b16 a[200:201], v45 offset:49152
    v_mfma_f32_16x16x32_bf16 v[172:175], a[140:143], a[108:111], v[172:175]
    ds_read_b64_tr_b16 a[202:203], v45 offset:53248
    v_mfma_f32_16x16x32_bf16 v[168:171], a[140:143], a[104:107], v[168:171]
    ds_read_b64_tr_b16 a[204:205], v45 offset:57344
    v_mfma_f32_16x16x32_bf16 v[168:171], a[136:139], a[96:99], v[168:171]
    ds_read_b64_tr_b16 a[206:207], v45 offset:61440
    s_waitcnt lgkmcnt(8)
    v_mfma_f32_16x16x32_bf16 v[176:179], a[144:147], a[96:99], v[176:179]
    ds_read_b64_tr_b16 a[208:209], v46 offset:49152
    v_mfma_f32_16x16x32_bf16 v[176:179], a[148:151], a[104:107], v[176:179]
    ds_read_b64_tr_b16 a[210:211], v46 offset:53248
    v_mfma_f32_16x16x32_bf16 v[180:183], a[148:151], a[108:111], v[180:183]
    ds_read_b64_tr_b16 a[212:213], v46 offset:57344
    v_mfma_f32_16x16x32_bf16 v[180:183], a[144:147], a[100:103], v[180:183]
    ds_read_b64_tr_b16 a[214:215], v46 offset:61440
    v_mfma_f32_16x16x32_bf16 v[188:191], a[152:155], a[100:103], v[188:191]
    ds_read_b64_tr_b16 a[216:217], v47 offset:49152
    v_mfma_f32_16x16x32_bf16 v[188:191], a[156:159], a[108:111], v[188:191]
    ds_read_b64_tr_b16 a[218:219], v47 offset:53248
    v_mfma_f32_16x16x32_bf16 v[184:187], a[156:159], a[104:107], v[184:187]
    ds_read_b64_tr_b16 a[220:221], v47 offset:57344
    v_mfma_f32_16x16x32_bf16 v[184:187], a[152:155], a[96:99], v[184:187]
    ds_read_b64_tr_b16 a[222:223], v47 offset:61440
    s_waitcnt vmcnt(0)
    s_waitcnt lgkmcnt(8)
    v_mfma_f32_16x16x32_bf16 v[160:163], a[192:195], a[112:115], v[160:163]
    ds_read_b64_tr_b16 a[160:161], v40 offset:0
    v_mfma_f32_16x16x32_bf16 v[160:163], a[196:199], a[120:123], v[160:163]
    ds_read_b64_tr_b16 a[162:163], v40 offset:4096
    v_mfma_f32_16x16x32_bf16 v[164:167], a[196:199], a[124:127], v[164:167]
    ds_read_b64_tr_b16 a[164:165], v40 offset:8192
    v_mfma_f32_16x16x32_bf16 v[164:167], a[192:195], a[116:119], v[164:167]
    ds_read_b64_tr_b16 a[166:167], v40 offset:12288
    v_mfma_f32_16x16x32_bf16 v[172:175], a[200:203], a[116:119], v[172:175]
    ds_read_b64_tr_b16 a[168:169], v41 offset:0
    v_mfma_f32_16x16x32_bf16 v[172:175], a[204:207], a[124:127], v[172:175]
    ds_read_b64_tr_b16 a[170:171], v41 offset:4096
    v_mfma_f32_16x16x32_bf16 v[168:171], a[204:207], a[120:123], v[168:171]
    ds_read_b64_tr_b16 a[172:173], v41 offset:8192
    v_mfma_f32_16x16x32_bf16 v[168:171], a[200:203], a[112:115], v[168:171]
    ds_read_b64_tr_b16 a[174:175], v41 offset:12288
    s_waitcnt lgkmcnt(8)
    v_mfma_f32_16x16x32_bf16 v[176:179], a[208:211], a[112:115], v[176:179]
    ds_read_b64_tr_b16 a[176:177], v42 offset:0
    v_mfma_f32_16x16x32_bf16 v[176:179], a[212:215], a[120:123], v[176:179]
    ds_read_b64_tr_b16 a[178:179], v42 offset:4096
    v_mfma_f32_16x16x32_bf16 v[180:183], a[212:215], a[124:127], v[180:183]
    ds_read_b64_tr_b16 a[180:181], v42 offset:8192
    v_mfma_f32_16x16x32_bf16 v[180:183], a[208:211], a[116:119], v[180:183]
    ds_read_b64_tr_b16 a[182:183], v42 offset:12288
    v_mfma_f32_16x16x32_bf16 v[188:191], a[216:219], a[116:119], v[188:191]
    ds_read_b64_tr_b16 a[184:185], v43 offset:0
    v_mfma_f32_16x16x32_bf16 v[188:191], a[220:223], a[124:127], v[188:191]
    ds_read_b64_tr_b16 a[186:187], v43 offset:4096
    v_mfma_f32_16x16x32_bf16 v[184:187], a[220:223], a[120:123], v[184:187]
    ds_read_b64_tr_b16 a[188:189], v43 offset:8192
    v_mfma_f32_16x16x32_bf16 v[184:187], a[216:219], a[112:115], v[184:187]
    ds_read_b64_tr_b16 a[190:191], v43 offset:12288
    s_nop 7
    s_nop 0
    v_pk_mul_f32 v[160:161], v[160:161], v[6:7] op_sel:[0,0] op_sel_hi:[1,0]
    v_pk_mul_f32 v[162:163], v[162:163], v[6:7] op_sel:[0,0] op_sel_hi:[1,0]
    v_pk_mul_f32 v[164:165], v[164:165], v[6:7] op_sel:[0,1] op_sel_hi:[1,1]
    v_pk_mul_f32 v[166:167], v[166:167], v[6:7] op_sel:[0,1] op_sel_hi:[1,1]
    v_pk_mul_f32 v[168:169], v[168:169], v[6:7] op_sel:[0,0] op_sel_hi:[1,0]
    v_pk_mul_f32 v[170:171], v[170:171], v[6:7] op_sel:[0,0] op_sel_hi:[1,0]
    v_pk_mul_f32 v[172:173], v[172:173], v[6:7] op_sel:[0,1] op_sel_hi:[1,1]
    v_pk_mul_f32 v[174:175], v[174:175], v[6:7] op_sel:[0,1] op_sel_hi:[1,1]
    v_pk_mul_f32 v[176:177], v[176:177], v[6:7] op_sel:[0,0] op_sel_hi:[1,0]
    v_pk_mul_f32 v[178:179], v[178:179], v[6:7] op_sel:[0,0] op_sel_hi:[1,0]
    v_pk_mul_f32 v[180:181], v[180:181], v[6:7] op_sel:[0,1] op_sel_hi:[1,1]
    v_pk_mul_f32 v[182:183], v[182:183], v[6:7] op_sel:[0,1] op_sel_hi:[1,1]
    v_pk_mul_f32 v[184:185], v[184:185], v[6:7] op_sel:[0,0] op_sel_hi:[1,0]
    v_pk_mul_f32 v[186:187], v[186:187], v[6:7] op_sel:[0,0] op_sel_hi:[1,0]
    v_pk_mul_f32 v[188:189], v[188:189], v[6:7] op_sel:[0,1] op_sel_hi:[1,1]
    v_pk_mul_f32 v[190:191], v[190:191], v[6:7] op_sel:[0,1] op_sel_hi:[1,1]
    v_cvt_pk_bf16_f32 v128, v160, v161
    v_cvt_pk_bf16_f32 v129, v162, v163
    v_cvt_pk_bf16_f32 v130, v164, v165
    v_cvt_pk_bf16_f32 v132, v166, v167
    v_cvt_pk_bf16_f32 v133, v168, v169
    v_cvt_pk_bf16_f32 v134, v170, v171
    v_cvt_pk_bf16_f32 v136, v172, v173
    v_cvt_pk_bf16_f32 v137, v174, v175
    v_cvt_pk_bf16_f32 v138, v176, v177
    v_cvt_pk_bf16_f32 v140, v178, v179
    v_cvt_pk_bf16_f32 v141, v180, v181
    v_cvt_pk_bf16_f32 v142, v182, v183
    v_cvt_pk_bf16_f32 v144, v184, v185
    v_cvt_pk_bf16_f32 v145, v186, v187
    v_cvt_pk_bf16_f32 v146, v188, v189
    v_cvt_pk_bf16_f32 v148, v190, v191
    s_waitcnt lgkmcnt(8)
    v_mfma_f32_16x16x32_bf16 v[192:195], a[160:163], a[0:3], v[192:195]
    ds_read_b64_tr_b16 a[224:225], v40 offset:16384
    v_mfma_f32_16x16x32_bf16 v[192:195], a[164:167], a[8:11], v[192:195]
    ds_read_b64_tr_b16 a[226:227], v40 offset:20480
    buffer_store_dwordx4 v[128:131], v118, s[20:23], 0 offen offset:0 sc1
    v_mfma_f32_16x16x32_bf16 v[196:199], a[164:167], a[12:15], v[196:199]
    ds_read_b64_tr_b16 a[228:229], v40 offset:24576
    v_mfma_f32_16x16x32_bf16 v[196:199], a[160:163], a[4:7], v[196:199]
    ds_read_b64_tr_b16 a[230:231], v40 offset:28672
    v_mfma_f32_16x16x32_bf16 v[204:207], a[168:171], a[4:7], v[204:207]
    ds_read_b64_tr_b16 a[232:233], v41 offset:16384
    v_mfma_f32_16x16x32_bf16 v[204:207], a[172:175], a[12:15], v[204:207]
    ds_read_b64_tr_b16 a[234:235], v41 offset:20480
    v_mfma_f32_16x16x32_bf16 v[200:203], a[172:175], a[8:11], v[200:203]
    ds_read_b64_tr_b16 a[236:237], v41 offset:24576
    buffer_store_dwordx4 v[132:135], v118, s[20:23], 0 offen offset:1024 sc1
    v_mfma_f32_16x16x32_bf16 v[200:203], a[168:171], a[0:3], v[200:203]
    ds_read_b64_tr_b16 a[238:239], v41 offset:28672
    s_waitcnt lgkmcnt(8)
    v_mfma_f32_16x16x32_bf16 v[208:211], a[176:179], a[0:3], v[208:211]
    ds_read_b64_tr_b16 a[240:241], v42 offset:16384
    v_mfma_f32_16x16x32_bf16 v[208:211], a[180:183], a[8:11], v[208:211]
    ds_read_b64_tr_b16 a[242:243], v42 offset:20480
    v_mfma_f32_16x16x32_bf16 v[212:215], a[180:183], a[12:15], v[212:215]
    ds_read_b64_tr_b16 a[244:245], v42 offset:24576
    v_mfma_f32_16x16x32_bf16 v[212:215], a[176:179], a[4:7], v[212:215]
    ds_read_b64_tr_b16 a[246:247], v42 offset:28672
    buffer_store_dwordx4 v[136:139], v118, s[20:23], 0 offen offset:2048 sc1
    v_mfma_f32_16x16x32_bf16 v[220:223], a[184:187], a[4:7], v[220:223]
    ds_read_b64_tr_b16 a[248:249], v43 offset:16384
    v_mfma_f32_16x16x32_bf16 v[220:223], a[188:191], a[12:15], v[220:223]
    ds_read_b64_tr_b16 a[250:251], v43 offset:20480
    v_mfma_f32_16x16x32_bf16 v[216:219], a[188:191], a[8:11], v[216:219]
    ds_read_b64_tr_b16 a[252:253], v43 offset:24576
    v_mfma_f32_16x16x32_bf16 v[216:219], a[184:187], a[0:3], v[216:219]
    ds_read_b64_tr_b16 a[254:255], v43 offset:28672
    s_waitcnt lgkmcnt(8)
    v_mfma_f32_16x16x32_bf16 v[192:195], a[224:227], a[16:19], v[192:195]
    ds_read_b64_tr_b16 a[160:161], v40 offset:32768
    v_mfma_f32_16x16x32_bf16 v[192:195], a[228:231], a[24:27], v[192:195]
    ds_read_b64_tr_b16 a[162:163], v40 offset:36864
    buffer_store_dwordx4 v[140:143], v118, s[20:23], 0 offen offset:3072 sc1
    v_mfma_f32_16x16x32_bf16 v[196:199], a[228:231], a[28:31], v[196:199]
    ds_read_b64_tr_b16 a[164:165], v40 offset:40960
    v_mfma_f32_16x16x32_bf16 v[196:199], a[224:227], a[20:23], v[196:199]
    ds_read_b64_tr_b16 a[166:167], v40 offset:45056
    v_mfma_f32_16x16x32_bf16 v[204:207], a[232:235], a[20:23], v[204:207]
    ds_read_b64_tr_b16 a[168:169], v41 offset:32768
    v_mfma_f32_16x16x32_bf16 v[204:207], a[236:239], a[28:31], v[204:207]
    ds_read_b64_tr_b16 a[170:171], v41 offset:36864
    v_mfma_f32_16x16x32_bf16 v[200:203], a[236:239], a[24:27], v[200:203]
    ds_read_b64_tr_b16 a[172:173], v41 offset:40960
    buffer_store_dwordx4 v[144:147], v18, s[20:23], 0 offen offset:0 sc1
    v_mfma_f32_16x16x32_bf16 v[200:203], a[232:235], a[16:19], v[200:203]
    ds_read_b64_tr_b16 a[174:175], v41 offset:45056
    s_waitcnt lgkmcnt(8)
    v_mfma_f32_16x16x32_bf16 v[208:211], a[240:243], a[16:19], v[208:211]
    ds_read_b64_tr_b16 a[176:177], v42 offset:32768
    v_mfma_f32_16x16x32_bf16 v[208:211], a[244:247], a[24:27], v[208:211]
    ds_read_b64_tr_b16 a[178:179], v42 offset:36864
    v_mfma_f32_16x16x32_bf16 v[212:215], a[244:247], a[28:31], v[212:215]
    ds_read_b64_tr_b16 a[180:181], v42 offset:40960
    v_mfma_f32_16x16x32_bf16 v[212:215], a[240:243], a[20:23], v[212:215]
    ds_read_b64_tr_b16 a[182:183], v42 offset:45056
    buffer_store_dwordx4 v[148:151], v18, s[20:23], 0 offen offset:1024 sc1
    v_mfma_f32_16x16x32_bf16 v[220:223], a[248:251], a[20:23], v[220:223]
    ds_read_b64_tr_b16 a[184:185], v43 offset:32768
    v_mfma_f32_16x16x32_bf16 v[220:223], a[252:255], a[28:31], v[220:223]
    ds_read_b64_tr_b16 a[186:187], v43 offset:36864
    v_mfma_f32_16x16x32_bf16 v[216:219], a[252:255], a[24:27], v[216:219]
    ds_read_b64_tr_b16 a[188:189], v43 offset:40960
    v_mfma_f32_16x16x32_bf16 v[216:219], a[248:251], a[16:19], v[216:219]
    ds_read_b64_tr_b16 a[190:191], v43 offset:45056
    s_waitcnt lgkmcnt(8)
    v_mfma_f32_16x16x32_bf16 v[192:195], a[160:163], a[32:35], v[192:195]
    ds_read_b64_tr_b16 a[224:225], v40 offset:49152
    v_mfma_f32_16x16x32_bf16 v[192:195], a[164:167], a[40:43], v[192:195]
    ds_read_b64_tr_b16 a[226:227], v40 offset:53248
    v_mfma_f32_16x16x32_bf16 v[196:199], a[164:167], a[44:47], v[196:199]
    ds_read_b64_tr_b16 a[228:229], v40 offset:57344
    v_mfma_f32_16x16x32_bf16 v[196:199], a[160:163], a[36:39], v[196:199]
    ds_read_b64_tr_b16 a[230:231], v40 offset:61440
    v_mfma_f32_16x16x32_bf16 v[204:207], a[168:171], a[36:39], v[204:207]
    ds_read_b64_tr_b16 a[232:233], v41 offset:49152
    v_mfma_f32_16x16x32_bf16 v[204:207], a[172:175], a[44:47], v[204:207]
    ds_read_b64_tr_b16 a[234:235], v41 offset:53248
    v_mfma_f32_16x16x32_bf16 v[200:203], a[172:175], a[40:43], v[200:203]
    ds_read_b64_tr_b16 a[236:237], v41 offset:57344
    v_mfma_f32_16x16x32_bf16 v[200:203], a[168:171], a[32:35], v[200:203]
    ds_read_b64_tr_b16 a[238:239], v41 offset:61440
    s_waitcnt lgkmcnt(8)
    v_mfma_f32_16x16x32_bf16 v[208:211], a[176:179], a[32:35], v[208:211]
    ds_read_b64_tr_b16 a[240:241], v42 offset:49152
    v_mfma_f32_16x16x32_bf16 v[208:211], a[180:183], a[40:43], v[208:211]
    ds_read_b64_tr_b16 a[242:243], v42 offset:53248
    v_mfma_f32_16x16x32_bf16 v[212:215], a[180:183], a[44:47], v[212:215]
    ds_read_b64_tr_b16 a[244:245], v42 offset:57344
    v_mfma_f32_16x16x32_bf16 v[212:215], a[176:179], a[36:39], v[212:215]
    ds_read_b64_tr_b16 a[246:247], v42 offset:61440
    v_mfma_f32_16x16x32_bf16 v[220:223], a[184:187], a[36:39], v[220:223]
    ds_read_b64_tr_b16 a[248:249], v43 offset:49152
    v_mfma_f32_16x16x32_bf16 v[220:223], a[188:191], a[44:47], v[220:223]
    ds_read_b64_tr_b16 a[250:251], v43 offset:53248
    v_mfma_f32_16x16x32_bf16 v[216:219], a[188:191], a[40:43], v[216:219]
    ds_read_b64_tr_b16 a[252:253], v43 offset:57344
    v_mfma_f32_16x16x32_bf16 v[216:219], a[184:187], a[32:35], v[216:219]
    ds_read_b64_tr_b16 a[254:255], v43 offset:61440
    s_waitcnt lgkmcnt(8)
    v_mfma_f32_16x16x32_bf16 v[192:195], a[224:227], a[48:51], v[192:195]
    ds_read_b64_tr_b16 a[160:161], v48 offset:0
    v_mfma_f32_16x16x32_bf16 v[192:195], a[228:231], a[56:59], v[192:195]
    ds_read_b64_tr_b16 a[162:163], v48 offset:4096
    v_mfma_f32_16x16x32_bf16 v[196:199], a[228:231], a[60:63], v[196:199]
    ds_read_b64_tr_b16 a[164:165], v48 offset:8192
    v_mfma_f32_16x16x32_bf16 v[196:199], a[224:227], a[52:55], v[196:199]
    ds_read_b64_tr_b16 a[166:167], v48 offset:12288
    v_mfma_f32_16x16x32_bf16 v[204:207], a[232:235], a[52:55], v[204:207]
    ds_read_b64_tr_b16 a[168:169], v49 offset:0
    v_mfma_f32_16x16x32_bf16 v[204:207], a[236:239], a[60:63], v[204:207]
    ds_read_b64_tr_b16 a[170:171], v49 offset:4096
    v_mfma_f32_16x16x32_bf16 v[200:203], a[236:239], a[56:59], v[200:203]
    ds_read_b64_tr_b16 a[172:173], v49 offset:8192
    v_mfma_f32_16x16x32_bf16 v[200:203], a[232:235], a[48:51], v[200:203]
    ds_read_b64_tr_b16 a[174:175], v49 offset:12288
    s_waitcnt lgkmcnt(8)
    v_mfma_f32_16x16x32_bf16 v[208:211], a[240:243], a[48:51], v[208:211]
    ds_read_b64_tr_b16 a[176:177], v50 offset:0
    v_mfma_f32_16x16x32_bf16 v[208:211], a[244:247], a[56:59], v[208:211]
    ds_read_b64_tr_b16 a[178:179], v50 offset:4096
    v_mfma_f32_16x16x32_bf16 v[212:215], a[244:247], a[60:63], v[212:215]
    ds_read_b64_tr_b16 a[180:181], v50 offset:8192
    v_mfma_f32_16x16x32_bf16 v[212:215], a[240:243], a[52:55], v[212:215]
    ds_read_b64_tr_b16 a[182:183], v50 offset:12288
    v_mfma_f32_16x16x32_bf16 v[220:223], a[248:251], a[52:55], v[220:223]
    ds_read_b64_tr_b16 a[184:185], v51 offset:0
    v_mfma_f32_16x16x32_bf16 v[220:223], a[252:255], a[60:63], v[220:223]
    ds_read_b64_tr_b16 a[186:187], v51 offset:4096
    v_mfma_f32_16x16x32_bf16 v[216:219], a[252:255], a[56:59], v[216:219]
    ds_read_b64_tr_b16 a[188:189], v51 offset:8192
    v_mfma_f32_16x16x32_bf16 v[216:219], a[248:251], a[48:51], v[216:219]
    ds_read_b64_tr_b16 a[190:191], v51 offset:12288
    s_waitcnt lgkmcnt(8)
    v_mfma_f32_16x16x32_bf16 v[192:195], a[160:163], a[64:67], v[192:195]
    ds_read_b64_tr_b16 a[224:225], v48 offset:16384
    v_mfma_f32_16x16x32_bf16 v[192:195], a[164:167], a[72:75], v[192:195]
    ds_read_b64_tr_b16 a[226:227], v48 offset:20480
    v_mfma_f32_16x16x32_bf16 v[196:199], a[164:167], a[76:79], v[196:199]
    ds_read_b64_tr_b16 a[228:229], v48 offset:24576
    v_mfma_f32_16x16x32_bf16 v[196:199], a[160:163], a[68:71], v[196:199]
    ds_read_b64_tr_b16 a[230:231], v48 offset:28672
    v_mfma_f32_16x16x32_bf16 v[204:207], a[168:171], a[68:71], v[204:207]
    ds_read_b64_tr_b16 a[232:233], v49 offset:16384
    v_mfma_f32_16x16x32_bf16 v[204:207], a[172:175], a[76:79], v[204:207]
    ds_read_b64_tr_b16 a[234:235], v49 offset:20480
    v_mfma_f32_16x16x32_bf16 v[200:203], a[172:175], a[72:75], v[200:203]
    ds_read_b64_tr_b16 a[236:237], v49 offset:24576
    v_mfma_f32_16x16x32_bf16 v[200:203], a[168:171], a[64:67], v[200:203]
    ds_read_b64_tr_b16 a[238:239], v49 offset:28672
    s_waitcnt lgkmcnt(8)
    v_mfma_f32_16x16x32_bf16 v[208:211], a[176:179], a[64:67], v[208:211]
    ds_read_b64_tr_b16 a[240:241], v50 offset:16384
    v_mfma_f32_16x16x32_bf16 v[208:211], a[180:183], a[72:75], v[208:211]
    ds_read_b64_tr_b16 a[242:243], v50 offset:20480
    v_mfma_f32_16x16x32_bf16 v[212:215], a[180:183], a[76:79], v[212:215]
    ds_read_b64_tr_b16 a[244:245], v50 offset:24576
    v_mfma_f32_16x16x32_bf16 v[212:215], a[176:179], a[68:71], v[212:215]
    ds_read_b64_tr_b16 a[246:247], v50 offset:28672
    v_mfma_f32_16x16x32_bf16 v[220:223], a[184:187], a[68:71], v[220:223]
    ds_read_b64_tr_b16 a[248:249], v51 offset:16384
    v_mfma_f32_16x16x32_bf16 v[220:223], a[188:191], a[76:79], v[220:223]
    ds_read_b64_tr_b16 a[250:251], v51 offset:20480
    v_mfma_f32_16x16x32_bf16 v[216:219], a[188:191], a[72:75], v[216:219]
    ds_read_b64_tr_b16 a[252:253], v51 offset:24576
    v_mfma_f32_16x16x32_bf16 v[216:219], a[184:187], a[64:67], v[216:219]
    ds_read_b64_tr_b16 a[254:255], v51 offset:28672
    s_waitcnt lgkmcnt(8)
    v_mfma_f32_16x16x32_bf16 v[192:195], a[224:227], a[80:83], v[192:195]
    ds_read_b64_tr_b16 a[160:161], v48 offset:32768
    v_mfma_f32_16x16x32_bf16 v[192:195], a[228:231], a[88:91], v[192:195]
    ds_read_b64_tr_b16 a[162:163], v48 offset:36864
    v_mfma_f32_16x16x32_bf16 v[196:199], a[228:231], a[92:95], v[196:199]
    ds_read_b64_tr_b16 a[164:165], v48 offset:40960
    v_mfma_f32_16x16x32_bf16 v[196:199], a[224:227], a[84:87], v[196:199]
    ds_read_b64_tr_b16 a[166:167], v48 offset:45056
    v_mfma_f32_16x16x32_bf16 v[204:207], a[232:235], a[84:87], v[204:207]
    ds_read_b64_tr_b16 a[168:169], v49 offset:32768
    v_mfma_f32_16x16x32_bf16 v[204:207], a[236:239], a[92:95], v[204:207]
    ds_read_b64_tr_b16 a[170:171], v49 offset:36864
    v_mfma_f32_16x16x32_bf16 v[200:203], a[236:239], a[88:91], v[200:203]
    ds_read_b64_tr_b16 a[172:173], v49 offset:40960
    v_mfma_f32_16x16x32_bf16 v[200:203], a[232:235], a[80:83], v[200:203]
    ds_read_b64_tr_b16 a[174:175], v49 offset:45056
    s_waitcnt lgkmcnt(8)
    v_mfma_f32_16x16x32_bf16 v[208:211], a[240:243], a[80:83], v[208:211]
    ds_read_b64_tr_b16 a[176:177], v50 offset:32768
    v_mfma_f32_16x16x32_bf16 v[208:211], a[244:247], a[88:91], v[208:211]
    ds_read_b64_tr_b16 a[178:179], v50 offset:36864
    v_mfma_f32_16x16x32_bf16 v[212:215], a[244:247], a[92:95], v[212:215]
    ds_read_b64_tr_b16 a[180:181], v50 offset:40960
    v_mfma_f32_16x16x32_bf16 v[212:215], a[240:243], a[84:87], v[212:215]
    ds_read_b64_tr_b16 a[182:183], v50 offset:45056
    v_mfma_f32_16x16x32_bf16 v[220:223], a[248:251], a[84:87], v[220:223]
    ds_read_b64_tr_b16 a[184:185], v51 offset:32768
    v_mfma_f32_16x16x32_bf16 v[220:223], a[252:255], a[92:95], v[220:223]
    ds_read_b64_tr_b16 a[186:187], v51 offset:36864
    v_mfma_f32_16x16x32_bf16 v[216:219], a[252:255], a[88:91], v[216:219]
    ds_read_b64_tr_b16 a[188:189], v51 offset:40960
    v_mfma_f32_16x16x32_bf16 v[216:219], a[248:251], a[80:83], v[216:219]
    ds_read_b64_tr_b16 a[190:191], v51 offset:45056
    s_waitcnt lgkmcnt(8)
    v_mfma_f32_16x16x32_bf16 v[192:195], a[160:163], a[96:99], v[192:195]
    ds_read_b64_tr_b16 a[224:225], v48 offset:49152
    v_mfma_f32_16x16x32_bf16 v[192:195], a[164:167], a[104:107], v[192:195]
    ds_read_b64_tr_b16 a[226:227], v48 offset:53248
    buffer_load_dwordx4 v[224:227], v19, s[20:23], 0 offen offset:0 sc1
    v_mfma_f32_16x16x32_bf16 v[196:199], a[164:167], a[108:111], v[196:199]
    ds_read_b64_tr_b16 a[228:229], v48 offset:57344
    v_mfma_f32_16x16x32_bf16 v[196:199], a[160:163], a[100:103], v[196:199]
    ds_read_b64_tr_b16 a[230:231], v48 offset:61440
    buffer_load_dwordx4 v[228:231], v19, s[20:23], 0 offen offset:1024 sc1
    v_mfma_f32_16x16x32_bf16 v[204:207], a[168:171], a[100:103], v[204:207]
    ds_read_b64_tr_b16 a[232:233], v49 offset:49152
    v_mfma_f32_16x16x32_bf16 v[204:207], a[172:175], a[108:111], v[204:207]
    ds_read_b64_tr_b16 a[234:235], v49 offset:53248
    v_mfma_f32_16x16x32_bf16 v[200:203], a[172:175], a[104:107], v[200:203]
    ds_read_b64_tr_b16 a[236:237], v49 offset:57344
    buffer_load_dwordx4 v[232:235], v19, s[20:23], 0 offen offset:2048 sc1
    v_mfma_f32_16x16x32_bf16 v[200:203], a[168:171], a[96:99], v[200:203]
    ds_read_b64_tr_b16 a[238:239], v49 offset:61440
    s_waitcnt lgkmcnt(8)
    v_mfma_f32_16x16x32_bf16 v[208:211], a[176:179], a[96:99], v[208:211]
    ds_read_b64_tr_b16 a[240:241], v50 offset:49152
    buffer_load_dwordx4 v[236:239], v19, s[20:23], 0 offen offset:3072 sc1
    v_mfma_f32_16x16x32_bf16 v[208:211], a[180:183], a[104:107], v[208:211]
    ds_read_b64_tr_b16 a[242:243], v50 offset:53248
    v_mfma_f32_16x16x32_bf16 v[212:215], a[180:183], a[108:111], v[212:215]
    ds_read_b64_tr_b16 a[244:245], v50 offset:57344
    v_mfma_f32_16x16x32_bf16 v[212:215], a[176:179], a[100:103], v[212:215]
    ds_read_b64_tr_b16 a[246:247], v50 offset:61440
    buffer_load_dwordx4 v[240:243], v17, s[20:23], 0 offen offset:0 sc1
    v_mfma_f32_16x16x32_bf16 v[220:223], a[184:187], a[100:103], v[220:223]
    ds_read_b64_tr_b16 a[248:249], v51 offset:49152
    v_mfma_f32_16x16x32_bf16 v[220:223], a[188:191], a[108:111], v[220:223]
    ds_read_b64_tr_b16 a[250:251], v51 offset:53248
    buffer_load_dwordx4 v[244:247], v17, s[20:23], 0 offen offset:1024 sc1
    v_mfma_f32_16x16x32_bf16 v[216:219], a[188:191], a[104:107], v[216:219]
    ds_read_b64_tr_b16 a[252:253], v51 offset:57344
    v_mfma_f32_16x16x32_bf16 v[216:219], a[184:187], a[96:99], v[216:219]
    ds_read_b64_tr_b16 a[254:255], v51 offset:61440
    s_waitcnt lgkmcnt(8)
    v_mfma_f32_16x16x32_bf16 v[192:195], a[224:227], a[112:115], v[192:195]
    v_mfma_f32_16x16x32_bf16 v[192:195], a[228:231], a[120:123], v[192:195]
    v_mfma_f32_16x16x32_bf16 v[196:199], a[228:231], a[124:127], v[196:199]
    v_mfma_f32_16x16x32_bf16 v[196:199], a[224:227], a[116:119], v[196:199]
    v_mfma_f32_16x16x32_bf16 v[204:207], a[232:235], a[116:119], v[204:207]
    v_mfma_f32_16x16x32_bf16 v[204:207], a[236:239], a[124:127], v[204:207]
    v_mfma_f32_16x16x32_bf16 v[200:203], a[236:239], a[120:123], v[200:203]
    v_mfma_f32_16x16x32_bf16 v[200:203], a[232:235], a[112:115], v[200:203]
    s_waitcnt lgkmcnt(0)
    v_mfma_f32_16x16x32_bf16 v[208:211], a[240:243], a[112:115], v[208:211]
    v_mfma_f32_16x16x32_bf16 v[208:211], a[244:247], a[120:123], v[208:211]
    v_mfma_f32_16x16x32_bf16 v[212:215], a[244:247], a[124:127], v[212:215]
    v_mfma_f32_16x16x32_bf16 v[212:215], a[240:243], a[116:119], v[212:215]
    v_mfma_f32_16x16x32_bf16 v[220:223], a[248:251], a[116:119], v[220:223]
    v_mfma_f32_16x16x32_bf16 v[220:223], a[252:255], a[124:127], v[220:223]
    v_mfma_f32_16x16x32_bf16 v[216:219], a[252:255], a[120:123], v[216:219]
    v_mfma_f32_16x16x32_bf16 v[216:219], a[248:251], a[112:115], v[216:219]
    v_and_b32 v2, 15, v1
    v_lshrrev_b32 v3, 4, v1
    s_add_u32 s3, s59, 131072
    v_lshrrev_b32 v4, 1, v3
    v_and_b32 v5, 7, v1
    v_xor_b32 v4, v4, v5
    v_lshlrev_b32 v4, 4, v4
    v_and_b32 v3, 1, v3
    v_lshl_add_u32 v4, v3, 3, v4
    v_lshl_add_u32 v4, v2, 7, v4
    v_add_u32 v8, s3, v4
    v_xor_b32 v9, 32, v8
    v_xor_b32 v10, 64, v8
    v_xor_b32 v11, 96, v8
    v_lshrrev_b32 v3, 3, v1
    v_xor_b32 v4, v3, v5
    v_lshlrev_b32 v4, 4, v4
    v_lshl_add_u32 v4, v3, 7, v4
    v_add_u32 v12, s3, v4
    v_lshlrev_b32_e64 v4, 4, v5
    v_lshl_add_u32 v13, v3, 11, v4
    v_pk_mul_f32 v[192:193], v[192:193], v[6:7] op_sel:[0,0] op_sel_hi:[1,0]
    v_pk_mul_f32 v[194:195], v[194:195], v[6:7] op_sel:[0,0] op_sel_hi:[1,0]
    v_pk_mul_f32 v[196:197], v[196:197], v[6:7] op_sel:[0,1] op_sel_hi:[1,1]
    v_pk_mul_f32 v[198:199], v[198:199], v[6:7] op_sel:[0,1] op_sel_hi:[1,1]
    v_pk_mul_f32 v[200:201], v[200:201], v[6:7] op_sel:[0,0] op_sel_hi:[1,0]
    v_pk_mul_f32 v[202:203], v[202:203], v[6:7] op_sel:[0,0] op_sel_hi:[1,0]
    v_pk_mul_f32 v[204:205], v[204:205], v[6:7] op_sel:[0,1] op_sel_hi:[1,1]
    v_pk_mul_f32 v[206:207], v[206:207], v[6:7] op_sel:[0,1] op_sel_hi:[1,1]
    v_pk_mul_f32 v[208:209], v[208:209], v[6:7] op_sel:[0,0] op_sel_hi:[1,0]
    v_pk_mul_f32 v[210:211], v[210:211], v[6:7] op_sel:[0,0] op_sel_hi:[1,0]
    v_pk_mul_f32 v[212:213], v[212:213], v[6:7] op_sel:[0,1] op_sel_hi:[1,1]
    v_pk_mul_f32 v[214:215], v[214:215], v[6:7] op_sel:[0,1] op_sel_hi:[1,1]
    v_pk_mul_f32 v[216:217], v[216:217], v[6:7] op_sel:[0,0] op_sel_hi:[1,0]
    v_pk_mul_f32 v[218:219], v[218:219], v[6:7] op_sel:[0,0] op_sel_hi:[1,0]
    v_pk_mul_f32 v[220:221], v[220:221], v[6:7] op_sel:[0,1] op_sel_hi:[1,1]
    v_pk_mul_f32 v[222:223], v[222:223], v[6:7] op_sel:[0,1] op_sel_hi:[1,1]
    s_movk_i32 s0, 0x3f80
    s_mov_b32 s1, 0x3f800000
    s_mov_b32 s3, 0
    s_waitcnt vmcnt(0)
K3_SPIN_P:
    v_xor_b32 v14, s46, v231
    v_xor_b32 v15, s46, v235
    v_xor_b32 v16, s46, v239
    v_xor_b32 v18, s46, v243
    v_xor_b32 v20, s46, v247
    v_xor_b32 v2, s46, v227
    v_or3_b32 v2, v2, v14, v15
    v_or3_b32 v2, v2, v16, v18
    v_or_b32_e64 v2, v2, v20
    v_cmp_ne_u32 vcc, 0, v2
    s_nop 4
    s_cmp_eq_u64 vcc, 0
    s_cbranch_scc0 K3_SPIN_P_RETRY
K3_SPIN_P_OK:
    v_dot2_f32_bf16 v192, v224, s0, v192
    v_dot2_f32_bf16 v193, v224, s1, v193
    v_dot2_f32_bf16 v194, v225, s0, v194
    v_dot2_f32_bf16 v195, v225, s1, v195
    v_dot2_f32_bf16 v196, v226, s0, v196
    v_dot2_f32_bf16 v197, v226, s1, v197
    v_dot2_f32_bf16 v198, v228, s0, v198
    v_dot2_f32_bf16 v199, v228, s1, v199
    v_cvt_pk_bf16_f32 v40, v192, v193
    v_cvt_pk_bf16_f32 v41, v194, v195
    ds_write_b64 v8, v[40:41] offset:0
    v_dot2_f32_bf16 v200, v229, s0, v200
    v_dot2_f32_bf16 v201, v229, s1, v201
    v_dot2_f32_bf16 v202, v230, s0, v202
    v_dot2_f32_bf16 v203, v230, s1, v203
    v_cvt_pk_bf16_f32 v42, v196, v197
    v_cvt_pk_bf16_f32 v43, v198, v199
    ds_write_b64 v8, v[42:43] offset:2048
    v_dot2_f32_bf16 v204, v232, s0, v204
    v_dot2_f32_bf16 v205, v232, s1, v205
    v_dot2_f32_bf16 v206, v233, s0, v206
    v_dot2_f32_bf16 v207, v233, s1, v207
    v_cvt_pk_bf16_f32 v44, v200, v201
    v_cvt_pk_bf16_f32 v45, v202, v203
    ds_write_b64 v9, v[44:45] offset:0
    v_dot2_f32_bf16 v208, v234, s0, v208
    v_dot2_f32_bf16 v209, v234, s1, v209
    v_dot2_f32_bf16 v210, v236, s0, v210
    v_dot2_f32_bf16 v211, v236, s1, v211
    v_cvt_pk_bf16_f32 v46, v204, v205
    v_cvt_pk_bf16_f32 v47, v206, v207
    ds_write_b64 v9, v[46:47] offset:2048
    v_dot2_f32_bf16 v212, v237, s0, v212
    v_dot2_f32_bf16 v213, v237, s1, v213
    v_dot2_f32_bf16 v214, v238, s0, v214
    v_dot2_f32_bf16 v215, v238, s1, v215
    v_cvt_pk_bf16_f32 v48, v208, v209
    v_cvt_pk_bf16_f32 v49, v210, v211
    ds_write_b64 v10, v[48:49] offset:0
    v_dot2_f32_bf16 v216, v240, s0, v216
    v_dot2_f32_bf16 v217, v240, s1, v217
    v_dot2_f32_bf16 v218, v241, s0, v218
    v_dot2_f32_bf16 v219, v241, s1, v219
    v_cvt_pk_bf16_f32 v50, v212, v213
    v_cvt_pk_bf16_f32 v51, v214, v215
    ds_write_b64 v10, v[50:51] offset:2048
    v_dot2_f32_bf16 v220, v242, s0, v220
    v_dot2_f32_bf16 v221, v242, s1, v221
    v_dot2_f32_bf16 v222, v244, s0, v222
    v_dot2_f32_bf16 v223, v244, s1, v223
    v_cvt_pk_bf16_f32 v52, v216, v217
    v_cvt_pk_bf16_f32 v53, v218, v219
    ds_write_b64 v11, v[52:53] offset:0
    s_nop 0
    v_cvt_pk_bf16_f32 v54, v220, v221
    v_cvt_pk_bf16_f32 v55, v222, v223
    ds_write_b64 v11, v[54:55] offset:2048
    s_waitcnt lgkmcnt(0)
    ds_read_b128 v[72:75], v12 offset:0
    ds_read_b128 v[76:79], v12 offset:1024
    ds_read_b128 v[80:83], v12 offset:2048
    ds_read_b128 v[84:87], v12 offset:3072
    s_waitcnt lgkmcnt(3)
    buffer_store_dwordx4 v[72:75], v13, s[16:19], s37 offen sc1
    s_add_u32 s37, s37, 16384
    s_waitcnt lgkmcnt(2)
    buffer_store_dwordx4 v[76:79], v13, s[16:19], s37 offen sc1
    s_add_u32 s37, s37, 16384
    s_waitcnt lgkmcnt(1)
    buffer_store_dwordx4 v[80:83], v13, s[16:19], s37 offen sc1
    s_add_u32 s37, s37, 16384
    s_waitcnt lgkmcnt(0)
    buffer_store_dwordx4 v[84:87], v13, s[16:19], s37 offen sc1
    s_add_u32 s37, s37, 16384
K3_DONE:
K_END:
    s_endpgm
.p2align 6
K1_W0_LOOPB:
    v_mfma_f32_16x16x32_bf16 a[16:19], a[160:163], a[224:227], a[16:19]
    ds_read_b64_tr_b16 a[128:129], v31 offset:0
    v_mfma_f32_16x16x32_bf16 a[16:19], a[164:167], a[228:231], a[16:19]
    ds_read_b64_tr_b16 a[130:131], v31 offset:1792
    s_mov_b32 m0, s36
    v_mfma_f32_16x16x32_bf16 a[20:23], a[164:167], a[236:239], a[20:23]
    buffer_load_dwordx4 v8, s[8:11], s24 offen offset:0 lds
    v_mfma_f32_16x16x32_bf16 a[20:23], a[160:163], a[232:235], a[20:23]
    ds_read_b64_tr_b16 a[132:133], v31 offset:7168
    v_mfma_f32_16x16x32_bf16 a[24:27], a[160:163], a[240:243], a[24:27]
    ds_read_b64_tr_b16 a[134:135], v31 offset:8960
    v_mfma_f32_16x16x32_bf16 a[24:27], a[164:167], a[244:247], a[24:27]
    v_mfma_f32_16x16x32_bf16 a[28:31], a[164:167], a[252:255], a[28:31]
    ds_read_b64_tr_b16 a[136:137], v31 offset:32
    v_mfma_f32_16x16x32_bf16 a[28:31], a[160:163], a[248:251], a[28:31]
    buffer_load_dwordx4 v9, s[8:11], s24 offen offset:1024 lds
    v_mfma_f32_16x16x32_bf16 a[60:63], a[168:171], a[248:251], a[60:63]
    ds_read_b64_tr_b16 a[138:139], v31 offset:1824
    v_mfma_f32_16x16x32_bf16 a[60:63], a[172:175], a[252:255], a[60:63]
    ds_read_b64_tr_b16 a[140:141], v31 offset:7200
    v_mfma_f32_16x16x32_bf16 a[56:59], a[172:175], a[244:247], a[56:59]
    ds_read_b64_tr_b16 a[142:143], v31 offset:8992
    v_mfma_f32_16x16x32_bf16 a[56:59], a[168:171], a[240:243], a[56:59]
    s_add_u32 m0, s36, 2048
    v_mfma_f32_16x16x32_bf16 a[52:55], a[168:171], a[232:235], a[52:55]
    buffer_load_dwordx4 v10, s[8:11], s24 offen offset:0 lds
    v_mfma_f32_16x16x32_bf16 a[52:55], a[172:175], a[236:239], a[52:55]
    ds_read_b64_tr_b16 a[144:145], v31 offset:64
    v_mfma_f32_16x16x32_bf16 a[48:51], a[172:175], a[228:231], a[48:51]
    ds_read_b64_tr_b16 a[146:147], v31 offset:1856
    v_mfma_f32_16x16x32_bf16 a[48:51], a[168:171], a[224:227], a[48:51]
    ds_read_b64_tr_b16 a[148:149], v31 offset:7232
    v_mfma_f32_16x16x32_bf16 a[80:83], a[176:179], a[224:227], a[80:83]
    ds_read_b64_tr_b16 a[150:151], v31 offset:9024
    v_mfma_f32_16x16x32_bf16 a[80:83], a[180:183], a[228:231], a[80:83]
    buffer_load_dwordx4 v11, s[8:11], s24 offen offset:1024 lds
    v_mfma_f32_16x16x32_bf16 a[84:87], a[180:183], a[236:239], a[84:87]
    v_mfma_f32_16x16x32_bf16 a[84:87], a[176:179], a[232:235], a[84:87]
    ds_read_b64_tr_b16 a[152:153], v31 offset:96
    v_mfma_f32_16x16x32_bf16 a[88:91], a[176:179], a[240:243], a[88:91]
    ds_read_b64_tr_b16 a[154:155], v31 offset:1888
    v_mfma_f32_16x16x32_bf16 a[88:91], a[180:183], a[244:247], a[88:91]
    ds_read_b64_tr_b16 a[156:157], v31 offset:7264
    s_mov_b32 m0, s37
    v_mfma_f32_16x16x32_bf16 a[92:95], a[180:183], a[252:255], a[92:95]
    buffer_load_dwordx4 v12, s[8:11], s24 offen offset:0 lds
    v_mfma_f32_16x16x32_bf16 a[92:95], a[176:179], a[248:251], a[92:95]
    ds_read_b64_tr_b16 a[158:159], v31 offset:9056
    v_mfma_f32_16x16x32_bf16 a[124:127], a[184:187], a[248:251], a[124:127]
    v_mfma_f32_16x16x32_bf16 a[124:127], a[188:191], a[252:255], a[124:127]
    v_mfma_f32_16x16x32_bf16 a[120:123], a[188:191], a[244:247], a[120:123]
    v_mfma_f32_16x16x32_bf16 a[120:123], a[184:187], a[240:243], a[120:123]
    buffer_load_dwordx4 v13, s[8:11], s24 offen offset:1024 lds
    v_mfma_f32_16x16x32_bf16 a[116:119], a[184:187], a[232:235], a[116:119]
    v_mfma_f32_16x16x32_bf16 a[116:119], a[188:191], a[236:239], a[116:119]
    v_mfma_f32_16x16x32_bf16 a[112:115], a[188:191], a[228:231], a[112:115]
    v_mfma_f32_16x16x32_bf16 a[112:115], a[184:187], a[224:227], a[112:115]
    s_add_u32 m0, s37, 2048
    v_mfma_f32_16x16x32_bf16 a[0:3], a[160:163], a[192:195], a[0:3]
    buffer_load_dwordx4 v14, s[8:11], s24 offen offset:0 lds
    v_mfma_f32_16x16x32_bf16 a[0:3], a[164:167], a[196:199], a[0:3]
    ds_read_b128 a[224:227], v28 offset:8192
    v_mfma_f32_16x16x32_bf16 a[4:7], a[164:167], a[204:207], a[4:7]
    ds_read_b128 a[228:231], v29 offset:8192
    v_mfma_f32_16x16x32_bf16 a[4:7], a[160:163], a[200:203], a[4:7]
    v_mfma_f32_16x16x32_bf16 a[8:11], a[160:163], a[208:211], a[8:11]
    ds_read_b128 a[232:235], v28 offset:10240
    v_mfma_f32_16x16x32_bf16 a[8:11], a[164:167], a[212:215], a[8:11]
    buffer_load_dwordx4 v15, s[8:11], s24 offen offset:1024 lds
    v_mfma_f32_16x16x32_bf16 a[12:15], a[164:167], a[220:223], a[12:15]
    v_mfma_f32_16x16x32_bf16 a[12:15], a[160:163], a[216:219], a[12:15]
    ds_read_b128 a[236:239], v29 offset:10240
    v_mfma_f32_16x16x32_bf16 a[44:47], a[168:171], a[216:219], a[44:47]
    ds_read_b128 a[240:243], v28 offset:12288
    v_mfma_f32_16x16x32_bf16 a[44:47], a[172:175], a[220:223], a[44:47]
    s_mov_b32 m0, s38
    v_mfma_f32_16x16x32_bf16 a[40:43], a[172:175], a[212:215], a[40:43]
    buffer_load_dwordx4 v16, s[12:15], s25 offen offset:0 lds
    v_mfma_f32_16x16x32_bf16 a[40:43], a[168:171], a[208:211], a[40:43]
    ds_read_b128 a[244:247], v29 offset:12288
    v_mfma_f32_16x16x32_bf16 a[36:39], a[168:171], a[200:203], a[36:39]
    v_mfma_f32_16x16x32_bf16 a[36:39], a[172:175], a[204:207], a[36:39]
    ds_read_b128 a[248:251], v28 offset:14336
    v_mfma_f32_16x16x32_bf16 a[32:35], a[172:175], a[196:199], a[32:35]
    ds_read_b128 a[252:255], v29 offset:14336
    v_mfma_f32_16x16x32_bf16 a[32:35], a[168:171], a[192:195], a[32:35]
    buffer_load_dwordx4 v17, s[12:15], s25 offen offset:1024 lds
    v_mfma_f32_16x16x32_bf16 a[64:67], a[176:179], a[192:195], a[64:67]
    v_mfma_f32_16x16x32_bf16 a[64:67], a[180:183], a[196:199], a[64:67]
    v_mfma_f32_16x16x32_bf16 a[68:71], a[180:183], a[204:207], a[68:71]
    v_mfma_f32_16x16x32_bf16 a[68:71], a[176:179], a[200:203], a[68:71]
    v_mfma_f32_16x16x32_bf16 a[72:75], a[176:179], a[208:211], a[72:75]
    buffer_load_dwordx4 v18, s[12:15], s25 offen offset:2048 lds
    v_mfma_f32_16x16x32_bf16 a[72:75], a[180:183], a[212:215], a[72:75]
    v_mfma_f32_16x16x32_bf16 a[76:79], a[180:183], a[220:223], a[76:79]
    v_mfma_f32_16x16x32_bf16 a[76:79], a[176:179], a[216:219], a[76:79]
    v_mfma_f32_16x16x32_bf16 a[108:111], a[184:187], a[216:219], a[108:111]
    v_mfma_f32_16x16x32_bf16 a[108:111], a[188:191], a[220:223], a[108:111]
    buffer_load_dwordx4 v19, s[12:15], s25 offen offset:3072 lds
    v_mfma_f32_16x16x32_bf16 a[104:107], a[188:191], a[212:215], a[104:107]
    v_mfma_f32_16x16x32_bf16 a[104:107], a[184:187], a[208:211], a[104:107]
    v_mfma_f32_16x16x32_bf16 a[100:103], a[184:187], a[200:203], a[100:103]
    v_mfma_f32_16x16x32_bf16 a[100:103], a[188:191], a[204:207], a[100:103]
    s_mov_b32 m0, s39
    v_mfma_f32_16x16x32_bf16 a[96:99], a[188:191], a[196:199], a[96:99]
    buffer_load_dwordx4 v20, s[12:15], s25 offen offset:0 lds
    v_mfma_f32_16x16x32_bf16 a[96:99], a[184:187], a[192:195], a[96:99]
    s_waitcnt lgkmcnt(0)
    v_mfma_f32_16x16x32_bf16 v[144:147], a[128:131], a[224:227], v[144:147]
    ds_read_b128 a[192:195], v28 offset:0
    v_mfma_f32_16x16x32_bf16 v[144:147], a[132:135], a[228:231], v[144:147]
    ds_read_b128 a[196:199], v29 offset:0
    v_mfma_f32_16x16x32_bf16 v[148:151], a[132:135], a[236:239], v[148:151]
    v_mfma_f32_16x16x32_bf16 v[148:151], a[128:131], a[232:235], v[148:151]
    buffer_load_dwordx4 v21, s[12:15], s25 offen offset:1024 lds
    v_mfma_f32_16x16x32_bf16 v[152:155], a[128:131], a[240:243], v[152:155]
    ds_read_b128 a[200:203], v28 offset:2048
    v_mfma_f32_16x16x32_bf16 v[152:155], a[132:135], a[244:247], v[152:155]
    v_mfma_f32_16x16x32_bf16 v[156:159], a[132:135], a[252:255], v[156:159]
    ds_read_b128 a[204:207], v29 offset:2048
    v_mfma_f32_16x16x32_bf16 v[156:159], a[128:131], a[248:251], v[156:159]
    ds_read_b128 a[208:211], v28 offset:4096
    s_add_u32 m0, s39, 2048
    v_mfma_f32_16x16x32_bf16 v[188:191], a[136:139], a[248:251], v[188:191]
    buffer_load_dwordx4 v22, s[16:19], s26 offen offset:0 lds
    v_mfma_f32_16x16x32_bf16 v[188:191], a[140:143], a[252:255], v[188:191]
    v_mfma_f32_16x16x32_bf16 v[184:187], a[140:143], a[244:247], v[184:187]
    ds_read_b128 a[212:215], v29 offset:4096
    v_mfma_f32_16x16x32_bf16 v[184:187], a[136:139], a[240:243], v[184:187]
    v_mfma_f32_16x16x32_bf16 v[180:183], a[136:139], a[232:235], v[180:183]
    ds_read_b128 a[216:219], v28 offset:6144
    v_mfma_f32_16x16x32_bf16 v[180:183], a[140:143], a[236:239], v[180:183]
    buffer_load_dwordx4 v23, s[16:19], s26 offen offset:1024 lds
    v_mfma_f32_16x16x32_bf16 v[176:179], a[140:143], a[228:231], v[176:179]
    ds_read_b128 a[220:223], v29 offset:6144
    v_mfma_f32_16x16x32_bf16 v[176:179], a[136:139], a[224:227], v[176:179]
    v_mfma_f32_16x16x32_bf16 v[208:211], a[144:147], a[224:227], v[208:211]
    v_mfma_f32_16x16x32_bf16 v[208:211], a[148:151], a[228:231], v[208:211]
    v_mfma_f32_16x16x32_bf16 v[212:215], a[148:151], a[236:239], v[212:215]
    v_mfma_f32_16x16x32_bf16 v[212:215], a[144:147], a[232:235], v[212:215]
    v_mfma_f32_16x16x32_bf16 v[216:219], a[144:147], a[240:243], v[216:219]
    v_mfma_f32_16x16x32_bf16 v[216:219], a[148:151], a[244:247], v[216:219]
    v_mfma_f32_16x16x32_bf16 v[220:223], a[148:151], a[252:255], v[220:223]
    v_mfma_f32_16x16x32_bf16 v[220:223], a[144:147], a[248:251], v[220:223]
    v_mfma_f32_16x16x32_bf16 v[252:255], a[152:155], a[248:251], v[252:255]
    v_mfma_f32_16x16x32_bf16 v[252:255], a[156:159], a[252:255], v[252:255]
    v_mfma_f32_16x16x32_bf16 v[248:251], a[156:159], a[244:247], v[248:251]
    buffer_load_dword v125, v41, s[12:15], s25 offen
    v_mfma_f32_16x16x32_bf16 v[248:251], a[152:155], a[240:243], v[248:251]
    v_mfma_f32_16x16x32_bf16 v[244:247], a[152:155], a[232:235], v[244:247]
    v_mfma_f32_16x16x32_bf16 v[244:247], a[156:159], a[236:239], v[244:247]
    v_mfma_f32_16x16x32_bf16 v[240:243], a[156:159], a[228:231], v[240:243]
    v_mfma_f32_16x16x32_bf16 v[240:243], a[152:155], a[224:227], v[240:243]
    buffer_load_dword v126, v42, s[16:19], s26 offen
    s_waitcnt lgkmcnt(0)
    v_mfma_f32_16x16x32_bf16 v[128:131], a[128:131], a[192:195], v[128:131]
    ds_read_b64_tr_b16 a[160:161], v31 offset:16384
    v_mfma_f32_16x16x32_bf16 v[128:131], a[132:135], a[196:199], v[128:131]
    ds_read_b64_tr_b16 a[162:163], v31 offset:18176
    v_mfma_f32_16x16x32_bf16 v[132:135], a[132:135], a[204:207], v[132:135]
    ds_read_b64_tr_b16 a[164:165], v31 offset:23552
    v_mfma_f32_16x16x32_bf16 v[132:135], a[128:131], a[200:203], v[132:135]
    ds_read_b64_tr_b16 a[166:167], v31 offset:25344
    v_mfma_f32_16x16x32_bf16 v[136:139], a[128:131], a[208:211], v[136:139]
    v_mfma_f32_16x16x32_bf16 v[136:139], a[132:135], a[212:215], v[136:139]
    ds_read_b64_tr_b16 a[168:169], v31 offset:16416
    v_mfma_f32_16x16x32_bf16 v[140:143], a[132:135], a[220:223], v[140:143]
    ds_read_b64_tr_b16 a[170:171], v31 offset:18208
    v_mfma_f32_16x16x32_bf16 v[140:143], a[128:131], a[216:219], v[140:143]
    ds_read_b64_tr_b16 a[172:173], v31 offset:23584
    v_mfma_f32_16x16x32_bf16 v[172:175], a[136:139], a[216:219], v[172:175]
    ds_read_b64_tr_b16 a[174:175], v31 offset:25376
    v_mfma_f32_16x16x32_bf16 v[172:175], a[140:143], a[220:223], v[172:175]
    v_mfma_f32_16x16x32_bf16 v[168:171], a[140:143], a[212:215], v[168:171]
    ds_read_b64_tr_b16 a[176:177], v31 offset:16448
    v_mfma_f32_16x16x32_bf16 v[168:171], a[136:139], a[208:211], v[168:171]
    ds_read_b64_tr_b16 a[178:179], v31 offset:18240
    v_mfma_f32_16x16x32_bf16 v[164:167], a[136:139], a[200:203], v[164:167]
    ds_read_b64_tr_b16 a[180:181], v31 offset:23616
    v_mfma_f32_16x16x32_bf16 v[164:167], a[140:143], a[204:207], v[164:167]
    ds_read_b64_tr_b16 a[182:183], v31 offset:25408
    v_mfma_f32_16x16x32_bf16 v[160:163], a[140:143], a[196:199], v[160:163]
    v_mfma_f32_16x16x32_bf16 v[160:163], a[136:139], a[192:195], v[160:163]
    ds_read_b64_tr_b16 a[184:185], v31 offset:16480
    v_mfma_f32_16x16x32_bf16 v[192:195], a[144:147], a[192:195], v[192:195]
    ds_read_b64_tr_b16 a[186:187], v31 offset:18272
    v_mfma_f32_16x16x32_bf16 v[192:195], a[148:151], a[196:199], v[192:195]
    ds_read_b64_tr_b16 a[188:189], v31 offset:23648
    v_mfma_f32_16x16x32_bf16 v[196:199], a[148:151], a[204:207], v[196:199]
    ds_read_b64_tr_b16 a[190:191], v31 offset:25440
    v_mfma_f32_16x16x32_bf16 v[196:199], a[144:147], a[200:203], v[196:199]
    v_mfma_f32_16x16x32_bf16 v[200:203], a[144:147], a[208:211], v[200:203]
    s_add_u32 s24, s24, 128
    v_mfma_f32_16x16x32_bf16 v[200:203], a[148:151], a[212:215], v[200:203]
    s_add_u32 s25, s25, 458752
    v_mfma_f32_16x16x32_bf16 v[204:207], a[148:151], a[220:223], v[204:207]
    s_add_u32 s26, s26, s27
    v_mfma_f32_16x16x32_bf16 v[204:207], a[144:147], a[216:219], v[204:207]
    s_add_u32 s33, s33, 4096
    v_mfma_f32_16x16x32_bf16 v[236:239], a[152:155], a[216:219], v[236:239]
    v_mfma_f32_16x16x32_bf16 v[236:239], a[156:159], a[220:223], v[236:239]
    v_mfma_f32_16x16x32_bf16 v[232:235], a[156:159], a[212:215], v[232:235]
    v_mfma_f32_16x16x32_bf16 v[232:235], a[152:155], a[208:211], v[232:235]
    v_mfma_f32_16x16x32_bf16 v[228:231], a[152:155], a[200:203], v[228:231]
    v_mfma_f32_16x16x32_bf16 v[228:231], a[156:159], a[204:207], v[228:231]
    v_mfma_f32_16x16x32_bf16 v[224:227], a[156:159], a[196:199], v[224:227]
    v_mfma_f32_16x16x32_bf16 v[224:227], a[152:155], a[192:195], v[224:227]
    s_waitcnt vmcnt(2) lgkmcnt(0)
    s_barrier
    v_mfma_f32_16x16x32_bf16 a[0:3], a[160:163], a[192:195], a[0:3]
    ds_read_b64_tr_b16 a[128:129], v30 offset:0
    v_mfma_f32_16x16x32_bf16 a[0:3], a[164:167], a[196:199], a[0:3]
    ds_read_b64_tr_b16 a[130:131], v30 offset:1792
    s_mov_b32 m0, s41
    v_mfma_f32_16x16x32_bf16 a[4:7], a[164:167], a[204:207], a[4:7]
    buffer_load_dwordx4 v8, s[8:11], s24 offen offset:0 lds
    v_mfma_f32_16x16x32_bf16 a[4:7], a[160:163], a[200:203], a[4:7]
    ds_read_b64_tr_b16 a[132:133], v30 offset:7168
    v_mfma_f32_16x16x32_bf16 a[8:11], a[160:163], a[208:211], a[8:11]
    ds_read_b64_tr_b16 a[134:135], v30 offset:8960
    v_mfma_f32_16x16x32_bf16 a[8:11], a[164:167], a[212:215], a[8:11]
    v_mfma_f32_16x16x32_bf16 a[12:15], a[164:167], a[220:223], a[12:15]
    ds_read_b64_tr_b16 a[136:137], v30 offset:32
    v_mfma_f32_16x16x32_bf16 a[12:15], a[160:163], a[216:219], a[12:15]
    buffer_load_dwordx4 v9, s[8:11], s24 offen offset:1024 lds
    v_mfma_f32_16x16x32_bf16 a[44:47], a[168:171], a[216:219], a[44:47]
    ds_read_b64_tr_b16 a[138:139], v30 offset:1824
    v_mfma_f32_16x16x32_bf16 a[44:47], a[172:175], a[220:223], a[44:47]
    ds_read_b64_tr_b16 a[140:141], v30 offset:7200
    v_mfma_f32_16x16x32_bf16 a[40:43], a[172:175], a[212:215], a[40:43]
    ds_read_b64_tr_b16 a[142:143], v30 offset:8992
    v_mfma_f32_16x16x32_bf16 a[40:43], a[168:171], a[208:211], a[40:43]
    s_add_u32 m0, s41, 2048
    v_mfma_f32_16x16x32_bf16 a[36:39], a[168:171], a[200:203], a[36:39]
    buffer_load_dwordx4 v10, s[8:11], s24 offen offset:0 lds
    v_mfma_f32_16x16x32_bf16 a[36:39], a[172:175], a[204:207], a[36:39]
    ds_read_b64_tr_b16 a[144:145], v30 offset:64
    v_mfma_f32_16x16x32_bf16 a[32:35], a[172:175], a[196:199], a[32:35]
    ds_read_b64_tr_b16 a[146:147], v30 offset:1856
    v_mfma_f32_16x16x32_bf16 a[32:35], a[168:171], a[192:195], a[32:35]
    ds_read_b64_tr_b16 a[148:149], v30 offset:7232
    v_mfma_f32_16x16x32_bf16 a[64:67], a[176:179], a[192:195], a[64:67]
    ds_read_b64_tr_b16 a[150:151], v30 offset:9024
    v_mfma_f32_16x16x32_bf16 a[64:67], a[180:183], a[196:199], a[64:67]
    buffer_load_dwordx4 v11, s[8:11], s24 offen offset:1024 lds
    v_mfma_f32_16x16x32_bf16 a[68:71], a[180:183], a[204:207], a[68:71]
    v_mfma_f32_16x16x32_bf16 a[68:71], a[176:179], a[200:203], a[68:71]
    ds_read_b64_tr_b16 a[152:153], v30 offset:96
    v_mfma_f32_16x16x32_bf16 a[72:75], a[176:179], a[208:211], a[72:75]
    ds_read_b64_tr_b16 a[154:155], v30 offset:1888
    v_mfma_f32_16x16x32_bf16 a[72:75], a[180:183], a[212:215], a[72:75]
    ds_read_b64_tr_b16 a[156:157], v30 offset:7264
    s_mov_b32 m0, s42
    v_mfma_f32_16x16x32_bf16 a[76:79], a[180:183], a[220:223], a[76:79]
    buffer_load_dwordx4 v12, s[8:11], s24 offen offset:0 lds
    v_mfma_f32_16x16x32_bf16 a[76:79], a[176:179], a[216:219], a[76:79]
    ds_read_b64_tr_b16 a[158:159], v30 offset:9056
    v_mfma_f32_16x16x32_bf16 a[108:111], a[184:187], a[216:219], a[108:111]
    v_mfma_f32_16x16x32_bf16 a[108:111], a[188:191], a[220:223], a[108:111]
    v_mfma_f32_16x16x32_bf16 a[104:107], a[188:191], a[212:215], a[104:107]
    v_mfma_f32_16x16x32_bf16 a[104:107], a[184:187], a[208:211], a[104:107]
    buffer_load_dwordx4 v13, s[8:11], s24 offen offset:1024 lds
    v_mfma_f32_16x16x32_bf16 a[100:103], a[184:187], a[200:203], a[100:103]
    v_mfma_f32_16x16x32_bf16 a[100:103], a[188:191], a[204:207], a[100:103]
    v_mfma_f32_16x16x32_bf16 a[96:99], a[188:191], a[196:199], a[96:99]
    v_mfma_f32_16x16x32_bf16 a[96:99], a[184:187], a[192:195], a[96:99]
    s_add_u32 m0, s42, 2048
    v_mfma_f32_16x16x32_bf16 a[16:19], a[160:163], a[224:227], a[16:19]
    buffer_load_dwordx4 v14, s[8:11], s24 offen offset:0 lds
    v_mfma_f32_16x16x32_bf16 a[16:19], a[164:167], a[228:231], a[16:19]
    ds_read_b128 a[192:195], v26 offset:0
    v_mfma_f32_16x16x32_bf16 a[20:23], a[164:167], a[236:239], a[20:23]
    ds_read_b128 a[196:199], v27 offset:0
    v_mfma_f32_16x16x32_bf16 a[20:23], a[160:163], a[232:235], a[20:23]
    v_mfma_f32_16x16x32_bf16 a[24:27], a[160:163], a[240:243], a[24:27]
    ds_read_b128 a[200:203], v26 offset:2048
    v_mfma_f32_16x16x32_bf16 a[24:27], a[164:167], a[244:247], a[24:27]
    buffer_load_dwordx4 v15, s[8:11], s24 offen offset:1024 lds
    v_mfma_f32_16x16x32_bf16 a[28:31], a[164:167], a[252:255], a[28:31]
    v_mfma_f32_16x16x32_bf16 a[28:31], a[160:163], a[248:251], a[28:31]
    ds_read_b128 a[204:207], v27 offset:2048
    v_mfma_f32_16x16x32_bf16 a[60:63], a[168:171], a[248:251], a[60:63]
    ds_read_b128 a[208:211], v26 offset:4096
    v_mfma_f32_16x16x32_bf16 a[60:63], a[172:175], a[252:255], a[60:63]
    s_mov_b32 m0, s43
    v_mfma_f32_16x16x32_bf16 a[56:59], a[172:175], a[244:247], a[56:59]
    buffer_load_dwordx4 v16, s[12:15], s25 offen offset:0 lds
    v_mfma_f32_16x16x32_bf16 a[56:59], a[168:171], a[240:243], a[56:59]
    ds_read_b128 a[212:215], v27 offset:4096
    v_mfma_f32_16x16x32_bf16 a[52:55], a[168:171], a[232:235], a[52:55]
    v_mfma_f32_16x16x32_bf16 a[52:55], a[172:175], a[236:239], a[52:55]
    ds_read_b128 a[216:219], v26 offset:6144
    v_mfma_f32_16x16x32_bf16 a[48:51], a[172:175], a[228:231], a[48:51]
    ds_read_b128 a[220:223], v27 offset:6144
    v_mfma_f32_16x16x32_bf16 a[48:51], a[168:171], a[224:227], a[48:51]
    buffer_load_dwordx4 v17, s[12:15], s25 offen offset:1024 lds
    v_mfma_f32_16x16x32_bf16 a[80:83], a[176:179], a[224:227], a[80:83]
    v_mfma_f32_16x16x32_bf16 a[80:83], a[180:183], a[228:231], a[80:83]
    v_mfma_f32_16x16x32_bf16 a[84:87], a[180:183], a[236:239], a[84:87]
    v_mfma_f32_16x16x32_bf16 a[84:87], a[176:179], a[232:235], a[84:87]
    v_mfma_f32_16x16x32_bf16 a[88:91], a[176:179], a[240:243], a[88:91]
    buffer_load_dwordx4 v18, s[12:15], s25 offen offset:2048 lds
    v_mfma_f32_16x16x32_bf16 a[88:91], a[180:183], a[244:247], a[88:91]
    v_mfma_f32_16x16x32_bf16 a[92:95], a[180:183], a[252:255], a[92:95]
    v_mfma_f32_16x16x32_bf16 a[92:95], a[176:179], a[248:251], a[92:95]
    v_mfma_f32_16x16x32_bf16 a[124:127], a[184:187], a[248:251], a[124:127]
    v_mfma_f32_16x16x32_bf16 a[124:127], a[188:191], a[252:255], a[124:127]
    buffer_load_dwordx4 v19, s[12:15], s25 offen offset:3072 lds
    v_mfma_f32_16x16x32_bf16 a[120:123], a[188:191], a[244:247], a[120:123]
    v_mfma_f32_16x16x32_bf16 a[120:123], a[184:187], a[240:243], a[120:123]
    v_mfma_f32_16x16x32_bf16 a[116:119], a[184:187], a[232:235], a[116:119]
    v_mfma_f32_16x16x32_bf16 a[116:119], a[188:191], a[236:239], a[116:119]
    s_mov_b32 m0, s44
    v_mfma_f32_16x16x32_bf16 a[112:115], a[188:191], a[228:231], a[112:115]
    buffer_load_dwordx4 v20, s[12:15], s25 offen offset:0 lds
    v_mfma_f32_16x16x32_bf16 a[112:115], a[184:187], a[224:227], a[112:115]
    s_waitcnt lgkmcnt(0)
    v_mfma_f32_16x16x32_bf16 v[128:131], a[128:131], a[192:195], v[128:131]
    ds_read_b128 a[224:227], v26 offset:8192
    v_mfma_f32_16x16x32_bf16 v[128:131], a[132:135], a[196:199], v[128:131]
    ds_read_b128 a[228:231], v27 offset:8192
    v_mfma_f32_16x16x32_bf16 v[132:135], a[132:135], a[204:207], v[132:135]
    v_mfma_f32_16x16x32_bf16 v[132:135], a[128:131], a[200:203], v[132:135]
    buffer_load_dwordx4 v21, s[12:15], s25 offen offset:1024 lds
    v_mfma_f32_16x16x32_bf16 v[136:139], a[128:131], a[208:211], v[136:139]
    ds_read_b128 a[232:235], v26 offset:10240
    v_mfma_f32_16x16x32_bf16 v[136:139], a[132:135], a[212:215], v[136:139]
    v_mfma_f32_16x16x32_bf16 v[140:143], a[132:135], a[220:223], v[140:143]
    ds_read_b128 a[236:239], v27 offset:10240
    v_mfma_f32_16x16x32_bf16 v[140:143], a[128:131], a[216:219], v[140:143]
    ds_read_b128 a[240:243], v26 offset:12288
    s_add_u32 m0, s44, 2048
    v_mfma_f32_16x16x32_bf16 v[172:175], a[136:139], a[216:219], v[172:175]
    buffer_load_dwordx4 v22, s[16:19], s26 offen offset:0 lds
    v_mfma_f32_16x16x32_bf16 v[172:175], a[140:143], a[220:223], v[172:175]
    v_mfma_f32_16x16x32_bf16 v[168:171], a[140:143], a[212:215], v[168:171]
    ds_read_b128 a[244:247], v27 offset:12288
    v_mfma_f32_16x16x32_bf16 v[168:171], a[136:139], a[208:211], v[168:171]
    v_mfma_f32_16x16x32_bf16 v[164:167], a[136:139], a[200:203], v[164:167]
    ds_read_b128 a[248:251], v26 offset:14336
    v_mfma_f32_16x16x32_bf16 v[164:167], a[140:143], a[204:207], v[164:167]
    buffer_load_dwordx4 v23, s[16:19], s26 offen offset:1024 lds
    v_mfma_f32_16x16x32_bf16 v[160:163], a[140:143], a[196:199], v[160:163]
    ds_read_b128 a[252:255], v27 offset:14336
    v_mfma_f32_16x16x32_bf16 v[160:163], a[136:139], a[192:195], v[160:163]
    v_mfma_f32_16x16x32_bf16 v[192:195], a[144:147], a[192:195], v[192:195]
    v_mfma_f32_16x16x32_bf16 v[192:195], a[148:151], a[196:199], v[192:195]
    v_mfma_f32_16x16x32_bf16 v[196:199], a[148:151], a[204:207], v[196:199]
    v_mfma_f32_16x16x32_bf16 v[196:199], a[144:147], a[200:203], v[196:199]
    v_mfma_f32_16x16x32_bf16 v[200:203], a[144:147], a[208:211], v[200:203]
    v_mfma_f32_16x16x32_bf16 v[200:203], a[148:151], a[212:215], v[200:203]
    v_mfma_f32_16x16x32_bf16 v[204:207], a[148:151], a[220:223], v[204:207]
    v_mfma_f32_16x16x32_bf16 v[204:207], a[144:147], a[216:219], v[204:207]
    v_mfma_f32_16x16x32_bf16 v[236:239], a[152:155], a[216:219], v[236:239]
    v_mfma_f32_16x16x32_bf16 v[236:239], a[156:159], a[220:223], v[236:239]
    v_mfma_f32_16x16x32_bf16 v[232:235], a[156:159], a[212:215], v[232:235]
    buffer_load_dword v124, v40, s[8:11], s24 offen offset:256
    v_mfma_f32_16x16x32_bf16 v[232:235], a[152:155], a[208:211], v[232:235]
    v_mfma_f32_16x16x32_bf16 v[228:231], a[152:155], a[200:203], v[228:231]
    v_mfma_f32_16x16x32_bf16 v[228:231], a[156:159], a[204:207], v[228:231]
    v_mfma_f32_16x16x32_bf16 v[224:227], a[156:159], a[196:199], v[224:227]
    v_mfma_f32_16x16x32_bf16 v[224:227], a[152:155], a[192:195], v[224:227]
    global_load_dword v127, v[122:123], off
    s_waitcnt lgkmcnt(0)
    v_mfma_f32_16x16x32_bf16 v[144:147], a[128:131], a[224:227], v[144:147]
    ds_read_b64_tr_b16 a[160:161], v30 offset:16384
    v_mfma_f32_16x16x32_bf16 v[144:147], a[132:135], a[228:231], v[144:147]
    ds_read_b64_tr_b16 a[162:163], v30 offset:18176
    v_mfma_f32_16x16x32_bf16 v[148:151], a[132:135], a[236:239], v[148:151]
    ds_read_b64_tr_b16 a[164:165], v30 offset:23552
    v_mfma_f32_16x16x32_bf16 v[148:151], a[128:131], a[232:235], v[148:151]
    ds_read_b64_tr_b16 a[166:167], v30 offset:25344
    v_mfma_f32_16x16x32_bf16 v[152:155], a[128:131], a[240:243], v[152:155]
    v_mfma_f32_16x16x32_bf16 v[152:155], a[132:135], a[244:247], v[152:155]
    ds_read_b64_tr_b16 a[168:169], v30 offset:16416
    v_mfma_f32_16x16x32_bf16 v[156:159], a[132:135], a[252:255], v[156:159]
    ds_read_b64_tr_b16 a[170:171], v30 offset:18208
    v_mfma_f32_16x16x32_bf16 v[156:159], a[128:131], a[248:251], v[156:159]
    ds_read_b64_tr_b16 a[172:173], v30 offset:23584
    v_mfma_f32_16x16x32_bf16 v[188:191], a[136:139], a[248:251], v[188:191]
    ds_read_b64_tr_b16 a[174:175], v30 offset:25376
    v_mfma_f32_16x16x32_bf16 v[188:191], a[140:143], a[252:255], v[188:191]
    v_mfma_f32_16x16x32_bf16 v[184:187], a[140:143], a[244:247], v[184:187]
    ds_read_b64_tr_b16 a[176:177], v30 offset:16448
    v_mfma_f32_16x16x32_bf16 v[184:187], a[136:139], a[240:243], v[184:187]
    ds_read_b64_tr_b16 a[178:179], v30 offset:18240
    v_mfma_f32_16x16x32_bf16 v[180:183], a[136:139], a[232:235], v[180:183]
    ds_read_b64_tr_b16 a[180:181], v30 offset:23616
    v_mfma_f32_16x16x32_bf16 v[180:183], a[140:143], a[236:239], v[180:183]
    ds_read_b64_tr_b16 a[182:183], v30 offset:25408
    v_mfma_f32_16x16x32_bf16 v[176:179], a[140:143], a[228:231], v[176:179]
    v_mfma_f32_16x16x32_bf16 v[176:179], a[136:139], a[224:227], v[176:179]
    ds_read_b64_tr_b16 a[184:185], v30 offset:16480
    v_mfma_f32_16x16x32_bf16 v[208:211], a[144:147], a[224:227], v[208:211]
    ds_read_b64_tr_b16 a[186:187], v30 offset:18272
    v_mfma_f32_16x16x32_bf16 v[208:211], a[148:151], a[228:231], v[208:211]
    ds_read_b64_tr_b16 a[188:189], v30 offset:23648
    v_mfma_f32_16x16x32_bf16 v[212:215], a[148:151], a[236:239], v[212:215]
    ds_read_b64_tr_b16 a[190:191], v30 offset:25440
    v_mfma_f32_16x16x32_bf16 v[212:215], a[144:147], a[232:235], v[212:215]
    v_mfma_f32_16x16x32_bf16 v[216:219], a[144:147], a[240:243], v[216:219]
    s_add_u32 s24, s24, 128
    v_mfma_f32_16x16x32_bf16 v[216:219], a[148:151], a[244:247], v[216:219]
    s_add_u32 s25, s25, 458752
    v_mfma_f32_16x16x32_bf16 v[220:223], a[148:151], a[252:255], v[220:223]
    s_add_u32 s26, s26, s27
    v_mfma_f32_16x16x32_bf16 v[220:223], a[144:147], a[248:251], v[220:223]
    s_add_u32 s33, s33, 4096
    v_mfma_f32_16x16x32_bf16 v[252:255], a[152:155], a[248:251], v[252:255]
    v_mfma_f32_16x16x32_bf16 v[252:255], a[156:159], a[252:255], v[252:255]
    v_mfma_f32_16x16x32_bf16 v[248:251], a[156:159], a[244:247], v[248:251]
    s_sub_u32 s32, s32, 1
    v_mfma_f32_16x16x32_bf16 v[248:251], a[152:155], a[240:243], v[248:251]
    s_cmp_lg_u32 s32, 0
    v_mfma_f32_16x16x32_bf16 v[244:247], a[152:155], a[232:235], v[244:247]
    v_mfma_f32_16x16x32_bf16 v[244:247], a[156:159], a[236:239], v[244:247]
    v_mfma_f32_16x16x32_bf16 v[240:243], a[156:159], a[228:231], v[240:243]
    v_mfma_f32_16x16x32_bf16 v[240:243], a[152:155], a[224:227], v[240:243]
    s_waitcnt vmcnt(2) lgkmcnt(0)
    s_barrier
    s_cbranch_scc1 K1_W0_LOOPB
    v_mfma_f32_16x16x32_bf16 a[16:19], a[160:163], a[224:227], a[16:19]
    ds_read_b64_tr_b16 a[128:129], v31 offset:0
    v_mfma_f32_16x16x32_bf16 a[16:19], a[164:167], a[228:231], a[16:19]
    ds_read_b64_tr_b16 a[130:131], v31 offset:1792
    v_mfma_f32_16x16x32_bf16 a[20:23], a[164:167], a[236:239], a[20:23]
    ds_read_b64_tr_b16 a[132:133], v31 offset:7168
    v_mfma_f32_16x16x32_bf16 a[20:23], a[160:163], a[232:235], a[20:23]
    ds_read_b64_tr_b16 a[134:135], v31 offset:8960
    v_mfma_f32_16x16x32_bf16 a[24:27], a[160:163], a[240:243], a[24:27]
    v_mfma_f32_16x16x32_bf16 a[24:27], a[164:167], a[244:247], a[24:27]
    ds_read_b64_tr_b16 a[136:137], v31 offset:32
    v_mfma_f32_16x16x32_bf16 a[28:31], a[164:167], a[252:255], a[28:31]
    ds_read_b64_tr_b16 a[138:139], v31 offset:1824
    v_mfma_f32_16x16x32_bf16 a[28:31], a[160:163], a[248:251], a[28:31]
    ds_read_b64_tr_b16 a[140:141], v31 offset:7200
    v_mfma_f32_16x16x32_bf16 a[60:63], a[168:171], a[248:251], a[60:63]
    ds_read_b64_tr_b16 a[142:143], v31 offset:8992
    v_mfma_f32_16x16x32_bf16 a[60:63], a[172:175], a[252:255], a[60:63]
    v_mfma_f32_16x16x32_bf16 a[56:59], a[172:175], a[244:247], a[56:59]
    ds_read_b64_tr_b16 a[144:145], v31 offset:64
    v_mfma_f32_16x16x32_bf16 a[56:59], a[168:171], a[240:243], a[56:59]
    ds_read_b64_tr_b16 a[146:147], v31 offset:1856
    v_mfma_f32_16x16x32_bf16 a[52:55], a[168:171], a[232:235], a[52:55]
    ds_read_b64_tr_b16 a[148:149], v31 offset:7232
    v_mfma_f32_16x16x32_bf16 a[52:55], a[172:175], a[236:239], a[52:55]
    ds_read_b64_tr_b16 a[150:151], v31 offset:9024
    v_mfma_f32_16x16x32_bf16 a[48:51], a[172:175], a[228:231], a[48:51]
    v_mfma_f32_16x16x32_bf16 a[48:51], a[168:171], a[224:227], a[48:51]
    ds_read_b64_tr_b16 a[152:153], v31 offset:96
    v_mfma_f32_16x16x32_bf16 a[80:83], a[176:179], a[224:227], a[80:83]
    ds_read_b64_tr_b16 a[154:155], v31 offset:1888
    v_mfma_f32_16x16x32_bf16 a[80:83], a[180:183], a[228:231], a[80:83]
    ds_read_b64_tr_b16 a[156:157], v31 offset:7264
    v_mfma_f32_16x16x32_bf16 a[84:87], a[180:183], a[236:239], a[84:87]
    ds_read_b64_tr_b16 a[158:159], v31 offset:9056
    v_mfma_f32_16x16x32_bf16 a[84:87], a[176:179], a[232:235], a[84:87]
    v_mfma_f32_16x16x32_bf16 a[88:91], a[176:179], a[240:243], a[88:91]
    v_mfma_f32_16x16x32_bf16 a[88:91], a[180:183], a[244:247], a[88:91]
    v_mfma_f32_16x16x32_bf16 a[92:95], a[180:183], a[252:255], a[92:95]
    v_mfma_f32_16x16x32_bf16 a[92:95], a[176:179], a[248:251], a[92:95]
    v_mfma_f32_16x16x32_bf16 a[124:127], a[184:187], a[248:251], a[124:127]
    v_mfma_f32_16x16x32_bf16 a[124:127], a[188:191], a[252:255], a[124:127]
    v_mfma_f32_16x16x32_bf16 a[120:123], a[188:191], a[244:247], a[120:123]
    v_mfma_f32_16x16x32_bf16 a[120:123], a[184:187], a[240:243], a[120:123]
    v_mfma_f32_16x16x32_bf16 a[116:119], a[184:187], a[232:235], a[116:119]
    v_mfma_f32_16x16x32_bf16 a[116:119], a[188:191], a[236:239], a[116:119]
    v_mfma_f32_16x16x32_bf16 a[112:115], a[188:191], a[228:231], a[112:115]
    v_mfma_f32_16x16x32_bf16 a[112:115], a[184:187], a[224:227], a[112:115]
    v_mfma_f32_16x16x32_bf16 a[0:3], a[160:163], a[192:195], a[0:3]
    ds_read_b128 a[224:227], v28 offset:8192
    v_mfma_f32_16x16x32_bf16 a[0:3], a[164:167], a[196:199], a[0:3]
    ds_read_b128 a[228:231], v29 offset:8192
    v_mfma_f32_16x16x32_bf16 a[4:7], a[164:167], a[204:207], a[4:7]
    v_mfma_f32_16x16x32_bf16 a[4:7], a[160:163], a[200:203], a[4:7]
    ds_read_b128 a[232:235], v28 offset:10240
    v_mfma_f32_16x16x32_bf16 a[8:11], a[160:163], a[208:211], a[8:11]
    v_mfma_f32_16x16x32_bf16 a[8:11], a[164:167], a[212:215], a[8:11]
    ds_read_b128 a[236:239], v29 offset:10240
    v_mfma_f32_16x16x32_bf16 a[12:15], a[164:167], a[220:223], a[12:15]
    ds_read_b128 a[240:243], v28 offset:12288
    v_mfma_f32_16x16x32_bf16 a[12:15], a[160:163], a[216:219], a[12:15]
    v_mfma_f32_16x16x32_bf16 a[44:47], a[168:171], a[216:219], a[44:47]
    ds_read_b128 a[244:247], v29 offset:12288
    v_mfma_f32_16x16x32_bf16 a[44:47], a[172:175], a[220:223], a[44:47]
    v_mfma_f32_16x16x32_bf16 a[40:43], a[172:175], a[212:215], a[40:43]
    ds_read_b128 a[248:251], v28 offset:14336
    v_mfma_f32_16x16x32_bf16 a[40:43], a[168:171], a[208:211], a[40:43]
    ds_read_b128 a[252:255], v29 offset:14336
    v_mfma_f32_16x16x32_bf16 a[36:39], a[168:171], a[200:203], a[36:39]
    v_mfma_f32_16x16x32_bf16 a[36:39], a[172:175], a[204:207], a[36:39]
    v_mfma_f32_16x16x32_bf16 a[32:35], a[172:175], a[196:199], a[32:35]
    v_mfma_f32_16x16x32_bf16 a[32:35], a[168:171], a[192:195], a[32:35]
    v_mfma_f32_16x16x32_bf16 a[64:67], a[176:179], a[192:195], a[64:67]
    v_mfma_f32_16x16x32_bf16 a[64:67], a[180:183], a[196:199], a[64:67]
    v_mfma_f32_16x16x32_bf16 a[68:71], a[180:183], a[204:207], a[68:71]
    v_mfma_f32_16x16x32_bf16 a[68:71], a[176:179], a[200:203], a[68:71]
    v_mfma_f32_16x16x32_bf16 a[72:75], a[176:179], a[208:211], a[72:75]
    v_mfma_f32_16x16x32_bf16 a[72:75], a[180:183], a[212:215], a[72:75]
    v_mfma_f32_16x16x32_bf16 a[76:79], a[180:183], a[220:223], a[76:79]
    v_mfma_f32_16x16x32_bf16 a[76:79], a[176:179], a[216:219], a[76:79]
    v_mfma_f32_16x16x32_bf16 a[108:111], a[184:187], a[216:219], a[108:111]
    v_mfma_f32_16x16x32_bf16 a[108:111], a[188:191], a[220:223], a[108:111]
    v_mfma_f32_16x16x32_bf16 a[104:107], a[188:191], a[212:215], a[104:107]
    v_mfma_f32_16x16x32_bf16 a[104:107], a[184:187], a[208:211], a[104:107]
    v_mfma_f32_16x16x32_bf16 a[100:103], a[184:187], a[200:203], a[100:103]
    v_mfma_f32_16x16x32_bf16 a[100:103], a[188:191], a[204:207], a[100:103]
    v_mfma_f32_16x16x32_bf16 a[96:99], a[188:191], a[196:199], a[96:99]
    v_mfma_f32_16x16x32_bf16 a[96:99], a[184:187], a[192:195], a[96:99]
    s_waitcnt lgkmcnt(0)
    v_mfma_f32_16x16x32_bf16 v[144:147], a[128:131], a[224:227], v[144:147]
    ds_read_b128 a[192:195], v28 offset:0
    s_lshr_b32 s3, s28, 1
    v_mfma_f32_16x16x32_bf16 v[144:147], a[132:135], a[228:231], v[144:147]
    ds_read_b128 a[196:199], v29 offset:0
    s_lshl_b32 s4, s29, 1
    v_mfma_f32_16x16x32_bf16 v[148:151], a[132:135], a[236:239], v[148:151]
    s_add_u32 s3, s3, s4
    v_mfma_f32_16x16x32_bf16 v[148:151], a[128:131], a[232:235], v[148:151]
    ds_read_b128 a[200:203], v28 offset:2048
    s_lshl_b32 s85, s3, 3
    v_mfma_f32_16x16x32_bf16 v[152:155], a[128:131], a[240:243], v[152:155]
    s_lshl_b32 s3, s3, 2
    v_mfma_f32_16x16x32_bf16 v[152:155], a[132:135], a[244:247], v[152:155]
    ds_read_b128 a[204:207], v29 offset:2048
    s_lshr_b32 s4, s31, 1
    v_mfma_f32_16x16x32_bf16 v[156:159], a[132:135], a[252:255], v[156:159]
    ds_read_b128 a[208:211], v28 offset:4096
    s_add_u32 s3, s3, s4
    v_mfma_f32_16x16x32_bf16 v[156:159], a[128:131], a[248:251], v[156:159]
    s_lshl_b32 s3, s3, 12
    v_mfma_f32_16x16x32_bf16 v[188:191], a[136:139], a[248:251], v[188:191]
    ds_read_b128 a[212:215], v29 offset:4096
    s_and_b32 s4, s31, 1
    v_mfma_f32_16x16x32_bf16 v[188:191], a[140:143], a[252:255], v[188:191]
    s_and_b32 s5, s30, 1
    v_mfma_f32_16x16x32_bf16 v[184:187], a[140:143], a[244:247], v[184:187]
    ds_read_b128 a[216:219], v28 offset:6144
    s_lshl_b32 s4, s4, 7
    v_mfma_f32_16x16x32_bf16 v[184:187], a[136:139], a[240:243], v[184:187]
    ds_read_b128 a[220:223], v29 offset:6144
    s_lshl_b32 s6, s5, 3
    v_mfma_f32_16x16x32_bf16 v[180:183], a[136:139], a[232:235], v[180:183]
    s_add_u32 s3, s3, s4
    v_mfma_f32_16x16x32_bf16 v[180:183], a[140:143], a[236:239], v[180:183]
    s_add_u32 s3, s3, s6
    v_mfma_f32_16x16x32_bf16 v[176:179], a[140:143], a[228:231], v[176:179]
    s_add_u32 s3, s3, 23068672
    v_mfma_f32_16x16x32_bf16 v[176:179], a[136:139], a[224:227], v[176:179]
    s_cmp_ge_u32 s30, 16
    v_mfma_f32_16x16x32_bf16 v[208:211], a[144:147], a[224:227], v[208:211]
    s_cselect_b32 s3, 2147418112, s3
    v_mfma_f32_16x16x32_bf16 v[208:211], a[148:151], a[228:231], v[208:211]
    v_mfma_f32_16x16x32_bf16 v[212:215], a[148:151], a[236:239], v[212:215]
    v_mfma_f32_16x16x32_bf16 v[212:215], a[144:147], a[232:235], v[212:215]
    v_mfma_f32_16x16x32_bf16 v[216:219], a[144:147], a[240:243], v[216:219]
    v_mfma_f32_16x16x32_bf16 v[216:219], a[148:151], a[244:247], v[216:219]
    v_mfma_f32_16x16x32_bf16 v[220:223], a[148:151], a[252:255], v[220:223]
    v_mfma_f32_16x16x32_bf16 v[220:223], a[144:147], a[248:251], v[220:223]
    v_mfma_f32_16x16x32_bf16 v[252:255], a[152:155], a[248:251], v[252:255]
    v_mfma_f32_16x16x32_bf16 v[252:255], a[156:159], a[252:255], v[252:255]
    v_mfma_f32_16x16x32_bf16 v[248:251], a[156:159], a[244:247], v[248:251]
    v_mfma_f32_16x16x32_bf16 v[248:251], a[152:155], a[240:243], v[248:251]
    v_mfma_f32_16x16x32_bf16 v[244:247], a[152:155], a[232:235], v[244:247]
    v_mfma_f32_16x16x32_bf16 v[244:247], a[156:159], a[236:239], v[244:247]
    v_mfma_f32_16x16x32_bf16 v[240:243], a[156:159], a[228:231], v[240:243]
    v_mfma_f32_16x16x32_bf16 v[240:243], a[152:155], a[224:227], v[240:243]
    s_waitcnt lgkmcnt(0)
    v_mfma_f32_16x16x32_bf16 v[128:131], a[128:131], a[192:195], v[128:131]
    ds_read_b64_tr_b16 a[160:161], v31 offset:16384
    v_mfma_f32_16x16x32_bf16 v[128:131], a[132:135], a[196:199], v[128:131]
    ds_read_b64_tr_b16 a[162:163], v31 offset:18176
    v_mfma_f32_16x16x32_bf16 v[132:135], a[132:135], a[204:207], v[132:135]
    ds_read_b64_tr_b16 a[164:165], v31 offset:23552
    v_mfma_f32_16x16x32_bf16 v[132:135], a[128:131], a[200:203], v[132:135]
    ds_read_b64_tr_b16 a[166:167], v31 offset:25344
    v_mfma_f32_16x16x32_bf16 v[136:139], a[128:131], a[208:211], v[136:139]
    v_mfma_f32_16x16x32_bf16 v[136:139], a[132:135], a[212:215], v[136:139]
    ds_read_b64_tr_b16 a[168:169], v31 offset:16416
    v_mfma_f32_16x16x32_bf16 v[140:143], a[132:135], a[220:223], v[140:143]
    ds_read_b64_tr_b16 a[170:171], v31 offset:18208
    v_mfma_f32_16x16x32_bf16 v[140:143], a[128:131], a[216:219], v[140:143]
    ds_read_b64_tr_b16 a[172:173], v31 offset:23584
    v_mfma_f32_16x16x32_bf16 v[172:175], a[136:139], a[216:219], v[172:175]
    ds_read_b64_tr_b16 a[174:175], v31 offset:25376
    v_mfma_f32_16x16x32_bf16 v[172:175], a[140:143], a[220:223], v[172:175]
    v_mfma_f32_16x16x32_bf16 v[168:171], a[140:143], a[212:215], v[168:171]
    ds_read_b64_tr_b16 a[176:177], v31 offset:16448
    v_mfma_f32_16x16x32_bf16 v[168:171], a[136:139], a[208:211], v[168:171]
    ds_read_b64_tr_b16 a[178:179], v31 offset:18240
    v_mfma_f32_16x16x32_bf16 v[164:167], a[136:139], a[200:203], v[164:167]
    ds_read_b64_tr_b16 a[180:181], v31 offset:23616
    v_mfma_f32_16x16x32_bf16 v[164:167], a[140:143], a[204:207], v[164:167]
    ds_read_b64_tr_b16 a[182:183], v31 offset:25408
    v_mfma_f32_16x16x32_bf16 v[160:163], a[140:143], a[196:199], v[160:163]
    v_mfma_f32_16x16x32_bf16 v[160:163], a[136:139], a[192:195], v[160:163]
    ds_read_b64_tr_b16 a[184:185], v31 offset:16480
    v_mfma_f32_16x16x32_bf16 v[192:195], a[144:147], a[192:195], v[192:195]
    ds_read_b64_tr_b16 a[186:187], v31 offset:18272
    v_mfma_f32_16x16x32_bf16 v[192:195], a[148:151], a[196:199], v[192:195]
    ds_read_b64_tr_b16 a[188:189], v31 offset:23648
    v_mfma_f32_16x16x32_bf16 v[196:199], a[148:151], a[204:207], v[196:199]
    ds_read_b64_tr_b16 a[190:191], v31 offset:25440
    v_mfma_f32_16x16x32_bf16 v[196:199], a[144:147], a[200:203], v[196:199]
    v_mfma_f32_16x16x32_bf16 v[200:203], a[144:147], a[208:211], v[200:203]
    v_mfma_f32_16x16x32_bf16 v[200:203], a[148:151], a[212:215], v[200:203]
    v_mfma_f32_16x16x32_bf16 v[204:207], a[148:151], a[220:223], v[204:207]
    v_mfma_f32_16x16x32_bf16 v[204:207], a[144:147], a[216:219], v[204:207]
    v_mfma_f32_16x16x32_bf16 v[236:239], a[152:155], a[216:219], v[236:239]
    v_mfma_f32_16x16x32_bf16 v[236:239], a[156:159], a[220:223], v[236:239]
    v_mfma_f32_16x16x32_bf16 v[232:235], a[156:159], a[212:215], v[232:235]
    v_mfma_f32_16x16x32_bf16 v[232:235], a[152:155], a[208:211], v[232:235]
    v_mfma_f32_16x16x32_bf16 v[228:231], a[152:155], a[200:203], v[228:231]
    v_mfma_f32_16x16x32_bf16 v[228:231], a[156:159], a[204:207], v[228:231]
    v_mfma_f32_16x16x32_bf16 v[224:227], a[156:159], a[196:199], v[224:227]
    v_mfma_f32_16x16x32_bf16 v[224:227], a[152:155], a[192:195], v[224:227]
    s_waitcnt lgkmcnt(0)
    s_branch K1_W0_TAIL
.p2align 6
K1_W1_LOOPB:
    v_mfma_f32_16x16x32_bf16 a[16:19], a[160:163], a[224:227], a[16:19]
    ds_read_b64_tr_b16 a[128:129], v31 offset:0
    v_mfma_f32_16x16x32_bf16 a[16:19], a[164:167], a[228:231], a[16:19]
    ds_read_b64_tr_b16 a[130:131], v31 offset:1792
    v_mfma_f32_16x16x32_bf16 a[20:23], a[164:167], a[236:239], a[20:23]
    ds_read_b64_tr_b16 a[132:133], v31 offset:7168
    v_mfma_f32_16x16x32_bf16 a[20:23], a[160:163], a[232:235], a[20:23]
    ds_read_b64_tr_b16 a[134:135], v31 offset:8960
    v_mfma_f32_16x16x32_bf16 a[24:27], a[160:163], a[240:243], a[24:27]
    s_mov_b32 m0, s36
    v_mfma_f32_16x16x32_bf16 a[24:27], a[164:167], a[244:247], a[24:27]
    buffer_load_dwordx4 v8, s[8:11], s24 offen offset:0 lds
    v_mfma_f32_16x16x32_bf16 a[28:31], a[164:167], a[252:255], a[28:31]
    ds_read_b64_tr_b16 a[136:137], v31 offset:32
    v_mfma_f32_16x16x32_bf16 a[28:31], a[160:163], a[248:251], a[28:31]
    ds_read_b64_tr_b16 a[138:139], v31 offset:1824
    v_mfma_f32_16x16x32_bf16 a[60:63], a[168:171], a[248:251], a[60:63]
    ds_read_b64_tr_b16 a[140:141], v31 offset:7200
    v_mfma_f32_16x16x32_bf16 a[60:63], a[172:175], a[252:255], a[60:63]
    ds_read_b64_tr_b16 a[142:143], v31 offset:8992
    v_mfma_f32_16x16x32_bf16 a[56:59], a[172:175], a[244:247], a[56:59]
    buffer_load_dwordx4 v9, s[8:11], s24 offen offset:1024 lds
    v_mfma_f32_16x16x32_bf16 a[56:59], a[168:171], a[240:243], a[56:59]
    v_mfma_f32_16x16x32_bf16 a[52:55], a[168:171], a[232:235], a[52:55]
    ds_read_b64_tr_b16 a[144:145], v33 offset:0
    v_mfma_f32_16x16x32_bf16 a[52:55], a[172:175], a[236:239], a[52:55]
    ds_read_b64_tr_b16 a[146:147], v33 offset:1792
    v_mfma_f32_16x16x32_bf16 a[48:51], a[172:175], a[228:231], a[48:51]
    ds_read_b64_tr_b16 a[148:149], v33 offset:7168
    s_add_u32 m0, s36, 2048
    v_mfma_f32_16x16x32_bf16 a[48:51], a[168:171], a[224:227], a[48:51]
    buffer_load_dwordx4 v10, s[8:11], s24 offen offset:0 lds
    v_mfma_f32_16x16x32_bf16 a[80:83], a[176:179], a[224:227], a[80:83]
    ds_read_b64_tr_b16 a[150:151], v33 offset:8960
    v_mfma_f32_16x16x32_bf16 a[80:83], a[180:183], a[228:231], a[80:83]
    v_mfma_f32_16x16x32_bf16 a[84:87], a[180:183], a[236:239], a[84:87]
    ds_read_b64_tr_b16 a[152:153], v35 offset:0
    v_mfma_f32_16x16x32_bf16 a[84:87], a[176:179], a[232:235], a[84:87]
    ds_read_b64_tr_b16 a[154:155], v35 offset:256
    v_mfma_f32_16x16x32_bf16 a[88:91], a[176:179], a[240:243], a[88:91]
    buffer_load_dwordx4 v11, s[8:11], s24 offen offset:1024 lds
    v_mfma_f32_16x16x32_bf16 a[88:91], a[180:183], a[244:247], a[88:91]
    ds_read_b64_tr_b16 a[156:157], v35 offset:16384
    v_mfma_f32_16x16x32_bf16 a[92:95], a[180:183], a[252:255], a[92:95]
    ds_read_b64_tr_b16 a[158:159], v35 offset:16640
    v_mfma_f32_16x16x32_bf16 a[92:95], a[176:179], a[248:251], a[92:95]
    v_mfma_f32_16x16x32_bf16 a[124:127], a[184:187], a[248:251], a[124:127]
    s_mov_b32 m0, s37
    v_mfma_f32_16x16x32_bf16 a[124:127], a[188:191], a[252:255], a[124:127]
    buffer_load_dwordx4 v12, s[8:11], s24 offen offset:0 lds
    v_mfma_f32_16x16x32_bf16 a[120:123], a[188:191], a[244:247], a[120:123]
    v_mfma_f32_16x16x32_bf16 a[120:123], a[184:187], a[240:243], a[120:123]
    v_mfma_f32_16x16x32_bf16 a[116:119], a[184:187], a[232:235], a[116:119]
    v_mfma_f32_16x16x32_bf16 a[116:119], a[188:191], a[236:239], a[116:119]
    v_mfma_f32_16x16x32_bf16 a[112:115], a[188:191], a[228:231], a[112:115]
    buffer_load_dwordx4 v13, s[8:11], s24 offen offset:1024 lds
    v_mfma_f32_16x16x32_bf16 a[112:115], a[184:187], a[224:227], a[112:115]
    v_mfma_f32_16x16x32_bf16 a[0:3], a[160:163], a[192:195], a[0:3]
    ds_read_b128 a[224:227], v28 offset:8192
    v_mfma_f32_16x16x32_bf16 a[0:3], a[164:167], a[196:199], a[0:3]
    ds_read_b128 a[228:231], v29 offset:8192
    v_mfma_f32_16x16x32_bf16 a[4:7], a[164:167], a[204:207], a[4:7]
    s_add_u32 m0, s37, 2048
    v_mfma_f32_16x16x32_bf16 a[4:7], a[160:163], a[200:203], a[4:7]
    buffer_load_dwordx4 v14, s[8:11], s24 offen offset:0 lds
    v_mfma_f32_16x16x32_bf16 a[8:11], a[160:163], a[208:211], a[8:11]
    ds_read_b128 a[232:235], v28 offset:10240
    v_mfma_f32_16x16x32_bf16 a[8:11], a[164:167], a[212:215], a[8:11]
    v_mfma_f32_16x16x32_bf16 a[12:15], a[164:167], a[220:223], a[12:15]
    ds_read_b128 a[236:239], v29 offset:10240
    v_mfma_f32_16x16x32_bf16 a[12:15], a[160:163], a[216:219], a[12:15]
    ds_read_b128 a[240:243], v28 offset:12288
    v_mfma_f32_16x16x32_bf16 a[44:47], a[168:171], a[216:219], a[44:47]
    buffer_load_dwordx4 v15, s[8:11], s24 offen offset:1024 lds
    v_mfma_f32_16x16x32_bf16 a[44:47], a[172:175], a[220:223], a[44:47]
    v_mfma_f32_16x16x32_bf16 a[40:43], a[172:175], a[212:215], a[40:43]
    ds_read_b128 a[244:247], v29 offset:12288
    v_mfma_f32_16x16x32_bf16 a[40:43], a[168:171], a[208:211], a[40:43]
    v_mfma_f32_16x16x32_bf16 a[36:39], a[168:171], a[200:203], a[36:39]
    ds_read_b128 a[248:251], v28 offset:14336
    s_mov_b32 m0, s38
    v_mfma_f32_16x16x32_bf16 a[36:39], a[172:175], a[204:207], a[36:39]
    buffer_load_dwordx4 v16, s[12:15], s25 offen offset:0 lds
    v_mfma_f32_16x16x32_bf16 a[32:35], a[172:175], a[196:199], a[32:35]
    ds_read_b128 a[252:255], v29 offset:14336
    v_mfma_f32_16x16x32_bf16 a[32:35], a[168:171], a[192:195], a[32:35]
    v_mfma_f32_16x16x32_bf16 a[64:67], a[176:179], a[192:195], a[64:67]
    v_mfma_f32_16x16x32_bf16 a[64:67], a[180:183], a[196:199], a[64:67]
    v_mfma_f32_16x16x32_bf16 a[68:71], a[180:183], a[204:207], a[68:71]
    buffer_load_dwordx4 v17, s[12:15], s25 offen offset:1024 lds
    v_mfma_f32_16x16x32_bf16 a[68:71], a[176:179], a[200:203], a[68:71]
    v_mfma_f32_16x16x32_bf16 a[72:75], a[176:179], a[208:211], a[72:75]
    v_mfma_f32_16x16x32_bf16 a[72:75], a[180:183], a[212:215], a[72:75]
    v_mfma_f32_16x16x32_bf16 a[76:79], a[180:183], a[220:223], a[76:79]
    v_mfma_f32_16x16x32_bf16 a[76:79], a[176:179], a[216:219], a[76:79]
    buffer_load_dwordx4 v18, s[12:15], s25 offen offset:2048 lds
    v_mfma_f32_16x16x32_bf16 a[108:111], a[184:187], a[216:219], a[108:111]
    v_mfma_f32_16x16x32_bf16 a[108:111], a[188:191], a[220:223], a[108:111]
    v_mfma_f32_16x16x32_bf16 a[104:107], a[188:191], a[212:215], a[104:107]
    v_mfma_f32_16x16x32_bf16 a[104:107], a[184:187], a[208:211], a[104:107]
    v_mfma_f32_16x16x32_bf16 a[100:103], a[184:187], a[200:203], a[100:103]
    buffer_load_dwordx4 v19, s[12:15], s25 offen offset:3072 lds
    v_mfma_f32_16x16x32_bf16 a[100:103], a[188:191], a[204:207], a[100:103]
    v_mfma_f32_16x16x32_bf16 a[96:99], a[188:191], a[196:199], a[96:99]
    v_mfma_f32_16x16x32_bf16 a[96:99], a[184:187], a[192:195], a[96:99]
    s_waitcnt lgkmcnt(0)
    v_mfma_f32_16x16x32_bf16 v[144:147], a[128:131], a[224:227], v[144:147]
    ds_read_b128 a[192:195], v28 offset:0
    s_mov_b32 m0, s39
    v_mfma_f32_16x16x32_bf16 v[144:147], a[132:135], a[228:231], v[144:147]
    buffer_load_dwordx4 v20, s[12:15], s25 offen offset:0 lds
    v_mfma_f32_16x16x32_bf16 v[148:151], a[132:135], a[236:239], v[148:151]
    ds_read_b128 a[196:199], v29 offset:0
    v_mfma_f32_16x16x32_bf16 v[148:151], a[128:131], a[232:235], v[148:151]
    v_mfma_f32_16x16x32_bf16 v[152:155], a[128:131], a[240:243], v[152:155]
    ds_read_b128 a[200:203], v28 offset:2048
    v_mfma_f32_16x16x32_bf16 v[152:155], a[132:135], a[244:247], v[152:155]
    v_mfma_f32_16x16x32_bf16 v[156:159], a[132:135], a[252:255], v[156:159]
    buffer_load_dwordx4 v21, s[12:15], s25 offen offset:1024 lds
    v_mfma_f32_16x16x32_bf16 v[156:159], a[128:131], a[248:251], v[156:159]
    ds_read_b128 a[204:207], v29 offset:2048
    v_mfma_f32_16x16x32_bf16 v[188:191], a[136:139], a[248:251], v[188:191]
    ds_read_b128 a[208:211], v28 offset:4096
    v_mfma_f32_16x16x32_bf16 v[188:191], a[140:143], a[252:255], v[188:191]
    v_mfma_f32_16x16x32_bf16 v[184:187], a[140:143], a[244:247], v[184:187]
    ds_read_b128 a[212:215], v29 offset:4096
    s_add_u32 m0, s39, 2048
    v_mfma_f32_16x16x32_bf16 v[184:187], a[136:139], a[240:243], v[184:187]
    buffer_load_dwordx4 v22, s[16:19], s26 offen offset:0 lds
    v_mfma_f32_16x16x32_bf16 v[180:183], a[136:139], a[232:235], v[180:183]
    v_mfma_f32_16x16x32_bf16 v[180:183], a[140:143], a[236:239], v[180:183]
    ds_read_b128 a[216:219], v28 offset:6144
    v_mfma_f32_16x16x32_bf16 v[176:179], a[140:143], a[228:231], v[176:179]
    ds_read_b128 a[220:223], v29 offset:6144
    v_mfma_f32_16x16x32_bf16 v[176:179], a[136:139], a[224:227], v[176:179]
    v_mfma_f32_16x16x32_bf16 v[208:211], a[144:147], a[224:227], v[208:211]
    buffer_load_dwordx4 v23, s[16:19], s26 offen offset:1024 lds
    v_mfma_f32_16x16x32_bf16 v[208:211], a[148:151], a[228:231], v[208:211]
    v_mfma_f32_16x16x32_bf16 v[212:215], a[148:151], a[236:239], v[212:215]
    v_mfma_f32_16x16x32_bf16 v[212:215], a[144:147], a[232:235], v[212:215]
    v_mfma_f32_16x16x32_bf16 v[216:219], a[144:147], a[240:243], v[216:219]
    v_mfma_f32_16x16x32_bf16 v[216:219], a[148:151], a[244:247], v[216:219]
    v_mfma_f32_16x16x32_bf16 v[220:223], a[148:151], a[252:255], v[220:223]
    v_mfma_f32_16x16x32_bf16 v[220:223], a[144:147], a[248:251], v[220:223]
    v_mfma_f32_16x16x32_bf16 v[252:255], a[152:155], a[248:251], v[252:255]
    v_mfma_f32_16x16x32_bf16 v[252:255], a[156:159], a[252:255], v[252:255]
    v_mfma_f32_16x16x32_bf16 v[248:251], a[156:159], a[244:247], v[248:251]
    v_mfma_f32_16x16x32_bf16 v[248:251], a[152:155], a[240:243], v[248:251]
    v_mfma_f32_16x16x32_bf16 v[244:247], a[152:155], a[232:235], v[244:247]
    v_mfma_f32_16x16x32_bf16 v[244:247], a[156:159], a[236:239], v[244:247]
    buffer_load_dword v125, v41, s[12:15], s25 offen
    v_mfma_f32_16x16x32_bf16 v[240:243], a[156:159], a[228:231], v[240:243]
    v_mfma_f32_16x16x32_bf16 v[240:243], a[152:155], a[224:227], v[240:243]
    s_waitcnt lgkmcnt(0)
    v_mfma_f32_16x16x32_bf16 v[128:131], a[128:131], a[192:195], v[128:131]
    ds_read_b64_tr_b16 a[160:161], v31 offset:16384
    v_mfma_f32_16x16x32_bf16 v[128:131], a[132:135], a[196:199], v[128:131]
    ds_read_b64_tr_b16 a[162:163], v31 offset:18176
    v_mfma_f32_16x16x32_bf16 v[132:135], a[132:135], a[204:207], v[132:135]
    buffer_load_dword v126, v42, s[16:19], s26 offen
    v_mfma_f32_16x16x32_bf16 v[132:135], a[128:131], a[200:203], v[132:135]
    ds_read_b64_tr_b16 a[164:165], v31 offset:23552
    v_mfma_f32_16x16x32_bf16 v[136:139], a[128:131], a[208:211], v[136:139]
    ds_read_b64_tr_b16 a[166:167], v31 offset:25344
    v_mfma_f32_16x16x32_bf16 v[136:139], a[132:135], a[212:215], v[136:139]
    v_mfma_f32_16x16x32_bf16 v[140:143], a[132:135], a[220:223], v[140:143]
    ds_read_b64_tr_b16 a[168:169], v31 offset:16416
    v_mfma_f32_16x16x32_bf16 v[140:143], a[128:131], a[216:219], v[140:143]
    ds_read_b64_tr_b16 a[170:171], v31 offset:18208
    v_mfma_f32_16x16x32_bf16 v[172:175], a[136:139], a[216:219], v[172:175]
    ds_read_b64_tr_b16 a[172:173], v31 offset:23584
    v_mfma_f32_16x16x32_bf16 v[172:175], a[140:143], a[220:223], v[172:175]
    ds_read_b64_tr_b16 a[174:175], v31 offset:25376
    v_mfma_f32_16x16x32_bf16 v[168:171], a[140:143], a[212:215], v[168:171]
    v_mfma_f32_16x16x32_bf16 v[168:171], a[136:139], a[208:211], v[168:171]
    ds_read_b64_tr_b16 a[176:177], v33 offset:16384
    v_mfma_f32_16x16x32_bf16 v[164:167], a[136:139], a[200:203], v[164:167]
    ds_read_b64_tr_b16 a[178:179], v33 offset:18176
    v_mfma_f32_16x16x32_bf16 v[164:167], a[140:143], a[204:207], v[164:167]
    ds_read_b64_tr_b16 a[180:181], v33 offset:23552
    v_mfma_f32_16x16x32_bf16 v[160:163], a[140:143], a[196:199], v[160:163]
    ds_read_b64_tr_b16 a[182:183], v33 offset:25344
    v_mfma_f32_16x16x32_bf16 v[160:163], a[136:139], a[192:195], v[160:163]
    v_mfma_f32_16x16x32_bf16 v[192:195], a[144:147], a[192:195], v[192:195]
    ds_read_b64_tr_b16 a[184:185], v37 offset:0
    v_mfma_f32_16x16x32_bf16 v[192:195], a[148:151], a[196:199], v[192:195]
    ds_read_b64_tr_b16 a[186:187], v37 offset:256
    v_mfma_f32_16x16x32_bf16 v[196:199], a[148:151], a[204:207], v[196:199]
    ds_read_b64_tr_b16 a[188:189], v37 offset:16384
    v_mfma_f32_16x16x32_bf16 v[196:199], a[144:147], a[200:203], v[196:199]
    ds_read_b64_tr_b16 a[190:191], v37 offset:16640
    v_mfma_f32_16x16x32_bf16 v[200:203], a[144:147], a[208:211], v[200:203]
    s_add_u32 s24, s24, 128
    v_mfma_f32_16x16x32_bf16 v[200:203], a[148:151], a[212:215], v[200:203]
    s_add_u32 s25, s25, 458752
    v_mfma_f32_16x16x32_bf16 v[204:207], a[148:151], a[220:223], v[204:207]
    s_add_u32 s26, s26, s27
    v_mfma_f32_16x16x32_bf16 v[204:207], a[144:147], a[216:219], v[204:207]
    s_add_u32 s33, s33, 4096
    v_mfma_f32_16x16x32_bf16 v[236:239], a[152:155], a[216:219], v[236:239]
    v_mfma_f32_16x16x32_bf16 v[236:239], a[156:159], a[220:223], v[236:239]
    v_mfma_f32_16x16x32_bf16 v[232:235], a[156:159], a[212:215], v[232:235]
    v_mfma_f32_16x16x32_bf16 v[232:235], a[152:155], a[208:211], v[232:235]
    v_mfma_f32_16x16x32_bf16 v[228:231], a[152:155], a[200:203], v[228:231]
    v_mfma_f32_16x16x32_bf16 v[228:231], a[156:159], a[204:207], v[228:231]
    v_mfma_f32_16x16x32_bf16 v[224:227], a[156:159], a[196:199], v[224:227]
    v_mfma_f32_16x16x32_bf16 v[224:227], a[152:155], a[192:195], v[224:227]
    s_waitcnt vmcnt(2) lgkmcnt(0)
    s_barrier
    v_mfma_f32_16x16x32_bf16 a[0:3], a[160:163], a[192:195], a[0:3]
    ds_read_b64_tr_b16 a[128:129], v30 offset:0
    v_mfma_f32_16x16x32_bf16 a[0:3], a[164:167], a[196:199], a[0:3]
    ds_read_b64_tr_b16 a[130:131], v30 offset:1792
    v_mfma_f32_16x16x32_bf16 a[4:7], a[164:167], a[204:207], a[4:7]
    ds_read_b64_tr_b16 a[132:133], v30 offset:7168
    v_mfma_f32_16x16x32_bf16 a[4:7], a[160:163], a[200:203], a[4:7]
    ds_read_b64_tr_b16 a[134:135], v30 offset:8960
    v_mfma_f32_16x16x32_bf16 a[8:11], a[160:163], a[208:211], a[8:11]
    s_mov_b32 m0, s41
    v_mfma_f32_16x16x32_bf16 a[8:11], a[164:167], a[212:215], a[8:11]
    buffer_load_dwordx4 v8, s[8:11], s24 offen offset:0 lds
    v_mfma_f32_16x16x32_bf16 a[12:15], a[164:167], a[220:223], a[12:15]
    ds_read_b64_tr_b16 a[136:137], v30 offset:32
    v_mfma_f32_16x16x32_bf16 a[12:15], a[160:163], a[216:219], a[12:15]
    ds_read_b64_tr_b16 a[138:139], v30 offset:1824
    v_mfma_f32_16x16x32_bf16 a[44:47], a[168:171], a[216:219], a[44:47]
    ds_read_b64_tr_b16 a[140:141], v30 offset:7200
    v_mfma_f32_16x16x32_bf16 a[44:47], a[172:175], a[220:223], a[44:47]
    ds_read_b64_tr_b16 a[142:143], v30 offset:8992
    v_mfma_f32_16x16x32_bf16 a[40:43], a[172:175], a[212:215], a[40:43]
    buffer_load_dwordx4 v9, s[8:11], s24 offen offset:1024 lds
    v_mfma_f32_16x16x32_bf16 a[40:43], a[168:171], a[208:211], a[40:43]
    v_mfma_f32_16x16x32_bf16 a[36:39], a[168:171], a[200:203], a[36:39]
    ds_read_b64_tr_b16 a[144:145], v32 offset:0
    v_mfma_f32_16x16x32_bf16 a[36:39], a[172:175], a[204:207], a[36:39]
    ds_read_b64_tr_b16 a[146:147], v32 offset:1792
    v_mfma_f32_16x16x32_bf16 a[32:35], a[172:175], a[196:199], a[32:35]
    ds_read_b64_tr_b16 a[148:149], v32 offset:7168
    s_add_u32 m0, s41, 2048
    v_mfma_f32_16x16x32_bf16 a[32:35], a[168:171], a[192:195], a[32:35]
    buffer_load_dwordx4 v10, s[8:11], s24 offen offset:0 lds
    v_mfma_f32_16x16x32_bf16 a[64:67], a[176:179], a[192:195], a[64:67]
    ds_read_b64_tr_b16 a[150:151], v32 offset:8960
    v_mfma_f32_16x16x32_bf16 a[64:67], a[180:183], a[196:199], a[64:67]
    v_mfma_f32_16x16x32_bf16 a[68:71], a[180:183], a[204:207], a[68:71]
    ds_read_b64_tr_b16 a[152:153], v34 offset:0
    v_mfma_f32_16x16x32_bf16 a[68:71], a[176:179], a[200:203], a[68:71]
    ds_read_b64_tr_b16 a[154:155], v34 offset:256
    v_mfma_f32_16x16x32_bf16 a[72:75], a[176:179], a[208:211], a[72:75]
    buffer_load_dwordx4 v11, s[8:11], s24 offen offset:1024 lds
    v_mfma_f32_16x16x32_bf16 a[72:75], a[180:183], a[212:215], a[72:75]
    ds_read_b64_tr_b16 a[156:157], v34 offset:16384
    v_mfma_f32_16x16x32_bf16 a[76:79], a[180:183], a[220:223], a[76:79]
    ds_read_b64_tr_b16 a[158:159], v34 offset:16640
    v_mfma_f32_16x16x32_bf16 a[76:79], a[176:179], a[216:219], a[76:79]
    v_mfma_f32_16x16x32_bf16 a[108:111], a[184:187], a[216:219], a[108:111]
    s_mov_b32 m0, s42
    v_mfma_f32_16x16x32_bf16 a[108:111], a[188:191], a[220:223], a[108:111]
    buffer_load_dwordx4 v12, s[8:11], s24 offen offset:0 lds
    v_mfma_f32_16x16x32_bf16 a[104:107], a[188:191], a[212:215], a[104:107]
    v_mfma_f32_16x16x32_bf16 a[104:107], a[184:187], a[208:211], a[104:107]
    v_mfma_f32_16x16x32_bf16 a[100:103], a[184:187], a[200:203], a[100:103]
    v_mfma_f32_16x16x32_bf16 a[100:103], a[188:191], a[204:207], a[100:103]
    v_mfma_f32_16x16x32_bf16 a[96:99], a[188:191], a[196:199], a[96:99]
    buffer_load_dwordx4 v13, s[8:11], s24 offen offset:1024 lds
    v_mfma_f32_16x16x32_bf16 a[96:99], a[184:187], a[192:195], a[96:99]
    v_mfma_f32_16x16x32_bf16 a[16:19], a[160:163], a[224:227], a[16:19]
    ds_read_b128 a[192:195], v26 offset:0
    v_mfma_f32_16x16x32_bf16 a[16:19], a[164:167], a[228:231], a[16:19]
    ds_read_b128 a[196:199], v27 offset:0
    v_mfma_f32_16x16x32_bf16 a[20:23], a[164:167], a[236:239], a[20:23]
    s_add_u32 m0, s42, 2048
    v_mfma_f32_16x16x32_bf16 a[20:23], a[160:163], a[232:235], a[20:23]
    buffer_load_dwordx4 v14, s[8:11], s24 offen offset:0 lds
    v_mfma_f32_16x16x32_bf16 a[24:27], a[160:163], a[240:243], a[24:27]
    ds_read_b128 a[200:203], v26 offset:2048
    v_mfma_f32_16x16x32_bf16 a[24:27], a[164:167], a[244:247], a[24:27]
    v_mfma_f32_16x16x32_bf16 a[28:31], a[164:167], a[252:255], a[28:31]
    ds_read_b128 a[204:207], v27 offset:2048
    v_mfma_f32_16x16x32_bf16 a[28:31], a[160:163], a[248:251], a[28:31]
    ds_read_b128 a[208:211], v26 offset:4096
    v_mfma_f32_16x16x32_bf16 a[60:63], a[168:171], a[248:251], a[60:63]
    buffer_load_dwordx4 v15, s[8:11], s24 offen offset:1024 lds
    v_mfma_f32_16x16x32_bf16 a[60:63], a[172:175], a[252:255], a[60:63]
    v_mfma_f32_16x16x32_bf16 a[56:59], a[172:175], a[244:247], a[56:59]
    ds_read_b128 a[212:215], v27 offset:4096
    v_mfma_f32_16x16x32_bf16 a[56:59], a[168:171], a[240:243], a[56:59]
    v_mfma_f32_16x16x32_bf16 a[52:55], a[168:171], a[232:235], a[52:55]
    ds_read_b128 a[216:219], v26 offset:6144
    s_mov_b32 m0, s43
    v_mfma_f32_16x16x32_bf16 a[52:55], a[172:175], a[236:239], a[52:55]
    buffer_load_dwordx4 v16, s[12:15], s25 offen offset:0 lds
    v_mfma_f32_16x16x32_bf16 a[48:51], a[172:175], a[228:231], a[48:51]
    ds_read_b128 a[220:223], v27 offset:6144
    v_mfma_f32_16x16x32_bf16 a[48:51], a[168:171], a[224:227], a[48:51]
    v_mfma_f32_16x16x32_bf16 a[80:83], a[176:179], a[224:227], a[80:83]
    v_mfma_f32_16x16x32_bf16 a[80:83], a[180:183], a[228:231], a[80:83]
    v_mfma_f32_16x16x32_bf16 a[84:87], a[180:183], a[236:239], a[84:87]
    buffer_load_dwordx4 v17, s[12:15], s25 offen offset:1024 lds
    v_mfma_f32_16x16x32_bf16 a[84:87], a[176:179], a[232:235], a[84:87]
    v_mfma_f32_16x16x32_bf16 a[88:91], a[176:179], a[240:243], a[88:91]
    v_mfma_f32_16x16x32_bf16 a[88:91], a[180:183], a[244:247], a[88:91]
    v_mfma_f32_16x16x32_bf16 a[92:95], a[180:183], a[252:255], a[92:95]
    v_mfma_f32_16x16x32_bf16 a[92:95], a[176:179], a[248:251], a[92:95]
    buffer_load_dwordx4 v18, s[12:15], s25 offen offset:2048 lds
    v_mfma_f32_16x16x32_bf16 a[124:127], a[184:187], a[248:251], a[124:127]
    v_mfma_f32_16x16x32_bf16 a[124:127], a[188:191], a[252:255], a[124:127]
    v_mfma_f32_16x16x32_bf16 a[120:123], a[188:191], a[244:247], a[120:123]
    v_mfma_f32_16x16x32_bf16 a[120:123], a[184:187], a[240:243], a[120:123]
    v_mfma_f32_16x16x32_bf16 a[116:119], a[184:187], a[232:235], a[116:119]
    buffer_load_dwordx4 v19, s[12:15], s25 offen offset:3072 lds
    v_mfma_f32_16x16x32_bf16 a[116:119], a[188:191], a[236:239], a[116:119]
    v_mfma_f32_16x16x32_bf16 a[112:115], a[188:191], a[228:231], a[112:115]
    v_mfma_f32_16x16x32_bf16 a[112:115], a[184:187], a[224:227], a[112:115]
    s_waitcnt lgkmcnt(0)
    v_mfma_f32_16x16x32_bf16 v[128:131], a[128:131], a[192:195], v[128:131]
    ds_read_b128 a[224:227], v26 offset:8192
    s_mov_b32 m0, s44
    v_mfma_f32_16x16x32_bf16 v[128:131], a[132:135], a[196:199], v[128:131]
    buffer_load_dwordx4 v20, s[12:15], s25 offen offset:0 lds
    v_mfma_f32_16x16x32_bf16 v[132:135], a[132:135], a[204:207], v[132:135]
    ds_read_b128 a[228:231], v27 offset:8192
    v_mfma_f32_16x16x32_bf16 v[132:135], a[128:131], a[200:203], v[132:135]
    v_mfma_f32_16x16x32_bf16 v[136:139], a[128:131], a[208:211], v[136:139]
    ds_read_b128 a[232:235], v26 offset:10240
    v_mfma_f32_16x16x32_bf16 v[136:139], a[132:135], a[212:215], v[136:139]
    v_mfma_f32_16x16x32_bf16 v[140:143], a[132:135], a[220:223], v[140:143]
    buffer_load_dwordx4 v21, s[12:15], s25 offen offset:1024 lds
    v_mfma_f32_16x16x32_bf16 v[140:143], a[128:131], a[216:219], v[140:143]
    ds_read_b128 a[236:239], v27 offset:10240
    v_mfma_f32_16x16x32_bf16 v[172:175], a[136:139], a[216:219], v[172:175]
    ds_read_b128 a[240:243], v26 offset:12288
    v_mfma_f32_16x16x32_bf16 v[172:175], a[140:143], a[220:223], v[172:175]
    v_mfma_f32_16x16x32_bf16 v[168:171], a[140:143], a[212:215], v[168:171]
    ds_read_b128 a[244:247], v27 offset:12288
    s_add_u32 m0, s44, 2048
    v_mfma_f32_16x16x32_bf16 v[168:171], a[136:139], a[208:211], v[168:171]
    buffer_load_dwordx4 v22, s[16:19], s26 offen offset:0 lds
    v_mfma_f32_16x16x32_bf16 v[164:167], a[136:139], a[200:203], v[164:167]
    v_mfma_f32_16x16x32_bf16 v[164:167], a[140:143], a[204:207], v[164:167]
    ds_read_b128 a[248:251], v26 offset:14336
    v_mfma_f32_16x16x32_bf16 v[160:163], a[140:143], a[196:199], v[160:163]
    ds_read_b128 a[252:255], v27 offset:14336
    v_mfma_f32_16x16x32_bf16 v[160:163], a[136:139], a[192:195], v[160:163]
    v_mfma_f32_16x16x32_bf16 v[192:195], a[144:147], a[192:195], v[192:195]
    buffer_load_dwordx4 v23, s[16:19], s26 offen offset:1024 lds
    v_mfma_f32_16x16x32_bf16 v[192:195], a[148:151], a[196:199], v[192:195]
    v_mfma_f32_16x16x32_bf16 v[196:199], a[148:151], a[204:207], v[196:199]
    v_mfma_f32_16x16x32_bf16 v[196:199], a[144:147], a[200:203], v[196:199]
    v_mfma_f32_16x16x32_bf16 v[200:203], a[144:147], a[208:211], v[200:203]
    v_mfma_f32_16x16x32_bf16 v[200:203], a[148:151], a[212:215], v[200:203]
    v_mfma_f32_16x16x32_bf16 v[204:207], a[148:151], a[220:223], v[204:207]
    v_mfma_f32_16x16x32_bf16 v[204:207], a[144:147], a[216:219], v[204:207]
    v_mfma_f32_16x16x32_bf16 v[236:239], a[152:155], a[216:219], v[236:239]
    v_mfma_f32_16x16x32_bf16 v[236:239], a[156:159], a[220:223], v[236:239]
    v_mfma_f32_16x16x32_bf16 v[232:235], a[156:159], a[212:215], v[232:235]
    v_mfma_f32_16x16x32_bf16 v[232:235], a[152:155], a[208:211], v[232:235]
    v_mfma_f32_16x16x32_bf16 v[228:231], a[152:155], a[200:203], v[228:231]
    v_mfma_f32_16x16x32_bf16 v[228:231], a[156:159], a[204:207], v[228:231]
    buffer_load_dword v124, v40, s[8:11], s24 offen offset:256
    v_mfma_f32_16x16x32_bf16 v[224:227], a[156:159], a[196:199], v[224:227]
    v_mfma_f32_16x16x32_bf16 v[224:227], a[152:155], a[192:195], v[224:227]
    s_waitcnt lgkmcnt(0)
    v_mfma_f32_16x16x32_bf16 v[144:147], a[128:131], a[224:227], v[144:147]
    ds_read_b64_tr_b16 a[160:161], v30 offset:16384
    v_mfma_f32_16x16x32_bf16 v[144:147], a[132:135], a[228:231], v[144:147]
    ds_read_b64_tr_b16 a[162:163], v30 offset:18176
    v_mfma_f32_16x16x32_bf16 v[148:151], a[132:135], a[236:239], v[148:151]
    global_load_dword v127, v[122:123], off
    v_mfma_f32_16x16x32_bf16 v[148:151], a[128:131], a[232:235], v[148:151]
    ds_read_b64_tr_b16 a[164:165], v30 offset:23552
    v_mfma_f32_16x16x32_bf16 v[152:155], a[128:131], a[240:243], v[152:155]
    ds_read_b64_tr_b16 a[166:167], v30 offset:25344
    v_mfma_f32_16x16x32_bf16 v[152:155], a[132:135], a[244:247], v[152:155]
    v_mfma_f32_16x16x32_bf16 v[156:159], a[132:135], a[252:255], v[156:159]
    ds_read_b64_tr_b16 a[168:169], v30 offset:16416
    v_mfma_f32_16x16x32_bf16 v[156:159], a[128:131], a[248:251], v[156:159]
    ds_read_b64_tr_b16 a[170:171], v30 offset:18208
    v_mfma_f32_16x16x32_bf16 v[188:191], a[136:139], a[248:251], v[188:191]
    ds_read_b64_tr_b16 a[172:173], v30 offset:23584
    v_mfma_f32_16x16x32_bf16 v[188:191], a[140:143], a[252:255], v[188:191]
    ds_read_b64_tr_b16 a[174:175], v30 offset:25376
    v_mfma_f32_16x16x32_bf16 v[184:187], a[140:143], a[244:247], v[184:187]
    v_mfma_f32_16x16x32_bf16 v[184:187], a[136:139], a[240:243], v[184:187]
    ds_read_b64_tr_b16 a[176:177], v32 offset:16384
    v_mfma_f32_16x16x32_bf16 v[180:183], a[136:139], a[232:235], v[180:183]
    ds_read_b64_tr_b16 a[178:179], v32 offset:18176
    v_mfma_f32_16x16x32_bf16 v[180:183], a[140:143], a[236:239], v[180:183]
    ds_read_b64_tr_b16 a[180:181], v32 offset:23552
    v_mfma_f32_16x16x32_bf16 v[176:179], a[140:143], a[228:231], v[176:179]
    ds_read_b64_tr_b16 a[182:183], v32 offset:25344
    v_mfma_f32_16x16x32_bf16 v[176:179], a[136:139], a[224:227], v[176:179]
    v_mfma_f32_16x16x32_bf16 v[208:211], a[144:147], a[224:227], v[208:211]
    ds_read_b64_tr_b16 a[184:185], v36 offset:0
    v_mfma_f32_16x16x32_bf16 v[208:211], a[148:151], a[228:231], v[208:211]
    ds_read_b64_tr_b16 a[186:187], v36 offset:256
    v_mfma_f32_16x16x32_bf16 v[212:215], a[148:151], a[236:239], v[212:215]
    ds_read_b64_tr_b16 a[188:189], v36 offset:16384
    v_mfma_f32_16x16x32_bf16 v[212:215], a[144:147], a[232:235], v[212:215]
    ds_read_b64_tr_b16 a[190:191], v36 offset:16640
    v_mfma_f32_16x16x32_bf16 v[216:219], a[144:147], a[240:243], v[216:219]
    s_add_u32 s24, s24, 128
    v_mfma_f32_16x16x32_bf16 v[216:219], a[148:151], a[244:247], v[216:219]
    s_add_u32 s25, s25, 458752
    v_mfma_f32_16x16x32_bf16 v[220:223], a[148:151], a[252:255], v[220:223]
    s_add_u32 s26, s26, s27
    v_mfma_f32_16x16x32_bf16 v[220:223], a[144:147], a[248:251], v[220:223]
    s_add_u32 s33, s33, 4096
    v_mfma_f32_16x16x32_bf16 v[252:255], a[152:155], a[248:251], v[252:255]
    v_mfma_f32_16x16x32_bf16 v[252:255], a[156:159], a[252:255], v[252:255]
    v_mfma_f32_16x16x32_bf16 v[248:251], a[156:159], a[244:247], v[248:251]
    s_sub_u32 s32, s32, 1
    v_mfma_f32_16x16x32_bf16 v[248:251], a[152:155], a[240:243], v[248:251]
    s_cmp_lg_u32 s32, 0
    v_mfma_f32_16x16x32_bf16 v[244:247], a[152:155], a[232:235], v[244:247]
    v_mfma_f32_16x16x32_bf16 v[244:247], a[156:159], a[236:239], v[244:247]
    v_mfma_f32_16x16x32_bf16 v[240:243], a[156:159], a[228:231], v[240:243]
    v_mfma_f32_16x16x32_bf16 v[240:243], a[152:155], a[224:227], v[240:243]
    s_waitcnt vmcnt(2) lgkmcnt(0)
    s_barrier
    s_cbranch_scc1 K1_W1_LOOPB
    v_mfma_f32_16x16x32_bf16 a[16:19], a[160:163], a[224:227], a[16:19]
    ds_read_b64_tr_b16 a[128:129], v31 offset:0
    v_mfma_f32_16x16x32_bf16 a[16:19], a[164:167], a[228:231], a[16:19]
    ds_read_b64_tr_b16 a[130:131], v31 offset:1792
    v_mfma_f32_16x16x32_bf16 a[20:23], a[164:167], a[236:239], a[20:23]
    ds_read_b64_tr_b16 a[132:133], v31 offset:7168
    v_mfma_f32_16x16x32_bf16 a[20:23], a[160:163], a[232:235], a[20:23]
    ds_read_b64_tr_b16 a[134:135], v31 offset:8960
    v_mfma_f32_16x16x32_bf16 a[24:27], a[160:163], a[240:243], a[24:27]
    v_mfma_f32_16x16x32_bf16 a[24:27], a[164:167], a[244:247], a[24:27]
    ds_read_b64_tr_b16 a[136:137], v31 offset:32
    v_mfma_f32_16x16x32_bf16 a[28:31], a[164:167], a[252:255], a[28:31]
    ds_read_b64_tr_b16 a[138:139], v31 offset:1824
    v_mfma_f32_16x16x32_bf16 a[28:31], a[160:163], a[248:251], a[28:31]
    ds_read_b64_tr_b16 a[140:141], v31 offset:7200
    v_mfma_f32_16x16x32_bf16 a[60:63], a[168:171], a[248:251], a[60:63]
    ds_read_b64_tr_b16 a[142:143], v31 offset:8992
    v_mfma_f32_16x16x32_bf16 a[60:63], a[172:175], a[252:255], a[60:63]
    v_mfma_f32_16x16x32_bf16 a[56:59], a[172:175], a[244:247], a[56:59]
    ds_read_b64_tr_b16 a[144:145], v33 offset:0
    v_mfma_f32_16x16x32_bf16 a[56:59], a[168:171], a[240:243], a[56:59]
    ds_read_b64_tr_b16 a[146:147], v33 offset:1792
    v_mfma_f32_16x16x32_bf16 a[52:55], a[168:171], a[232:235], a[52:55]
    ds_read_b64_tr_b16 a[148:149], v33 offset:7168
    v_mfma_f32_16x16x32_bf16 a[52:55], a[172:175], a[236:239], a[52:55]
    ds_read_b64_tr_b16 a[150:151], v33 offset:8960
    v_mfma_f32_16x16x32_bf16 a[48:51], a[172:175], a[228:231], a[48:51]
    v_mfma_f32_16x16x32_bf16 a[48:51], a[168:171], a[224:227], a[48:51]
    ds_read_b64_tr_b16 a[152:153], v35 offset:0
    v_mfma_f32_16x16x32_bf16 a[80:83], a[176:179], a[224:227], a[80:83]
    ds_read_b64_tr_b16 a[154:155], v35 offset:256
    v_mfma_f32_16x16x32_bf16 a[80:83], a[180:183], a[228:231], a[80:83]
    ds_read_b64_tr_b16 a[156:157], v35 offset:16384
    v_mfma_f32_16x16x32_bf16 a[84:87], a[180:183], a[236:239], a[84:87]
    ds_read_b64_tr_b16 a[158:159], v35 offset:16640
    v_mfma_f32_16x16x32_bf16 a[84:87], a[176:179], a[232:235], a[84:87]
    v_mfma_f32_16x16x32_bf16 a[88:91], a[176:179], a[240:243], a[88:91]
    v_mfma_f32_16x16x32_bf16 a[88:91], a[180:183], a[244:247], a[88:91]
    v_mfma_f32_16x16x32_bf16 a[92:95], a[180:183], a[252:255], a[92:95]
    v_mfma_f32_16x16x32_bf16 a[92:95], a[176:179], a[248:251], a[92:95]
    v_mfma_f32_16x16x32_bf16 a[124:127], a[184:187], a[248:251], a[124:127]
    v_mfma_f32_16x16x32_bf16 a[124:127], a[188:191], a[252:255], a[124:127]
    v_mfma_f32_16x16x32_bf16 a[120:123], a[188:191], a[244:247], a[120:123]
    v_mfma_f32_16x16x32_bf16 a[120:123], a[184:187], a[240:243], a[120:123]
    v_mfma_f32_16x16x32_bf16 a[116:119], a[184:187], a[232:235], a[116:119]
    v_mfma_f32_16x16x32_bf16 a[116:119], a[188:191], a[236:239], a[116:119]
    v_mfma_f32_16x16x32_bf16 a[112:115], a[188:191], a[228:231], a[112:115]
    v_mfma_f32_16x16x32_bf16 a[112:115], a[184:187], a[224:227], a[112:115]
    v_mfma_f32_16x16x32_bf16 a[0:3], a[160:163], a[192:195], a[0:3]
    ds_read_b128 a[224:227], v28 offset:8192
    v_mfma_f32_16x16x32_bf16 a[0:3], a[164:167], a[196:199], a[0:3]
    ds_read_b128 a[228:231], v29 offset:8192
    v_mfma_f32_16x16x32_bf16 a[4:7], a[164:167], a[204:207], a[4:7]
    v_mfma_f32_16x16x32_bf16 a[4:7], a[160:163], a[200:203], a[4:7]
    ds_read_b128 a[232:235], v28 offset:10240
    v_mfma_f32_16x16x32_bf16 a[8:11], a[160:163], a[208:211], a[8:11]
    v_mfma_f32_16x16x32_bf16 a[8:11], a[164:167], a[212:215], a[8:11]
    ds_read_b128 a[236:239], v29 offset:10240
    v_mfma_f32_16x16x32_bf16 a[12:15], a[164:167], a[220:223], a[12:15]
    ds_read_b128 a[240:243], v28 offset:12288
    v_mfma_f32_16x16x32_bf16 a[12:15], a[160:163], a[216:219], a[12:15]
    v_mfma_f32_16x16x32_bf16 a[44:47], a[168:171], a[216:219], a[44:47]
    ds_read_b128 a[244:247], v29 offset:12288
    v_mfma_f32_16x16x32_bf16 a[44:47], a[172:175], a[220:223], a[44:47]
    v_mfma_f32_16x16x32_bf16 a[40:43], a[172:175], a[212:215], a[40:43]
    ds_read_b128 a[248:251], v28 offset:14336
    v_mfma_f32_16x16x32_bf16 a[40:43], a[168:171], a[208:211], a[40:43]
    ds_read_b128 a[252:255], v29 offset:14336
    v_mfma_f32_16x16x32_bf16 a[36:39], a[168:171], a[200:203], a[36:39]
    v_mfma_f32_16x16x32_bf16 a[36:39], a[172:175], a[204:207], a[36:39]
    v_mfma_f32_16x16x32_bf16 a[32:35], a[172:175], a[196:199], a[32:35]
    v_mfma_f32_16x16x32_bf16 a[32:35], a[168:171], a[192:195], a[32:35]
    v_mfma_f32_16x16x32_bf16 a[64:67], a[176:179], a[192:195], a[64:67]
    v_mfma_f32_16x16x32_bf16 a[64:67], a[180:183], a[196:199], a[64:67]
    v_mfma_f32_16x16x32_bf16 a[68:71], a[180:183], a[204:207], a[68:71]
    v_mfma_f32_16x16x32_bf16 a[68:71], a[176:179], a[200:203], a[68:71]
    v_mfma_f32_16x16x32_bf16 a[72:75], a[176:179], a[208:211], a[72:75]
    v_mfma_f32_16x16x32_bf16 a[72:75], a[180:183], a[212:215], a[72:75]
    v_mfma_f32_16x16x32_bf16 a[76:79], a[180:183], a[220:223], a[76:79]
    v_mfma_f32_16x16x32_bf16 a[76:79], a[176:179], a[216:219], a[76:79]
    v_mfma_f32_16x16x32_bf16 a[108:111], a[184:187], a[216:219], a[108:111]
    v_mfma_f32_16x16x32_bf16 a[108:111], a[188:191], a[220:223], a[108:111]
    v_mfma_f32_16x16x32_bf16 a[104:107], a[188:191], a[212:215], a[104:107]
    v_mfma_f32_16x16x32_bf16 a[104:107], a[184:187], a[208:211], a[104:107]
    v_mfma_f32_16x16x32_bf16 a[100:103], a[184:187], a[200:203], a[100:103]
    v_mfma_f32_16x16x32_bf16 a[100:103], a[188:191], a[204:207], a[100:103]
    v_mfma_f32_16x16x32_bf16 a[96:99], a[188:191], a[196:199], a[96:99]
    v_mfma_f32_16x16x32_bf16 a[96:99], a[184:187], a[192:195], a[96:99]
    s_waitcnt lgkmcnt(0)
    v_mfma_f32_16x16x32_bf16 v[144:147], a[128:131], a[224:227], v[144:147]
    ds_read_b128 a[192:195], v28 offset:0
    s_lshr_b32 s3, s28, 1
    v_mfma_f32_16x16x32_bf16 v[144:147], a[132:135], a[228:231], v[144:147]
    ds_read_b128 a[196:199], v29 offset:0
    s_lshl_b32 s4, s29, 1
    v_mfma_f32_16x16x32_bf16 v[148:151], a[132:135], a[236:239], v[148:151]
    s_add_u32 s3, s3, s4
    v_mfma_f32_16x16x32_bf16 v[148:151], a[128:131], a[232:235], v[148:151]
    ds_read_b128 a[200:203], v28 offset:2048
    s_lshl_b32 s85, s3, 3
    v_mfma_f32_16x16x32_bf16 v[152:155], a[128:131], a[240:243], v[152:155]
    s_lshl_b32 s3, s3, 2
    v_mfma_f32_16x16x32_bf16 v[152:155], a[132:135], a[244:247], v[152:155]
    ds_read_b128 a[204:207], v29 offset:2048
    s_lshr_b32 s4, s31, 1
    v_mfma_f32_16x16x32_bf16 v[156:159], a[132:135], a[252:255], v[156:159]
    ds_read_b128 a[208:211], v28 offset:4096
    s_add_u32 s3, s3, s4
    v_mfma_f32_16x16x32_bf16 v[156:159], a[128:131], a[248:251], v[156:159]
    s_lshl_b32 s3, s3, 12
    v_mfma_f32_16x16x32_bf16 v[188:191], a[136:139], a[248:251], v[188:191]
    ds_read_b128 a[212:215], v29 offset:4096
    s_and_b32 s4, s31, 1
    v_mfma_f32_16x16x32_bf16 v[188:191], a[140:143], a[252:255], v[188:191]
    s_and_b32 s5, s30, 1
    v_mfma_f32_16x16x32_bf16 v[184:187], a[140:143], a[244:247], v[184:187]
    ds_read_b128 a[216:219], v28 offset:6144
    s_lshl_b32 s4, s4, 3
    v_mfma_f32_16x16x32_bf16 v[184:187], a[136:139], a[240:243], v[184:187]
    ds_read_b128 a[220:223], v29 offset:6144
    s_lshl_b32 s6, s5, 8
    v_mfma_f32_16x16x32_bf16 v[180:183], a[136:139], a[232:235], v[180:183]
    s_add_u32 s3, s3, s4
    v_mfma_f32_16x16x32_bf16 v[180:183], a[140:143], a[236:239], v[180:183]
    s_add_u32 s3, s3, s6
    v_mfma_f32_16x16x32_bf16 v[176:179], a[140:143], a[228:231], v[176:179]
    s_add_u32 s3, s3, 23070720
    v_mfma_f32_16x16x32_bf16 v[176:179], a[136:139], a[224:227], v[176:179]
    s_cmp_ge_u32 s30, 16
    v_mfma_f32_16x16x32_bf16 v[208:211], a[144:147], a[224:227], v[208:211]
    s_cselect_b32 s3, 2147418112, s3
    v_mfma_f32_16x16x32_bf16 v[208:211], a[148:151], a[228:231], v[208:211]
    v_mfma_f32_16x16x32_bf16 v[212:215], a[148:151], a[236:239], v[212:215]
    v_mfma_f32_16x16x32_bf16 v[212:215], a[144:147], a[232:235], v[212:215]
    v_mfma_f32_16x16x32_bf16 v[216:219], a[144:147], a[240:243], v[216:219]
    v_mfma_f32_16x16x32_bf16 v[216:219], a[148:151], a[244:247], v[216:219]
    v_mfma_f32_16x16x32_bf16 v[220:223], a[148:151], a[252:255], v[220:223]
    v_mfma_f32_16x16x32_bf16 v[220:223], a[144:147], a[248:251], v[220:223]
    v_mfma_f32_16x16x32_bf16 v[252:255], a[152:155], a[248:251], v[252:255]
    v_mfma_f32_16x16x32_bf16 v[252:255], a[156:159], a[252:255], v[252:255]
    v_mfma_f32_16x16x32_bf16 v[248:251], a[156:159], a[244:247], v[248:251]
    v_mfma_f32_16x16x32_bf16 v[248:251], a[152:155], a[240:243], v[248:251]
    v_mfma_f32_16x16x32_bf16 v[244:247], a[152:155], a[232:235], v[244:247]
    v_mfma_f32_16x16x32_bf16 v[244:247], a[156:159], a[236:239], v[244:247]
    v_mfma_f32_16x16x32_bf16 v[240:243], a[156:159], a[228:231], v[240:243]
    v_mfma_f32_16x16x32_bf16 v[240:243], a[152:155], a[224:227], v[240:243]
    s_waitcnt lgkmcnt(0)
    v_mfma_f32_16x16x32_bf16 v[128:131], a[128:131], a[192:195], v[128:131]
    ds_read_b64_tr_b16 a[160:161], v31 offset:16384
    v_mfma_f32_16x16x32_bf16 v[128:131], a[132:135], a[196:199], v[128:131]
    ds_read_b64_tr_b16 a[162:163], v31 offset:18176
    v_mfma_f32_16x16x32_bf16 v[132:135], a[132:135], a[204:207], v[132:135]
    ds_read_b64_tr_b16 a[164:165], v31 offset:23552
    v_mfma_f32_16x16x32_bf16 v[132:135], a[128:131], a[200:203], v[132:135]
    ds_read_b64_tr_b16 a[166:167], v31 offset:25344
    v_mfma_f32_16x16x32_bf16 v[136:139], a[128:131], a[208:211], v[136:139]
    v_mfma_f32_16x16x32_bf16 v[136:139], a[132:135], a[212:215], v[136:139]
    ds_read_b64_tr_b16 a[168:169], v31 offset:16416
    v_mfma_f32_16x16x32_bf16 v[140:143], a[132:135], a[220:223], v[140:143]
    ds_read_b64_tr_b16 a[170:171], v31 offset:18208
    v_mfma_f32_16x16x32_bf16 v[140:143], a[128:131], a[216:219], v[140:143]
    ds_read_b64_tr_b16 a[172:173], v31 offset:23584
    v_mfma_f32_16x16x32_bf16 v[172:175], a[136:139], a[216:219], v[172:175]
    ds_read_b64_tr_b16 a[174:175], v31 offset:25376
    v_mfma_f32_16x16x32_bf16 v[172:175], a[140:143], a[220:223], v[172:175]
    v_mfma_f32_16x16x32_bf16 v[168:171], a[140:143], a[212:215], v[168:171]
    ds_read_b64_tr_b16 a[176:177], v33 offset:16384
    v_mfma_f32_16x16x32_bf16 v[168:171], a[136:139], a[208:211], v[168:171]
    ds_read_b64_tr_b16 a[178:179], v33 offset:18176
    v_mfma_f32_16x16x32_bf16 v[164:167], a[136:139], a[200:203], v[164:167]
    ds_read_b64_tr_b16 a[180:181], v33 offset:23552
    v_mfma_f32_16x16x32_bf16 v[164:167], a[140:143], a[204:207], v[164:167]
    ds_read_b64_tr_b16 a[182:183], v33 offset:25344
    v_mfma_f32_16x16x32_bf16 v[160:163], a[140:143], a[196:199], v[160:163]
    v_mfma_f32_16x16x32_bf16 v[160:163], a[136:139], a[192:195], v[160:163]
    ds_read_b64_tr_b16 a[184:185], v37 offset:0
    v_mfma_f32_16x16x32_bf16 v[192:195], a[144:147], a[192:195], v[192:195]
    ds_read_b64_tr_b16 a[186:187], v37 offset:256
    v_mfma_f32_16x16x32_bf16 v[192:195], a[148:151], a[196:199], v[192:195]
    ds_read_b64_tr_b16 a[188:189], v37 offset:16384
    v_mfma_f32_16x16x32_bf16 v[196:199], a[148:151], a[204:207], v[196:199]
    ds_read_b64_tr_b16 a[190:191], v37 offset:16640
    v_mfma_f32_16x16x32_bf16 v[196:199], a[144:147], a[200:203], v[196:199]
    v_mfma_f32_16x16x32_bf16 v[200:203], a[144:147], a[208:211], v[200:203]
    v_mfma_f32_16x16x32_bf16 v[200:203], a[148:151], a[212:215], v[200:203]
    v_mfma_f32_16x16x32_bf16 v[204:207], a[148:151], a[220:223], v[204:207]
    v_mfma_f32_16x16x32_bf16 v[204:207], a[144:147], a[216:219], v[204:207]
    v_mfma_f32_16x16x32_bf16 v[236:239], a[152:155], a[216:219], v[236:239]
    v_mfma_f32_16x16x32_bf16 v[236:239], a[156:159], a[220:223], v[236:239]
    v_mfma_f32_16x16x32_bf16 v[232:235], a[156:159], a[212:215], v[232:235]
    v_mfma_f32_16x16x32_bf16 v[232:235], a[152:155], a[208:211], v[232:235]
    v_mfma_f32_16x16x32_bf16 v[228:231], a[152:155], a[200:203], v[228:231]
    v_mfma_f32_16x16x32_bf16 v[228:231], a[156:159], a[204:207], v[228:231]
    v_mfma_f32_16x16x32_bf16 v[224:227], a[156:159], a[196:199], v[224:227]
    v_mfma_f32_16x16x32_bf16 v[224:227], a[152:155], a[192:195], v[224:227]
    s_waitcnt lgkmcnt(0)
    s_branch K1_W1_TAIL
K2_SYNC:
    s_waitcnt vmcnt(0)
    s_barrier
    s_cmp_lg_u32 s28, 0
    s_cbranch_scc1 K2_NOSYNC
    s_mov_b64 exec, 1
    v_mov_b32 v2, s46
    v_mov_b32 v3, s47
    buffer_store_dwordx2 v[2:3], off, s[20:23], s45 sc1
    s_mov_b64 exec, -1
    s_branch K2_NOSYNC
K3_SCALE:
    s_nop 7
    v_pk_mul_f32 v[160:161], v[160:161], v[90:91] op_sel:[0,0] op_sel_hi:[1,0]
    v_pk_mul_f32 v[162:163], v[162:163], v[90:91] op_sel:[0,0] op_sel_hi:[1,0]
    v_pk_mul_f32 v[164:165], v[164:165], v[90:91] op_sel:[0,1] op_sel_hi:[1,1]
    v_pk_mul_f32 v[166:167], v[166:167], v[90:91] op_sel:[0,1] op_sel_hi:[1,1]
    v_pk_mul_f32 v[168:169], v[168:169], v[90:91] op_sel:[0,0] op_sel_hi:[1,0]
    v_pk_mul_f32 v[170:171], v[170:171], v[90:91] op_sel:[0,0] op_sel_hi:[1,0]
    v_pk_mul_f32 v[172:173], v[172:173], v[90:91] op_sel:[0,1] op_sel_hi:[1,1]
    v_pk_mul_f32 v[174:175], v[174:175], v[90:91] op_sel:[0,1] op_sel_hi:[1,1]
    v_pk_mul_f32 v[176:177], v[176:177], v[90:91] op_sel:[0,0] op_sel_hi:[1,0]
    v_pk_mul_f32 v[178:179], v[178:179], v[90:91] op_sel:[0,0] op_sel_hi:[1,0]
    v_pk_mul_f32 v[180:181], v[180:181], v[90:91] op_sel:[0,1] op_sel_hi:[1,1]
    v_pk_mul_f32 v[182:183], v[182:183], v[90:91] op_sel:[0,1] op_sel_hi:[1,1]
    v_pk_mul_f32 v[184:185], v[184:185], v[90:91] op_sel:[0,0] op_sel_hi:[1,0]
    v_pk_mul_f32 v[186:187], v[186:187], v[90:91] op_sel:[0,0] op_sel_hi:[1,0]
    v_pk_mul_f32 v[188:189], v[188:189], v[90:91] op_sel:[0,1] op_sel_hi:[1,1]
    v_pk_mul_f32 v[190:191], v[190:191], v[90:91] op_sel:[0,1] op_sel_hi:[1,1]
    v_pk_mul_f32 v[192:193], v[192:193], v[90:91] op_sel:[0,0] op_sel_hi:[1,0]
    v_pk_mul_f32 v[194:195], v[194:195], v[90:91] op_sel:[0,0] op_sel_hi:[1,0]
    v_pk_mul_f32 v[196:197], v[196:197], v[90:91] op_sel:[0,1] op_sel_hi:[1,1]
    v_pk_mul_f32 v[198:199], v[198:199], v[90:91] op_sel:[0,1] op_sel_hi:[1,1]
    v_pk_mul_f32 v[200:201], v[200:201], v[90:91] op_sel:[0,0] op_sel_hi:[1,0]
    v_pk_mul_f32 v[202:203], v[202:203], v[90:91] op_sel:[0,0] op_sel_hi:[1,0]
    v_pk_mul_f32 v[204:205], v[204:205], v[90:91] op_sel:[0,1] op_sel_hi:[1,1]
    v_pk_mul_f32 v[206:207], v[206:207], v[90:91] op_sel:[0,1] op_sel_hi:[1,1]
    v_pk_mul_f32 v[208:209], v[208:209], v[90:91] op_sel:[0,0] op_sel_hi:[1,0]
    v_pk_mul_f32 v[210:211], v[210:211], v[90:91] op_sel:[0,0] op_sel_hi:[1,0]
    v_pk_mul_f32 v[212:213], v[212:213], v[90:91] op_sel:[0,1] op_sel_hi:[1,1]
    v_pk_mul_f32 v[214:215], v[214:215], v[90:91] op_sel:[0,1] op_sel_hi:[1,1]
    v_pk_mul_f32 v[216:217], v[216:217], v[90:91] op_sel:[0,0] op_sel_hi:[1,0]
    v_pk_mul_f32 v[218:219], v[218:219], v[90:91] op_sel:[0,0] op_sel_hi:[1,0]
    v_pk_mul_f32 v[220:221], v[220:221], v[90:91] op_sel:[0,1] op_sel_hi:[1,1]
    v_pk_mul_f32 v[222:223], v[222:223], v[90:91] op_sel:[0,1] op_sel_hi:[1,1]
    s_branch K3_SCALE_BACK
K3_SW:
    s_mov_b32 s12, s90
    s_mov_b32 s13, s91
    s_mov_b32 s14, 0x200000
    s_mov_b32 s15, 0x20000
    s_mov_b32 s58, 0
    v_add_u32 v112, 16384, v112
    v_add_u32 v113, 16384, v113
    v_subrev_u32 v114, 16384, v114
    v_subrev_u32 v115, 16384, v115
    buffer_load_dwordx2 v[88:89], v103, s[20:23], s61 offen sc1
    s_branch K3_SW_BACK
K3_FLAG:
    s_mov_b64 exec, 1
    v_mov_b32 v2, s46
    v_mov_b32 v3, s47
    buffer_store_dwordx2 v[2:3], off, s[20:23], s43 sc1
    s_mov_b64 exec, -1
    s_branch K3_FLAG_BACK
K3_WRAP:
    s_mov_b32 s60, 0
    s_mov_b32 s3, 0
    s_waitcnt vmcnt(8)
K3_SPIN_O:
    v_cmp_ne_u64 vcc, s[46:47], v[88:89]
    s_nop 4
    s_cmp_eq_u64 vcc, 0
    s_cbranch_scc0 K3_SPIN_O_RETRY
K3_SPIN_O_OK:
    s_branch K3_WRAP_BACK
K_TAG0_RETRY:
    buffer_load_dwordx2 v[88:89], off, s[16:19], 0 sc1
    s_add_u32 s3, s3, 1
    s_waitcnt vmcnt(0)
    v_readfirstlane_b32 s46, v88
    v_readfirstlane_b32 s47, v89
    s_cmp_lt_u32 s3, 0x20000
    s_cbranch_scc1 K_TAG0
    s_branch K_TAG0_OK
K_SPIN_KV0_RETRY:
    buffer_load_dwordx4 v[88:91], v92, s[20:23], s59 offen sc1
    s_add_u32 s3, s3, 1
    s_waitcnt vmcnt(0)
    s_cmp_lt_u32 s3, 0x20000
    s_cbranch_scc1 K_SPIN_KV0
    s_branch K_SPIN_KV0_OK
K_TAG1_RETRY:
    buffer_load_dwordx2 v[88:89], off, s[16:19], 0 sc1
    s_add_u32 s3, s3, 1
    s_waitcnt vmcnt(0)
    v_readfirstlane_b32 s46, v88
    v_readfirstlane_b32 s47, v89
    s_cmp_lt_u32 s3, 0x20000
    s_cbranch_scc1 K_TAG1
    s_branch K_TAG1_OK
K_SPIN_KV1_RETRY:
    buffer_load_dwordx4 v[88:91], v92, s[20:23], s59 offen sc1
    s_add_u32 s3, s3, 1
    s_waitcnt vmcnt(0)
    s_cmp_lt_u32 s3, 0x20000
    s_cbranch_scc1 K_SPIN_KV1
    s_branch K_SPIN_KV1_OK
K_SPIN_H_RETRY:
    buffer_load_dwordx2 v[88:89], v104, s[20:23], 0 offen sc1
    s_add_u32 s3, s3, 1
    s_waitcnt vmcnt(0)
    s_cmp_lt_u32 s3, 0x20000
    s_cbranch_scc1 K_SPIN_H
    s_branch K_SPIN_H_OK
K3_SPIN_O_RETRY:
    buffer_load_dwordx2 v[88:89], v103, s[20:23], s61 offen sc1
    s_add_u32 s3, s3, 1
    s_waitcnt vmcnt(0)
    s_cmp_lt_u32 s3, 0x20000
    s_cbranch_scc1 K3_SPIN_O
    s_branch K3_SPIN_O_OK
K3_SPIN_P_RETRY:
    buffer_load_dwordx4 v[224:227], v19, s[20:23], 0 offen offset:0 sc1
    buffer_load_dwordx4 v[228:231], v19, s[20:23], 0 offen offset:1024 sc1
    buffer_load_dwordx4 v[232:235], v19, s[20:23], 0 offen offset:2048 sc1
    buffer_load_dwordx4 v[236:239], v19, s[20:23], 0 offen offset:3072 sc1
    buffer_load_dwordx4 v[240:243], v17, s[20:23], 0 offen offset:0 sc1
    buffer_load_dwordx4 v[244:247], v17, s[20:23], 0 offen offset:1024 sc1
    s_add_u32 s3, s3, 1
    s_waitcnt vmcnt(0)
    s_cmp_lt_u32 s3, 0x20000
    s_cbranch_scc1 K3_SPIN_P
    s_branch K3_SPIN_P_OK
K2_SLOW:
    s_waitcnt vmcnt(0)
    v_mov_b32 v2, 0xff61b1e6
    v_mov_b32 v8, 0
    v_mov_b32 v128, 0
    v_mov_b32 v129, 0
    v_mov_b32 v130, 0
    v_mov_b32 v131, 0
    v_mov_b32 v132, 0
    v_mov_b32 v133, 0
    v_mov_b32 v134, 0
    v_mov_b32 v135, 0
    v_mov_b32 v136, 0
    v_mov_b32 v137, 0
    v_mov_b32 v138, 0
    v_mov_b32 v139, 0
    v_mov_b32 v140, 0
    v_mov_b32 v141, 0
    v_mov_b32 v142, 0
    v_mov_b32 v143, 0
    v_mov_b32 v3, 0xff61b1e6
    v_mov_b32 v12, 0
    v_mov_b32 v144, 0
    v_mov_b32 v145, 0
    v_mov_b32 v146, 0
    v_mov_b32 v147, 0
    v_mov_b32 v148, 0
    v_mov_b32 v149, 0
    v_mov_b32 v150, 0
    v_mov_b32 v151, 0
    v_mov_b32 v152, 0
    v_mov_b32 v153, 0
    v_mov_b32 v154, 0
    v_mov_b32 v155, 0
    v_mov_b32 v156, 0
    v_mov_b32 v157, 0
    v_mov_b32 v158, 0
    v_mov_b32 v159, 0
    s_mov_b32 s26, 0
K2_SLOW_LOOP:
    buffer_load_dwordx4 v[36:39], v92, s[8:11], s26 offen offset:0 sc1
    buffer_load_dwordx4 v[40:43], v92, s[8:11], s26 offen offset:1024 sc1
    buffer_load_dwordx4 v[52:55], v92, s[8:11], s26 offen offset:2048 sc1
    buffer_load_dwordx4 v[56:59], v92, s[8:11], s26 offen offset:3072 sc1
    s_waitcnt vmcnt(0)
    v_mfma_f32_32x32x16_bf16 v[68:83], v[36:39], v[20:23], 0
    v_mfma_f32_32x32x16_bf16 v[68:83], v[40:43], v[24:27], v[68:83]
    v_mfma_f32_32x32x16_bf16 v[224:239], v[36:39], v[28:31], 0
    v_mfma_f32_32x32x16_bf16 v[224:239], v[40:43], v[32:35], v[224:239]
    s_nop 15
    v_max3_f32 v4, v68, v69, v2
    v_max3_f32 v4, v70, v71, v4
    v_max3_f32 v4, v72, v73, v4
    v_max3_f32 v4, v74, v75, v4
    v_max3_f32 v4, v76, v77, v4
    v_max3_f32 v4, v78, v79, v4
    v_max3_f32 v4, v80, v81, v4
    v_max3_f32 v4, v82, v83, v4
    v_mov_b32 v5, v4
    s_nop 1
    v_permlane32_swap_b32 v4, v5
    s_nop 1
    v_max_f32 v4, v4, v5
    v_sub_f32 v5, v2, v4
    v_mov_b32 v2, v4
    v_exp_f32 v5, v5
    v_sub_f32 v68, v68, v4
    v_sub_f32 v69, v69, v4
    v_sub_f32 v70, v70, v4
    v_sub_f32 v71, v71, v4
    v_sub_f32 v72, v72, v4
    v_sub_f32 v73, v73, v4
    v_sub_f32 v74, v74, v4
    v_sub_f32 v75, v75, v4
    v_sub_f32 v76, v76, v4
    v_sub_f32 v77, v77, v4
    v_sub_f32 v78, v78, v4
    v_sub_f32 v79, v79, v4
    v_sub_f32 v80, v80, v4
    v_sub_f32 v81, v81, v4
    v_sub_f32 v82, v82, v4
    v_sub_f32 v83, v83, v4
    v_exp_f32 v68, v68
    v_exp_f32 v69, v69
    v_exp_f32 v70, v70
    v_exp_f32 v71, v71
    v_exp_f32 v72, v72
    v_exp_f32 v73, v73
    v_exp_f32 v74, v74
    v_exp_f32 v75, v75
    v_exp_f32 v76, v76
    v_exp_f32 v77, v77
    v_exp_f32 v78, v78
    v_exp_f32 v79, v79
    v_exp_f32 v80, v80
    v_exp_f32 v81, v81
    v_exp_f32 v82, v82
    v_exp_f32 v83, v83
    v_mul_f32 v8, v8, v5
    v_mul_f32 v128, v128, v5
    v_mul_f32 v129, v129, v5
    v_mul_f32 v130, v130, v5
    v_mul_f32 v131, v131, v5
    v_mul_f32 v132, v132, v5
    v_mul_f32 v133, v133, v5
    v_mul_f32 v134, v134, v5
    v_mul_f32 v135, v135, v5
    v_mul_f32 v136, v136, v5
    v_mul_f32 v137, v137, v5
    v_mul_f32 v138, v138, v5
    v_mul_f32 v139, v139, v5
    v_mul_f32 v140, v140, v5
    v_mul_f32 v141, v141, v5
    v_mul_f32 v142, v142, v5
    v_mul_f32 v143, v143, v5
    v_add_f32 v8, v8, v68
    v_add_f32 v8, v8, v69
    v_add_f32 v8, v8, v70
    v_add_f32 v8, v8, v71
    v_add_f32 v8, v8, v72
    v_add_f32 v8, v8, v73
    v_add_f32 v8, v8, v74
    v_add_f32 v8, v8, v75
    v_add_f32 v8, v8, v76
    v_add_f32 v8, v8, v77
    v_add_f32 v8, v8, v78
    v_add_f32 v8, v8, v79
    v_add_f32 v8, v8, v80
    v_add_f32 v8, v8, v81
    v_add_f32 v8, v8, v82
    v_add_f32_e64 v8, v8, v83
    v_cvt_pk_bf16_f32 v240, v68, v69
    v_cvt_pk_bf16_f32 v241, v70, v71
    v_cvt_pk_bf16_f32 v242, v72, v73
    v_cvt_pk_bf16_f32 v243, v74, v75
    v_cvt_pk_bf16_f32 v244, v76, v77
    v_cvt_pk_bf16_f32 v245, v78, v79
    v_cvt_pk_bf16_f32 v246, v80, v81
    v_cvt_pk_bf16_f32 v247, v82, v83
    s_nop 1
    v_mfma_f32_32x32x16_bf16 v[128:143], v[52:55], v[240:243], v[128:143]
    v_mfma_f32_32x32x16_bf16 v[128:143], v[56:59], v[244:247], v[128:143]
    s_nop 0
    v_max3_f32 v4, v224, v225, v3
    v_max3_f32 v4, v226, v227, v4
    v_max3_f32 v4, v228, v229, v4
    v_max3_f32 v4, v230, v231, v4
    v_max3_f32 v4, v232, v233, v4
    v_max3_f32 v4, v234, v235, v4
    v_max3_f32 v4, v236, v237, v4
    v_max3_f32 v4, v238, v239, v4
    v_mov_b32 v5, v4
    s_nop 1
    v_permlane32_swap_b32 v4, v5
    s_nop 1
    v_max_f32 v4, v4, v5
    v_sub_f32 v5, v3, v4
    v_mov_b32 v3, v4
    v_exp_f32 v5, v5
    v_sub_f32 v224, v224, v4
    v_sub_f32 v225, v225, v4
    v_sub_f32 v226, v226, v4
    v_sub_f32 v227, v227, v4
    v_sub_f32 v228, v228, v4
    v_sub_f32 v229, v229, v4
    v_sub_f32 v230, v230, v4
    v_sub_f32 v231, v231, v4
    v_sub_f32 v232, v232, v4
    v_sub_f32 v233, v233, v4
    v_sub_f32 v234, v234, v4
    v_sub_f32 v235, v235, v4
    v_sub_f32 v236, v236, v4
    v_sub_f32 v237, v237, v4
    v_sub_f32 v238, v238, v4
    v_sub_f32 v239, v239, v4
    v_exp_f32 v224, v224
    v_exp_f32 v225, v225
    v_exp_f32 v226, v226
    v_exp_f32 v227, v227
    v_exp_f32 v228, v228
    v_exp_f32 v229, v229
    v_exp_f32 v230, v230
    v_exp_f32 v231, v231
    v_exp_f32 v232, v232
    v_exp_f32 v233, v233
    v_exp_f32 v234, v234
    v_exp_f32 v235, v235
    v_exp_f32 v236, v236
    v_exp_f32 v237, v237
    v_exp_f32 v238, v238
    v_exp_f32 v239, v239
    v_mul_f32 v12, v12, v5
    v_mul_f32 v144, v144, v5
    v_mul_f32 v145, v145, v5
    v_mul_f32 v146, v146, v5
    v_mul_f32 v147, v147, v5
    v_mul_f32 v148, v148, v5
    v_mul_f32 v149, v149, v5
    v_mul_f32 v150, v150, v5
    v_mul_f32 v151, v151, v5
    v_mul_f32 v152, v152, v5
    v_mul_f32 v153, v153, v5
    v_mul_f32 v154, v154, v5
    v_mul_f32 v155, v155, v5
    v_mul_f32 v156, v156, v5
    v_mul_f32 v157, v157, v5
    v_mul_f32 v158, v158, v5
    v_mul_f32 v159, v159, v5
    v_add_f32 v12, v12, v224
    v_add_f32 v12, v12, v225
    v_add_f32 v12, v12, v226
    v_add_f32 v12, v12, v227
    v_add_f32 v12, v12, v228
    v_add_f32 v12, v12, v229
    v_add_f32 v12, v12, v230
    v_add_f32 v12, v12, v231
    v_add_f32 v12, v12, v232
    v_add_f32 v12, v12, v233
    v_add_f32 v12, v12, v234
    v_add_f32 v12, v12, v235
    v_add_f32 v12, v12, v236
    v_add_f32 v12, v12, v237
    v_add_f32 v12, v12, v238
    v_add_f32_e64 v12, v12, v239
    v_cvt_pk_bf16_f32 v248, v224, v225
    v_cvt_pk_bf16_f32 v249, v226, v227
    v_cvt_pk_bf16_f32 v250, v228, v229
    v_cvt_pk_bf16_f32 v251, v230, v231
    v_cvt_pk_bf16_f32 v252, v232, v233
    v_cvt_pk_bf16_f32 v253, v234, v235
    v_cvt_pk_bf16_f32 v254, v236, v237
    v_cvt_pk_bf16_f32 v255, v238, v239
    s_nop 1
    v_mfma_f32_32x32x16_bf16 v[144:159], v[52:55], v[248:251], v[144:159]
    v_mfma_f32_32x32x16_bf16 v[144:159], v[56:59], v[252:255], v[144:159]
    s_nop 15
    s_add_u32 s26, s26, 4096
    s_cmp_lt_u32 s26, 0x40000
    s_cbranch_scc1 K2_SLOW_LOOP
    v_mov_b32 v5, v8
    s_nop 1
    v_permlane32_swap_b32 v8, v5
    s_nop 1
    v_add_f32 v8, v8, v5
    v_mov_b32 v5, v12
    s_nop 1
    v_permlane32_swap_b32 v12, v5
    s_nop 1
    v_add_f32 v12, v12, v5
    v_mov_b32 v36, v109
    v_xor_b32 v37, 32, v109
    v_xor_b32 v38, 64, v109
    v_xor_b32 v39, 96, v109
    v_xor_b32 v40, 128, v109
    v_xor_b32 v41, 160, v109
    v_xor_b32 v42, 192, v109
    v_xor_b32 v43, 224, v109
    v_add_u32 v44, 65536, v36
    v_add_u32 v45, 65536, v37
    v_add_u32 v46, 65536, v38
    v_add_u32 v47, 65536, v39
    v_add_u32 v48, 65536, v40
    v_add_u32 v49, 65536, v41
    v_add_u32 v50, 65536, v42
    v_add_u32 v51, 65536, v43
    s_branch K2_FIN
K_CODE_END:
.section .rodata,"a"
.p2align 6
.amdhsa_kernel gated_mix__grouped_kv_mqa__glu_gated_glu__prompt_kernel
  .amdhsa_next_free_vgpr 512
  .amdhsa_next_free_sgpr 102
  .amdhsa_accum_offset 256
  .amdhsa_group_segment_fixed_size 0
  .amdhsa_kernarg_size 104
  .amdhsa_user_sgpr_count 2
  .amdhsa_user_sgpr_kernarg_segment_ptr 1
  .amdhsa_system_sgpr_workgroup_id_x 1
.end_amdhsa_kernel
```
